```python
import torch

def _softmax(x, axis=-1):
    return torch.softmax(x, dim=axis)
def _gelu(x):
    return torch.nn.functional.gelu(x, approximate="tanh")
def _silu(x):
    return torch.nn.functional.silu(x)
def _sigmoid(x):
    return torch.sigmoid(x)
def _layernorm(x, axis=-1, eps=1e-5):
    m = x.mean(dim=axis, keepdim=True)
    v = x.var(dim=axis, keepdim=True, unbiased=False)
    return (x - m) / torch.sqrt(v + eps)
def _scatter_add(tgt, idx, src, axis=0):
    return tgt.clone().index_add_(axis, idx, src)
def _segment_sum(src, seg, n):
    out = torch.zeros((n,) + src.shape[1:], dtype=src.dtype)
    return out.index_add_(0, seg, src)
def _pad(x, pw):
    flat = tuple(v for pair in reversed(pw) for v in pair)
    return torch.nn.functional.pad(x, flat)

kernel_name = 'sequential_preLN__compressed_kv_cla__glu_gated_reglu__prompt'

def setup_inputs():

    _w = (lambda a: (lambda t: t.to(torch.bfloat16) if t.is_floating_point() else t)(torch.as_tensor(a)))
    def _A_setup():
        B, H, Sq, Sk, D, M = 1, 32, 2048, 2048, 128, 576
        Dc = 4 * D
        return {
            "x": _w((lambda *s: torch.randn(*s, dtype=torch.bfloat16) * 0.05)(B, Sq, M)),
            "c_kv": _w((lambda *s: torch.randn(*s, dtype=torch.bfloat16) * 0.4)(B, Sk, Dc)),
            "w_q": _w((lambda *s: torch.randn(*s, dtype=torch.bfloat16) * 1.6)(M, H, D) * (M ** -0.5)),
            "w_uk": _w((lambda *s: torch.randn(*s, dtype=torch.bfloat16) * 1.6)(Dc, H, D) * (Dc ** -0.5)),
            "w_uv": _w((lambda *s: torch.randn(*s, dtype=torch.bfloat16) * 0.4)(Dc, H, D) * (Dc ** -0.5)),
            "w_o": _w((lambda *s: torch.randn(*s, dtype=torch.bfloat16) * 0.4)(H, D, M) * ((H * D) ** -0.5)),
        }
    _A_in = _A_setup()

    def _B_setup():
        B, S, D, F = 1, 2048, 576, 4608
        return {
            "x": _w((lambda *s: torch.randn(*s, dtype=torch.bfloat16) * 0.05)(B, S, D)),
            "W_gate": _w((lambda *s: torch.randn(*s, dtype=torch.bfloat16) * 0.2)(D, F) * (2.0 / D) ** 0.5),
            "W_up": _w((lambda *s: torch.randn(*s, dtype=torch.bfloat16) * 0.2)(D, F) * (2.0 / D) ** 0.5),
            "W_down": _w((lambda *s: torch.randn(*s, dtype=torch.bfloat16) * 0.2)(F, D) * (1.0 / F) ** 0.5),
        }
    _B_in = _B_setup()

    return {
        "A_x": _A_in["x"],
        "A_c_kv": _A_in["c_kv"],
        "A_w_q": _A_in["w_q"],
        "A_w_uk": _A_in["w_uk"],
        "A_w_uv": _A_in["w_uv"],
        "A_w_o": _A_in["w_o"],
        "B_x": _B_in["x"],
        "B_W_gate": _B_in["W_gate"],
        "B_W_up": _B_in["W_up"],
        "B_W_down": _B_in["W_down"],
    }

def reference(A_x, A_c_kv, A_w_q, A_w_uk, A_w_uv, A_w_o, B_x, B_W_gate, B_W_up, B_W_down):
    def _A_ref(x, c_kv, w_q, w_uk, w_uv, w_o):
        B, Sq, M = x.shape[0], x.shape[1], x.shape[2]
        Sk = c_kv.shape[1]
        H, D = w_q.shape[1], w_q.shape[2]
        q = torch.einsum("bqm,mhd->bhqd", x, w_q)
        k = torch.einsum("bkc,chd->bhkd", c_kv, w_uk)
        v = torch.einsum("bkc,chd->bhkd", c_kv, w_uv)
        scores = torch.einsum("bhqd,bhkd->bhqk", q, k) * (D ** -0.5)
        off = Sk - Sq
        qi = torch.arange(Sq)[:, None]
        kj = torch.arange(Sk)[None, :]
        cmask = kj <= (qi + off)
        scores = torch.where(cmask[None, None], scores, -1e9)
        p = _softmax(scores, axis=-1)
        ctx = torch.einsum("bhqk,bhkd->bhqd", p, v)
        return torch.einsum("bhqd,hdm->bqm", ctx, w_o)

    def _B_ref(x, W_gate, W_up, W_down):
        gate = torch.einsum("bsd,df->bsf", x, W_gate)
        up = torch.einsum("bsd,df->bsf", x, W_up)
        gate = gate * (lambda x, dt: x.to(dt))(gate > 0, gate.dtype)
        h = gate * up
        return torch.einsum("bsf,fd->bsd", h, W_down)

    x = A_x
    h = x + _A_ref(_layernorm(x, axis=-1), A_c_kv, A_w_q, A_w_uk, A_w_uv, A_w_o)
    h2 = h + _B_ref(_layernorm(h, axis=-1), B_W_gate, B_W_up, B_W_down)
    return h2
```

```asm
; @launch kernel=kvattn_kernel grid=(256,1,1) block=(256,1,1) lds=163840
; @launch kernel=oproj_kernel grid=(256,1,1) block=(256,1,1) lds=163840
; @launch kernel=ffn_kernel grid=(256,1,1) block=(256,1,1) lds=163840
.amdgcn_target "amdgcn-amd-amdhsa--gfx950"
.text
.globl kvattn_kernel
.p2align 8
.type kvattn_kernel,@function
kvattn_kernel:
  s_cmp_ge_u32 s2, 256
  s_cbranch_scc1 K2_END
  v_mov_b32 v255, v0
  s_load_dwordx2 s[4:5], s[0:1], 0
  s_load_dwordx2 s[6:7], s[0:1], 8
  s_load_dwordx4 s[8:11], s[0:1], 24
  s_load_dwordx2 s[12:13], s[0:1], 96
  s_load_dwordx2 s[14:15], s[0:1], 16
  s_load_dwordx2 s[58:59], s[0:1], 88
  s_load_dwordx2 s[72:73], s[0:1], 40
  s_load_dwordx2 s[74:75], s[0:1], 72
  s_load_dwordx4 s[76:79], s[0:1], 56
  v_and_b32 v248, 63, v0
  v_lshrrev_b32 v249, 6, v0
  s_nop 0
  v_readfirstlane_b32 s36, v249
  s_and_b32 s54, s2, 7
  s_lshr_b32 s55, s2, 3
  s_and_b32 s37, s54, 3
  s_lshl_b32 s37, s37, 3
  s_and_b32 s56, s55, 7
  s_add_u32 s37, s37, s56
  s_lshr_b32 s38, s54, 2
  s_lshl_b32 s38, s38, 2
  s_lshr_b32 s56, s55, 3
  s_add_u32 s38, s38, s56
  s_lshl_b32 s39, s36, 12
  s_mul_i32 s40, s36, 24576
  s_add_u32 s40, s40, 65536
  s_movk_i32 s60, 4096
  s_movk_i32 s61, 8192
  s_movk_i32 s62, 12288
  s_movk_i32 s63, 16384
  s_movk_i32 s64, 20480
  s_movk_i32 s65, 24576
  s_movk_i32 s66, 28672
  s_lshl_b32 s54, s38, 2
  s_add_u32 s54, s54, s36
  s_lshl_b32 s55, s54, 16
  v_lshrrev_b32 v250, 3, v248
  v_lshlrev_b32 v250, 10, v250
  v_add_u32 v250, s55, v250
  v_and_b32 v251, 7, v248
  v_lshrrev_b32 v252, 4, v248
  v_xor_b32 v251, v251, v252
  v_lshlrev_b32 v253, 4, v251
  v_add_u32 v132, v250, v253
  v_xor_b32 v253, 64, v253
  v_add_u32 v133, v250, v253
  v_add_u32 v139, 54272, v133
  v_add_u32 v138, 47104, v132
  v_add_u32 v137, 39936, v133
  v_add_u32 v136, 32768, v132
  v_add_u32 v135, 21504, v133
  v_add_u32 v134, 14336, v132
  v_add_u32 v133, 7168, v133
  s_lshl_b32 s56, s37, 8
  s_lshl_b32 s57, s36, 17
  s_add_u32 s57, s57, s56
  v_lshlrev_b32 v250, 13, v252
  v_add_u32 v250, s57, v250
  v_and_b32 v251, 15, v248
  v_lshlrev_b32 v253, 2, v252
  v_xor_b32 v251, v251, v253
  v_lshlrev_b32 v251, 4, v251
  v_add_u32 v230, v250, v251
  v_add_u32 v231, 31744, v230
  v_add_u32 v232, 63488, v230
  v_add_u32 v233, 95232, v230
  s_lshl_b32 s57, s36, 18
  s_add_u32 s57, s57, s56
  v_lshrrev_b32 v250, 3, v248
  v_lshlrev_b32 v250, 13, v250
  v_add_u32 v250, s57, v250
  v_and_b32 v251, 1, v252
  v_lshlrev_b32 v251, 2, v251
  v_and_b32 v253, 7, v248
  v_xor_b32 v251, v251, v253
  v_lshlrev_b32 v251, 4, v251
  v_add_u32 v234, v250, v251
  v_add_u32 v235, 64512, v234
  v_add_u32 v236, 129024, v234
  v_add_u32 v237, 193536, v234
  s_waitcnt lgkmcnt(0)
  s_mov_b32 s16, s6
  s_mov_b32 s17, s7
  s_mov_b32 s18, 2097152
  s_mov_b32 s19, 0x00020000
  s_mov_b32 s20, s8
  s_mov_b32 s21, s9
  s_mov_b32 s22, 4194304
  s_mov_b32 s23, 0x00020000
  s_mov_b32 s24, s10
  s_mov_b32 s25, s11
  s_mov_b32 s26, 4194304
  s_mov_b32 s27, 0x00020000
  s_mov_b32 s28, s4
  s_mov_b32 s29, s5
  s_mov_b32 s30, 2359296
  s_mov_b32 s31, 0x00020000
  s_mov_b32 s32, s12
  s_mov_b32 s33, s13
  s_mov_b32 s34, 35913728
  s_mov_b32 s35, 0x00020000
  s_mov_b32 s8, s58
  s_mov_b32 s9, s59
  s_mov_b32 s10, 256
  s_mov_b32 s11, 0x00020000
  s_mov_b64 s[4:5], s[14:15]
  s_mov_b64 s[6:7], s[12:13]
  s_add_u32 m0, s40, 0
  s_movk_i32 s52, 0
  buffer_load_dwordx4 v132, s[16:19], s52 offen offset:0 lds
  buffer_load_dwordx4 v133, s[16:19], s52 offen offset:1024 lds
  buffer_load_dwordx4 v134, s[16:19], s52 offen offset:2048 lds
  buffer_load_dwordx4 v135, s[16:19], s52 offen offset:3072 lds
  s_add_u32 m0, s40, 4096
  s_nop 0
  buffer_load_dwordx4 v136, s[16:19], s52 offen offset:0 lds
  buffer_load_dwordx4 v137, s[16:19], s52 offen offset:1024 lds
  buffer_load_dwordx4 v138, s[16:19], s52 offen offset:2048 lds
  buffer_load_dwordx4 v139, s[16:19], s52 offen offset:3072 lds
  s_add_u32 m0, s39, 0
  s_mov_b32 s41, 0
  buffer_load_dwordx4 v230, s[20:23], s41 offen offset:0 lds
  buffer_load_dwordx4 v231, s[20:23], s41 offen offset:1024 lds
  buffer_load_dwordx4 v232, s[20:23], s41 offen offset:2048 lds
  buffer_load_dwordx4 v233, s[20:23], s41 offen offset:3072 lds
  s_add_u32 m0, s39, 16384
  s_mov_b32 s41, 524288
  buffer_load_dwordx4 v230, s[20:23], s41 offen offset:0 lds
  buffer_load_dwordx4 v231, s[20:23], s41 offen offset:1024 lds
  buffer_load_dwordx4 v232, s[20:23], s41 offen offset:2048 lds
  buffer_load_dwordx4 v233, s[20:23], s41 offen offset:3072 lds
  s_add_u32 m0, s40, 8192
  s_movk_i32 s52, 128
  buffer_load_dwordx4 v132, s[16:19], s52 offen offset:0 lds
  buffer_load_dwordx4 v133, s[16:19], s52 offen offset:1024 lds
  buffer_load_dwordx4 v134, s[16:19], s52 offen offset:2048 lds
  buffer_load_dwordx4 v135, s[16:19], s52 offen offset:3072 lds
  s_add_u32 m0, s40, 12288
  s_nop 0
  buffer_load_dwordx4 v136, s[16:19], s52 offen offset:0 lds
  buffer_load_dwordx4 v137, s[16:19], s52 offen offset:1024 lds
  buffer_load_dwordx4 v138, s[16:19], s52 offen offset:2048 lds
  buffer_load_dwordx4 v139, s[16:19], s52 offen offset:3072 lds
  s_add_u32 m0, s39, 32768
  s_mov_b32 s41, 1048576
  buffer_load_dwordx4 v230, s[20:23], s41 offen offset:0 lds
  buffer_load_dwordx4 v231, s[20:23], s41 offen offset:1024 lds
  buffer_load_dwordx4 v232, s[20:23], s41 offen offset:2048 lds
  buffer_load_dwordx4 v233, s[20:23], s41 offen offset:3072 lds
  s_add_u32 m0, s40, 16384
  s_movk_i32 s52, 256
  buffer_load_dwordx4 v132, s[16:19], s52 offen offset:0 lds
  buffer_load_dwordx4 v133, s[16:19], s52 offen offset:1024 lds
  buffer_load_dwordx4 v134, s[16:19], s52 offen offset:2048 lds
  buffer_load_dwordx4 v135, s[16:19], s52 offen offset:3072 lds
  s_add_u32 m0, s40, 20480
  s_nop 0
  buffer_load_dwordx4 v136, s[16:19], s52 offen offset:0 lds
  buffer_load_dwordx4 v137, s[16:19], s52 offen offset:1024 lds
  buffer_load_dwordx4 v138, s[16:19], s52 offen offset:2048 lds
  buffer_load_dwordx4 v139, s[16:19], s52 offen offset:3072 lds
  v_bfe_u32 v250, v248, 2, 2
  v_lshrrev_b32 v251, 5, v248
  v_lshl_add_u32 v251, v251, 3, v250
  v_bfe_u32 v252, v248, 4, 1
  v_lshlrev_b32 v252, 5, v252
  v_and_b32 v253, 3, v248
  v_lshl_add_u32 v252, v253, 3, v252
  v_lshl_add_u32 v253, v251, 8, v252
  v_xor_b32 v224, 0, v250
  v_lshl_add_u32 v224, v224, 6, v253
  v_xor_b32 v225, 1, v250
  v_lshl_add_u32 v225, v225, 6, v253
  v_xor_b32 v226, 2, v250
  v_lshl_add_u32 v226, v226, 6, v253
  v_xor_b32 v227, 3, v250
  v_lshl_add_u32 v227, v227, 6, v253
  v_lshl_add_u32 v253, v251, 7, v252
  v_lshrrev_b32 v250, 1, v250
  v_xor_b32 v228, 0, v250
  v_lshl_add_u32 v228, v228, 6, v253
  v_xor_b32 v229, 1, v250
  v_lshl_add_u32 v229, v229, 6, v253
  v_and_b32 v251, 31, v248
  v_lshlrev_b32 v252, 7, v251
  v_add_u32 v252, s40, v252
  v_bfe_u32 v251, v248, 1, 3
  v_lshrrev_b32 v253, 5, v248
  v_xor_b32 v251, v251, v253
  v_xor_b32 v128, 0, v251
  v_lshl_add_u32 v128, v128, 4, v252
  v_xor_b32 v129, 2, v251
  v_lshl_add_u32 v129, v129, 4, v252
  v_xor_b32 v130, 4, v251
  v_lshl_add_u32 v130, v130, 4, v252
  v_xor_b32 v131, 6, v251
  v_lshl_add_u32 v131, v131, 4, v252
  s_lshl_b32 s56, s37, 5
  s_add_u32 s56, s56, s54
  s_lshl_b32 s56, s56, 15
  v_lshlrev_b32 v238, 4, v248
  v_add_u32 v238, s56, v238
  s_waitcnt vmcnt(28)
  ds_read_b128 a[0:3], v128 offset:0
  ds_read_b128 a[4:7], v128 offset:4096
  ds_read_b128 a[8:11], v129 offset:0
  ds_read_b128 a[12:15], v129 offset:4096
  ds_read_b128 a[16:19], v130 offset:0
  ds_read_b128 a[20:23], v130 offset:4096
  ds_read_b128 a[24:27], v131 offset:0
  ds_read_b128 a[28:31], v131 offset:4096
  s_waitcnt vmcnt(24)
  s_barrier
  ds_read_b64_tr_b16 v[192:193], v224 offset:0
  ds_read_b64_tr_b16 v[194:195], v224 offset:1024
  ds_read_b64_tr_b16 v[196:197], v225 offset:0
  ds_read_b64_tr_b16 v[198:199], v225 offset:1024
  ds_read_b64_tr_b16 v[200:201], v226 offset:0
  ds_read_b64_tr_b16 v[202:203], v226 offset:1024
  ds_read_b64_tr_b16 v[204:205], v227 offset:0
  ds_read_b64_tr_b16 v[206:207], v227 offset:1024
  s_waitcnt lgkmcnt(6)
  v_mfma_f32_32x32x16_bf16 v[0:15], v[192:195], a[0:3], 0
  ds_read_b64_tr_b16 v[208:209], v224 offset:4096
  v_mfma_f32_32x32x16_bf16 v[16:31], v[192:195], a[4:7], 0
  ds_read_b64_tr_b16 v[210:211], v224 offset:5120
  s_waitcnt lgkmcnt(6)
  v_mfma_f32_32x32x16_bf16 v[32:47], v[196:199], a[0:3], 0
  ds_read_b64_tr_b16 v[212:213], v225 offset:4096
  s_add_u32 m0, s40, 0
  s_movk_i32 s52, 384
  v_mfma_f32_32x32x16_bf16 v[48:63], v[196:199], a[4:7], 0
  ds_read_b64_tr_b16 v[214:215], v225 offset:5120
  buffer_load_dwordx4 v132, s[16:19], s52 offen offset:0 lds
  s_waitcnt lgkmcnt(6)
  v_mfma_f32_32x32x16_bf16 v[64:79], v[200:203], a[0:3], 0
  ds_read_b64_tr_b16 v[216:217], v226 offset:4096
  v_mfma_f32_32x32x16_bf16 v[80:95], v[200:203], a[4:7], 0
  ds_read_b64_tr_b16 v[218:219], v226 offset:5120
  buffer_load_dwordx4 v133, s[16:19], s52 offen offset:1024 lds
  s_waitcnt lgkmcnt(6)
  v_mfma_f32_32x32x16_bf16 v[96:111], v[204:207], a[0:3], 0
  ds_read_b64_tr_b16 v[220:221], v227 offset:4096
  v_mfma_f32_32x32x16_bf16 v[112:127], v[204:207], a[4:7], 0
  ds_read_b64_tr_b16 v[222:223], v227 offset:5120
  buffer_load_dwordx4 v134, s[16:19], s52 offen offset:2048 lds
  s_waitcnt lgkmcnt(6)
  v_mfma_f32_32x32x16_bf16 v[0:15], v[208:211], a[8:11], v[0:15]
  ds_read_b64_tr_b16 v[192:193], v224 offset:8192
  v_mfma_f32_32x32x16_bf16 v[16:31], v[208:211], a[12:15], v[16:31]
  ds_read_b64_tr_b16 v[194:195], v224 offset:9216
  buffer_load_dwordx4 v135, s[16:19], s52 offen offset:3072 lds
  s_waitcnt lgkmcnt(6)
  v_mfma_f32_32x32x16_bf16 v[32:47], v[212:215], a[8:11], v[32:47]
  ds_read_b64_tr_b16 v[196:197], v225 offset:8192
  s_add_u32 m0, s40, 4096
  v_mfma_f32_32x32x16_bf16 v[48:63], v[212:215], a[12:15], v[48:63]
  ds_read_b64_tr_b16 v[198:199], v225 offset:9216
  buffer_load_dwordx4 v136, s[16:19], s52 offen offset:0 lds
  s_waitcnt lgkmcnt(6)
  v_mfma_f32_32x32x16_bf16 v[64:79], v[216:219], a[8:11], v[64:79]
  ds_read_b64_tr_b16 v[200:201], v226 offset:8192
  v_mfma_f32_32x32x16_bf16 v[80:95], v[216:219], a[12:15], v[80:95]
  ds_read_b64_tr_b16 v[202:203], v226 offset:9216
  buffer_load_dwordx4 v137, s[16:19], s52 offen offset:1024 lds
  s_waitcnt lgkmcnt(6)
  v_mfma_f32_32x32x16_bf16 v[96:111], v[220:223], a[8:11], v[96:111]
  s_waitcnt vmcnt(18)
  ds_read_b64_tr_b16 v[204:205], v227 offset:8192
  ds_read_b128 a[32:35], v128 offset:8192
  v_mfma_f32_32x32x16_bf16 v[112:127], v[220:223], a[12:15], v[112:127]
  ds_read_b64_tr_b16 v[206:207], v227 offset:9216
  buffer_load_dwordx4 v138, s[16:19], s52 offen offset:2048 lds
  s_waitcnt lgkmcnt(7)
  v_mfma_f32_32x32x16_bf16 v[0:15], v[192:195], a[16:19], v[0:15]
  ds_read_b64_tr_b16 v[208:209], v224 offset:12288
  ds_read_b128 a[36:39], v128 offset:12288
  v_mfma_f32_32x32x16_bf16 v[16:31], v[192:195], a[20:23], v[16:31]
  ds_read_b64_tr_b16 v[210:211], v224 offset:13312
  buffer_load_dwordx4 v139, s[16:19], s52 offen offset:3072 lds
  s_waitcnt lgkmcnt(8)
  v_mfma_f32_32x32x16_bf16 v[32:47], v[196:199], a[16:19], v[32:47]
  ds_read_b64_tr_b16 v[212:213], v225 offset:12288
  ds_read_b128 a[40:43], v129 offset:8192
  s_barrier
  v_mfma_f32_32x32x16_bf16 v[48:63], v[196:199], a[20:23], v[48:63]
  ds_read_b64_tr_b16 v[214:215], v225 offset:13312
  s_add_u32 m0, s39, 49152
  s_mov_b32 s41, 1572864
  s_waitcnt lgkmcnt(9)
  v_mfma_f32_32x32x16_bf16 v[64:79], v[200:203], a[16:19], v[64:79]
  ds_read_b64_tr_b16 v[216:217], v226 offset:12288
  ds_read_b128 a[44:47], v129 offset:12288
  buffer_load_dwordx4 v230, s[20:23], s41 offen offset:0 lds
  v_mfma_f32_32x32x16_bf16 v[80:95], v[200:203], a[20:23], v[80:95]
  ds_read_b64_tr_b16 v[218:219], v226 offset:13312
  s_waitcnt lgkmcnt(9)
  v_mfma_f32_32x32x16_bf16 v[96:111], v[204:207], a[16:19], v[96:111]
  ds_read_b64_tr_b16 v[220:221], v227 offset:12288
  ds_read_b128 a[48:51], v130 offset:8192
  buffer_load_dwordx4 v231, s[20:23], s41 offen offset:1024 lds
  v_mfma_f32_32x32x16_bf16 v[112:127], v[204:207], a[20:23], v[112:127]
  ds_read_b64_tr_b16 v[222:223], v227 offset:13312
  s_waitcnt lgkmcnt(9)
  v_mfma_f32_32x32x16_bf16 v[0:15], v[208:211], a[24:27], v[0:15]
  ds_read_b64_tr_b16 v[192:193], v224 offset:16384
  ds_read_b128 a[52:55], v130 offset:12288
  buffer_load_dwordx4 v232, s[20:23], s41 offen offset:2048 lds
  v_mfma_f32_32x32x16_bf16 v[16:31], v[208:211], a[28:31], v[16:31]
  ds_read_b64_tr_b16 v[194:195], v224 offset:17408
  s_waitcnt lgkmcnt(9)
  v_mfma_f32_32x32x16_bf16 v[32:47], v[212:215], a[24:27], v[32:47]
  ds_read_b64_tr_b16 v[196:197], v225 offset:16384
  ds_read_b128 a[56:59], v131 offset:8192
  buffer_load_dwordx4 v233, s[20:23], s41 offen offset:3072 lds
  v_mfma_f32_32x32x16_bf16 v[48:63], v[212:215], a[28:31], v[48:63]
  ds_read_b64_tr_b16 v[198:199], v225 offset:17408
  s_waitcnt lgkmcnt(9)
  v_mfma_f32_32x32x16_bf16 v[64:79], v[216:219], a[24:27], v[64:79]
  ds_read_b64_tr_b16 v[200:201], v226 offset:16384
  ds_read_b128 a[60:63], v131 offset:12288
  v_mfma_f32_32x32x16_bf16 v[80:95], v[216:219], a[28:31], v[80:95]
  ds_read_b64_tr_b16 v[202:203], v226 offset:17408
  s_waitcnt lgkmcnt(9)
  v_mfma_f32_32x32x16_bf16 v[96:111], v[220:223], a[24:27], v[96:111]
  ds_read_b64_tr_b16 v[204:205], v227 offset:16384
  v_mfma_f32_32x32x16_bf16 v[112:127], v[220:223], a[28:31], v[112:127]
  ds_read_b64_tr_b16 v[206:207], v227 offset:17408
  s_waitcnt lgkmcnt(8)
  v_mfma_f32_32x32x16_bf16 v[0:15], v[192:195], a[32:35], v[0:15]
  ds_read_b64_tr_b16 v[208:209], v224 offset:20480
  v_mfma_f32_32x32x16_bf16 v[16:31], v[192:195], a[36:39], v[16:31]
  ds_read_b64_tr_b16 v[210:211], v224 offset:21504
  s_waitcnt lgkmcnt(7)
  v_mfma_f32_32x32x16_bf16 v[32:47], v[196:199], a[32:35], v[32:47]
  ds_read_b64_tr_b16 v[212:213], v225 offset:20480
  s_waitcnt lgkmcnt(6)
  s_add_u32 m0, s40, 8192
  s_movk_i32 s52, 512
  v_mfma_f32_32x32x16_bf16 v[48:63], v[196:199], a[36:39], v[48:63]
  ds_read_b64_tr_b16 v[214:215], v225 offset:21504
  buffer_load_dwordx4 v132, s[16:19], s52 offen offset:0 lds
  s_min_u32 s54, s36, 2
  s_waitcnt lgkmcnt(6)
  v_mfma_f32_32x32x16_bf16 v[64:79], v[200:203], a[32:35], v[64:79]
  ds_read_b64_tr_b16 v[216:217], v226 offset:20480
  s_mul_i32 s55, s54, 384
  s_mul_i32 s56, s2, 9216
  v_mfma_f32_32x32x16_bf16 v[80:95], v[200:203], a[36:39], v[80:95]
  ds_read_b64_tr_b16 v[218:219], v226 offset:21504
  buffer_load_dwordx4 v133, s[16:19], s52 offen offset:1024 lds
  s_add_u32 s55, s55, s56
  s_waitcnt lgkmcnt(6)
  v_mfma_f32_32x32x16_bf16 v[96:111], v[204:207], a[32:35], v[96:111]
  ds_read_b64_tr_b16 v[220:221], v227 offset:20480
  v_and_b32 v178, 7, v248
  v_lshrrev_b32 v179, 3, v248
  v_mfma_f32_32x32x16_bf16 v[112:127], v[204:207], a[36:39], v[112:127]
  ds_read_b64_tr_b16 v[222:223], v227 offset:21504
  buffer_load_dwordx4 v134, s[16:19], s52 offen offset:2048 lds
  v_mul_u32_u24 v180, 1152, v178
  s_waitcnt lgkmcnt(6)
  v_mfma_f32_32x32x16_bf16 v[0:15], v[208:211], a[40:43], v[0:15]
  ds_read_b64_tr_b16 v[192:193], v224 offset:24576
  v_lshl_add_u32 v180, v179, 4, v180
  v_add_u32 v180, s55, v180
  v_mfma_f32_32x32x16_bf16 v[16:31], v[208:211], a[44:47], v[16:31]
  ds_read_b64_tr_b16 v[194:195], v224 offset:25600
  buffer_load_dwordx4 v135, s[16:19], s52 offen offset:3072 lds
  s_lshr_b32 s55, s2, 2
  s_waitcnt lgkmcnt(6)
  v_mfma_f32_32x32x16_bf16 v[32:47], v[212:215], a[40:43], v[32:47]
  ds_read_b64_tr_b16 v[196:197], v225 offset:24576
  s_mul_i32 s55, s55, 36864
  s_add_u32 m0, s40, 12288
  v_mfma_f32_32x32x16_bf16 v[48:63], v[212:215], a[44:47], v[48:63]
  ds_read_b64_tr_b16 v[198:199], v225 offset:25600
  buffer_load_dwordx4 v136, s[16:19], s52 offen offset:0 lds
  s_mul_i32 s56, s54, 12288
  s_waitcnt lgkmcnt(6)
  v_mfma_f32_32x32x16_bf16 v[64:79], v[216:219], a[40:43], v[64:79]
  ds_read_b64_tr_b16 v[200:201], v226 offset:24576
  s_add_u32 s55, s55, s56
  s_and_b32 s56, s2, 3
  v_mfma_f32_32x32x16_bf16 v[80:95], v[216:219], a[44:47], v[80:95]
  ds_read_b64_tr_b16 v[202:203], v226 offset:25600
  buffer_load_dwordx4 v137, s[16:19], s52 offen offset:1024 lds
  s_lshl_b32 s56, s56, 7
  s_waitcnt lgkmcnt(6)
  v_mfma_f32_32x32x16_bf16 v[96:111], v[220:223], a[40:43], v[96:111]
  s_waitcnt vmcnt(18)
  ds_read_b64_tr_b16 v[204:205], v227 offset:24576
  ds_read_b128 a[64:67], v128 offset:16384
  v_mfma_f32_32x32x16_bf16 v[112:127], v[220:223], a[44:47], v[112:127]
  ds_read_b64_tr_b16 v[206:207], v227 offset:25600
  buffer_load_dwordx4 v138, s[16:19], s52 offen offset:2048 lds
  s_add_u32 s55, s55, s56
  s_waitcnt lgkmcnt(7)
  v_mfma_f32_32x32x16_bf16 v[0:15], v[192:195], a[48:51], v[0:15]
  ds_read_b64_tr_b16 v[208:209], v224 offset:28672
  ds_read_b128 a[68:71], v128 offset:20480
  s_add_u32 s55, s55, 33554432
  v_mfma_f32_32x32x16_bf16 v[16:31], v[192:195], a[52:55], v[16:31]
  ds_read_b64_tr_b16 v[210:211], v224 offset:29696
  buffer_load_dwordx4 v139, s[16:19], s52 offen offset:3072 lds
  v_lshrrev_b32 v181, 1, v179
  s_waitcnt lgkmcnt(8)
  v_mfma_f32_32x32x16_bf16 v[32:47], v[196:199], a[48:51], v[32:47]
  ds_read_b64_tr_b16 v[212:213], v225 offset:28672
  ds_read_b128 a[72:75], v129 offset:16384
  s_barrier
  v_mfma_f32_32x32x16_bf16 v[48:63], v[196:199], a[52:55], v[48:63]
  ds_read_b64_tr_b16 v[214:215], v225 offset:29696
  s_add_u32 m0, s39, 0
  s_mov_b32 s41, 2097152
  s_waitcnt lgkmcnt(9)
  v_mfma_f32_32x32x16_bf16 v[64:79], v[200:203], a[48:51], v[64:79]
  ds_read_b64_tr_b16 v[216:217], v226 offset:28672
  ds_read_b128 a[76:79], v129 offset:20480
  buffer_load_dwordx4 v230, s[20:23], s41 offen offset:0 lds
  v_mfma_f32_32x32x16_bf16 v[80:95], v[200:203], a[52:55], v[80:95]
  ds_read_b64_tr_b16 v[218:219], v226 offset:29696
  v_lshlrev_b32 v181, 10, v181
  v_and_b32 v179, 1, v179
  s_waitcnt lgkmcnt(9)
  v_mfma_f32_32x32x16_bf16 v[96:111], v[204:207], a[48:51], v[96:111]
  ds_read_b64_tr_b16 v[220:221], v227 offset:28672
  ds_read_b128 a[80:83], v130 offset:16384
  buffer_load_dwordx4 v231, s[20:23], s41 offen offset:1024 lds
  v_mfma_f32_32x32x16_bf16 v[112:127], v[204:207], a[52:55], v[112:127]
  ds_read_b64_tr_b16 v[222:223], v227 offset:29696
  v_lshl_add_u32 v181, v179, 9, v181
  v_lshl_add_u32 v181, v178, 4, v181
  s_waitcnt lgkmcnt(9)
  v_mfma_f32_32x32x16_bf16 v[0:15], v[208:211], a[56:59], v[0:15]
  ds_read_b64_tr_b16 v[192:193], v224 offset:32768
  ds_read_b128 a[84:87], v130 offset:20480
  buffer_load_dwordx4 v232, s[20:23], s41 offen offset:2048 lds
  v_mfma_f32_32x32x16_bf16 v[16:31], v[208:211], a[60:63], v[16:31]
  ds_read_b64_tr_b16 v[194:195], v224 offset:33792
  v_add_u32 v181, s55, v181
  v_lshlrev_b32 v182, 3, v178
  s_waitcnt lgkmcnt(9)
  v_mfma_f32_32x32x16_bf16 v[32:47], v[212:215], a[56:59], v[32:47]
  ds_read_b64_tr_b16 v[196:197], v225 offset:32768
  ds_read_b128 a[88:91], v131 offset:16384
  buffer_load_dwordx4 v233, s[20:23], s41 offen offset:3072 lds
  v_mfma_f32_32x32x16_bf16 v[48:63], v[212:215], a[60:63], v[48:63]
  ds_read_b64_tr_b16 v[198:199], v225 offset:33792
  v_add_u32 v182, 81920, v182
  s_lshl_b32 s56, s36, 6
  s_waitcnt lgkmcnt(9)
  v_mfma_f32_32x32x16_bf16 v[64:79], v[216:219], a[56:59], v[64:79]
  ds_read_b64_tr_b16 v[200:201], v226 offset:32768
  ds_read_b128 a[92:95], v131 offset:20480
  v_add_u32 v183, s56, v182
  v_mfma_f32_32x32x16_bf16 v[80:95], v[216:219], a[60:63], v[80:95]
  ds_read_b64_tr_b16 v[202:203], v226 offset:33792
  s_waitcnt lgkmcnt(9)
  v_mfma_f32_32x32x16_bf16 v[96:111], v[220:223], a[56:59], v[96:111]
  ds_read_b64_tr_b16 v[204:205], v227 offset:32768
  v_mfma_f32_32x32x16_bf16 v[112:127], v[220:223], a[60:63], v[112:127]
  ds_read_b64_tr_b16 v[206:207], v227 offset:33792
  s_waitcnt lgkmcnt(8)
  v_mfma_f32_32x32x16_bf16 v[0:15], v[192:195], a[64:67], v[0:15]
  ds_read_b64_tr_b16 v[208:209], v224 offset:36864
  v_mfma_f32_32x32x16_bf16 v[16:31], v[192:195], a[68:71], v[16:31]
  ds_read_b64_tr_b16 v[210:211], v224 offset:37888
  s_waitcnt lgkmcnt(7)
  v_mfma_f32_32x32x16_bf16 v[32:47], v[196:199], a[64:67], v[32:47]
  ds_read_b64_tr_b16 v[212:213], v225 offset:36864
  s_waitcnt lgkmcnt(6)
  s_add_u32 m0, s40, 16384
  s_movk_i32 s52, 640
  v_mfma_f32_32x32x16_bf16 v[48:63], v[196:199], a[68:71], v[48:63]
  ds_read_b64_tr_b16 v[214:215], v225 offset:37888
  buffer_load_dwordx4 v132, s[16:19], s52 offen offset:0 lds
  s_waitcnt lgkmcnt(6)
  v_mfma_f32_32x32x16_bf16 v[64:79], v[200:203], a[64:67], v[64:79]
  ds_read_b64_tr_b16 v[216:217], v226 offset:36864
  v_mfma_f32_32x32x16_bf16 v[80:95], v[200:203], a[68:71], v[80:95]
  ds_read_b64_tr_b16 v[218:219], v226 offset:37888
  buffer_load_dwordx4 v133, s[16:19], s52 offen offset:1024 lds
  s_waitcnt lgkmcnt(6)
  v_mfma_f32_32x32x16_bf16 v[96:111], v[204:207], a[64:67], v[96:111]
  ds_read_b64_tr_b16 v[220:221], v227 offset:36864
  v_mfma_f32_32x32x16_bf16 v[112:127], v[204:207], a[68:71], v[112:127]
  ds_read_b64_tr_b16 v[222:223], v227 offset:37888
  buffer_load_dwordx4 v134, s[16:19], s52 offen offset:2048 lds
  s_waitcnt lgkmcnt(6)
  v_mfma_f32_32x32x16_bf16 v[0:15], v[208:211], a[72:75], v[0:15]
  ds_read_b64_tr_b16 v[192:193], v224 offset:40960
  v_mfma_f32_32x32x16_bf16 v[16:31], v[208:211], a[76:79], v[16:31]
  ds_read_b64_tr_b16 v[194:195], v224 offset:41984
  buffer_load_dwordx4 v135, s[16:19], s52 offen offset:3072 lds
  s_waitcnt lgkmcnt(6)
  v_mfma_f32_32x32x16_bf16 v[32:47], v[212:215], a[72:75], v[32:47]
  ds_read_b64_tr_b16 v[196:197], v225 offset:40960
  s_add_u32 m0, s40, 20480
  v_mfma_f32_32x32x16_bf16 v[48:63], v[212:215], a[76:79], v[48:63]
  ds_read_b64_tr_b16 v[198:199], v225 offset:41984
  buffer_load_dwordx4 v136, s[16:19], s52 offen offset:0 lds
  s_waitcnt lgkmcnt(6)
  v_mfma_f32_32x32x16_bf16 v[64:79], v[216:219], a[72:75], v[64:79]
  ds_read_b64_tr_b16 v[200:201], v226 offset:40960
  v_mfma_f32_32x32x16_bf16 v[80:95], v[216:219], a[76:79], v[80:95]
  ds_read_b64_tr_b16 v[202:203], v226 offset:41984
  buffer_load_dwordx4 v137, s[16:19], s52 offen offset:1024 lds
  s_waitcnt lgkmcnt(6)
  v_mfma_f32_32x32x16_bf16 v[96:111], v[220:223], a[72:75], v[96:111]
  s_waitcnt vmcnt(22)
  ds_read_b64_tr_b16 v[204:205], v227 offset:40960
  ds_read_b128 a[96:99], v128 offset:0
  v_mfma_f32_32x32x16_bf16 v[112:127], v[220:223], a[76:79], v[112:127]
  ds_read_b64_tr_b16 v[206:207], v227 offset:41984
  buffer_load_dwordx4 v138, s[16:19], s52 offen offset:2048 lds
  s_waitcnt lgkmcnt(7)
  v_mfma_f32_32x32x16_bf16 v[0:15], v[192:195], a[80:83], v[0:15]
  ds_read_b64_tr_b16 v[208:209], v224 offset:45056
  ds_read_b128 a[100:103], v128 offset:4096
  v_mfma_f32_32x32x16_bf16 v[16:31], v[192:195], a[84:87], v[16:31]
  ds_read_b64_tr_b16 v[210:211], v224 offset:46080
  buffer_load_dwordx4 v139, s[16:19], s52 offen offset:3072 lds
  s_waitcnt lgkmcnt(8)
  v_mfma_f32_32x32x16_bf16 v[32:47], v[196:199], a[80:83], v[32:47]
  ds_read_b64_tr_b16 v[212:213], v225 offset:45056
  ds_read_b128 a[104:107], v129 offset:0
  s_waitcnt vmcnt(20)
  s_barrier
  v_mfma_f32_32x32x16_bf16 v[48:63], v[196:199], a[84:87], v[48:63]
  ds_read_b64_tr_b16 v[214:215], v225 offset:46080
  s_add_u32 m0, s39, 16384
  s_mov_b32 s41, 2621440
  s_waitcnt lgkmcnt(9)
  v_mfma_f32_32x32x16_bf16 v[64:79], v[200:203], a[80:83], v[64:79]
  ds_read_b64_tr_b16 v[216:217], v226 offset:45056
  ds_read_b128 a[108:111], v129 offset:4096
  buffer_load_dwordx4 v230, s[20:23], s41 offen offset:0 lds
  v_mfma_f32_32x32x16_bf16 v[80:95], v[200:203], a[84:87], v[80:95]
  ds_read_b64_tr_b16 v[218:219], v226 offset:46080
  s_waitcnt lgkmcnt(9)
  v_mfma_f32_32x32x16_bf16 v[96:111], v[204:207], a[80:83], v[96:111]
  ds_read_b64_tr_b16 v[220:221], v227 offset:45056
  ds_read_b128 a[112:115], v130 offset:0
  buffer_load_dwordx4 v231, s[20:23], s41 offen offset:1024 lds
  v_mfma_f32_32x32x16_bf16 v[112:127], v[204:207], a[84:87], v[112:127]
  ds_read_b64_tr_b16 v[222:223], v227 offset:46080
  s_waitcnt lgkmcnt(9)
  v_mfma_f32_32x32x16_bf16 v[0:15], v[208:211], a[88:91], v[0:15]
  ds_read_b64_tr_b16 v[192:193], v224 offset:49152
  ds_read_b128 a[116:119], v130 offset:4096
  buffer_load_dwordx4 v232, s[20:23], s41 offen offset:2048 lds
  v_mfma_f32_32x32x16_bf16 v[16:31], v[208:211], a[92:95], v[16:31]
  ds_read_b64_tr_b16 v[194:195], v224 offset:50176
  s_waitcnt lgkmcnt(9)
  v_mfma_f32_32x32x16_bf16 v[32:47], v[212:215], a[88:91], v[32:47]
  ds_read_b64_tr_b16 v[196:197], v225 offset:49152
  ds_read_b128 a[120:123], v131 offset:0
  buffer_load_dwordx4 v233, s[20:23], s41 offen offset:3072 lds
  v_mfma_f32_32x32x16_bf16 v[48:63], v[212:215], a[92:95], v[48:63]
  ds_read_b64_tr_b16 v[198:199], v225 offset:50176
  s_waitcnt lgkmcnt(9)
  v_mfma_f32_32x32x16_bf16 v[64:79], v[216:219], a[88:91], v[64:79]
  ds_read_b64_tr_b16 v[200:201], v226 offset:49152
  ds_read_b128 a[124:127], v131 offset:4096
  buffer_load_dwordx4 v[140:143], v180, s[28:31], 0 offen offset:0
  v_mfma_f32_32x32x16_bf16 v[80:95], v[216:219], a[92:95], v[80:95]
  ds_read_b64_tr_b16 v[202:203], v226 offset:50176
  buffer_load_dwordx4 v[144:147], v180, s[28:31], 0 offen offset:128
  s_waitcnt lgkmcnt(9)
  v_mfma_f32_32x32x16_bf16 v[96:111], v[220:223], a[88:91], v[96:111]
  ds_read_b64_tr_b16 v[204:205], v227 offset:49152
  buffer_load_dwordx4 v[148:151], v180, s[28:31], 0 offen offset:256
  v_mfma_f32_32x32x16_bf16 v[112:127], v[220:223], a[92:95], v[112:127]
  ds_read_b64_tr_b16 v[206:207], v227 offset:50176
  s_waitcnt lgkmcnt(8)
  v_mfma_f32_32x32x16_bf16 v[0:15], v[192:195], a[96:99], v[0:15]
  ds_read_b64_tr_b16 v[208:209], v224 offset:53248
  v_mfma_f32_32x32x16_bf16 v[16:31], v[192:195], a[100:103], v[16:31]
  ds_read_b64_tr_b16 v[210:211], v224 offset:54272
  s_waitcnt lgkmcnt(7)
  v_mfma_f32_32x32x16_bf16 v[32:47], v[196:199], a[96:99], v[32:47]
  ds_read_b64_tr_b16 v[212:213], v225 offset:53248
  s_waitcnt lgkmcnt(6)
  s_add_u32 m0, s40, 0
  s_movk_i32 s52, 768
  v_mfma_f32_32x32x16_bf16 v[48:63], v[196:199], a[100:103], v[48:63]
  ds_read_b64_tr_b16 v[214:215], v225 offset:54272
  buffer_load_dwordx4 v132, s[16:19], s52 offen offset:0 lds
  s_waitcnt lgkmcnt(6)
  v_mfma_f32_32x32x16_bf16 v[64:79], v[200:203], a[96:99], v[64:79]
  ds_read_b64_tr_b16 v[216:217], v226 offset:53248
  v_mfma_f32_32x32x16_bf16 v[80:95], v[200:203], a[100:103], v[80:95]
  ds_read_b64_tr_b16 v[218:219], v226 offset:54272
  buffer_load_dwordx4 v133, s[16:19], s52 offen offset:1024 lds
  s_waitcnt lgkmcnt(6)
  v_mfma_f32_32x32x16_bf16 v[96:111], v[204:207], a[96:99], v[96:111]
  ds_read_b64_tr_b16 v[220:221], v227 offset:53248
  v_mfma_f32_32x32x16_bf16 v[112:127], v[204:207], a[100:103], v[112:127]
  ds_read_b64_tr_b16 v[222:223], v227 offset:54272
  buffer_load_dwordx4 v134, s[16:19], s52 offen offset:2048 lds
  s_waitcnt lgkmcnt(6)
  v_mfma_f32_32x32x16_bf16 v[0:15], v[208:211], a[104:107], v[0:15]
  ds_read_b64_tr_b16 v[192:193], v224 offset:57344
  v_mfma_f32_32x32x16_bf16 v[16:31], v[208:211], a[108:111], v[16:31]
  ds_read_b64_tr_b16 v[194:195], v224 offset:58368
  buffer_load_dwordx4 v135, s[16:19], s52 offen offset:3072 lds
  s_waitcnt lgkmcnt(6)
  v_mfma_f32_32x32x16_bf16 v[32:47], v[212:215], a[104:107], v[32:47]
  ds_read_b64_tr_b16 v[196:197], v225 offset:57344
  s_add_u32 m0, s40, 4096
  v_mfma_f32_32x32x16_bf16 v[48:63], v[212:215], a[108:111], v[48:63]
  ds_read_b64_tr_b16 v[198:199], v225 offset:58368
  buffer_load_dwordx4 v136, s[16:19], s52 offen offset:0 lds
  s_waitcnt lgkmcnt(6)
  v_mfma_f32_32x32x16_bf16 v[64:79], v[216:219], a[104:107], v[64:79]
  ds_read_b64_tr_b16 v[200:201], v226 offset:57344
  v_mfma_f32_32x32x16_bf16 v[80:95], v[216:219], a[108:111], v[80:95]
  ds_read_b64_tr_b16 v[202:203], v226 offset:58368
  buffer_load_dwordx4 v137, s[16:19], s52 offen offset:1024 lds
  s_waitcnt lgkmcnt(6)
  v_mfma_f32_32x32x16_bf16 v[96:111], v[220:223], a[104:107], v[96:111]
  s_waitcnt vmcnt(25)
  ds_read_b64_tr_b16 v[204:205], v227 offset:57344
  ds_read_b128 a[128:131], v128 offset:8192
  v_mfma_f32_32x32x16_bf16 v[112:127], v[220:223], a[108:111], v[112:127]
  ds_read_b64_tr_b16 v[206:207], v227 offset:58368
  buffer_load_dwordx4 v138, s[16:19], s52 offen offset:2048 lds
  s_waitcnt lgkmcnt(7)
  v_mfma_f32_32x32x16_bf16 v[0:15], v[192:195], a[112:115], v[0:15]
  ds_read_b64_tr_b16 v[208:209], v224 offset:61440
  ds_read_b128 a[132:135], v128 offset:12288
  v_mfma_f32_32x32x16_bf16 v[16:31], v[192:195], a[116:119], v[16:31]
  ds_read_b64_tr_b16 v[210:211], v224 offset:62464
  buffer_load_dwordx4 v139, s[16:19], s52 offen offset:3072 lds
  s_waitcnt lgkmcnt(8)
  v_mfma_f32_32x32x16_bf16 v[32:47], v[196:199], a[112:115], v[32:47]
  ds_read_b64_tr_b16 v[212:213], v225 offset:61440
  ds_read_b128 a[136:139], v129 offset:8192
  s_waitcnt vmcnt(23)
  s_barrier
  v_mfma_f32_32x32x16_bf16 v[48:63], v[196:199], a[116:119], v[48:63]
  ds_read_b64_tr_b16 v[214:215], v225 offset:62464
  s_add_u32 m0, s39, 32768
  s_mov_b32 s41, 3145728
  s_waitcnt lgkmcnt(9)
  v_mfma_f32_32x32x16_bf16 v[64:79], v[200:203], a[112:115], v[64:79]
  ds_read_b64_tr_b16 v[216:217], v226 offset:61440
  ds_read_b128 a[140:143], v129 offset:12288
  buffer_load_dwordx4 v230, s[20:23], s41 offen offset:0 lds
  v_mfma_f32_32x32x16_bf16 v[80:95], v[200:203], a[116:119], v[80:95]
  ds_read_b64_tr_b16 v[218:219], v226 offset:62464
  s_waitcnt lgkmcnt(9)
  v_mfma_f32_32x32x16_bf16 v[96:111], v[204:207], a[112:115], v[96:111]
  ds_read_b64_tr_b16 v[220:221], v227 offset:61440
  ds_read_b128 a[144:147], v130 offset:8192
  buffer_load_dwordx4 v231, s[20:23], s41 offen offset:1024 lds
  v_mfma_f32_32x32x16_bf16 v[112:127], v[204:207], a[116:119], v[112:127]
  ds_read_b64_tr_b16 v[222:223], v227 offset:62464
  s_waitcnt lgkmcnt(9)
  v_mfma_f32_32x32x16_bf16 v[0:15], v[208:211], a[120:123], v[0:15]
  ds_read_b64_tr_b16 v[192:193], v224 offset:0
  ds_read_b128 a[148:151], v130 offset:12288
  buffer_load_dwordx4 v232, s[20:23], s41 offen offset:2048 lds
  v_mfma_f32_32x32x16_bf16 v[16:31], v[208:211], a[124:127], v[16:31]
  ds_read_b64_tr_b16 v[194:195], v224 offset:1024
  s_waitcnt lgkmcnt(9)
  v_mfma_f32_32x32x16_bf16 v[32:47], v[212:215], a[120:123], v[32:47]
  ds_read_b64_tr_b16 v[196:197], v225 offset:0
  ds_read_b128 a[152:155], v131 offset:8192
  buffer_load_dwordx4 v233, s[20:23], s41 offen offset:3072 lds
  v_mfma_f32_32x32x16_bf16 v[48:63], v[212:215], a[124:127], v[48:63]
  ds_read_b64_tr_b16 v[198:199], v225 offset:1024
  s_waitcnt lgkmcnt(9)
  v_mfma_f32_32x32x16_bf16 v[64:79], v[216:219], a[120:123], v[64:79]
  ds_read_b64_tr_b16 v[200:201], v226 offset:0
  ds_read_b128 a[156:159], v131 offset:12288
  v_mfma_f32_32x32x16_bf16 v[80:95], v[216:219], a[124:127], v[80:95]
  ds_read_b64_tr_b16 v[202:203], v226 offset:1024
  s_waitcnt lgkmcnt(9)
  v_mfma_f32_32x32x16_bf16 v[96:111], v[220:223], a[120:123], v[96:111]
  ds_read_b64_tr_b16 v[204:205], v227 offset:0
  v_mfma_f32_32x32x16_bf16 v[112:127], v[220:223], a[124:127], v[112:127]
  ds_read_b64_tr_b16 v[206:207], v227 offset:1024
  s_waitcnt lgkmcnt(8)
  v_mfma_f32_32x32x16_bf16 v[0:15], v[192:195], a[128:131], v[0:15]
  ds_read_b64_tr_b16 v[208:209], v224 offset:4096
  v_mfma_f32_32x32x16_bf16 v[16:31], v[192:195], a[132:135], v[16:31]
  ds_read_b64_tr_b16 v[210:211], v224 offset:5120
  s_waitcnt lgkmcnt(7)
  v_mfma_f32_32x32x16_bf16 v[32:47], v[196:199], a[128:131], v[32:47]
  ds_read_b64_tr_b16 v[212:213], v225 offset:4096
  s_waitcnt lgkmcnt(6)
  s_add_u32 m0, s40, 8192
  s_movk_i32 s52, 896
  v_mfma_f32_32x32x16_bf16 v[48:63], v[196:199], a[132:135], v[48:63]
  ds_read_b64_tr_b16 v[214:215], v225 offset:5120
  buffer_load_dwordx4 v132, s[16:19], s52 offen offset:0 lds
  s_waitcnt lgkmcnt(6)
  v_mfma_f32_32x32x16_bf16 v[64:79], v[200:203], a[128:131], v[64:79]
  ds_read_b64_tr_b16 v[216:217], v226 offset:4096
  v_mfma_f32_32x32x16_bf16 v[80:95], v[200:203], a[132:135], v[80:95]
  ds_read_b64_tr_b16 v[218:219], v226 offset:5120
  buffer_load_dwordx4 v133, s[16:19], s52 offen offset:1024 lds
  s_waitcnt lgkmcnt(6)
  v_mfma_f32_32x32x16_bf16 v[96:111], v[204:207], a[128:131], v[96:111]
  ds_read_b64_tr_b16 v[220:221], v227 offset:4096
  v_mfma_f32_32x32x16_bf16 v[112:127], v[204:207], a[132:135], v[112:127]
  ds_read_b64_tr_b16 v[222:223], v227 offset:5120
  buffer_load_dwordx4 v134, s[16:19], s52 offen offset:2048 lds
  s_waitcnt lgkmcnt(6)
  v_mfma_f32_32x32x16_bf16 v[0:15], v[208:211], a[136:139], v[0:15]
  ds_read_b64_tr_b16 v[192:193], v224 offset:8192
  v_mfma_f32_32x32x16_bf16 v[16:31], v[208:211], a[140:143], v[16:31]
  ds_read_b64_tr_b16 v[194:195], v224 offset:9216
  buffer_load_dwordx4 v135, s[16:19], s52 offen offset:3072 lds
  s_waitcnt lgkmcnt(6)
  v_mfma_f32_32x32x16_bf16 v[32:47], v[212:215], a[136:139], v[32:47]
  ds_read_b64_tr_b16 v[196:197], v225 offset:8192
  s_add_u32 m0, s40, 12288
  v_mfma_f32_32x32x16_bf16 v[48:63], v[212:215], a[140:143], v[48:63]
  ds_read_b64_tr_b16 v[198:199], v225 offset:9216
  buffer_load_dwordx4 v136, s[16:19], s52 offen offset:0 lds
  s_waitcnt lgkmcnt(6)
  v_mfma_f32_32x32x16_bf16 v[64:79], v[216:219], a[136:139], v[64:79]
  ds_read_b64_tr_b16 v[200:201], v226 offset:8192
  v_mfma_f32_32x32x16_bf16 v[80:95], v[216:219], a[140:143], v[80:95]
  ds_read_b64_tr_b16 v[202:203], v226 offset:9216
  buffer_load_dwordx4 v137, s[16:19], s52 offen offset:1024 lds
  s_waitcnt lgkmcnt(6)
  v_mfma_f32_32x32x16_bf16 v[96:111], v[220:223], a[136:139], v[96:111]
  s_waitcnt vmcnt(25)
  ds_read_b64_tr_b16 v[204:205], v227 offset:8192
  ds_read_b128 a[160:163], v128 offset:16384
  v_mfma_f32_32x32x16_bf16 v[112:127], v[220:223], a[140:143], v[112:127]
  ds_read_b64_tr_b16 v[206:207], v227 offset:9216
  buffer_load_dwordx4 v138, s[16:19], s52 offen offset:2048 lds
  s_waitcnt lgkmcnt(7)
  v_mfma_f32_32x32x16_bf16 v[0:15], v[192:195], a[144:147], v[0:15]
  ds_read_b64_tr_b16 v[208:209], v224 offset:12288
  ds_read_b128 a[164:167], v128 offset:20480
  v_mfma_f32_32x32x16_bf16 v[16:31], v[192:195], a[148:151], v[16:31]
  ds_read_b64_tr_b16 v[210:211], v224 offset:13312
  buffer_load_dwordx4 v139, s[16:19], s52 offen offset:3072 lds
  s_waitcnt lgkmcnt(8)
  v_mfma_f32_32x32x16_bf16 v[32:47], v[196:199], a[144:147], v[32:47]
  ds_read_b64_tr_b16 v[212:213], v225 offset:12288
  ds_read_b128 a[168:171], v129 offset:16384
  s_waitcnt vmcnt(23)
  s_barrier
  v_mfma_f32_32x32x16_bf16 v[48:63], v[196:199], a[148:151], v[48:63]
  ds_read_b64_tr_b16 v[214:215], v225 offset:13312
  s_add_u32 m0, s39, 49152
  s_mov_b32 s41, 3670016
  s_waitcnt lgkmcnt(9)
  v_mfma_f32_32x32x16_bf16 v[64:79], v[200:203], a[144:147], v[64:79]
  ds_read_b64_tr_b16 v[216:217], v226 offset:12288
  ds_read_b128 a[172:175], v129 offset:20480
  buffer_load_dwordx4 v230, s[20:23], s41 offen offset:0 lds
  v_mfma_f32_32x32x16_bf16 v[80:95], v[200:203], a[148:151], v[80:95]
  ds_read_b64_tr_b16 v[218:219], v226 offset:13312
  s_waitcnt lgkmcnt(9)
  v_mfma_f32_32x32x16_bf16 v[96:111], v[204:207], a[144:147], v[96:111]
  ds_read_b64_tr_b16 v[220:221], v227 offset:12288
  ds_read_b128 a[176:179], v130 offset:16384
  buffer_load_dwordx4 v231, s[20:23], s41 offen offset:1024 lds
  v_mfma_f32_32x32x16_bf16 v[112:127], v[204:207], a[148:151], v[112:127]
  ds_read_b64_tr_b16 v[222:223], v227 offset:13312
  s_waitcnt lgkmcnt(9)
  v_mfma_f32_32x32x16_bf16 v[0:15], v[208:211], a[152:155], v[0:15]
  ds_read_b64_tr_b16 v[192:193], v224 offset:16384
  ds_read_b128 a[180:183], v130 offset:20480
  buffer_load_dwordx4 v232, s[20:23], s41 offen offset:2048 lds
  v_mfma_f32_32x32x16_bf16 v[16:31], v[208:211], a[156:159], v[16:31]
  ds_read_b64_tr_b16 v[194:195], v224 offset:17408
  s_waitcnt lgkmcnt(9)
  v_mfma_f32_32x32x16_bf16 v[32:47], v[212:215], a[152:155], v[32:47]
  ds_read_b64_tr_b16 v[196:197], v225 offset:16384
  ds_read_b128 a[184:187], v131 offset:16384
  buffer_load_dwordx4 v233, s[20:23], s41 offen offset:3072 lds
  v_mfma_f32_32x32x16_bf16 v[48:63], v[212:215], a[156:159], v[48:63]
  ds_read_b64_tr_b16 v[198:199], v225 offset:17408
  s_waitcnt lgkmcnt(9)
  v_mfma_f32_32x32x16_bf16 v[64:79], v[216:219], a[152:155], v[64:79]
  ds_read_b64_tr_b16 v[200:201], v226 offset:16384
  ds_read_b128 a[188:191], v131 offset:20480
  v_mfma_f32_32x32x16_bf16 v[80:95], v[216:219], a[156:159], v[80:95]
  ds_read_b64_tr_b16 v[202:203], v226 offset:17408
  s_waitcnt lgkmcnt(9)
  v_mfma_f32_32x32x16_bf16 v[96:111], v[220:223], a[152:155], v[96:111]
  ds_read_b64_tr_b16 v[204:205], v227 offset:16384
  v_mfma_f32_32x32x16_bf16 v[112:127], v[220:223], a[156:159], v[112:127]
  ds_read_b64_tr_b16 v[206:207], v227 offset:17408
  s_waitcnt lgkmcnt(8)
  v_mfma_f32_32x32x16_bf16 v[0:15], v[192:195], a[160:163], v[0:15]
  ds_read_b64_tr_b16 v[208:209], v224 offset:20480
  v_mfma_f32_32x32x16_bf16 v[16:31], v[192:195], a[164:167], v[16:31]
  ds_read_b64_tr_b16 v[210:211], v224 offset:21504
  s_lshr_b32 s56, s2, 3
  s_lshl_b32 s56, s56, 2
  s_waitcnt lgkmcnt(7)
  v_mfma_f32_32x32x16_bf16 v[32:47], v[196:199], a[160:163], v[32:47]
  ds_read_b64_tr_b16 v[212:213], v225 offset:20480
  s_add_u32 s56, s56, s36
  s_mul_i32 s56, s56, 36
  v_mfma_f32_32x32x16_bf16 v[48:63], v[196:199], a[164:167], v[48:63]
  ds_read_b64_tr_b16 v[214:215], v225 offset:21504
  v_add_u32 v254, s56, v248
  v_lshrrev_b32 v239, 3, v254
  s_waitcnt lgkmcnt(6)
  v_mfma_f32_32x32x16_bf16 v[64:79], v[200:203], a[160:163], v[64:79]
  ds_read_b64_tr_b16 v[216:217], v226 offset:20480
  v_lshlrev_b32 v239, 13, v239
  v_and_b32 v254, 7, v254
  v_mfma_f32_32x32x16_bf16 v[80:95], v[200:203], a[164:167], v[80:95]
  ds_read_b64_tr_b16 v[218:219], v226 offset:21504
  v_lshl_add_u32 v254, v254, 7, v239
  s_and_b32 s56, s2, 7
  s_waitcnt lgkmcnt(6)
  v_mfma_f32_32x32x16_bf16 v[96:111], v[204:207], a[160:163], v[96:111]
  ds_read_b64_tr_b16 v[220:221], v227 offset:20480
  s_lshl_b32 s56, s56, 10
  v_add_u32 v254, s56, v254
  v_mfma_f32_32x32x16_bf16 v[112:127], v[204:207], a[164:167], v[112:127]
  ds_read_b64_tr_b16 v[222:223], v227 offset:21504
  v_mov_b32 v239, 0x7f000000
  v_cmp_gt_u32 vcc, 36, v248
  s_waitcnt lgkmcnt(6)
  v_mfma_f32_32x32x16_bf16 v[0:15], v[208:211], a[168:171], v[0:15]
  ds_read_b64_tr_b16 v[192:193], v224 offset:24576
  s_waitcnt vmcnt(26)
  v_lshlrev_b32 v152, 16, v140
  v_and_b32 v153, 0xffff0000, v140
  v_lshlrev_b32 v154, 16, v141
  v_mfma_f32_32x32x16_bf16 v[16:31], v[208:211], a[172:175], v[16:31]
  ds_read_b64_tr_b16 v[194:195], v224 offset:25600
  v_and_b32 v155, 0xffff0000, v141
  v_lshlrev_b32 v156, 16, v142
  v_and_b32 v157, 0xffff0000, v142
  s_waitcnt lgkmcnt(6)
  v_mfma_f32_32x32x16_bf16 v[32:47], v[212:215], a[168:171], v[32:47]
  ds_read_b64_tr_b16 v[196:197], v225 offset:24576
  v_lshlrev_b32 v158, 16, v143
  v_and_b32 v159, 0xffff0000, v143
  s_waitcnt vmcnt(25)
  v_lshlrev_b32 v160, 16, v144
  v_mfma_f32_32x32x16_bf16 v[48:63], v[212:215], a[172:175], v[48:63]
  ds_read_b64_tr_b16 v[198:199], v225 offset:25600
  v_and_b32 v161, 0xffff0000, v144
  v_lshlrev_b32 v162, 16, v145
  v_and_b32 v163, 0xffff0000, v145
  s_waitcnt lgkmcnt(6)
  v_mfma_f32_32x32x16_bf16 v[64:79], v[216:219], a[168:171], v[64:79]
  ds_read_b64_tr_b16 v[200:201], v226 offset:24576
  v_lshlrev_b32 v164, 16, v146
  v_and_b32 v165, 0xffff0000, v146
  v_lshlrev_b32 v166, 16, v147
  v_mfma_f32_32x32x16_bf16 v[80:95], v[216:219], a[172:175], v[80:95]
  ds_read_b64_tr_b16 v[202:203], v226 offset:25600
  v_and_b32 v167, 0xffff0000, v147
  s_waitcnt vmcnt(24)
  v_lshlrev_b32 v168, 16, v148
  v_and_b32 v169, 0xffff0000, v148
  s_waitcnt lgkmcnt(6)
  v_mfma_f32_32x32x16_bf16 v[96:111], v[220:223], a[168:171], v[96:111]
  s_waitcnt vmcnt(16)
  ds_read_b64_tr_b16 v[204:205], v227 offset:24576
  ds_read_b128 a[192:195], v128 offset:0
  v_lshlrev_b32 v170, 16, v149
  v_mfma_f32_32x32x16_bf16 v[112:127], v[220:223], a[172:175], v[112:127]
  ds_read_b64_tr_b16 v[206:207], v227 offset:25600
  v_and_b32 v171, 0xffff0000, v149
  v_lshlrev_b32 v172, 16, v150
  v_and_b32 v173, 0xffff0000, v150
  s_waitcnt lgkmcnt(7)
  v_mfma_f32_32x32x16_bf16 v[0:15], v[192:195], a[176:179], v[0:15]
  ds_read_b64_tr_b16 v[208:209], v224 offset:28672
  ds_read_b128 a[196:199], v128 offset:4096
  v_lshlrev_b32 v174, 16, v151
  v_and_b32 v175, 0xffff0000, v151
  v_mfma_f32_32x32x16_bf16 v[16:31], v[192:195], a[180:183], v[16:31]
  ds_read_b64_tr_b16 v[210:211], v224 offset:29696
  v_add_f32 v176, v152, v153
  v_mul_f32 v177, v152, v152
  v_fmac_f32 v177, v153, v153
  s_waitcnt lgkmcnt(8)
  v_mfma_f32_32x32x16_bf16 v[32:47], v[196:199], a[176:179], v[32:47]
  ds_read_b64_tr_b16 v[212:213], v225 offset:28672
  ds_read_b128 a[200:203], v129 offset:0
  s_waitcnt vmcnt(12)
  s_barrier
  v_mfma_f32_32x32x16_bf16 v[48:63], v[196:199], a[180:183], v[48:63]
  ds_read_b64_tr_b16 v[214:215], v225 offset:29696
  v_add_f32 v176, v176, v154
  s_mov_b32 s16, s14
  s_mov_b32 s17, s15
  v_cndmask_b32 v254, v239, v254, vcc
  s_mov_b32 s18, 4718592
  s_add_u32 m0, s39, 0
  s_mov_b32 s41, 0
  s_waitcnt lgkmcnt(9)
  v_mfma_f32_32x32x16_bf16 v[64:79], v[200:203], a[176:179], v[64:79]
  ds_read_b64_tr_b16 v[216:217], v226 offset:28672
  ds_read_b128 a[204:207], v129 offset:4096
  buffer_load_dwordx4 v234, s[24:27], s41 offen offset:0 lds
  v_fmac_f32 v177, v154, v154
  v_mfma_f32_32x32x16_bf16 v[80:95], v[200:203], a[180:183], v[80:95]
  ds_read_b64_tr_b16 v[218:219], v226 offset:29696
  v_add_f32 v176, v176, v155
  v_fmac_f32 v177, v155, v155
  v_add_f32 v176, v176, v156
  s_waitcnt lgkmcnt(9)
  v_mfma_f32_32x32x16_bf16 v[96:111], v[204:207], a[176:179], v[96:111]
  ds_read_b64_tr_b16 v[220:221], v227 offset:28672
  ds_read_b128 a[208:211], v130 offset:0
  buffer_load_dwordx4 v235, s[24:27], s41 offen offset:1024 lds
  v_fmac_f32 v177, v156, v156
  v_mfma_f32_32x32x16_bf16 v[112:127], v[204:207], a[180:183], v[112:127]
  ds_read_b64_tr_b16 v[222:223], v227 offset:29696
  v_add_f32 v176, v176, v157
  v_fmac_f32 v177, v157, v157
  v_add_f32 v176, v176, v158
  s_waitcnt lgkmcnt(9)
  v_mfma_f32_32x32x16_bf16 v[0:15], v[208:211], a[184:187], v[0:15]
  ds_read_b64_tr_b16 v[192:193], v224 offset:32768
  ds_read_b128 a[212:215], v130 offset:4096
  buffer_load_dwordx4 v236, s[24:27], s41 offen offset:2048 lds
  v_fmac_f32 v177, v158, v158
  v_mfma_f32_32x32x16_bf16 v[16:31], v[208:211], a[188:191], v[16:31]
  ds_read_b64_tr_b16 v[194:195], v224 offset:33792
  v_add_f32 v176, v176, v159
  v_fmac_f32 v177, v159, v159
  v_add_f32 v176, v176, v160
  s_waitcnt lgkmcnt(9)
  v_mfma_f32_32x32x16_bf16 v[32:47], v[212:215], a[184:187], v[32:47]
  ds_read_b64_tr_b16 v[196:197], v225 offset:32768
  ds_read_b128 a[216:219], v131 offset:0
  buffer_load_dwordx4 v237, s[24:27], s41 offen offset:3072 lds
  v_fmac_f32 v177, v160, v160
  v_mfma_f32_32x32x16_bf16 v[48:63], v[212:215], a[188:191], v[48:63]
  ds_read_b64_tr_b16 v[198:199], v225 offset:33792
  v_add_f32 v176, v176, v161
  v_fmac_f32 v177, v161, v161
  v_add_f32 v176, v176, v162
  s_waitcnt lgkmcnt(9)
  v_mfma_f32_32x32x16_bf16 v[64:79], v[216:219], a[184:187], v[64:79]
  ds_read_b64_tr_b16 v[200:201], v226 offset:32768
  ds_read_b128 a[220:223], v131 offset:4096
  v_fmac_f32 v177, v162, v162
  v_add_f32 v176, v176, v163
  buffer_load_dword v239, v254, s[16:19], 0 offen
  v_mfma_f32_32x32x16_bf16 v[80:95], v[216:219], a[188:191], v[80:95]
  ds_read_b64_tr_b16 v[202:203], v226 offset:33792
  v_fmac_f32 v177, v163, v163
  v_add_f32 v176, v176, v164
  v_fmac_f32 v177, v164, v164
  s_waitcnt lgkmcnt(9)
  v_mfma_f32_32x32x16_bf16 v[96:111], v[220:223], a[184:187], v[96:111]
  ds_read_b64_tr_b16 v[204:205], v227 offset:32768
  v_add_f32 v176, v176, v165
  v_fmac_f32 v177, v165, v165
  v_add_f32 v176, v176, v166
  v_mfma_f32_32x32x16_bf16 v[112:127], v[220:223], a[188:191], v[112:127]
  ds_read_b64_tr_b16 v[206:207], v227 offset:33792
  v_fmac_f32 v177, v166, v166
  v_add_f32 v176, v176, v167
  v_fmac_f32 v177, v167, v167
  s_waitcnt lgkmcnt(8)
  v_mfma_f32_32x32x16_bf16 v[0:15], v[192:195], a[192:195], v[0:15]
  ds_read_b64_tr_b16 v[208:209], v224 offset:36864
  v_add_f32 v176, v176, v168
  v_fmac_f32 v177, v168, v168
  v_add_f32 v176, v176, v169
  v_mfma_f32_32x32x16_bf16 v[16:31], v[192:195], a[196:199], v[16:31]
  ds_read_b64_tr_b16 v[210:211], v224 offset:37888
  v_fmac_f32 v177, v169, v169
  v_add_f32 v176, v176, v170
  v_fmac_f32 v177, v170, v170
  s_waitcnt lgkmcnt(7)
  v_mfma_f32_32x32x16_bf16 v[32:47], v[196:199], a[192:195], v[32:47]
  ds_read_b64_tr_b16 v[212:213], v225 offset:36864
  v_add_f32 v176, v176, v171
  v_fmac_f32 v177, v171, v171
  v_add_f32 v176, v176, v172
  v_mfma_f32_32x32x16_bf16 v[48:63], v[196:199], a[196:199], v[48:63]
  ds_read_b64_tr_b16 v[214:215], v225 offset:37888
  v_fmac_f32 v177, v172, v172
  v_add_f32 v176, v176, v173
  v_fmac_f32 v177, v173, v173
  s_waitcnt lgkmcnt(6)
  v_mfma_f32_32x32x16_bf16 v[64:79], v[200:203], a[192:195], v[64:79]
  ds_read_b64_tr_b16 v[216:217], v226 offset:36864
  v_add_f32 v176, v176, v174
  v_fmac_f32 v177, v174, v174
  v_add_f32 v176, v176, v175
  v_mfma_f32_32x32x16_bf16 v[80:95], v[200:203], a[196:199], v[80:95]
  ds_read_b64_tr_b16 v[218:219], v226 offset:37888
  v_fmac_f32 v177, v175, v175
  v_add_f32_dpp v176, v176, v176 row_ror:8 row_mask:0xf bank_mask:0xf
  s_nop 0
  v_add_f32_dpp v177, v177, v177 row_ror:8 row_mask:0xf bank_mask:0xf
  s_waitcnt lgkmcnt(6)
  v_mfma_f32_32x32x16_bf16 v[96:111], v[204:207], a[192:195], v[96:111]
  ds_read_b64_tr_b16 v[220:221], v227 offset:36864
  v_mov_b32 v178, v176
  v_mov_b32 v179, v177
  s_nop 0
  v_permlane16_swap_b32 v178, v176
  v_mfma_f32_32x32x16_bf16 v[112:127], v[204:207], a[196:199], v[112:127]
  ds_read_b64_tr_b16 v[222:223], v227 offset:37888
  v_permlane16_swap_b32 v179, v177
  v_add_f32 v176, v176, v178
  v_add_f32 v177, v177, v179
  s_waitcnt lgkmcnt(6)
  v_mfma_f32_32x32x16_bf16 v[0:15], v[208:211], a[200:203], v[0:15]
  ds_read_b64_tr_b16 v[192:193], v224 offset:40960
  v_mov_b32 v178, v176
  v_mov_b32 v179, v177
  s_nop 0
  v_permlane32_swap_b32 v178, v176
  v_mfma_f32_32x32x16_bf16 v[16:31], v[208:211], a[204:207], v[16:31]
  ds_read_b64_tr_b16 v[194:195], v224 offset:41984
  v_permlane32_swap_b32 v179, v177
  v_add_f32 v176, v176, v178
  v_add_f32 v177, v177, v179
  s_waitcnt lgkmcnt(6)
  v_mfma_f32_32x32x16_bf16 v[32:47], v[212:215], a[200:203], v[32:47]
  ds_read_b64_tr_b16 v[196:197], v225 offset:40960
  ds_write_b64 v183, v[176:177]
  v_mfma_f32_32x32x16_bf16 v[48:63], v[212:215], a[204:207], v[48:63]
  ds_read_b64_tr_b16 v[198:199], v225 offset:41984
  s_waitcnt lgkmcnt(7)
  v_mfma_f32_32x32x16_bf16 v[64:79], v[216:219], a[200:203], v[64:79]
  ds_read_b64_tr_b16 v[200:201], v226 offset:40960
  v_mfma_f32_32x32x16_bf16 v[80:95], v[216:219], a[204:207], v[80:95]
  ds_read_b64_tr_b16 v[202:203], v226 offset:41984
  s_waitcnt lgkmcnt(7)
  v_mfma_f32_32x32x16_bf16 v[96:111], v[220:223], a[200:203], v[96:111]
  s_waitcnt vmcnt(9)
  ds_read_b64_tr_b16 v[204:205], v227 offset:40960
  ds_read_b128 a[224:227], v128 offset:8192
  v_mfma_f32_32x32x16_bf16 v[112:127], v[220:223], a[204:207], v[112:127]
  ds_read_b64_tr_b16 v[206:207], v227 offset:41984
  s_waitcnt lgkmcnt(8)
  v_mfma_f32_32x32x16_bf16 v[0:15], v[192:195], a[208:211], v[0:15]
  ds_read_b64_tr_b16 v[208:209], v224 offset:45056
  ds_read_b128 a[228:231], v128 offset:12288
  v_mfma_f32_32x32x16_bf16 v[16:31], v[192:195], a[212:215], v[16:31]
  ds_read_b64_tr_b16 v[210:211], v224 offset:46080
  s_waitcnt lgkmcnt(8)
  v_mfma_f32_32x32x16_bf16 v[32:47], v[196:199], a[208:211], v[32:47]
  ds_read_b64_tr_b16 v[212:213], v225 offset:45056
  ds_read_b128 a[232:235], v129 offset:8192
  s_waitcnt lgkmcnt(0)
  s_waitcnt vmcnt(5)
  s_barrier
  v_mfma_f32_32x32x16_bf16 v[48:63], v[196:199], a[212:215], v[48:63]
  ds_read_b64_tr_b16 v[214:215], v225 offset:46080
  s_add_u32 m0, s39, 16384
  s_mov_b32 s41, 1048576
  v_mfma_f32_32x32x16_bf16 v[64:79], v[200:203], a[208:211], v[64:79]
  ds_read_b64_tr_b16 v[216:217], v226 offset:45056
  ds_read_b128 a[236:239], v129 offset:12288
  buffer_load_dwordx4 v234, s[24:27], s41 offen offset:0 lds
  ds_read_b64 v[184:185], v182 offset:0
  v_mfma_f32_32x32x16_bf16 v[80:95], v[200:203], a[212:215], v[80:95]
  ds_read_b64_tr_b16 v[218:219], v226 offset:46080
  ds_read_b64 v[186:187], v182 offset:64
  ds_read_b64 v[188:189], v182 offset:128
  s_waitcnt lgkmcnt(1)
  v_add_f32 v176, v184, v186
  v_mfma_f32_32x32x16_bf16 v[96:111], v[204:207], a[208:211], v[96:111]
  ds_read_b64_tr_b16 v[220:221], v227 offset:45056
  ds_read_b128 a[240:243], v130 offset:8192
  buffer_load_dwordx4 v235, s[24:27], s41 offen offset:1024 lds
  v_add_f32 v177, v185, v187
  v_mfma_f32_32x32x16_bf16 v[112:127], v[204:207], a[212:215], v[112:127]
  ds_read_b64_tr_b16 v[222:223], v227 offset:46080
  s_waitcnt lgkmcnt(3)
  v_add_f32 v176, v176, v188
  v_add_f32 v177, v177, v189
  v_mul_f32 v176, 0.001736111111111111, v176
  v_mfma_f32_32x32x16_bf16 v[0:15], v[208:211], a[216:219], v[0:15]
  ds_read_b64_tr_b16 v[192:193], v224 offset:49152
  ds_read_b128 a[244:247], v130 offset:12288
  buffer_load_dwordx4 v236, s[24:27], s41 offen offset:2048 lds
  v_mul_f32 v177, 0.001736111111111111, v177
  v_mfma_f32_32x32x16_bf16 v[16:31], v[208:211], a[220:223], v[16:31]
  ds_read_b64_tr_b16 v[194:195], v224 offset:50176
  v_fma_f32 v177, -v176, v176, v177
  v_max_f32 v177, 0, v177
  v_add_f32 v177, 1e-05, v177
  v_mfma_f32_32x32x16_bf16 v[32:47], v[212:215], a[216:219], v[32:47]
  ds_read_b64_tr_b16 v[196:197], v225 offset:49152
  ds_read_b128 a[248:251], v131 offset:8192
  buffer_load_dwordx4 v237, s[24:27], s41 offen offset:3072 lds
  v_mfma_f32_32x32x16_bf16 v[48:63], v[212:215], a[220:223], v[48:63]
  ds_read_b64_tr_b16 v[198:199], v225 offset:50176
  v_rsq_f32 v177, v177
  s_nop 0
  v_mul_f32 v177, 0.12751743082459868, v177
  v_mfma_f32_32x32x16_bf16 v[64:79], v[216:219], a[216:219], v[64:79]
  ds_read_b64_tr_b16 v[200:201], v226 offset:49152
  ds_read_b128 a[252:255], v131 offset:12288
  v_mul_f32 v176, v176, v177
  v_fma_f32 v152, v152, v177, -v176
  v_mfma_f32_32x32x16_bf16 v[80:95], v[216:219], a[220:223], v[80:95]
  ds_read_b64_tr_b16 v[202:203], v226 offset:50176
  v_fma_f32 v153, v153, v177, -v176
  v_cvt_pk_bf16_f32 v140, v152, v153
  v_fma_f32 v154, v154, v177, -v176
  s_waitcnt lgkmcnt(9)
  v_mfma_f32_32x32x16_bf16 v[96:111], v[220:223], a[216:219], v[96:111]
  ds_read_b64_tr_b16 v[204:205], v227 offset:49152
  v_fma_f32 v155, v155, v177, -v176
  v_cvt_pk_bf16_f32 v141, v154, v155
  v_fma_f32 v156, v156, v177, -v176
  v_mfma_f32_32x32x16_bf16 v[112:127], v[220:223], a[220:223], v[112:127]
  ds_read_b64_tr_b16 v[206:207], v227 offset:50176
  v_fma_f32 v157, v157, v177, -v176
  v_cvt_pk_bf16_f32 v142, v156, v157
  v_fma_f32 v158, v158, v177, -v176
  s_waitcnt lgkmcnt(8)
  v_mfma_f32_32x32x16_bf16 v[0:15], v[192:195], a[224:227], v[0:15]
  ds_read_b64_tr_b16 v[208:209], v224 offset:53248
  v_fma_f32 v159, v159, v177, -v176
  v_cvt_pk_bf16_f32 v143, v158, v159
  buffer_store_dwordx4 v[140:143], v181, s[32:35], 0 offen sc1
  v_mfma_f32_32x32x16_bf16 v[16:31], v[192:195], a[228:231], v[16:31]
  ds_read_b64_tr_b16 v[210:211], v224 offset:54272
  v_fma_f32 v160, v160, v177, -v176
  v_fma_f32 v161, v161, v177, -v176
  v_cvt_pk_bf16_f32 v144, v160, v161
  s_waitcnt lgkmcnt(7)
  v_mfma_f32_32x32x16_bf16 v[32:47], v[196:199], a[224:227], v[32:47]
  ds_read_b64_tr_b16 v[212:213], v225 offset:53248
  v_fma_f32 v162, v162, v177, -v176
  v_fma_f32 v163, v163, v177, -v176
  v_cvt_pk_bf16_f32 v145, v162, v163
  v_mfma_f32_32x32x16_bf16 v[48:63], v[196:199], a[228:231], v[48:63]
  ds_read_b64_tr_b16 v[214:215], v225 offset:54272
  v_fma_f32 v164, v164, v177, -v176
  v_fma_f32 v165, v165, v177, -v176
  v_cvt_pk_bf16_f32 v146, v164, v165
  s_waitcnt lgkmcnt(6)
  v_mfma_f32_32x32x16_bf16 v[64:79], v[200:203], a[224:227], v[64:79]
  ds_read_b64_tr_b16 v[216:217], v226 offset:53248
  v_fma_f32 v166, v166, v177, -v176
  v_fma_f32 v167, v167, v177, -v176
  v_cvt_pk_bf16_f32 v147, v166, v167
  v_mfma_f32_32x32x16_bf16 v[80:95], v[200:203], a[228:231], v[80:95]
  ds_read_b64_tr_b16 v[218:219], v226 offset:54272
  buffer_store_dwordx4 v[144:147], v181, s[32:35], s60 offen sc1
  v_fma_f32 v168, v168, v177, -v176
  v_fma_f32 v169, v169, v177, -v176
  s_waitcnt lgkmcnt(6)
  v_mfma_f32_32x32x16_bf16 v[96:111], v[204:207], a[224:227], v[96:111]
  ds_read_b64_tr_b16 v[220:221], v227 offset:53248
  v_cvt_pk_bf16_f32 v148, v168, v169
  v_fma_f32 v170, v170, v177, -v176
  v_fma_f32 v171, v171, v177, -v176
  v_mfma_f32_32x32x16_bf16 v[112:127], v[204:207], a[228:231], v[112:127]
  ds_read_b64_tr_b16 v[222:223], v227 offset:54272
  v_cvt_pk_bf16_f32 v149, v170, v171
  v_fma_f32 v172, v172, v177, -v176
  v_fma_f32 v173, v173, v177, -v176
  s_waitcnt lgkmcnt(6)
  v_mfma_f32_32x32x16_bf16 v[0:15], v[208:211], a[232:235], v[0:15]
  ds_read_b64_tr_b16 v[192:193], v224 offset:57344
  v_cvt_pk_bf16_f32 v150, v172, v173
  v_fma_f32 v174, v174, v177, -v176
  v_fma_f32 v175, v175, v177, -v176
  v_mfma_f32_32x32x16_bf16 v[16:31], v[208:211], a[236:239], v[16:31]
  ds_read_b64_tr_b16 v[194:195], v224 offset:58368
  v_cvt_pk_bf16_f32 v151, v174, v175
  buffer_store_dwordx4 v[148:151], v181, s[32:35], s61 offen sc1
  s_waitcnt lgkmcnt(6)
  v_mfma_f32_32x32x16_bf16 v[32:47], v[212:215], a[232:235], v[32:47]
  ds_read_b64_tr_b16 v[196:197], v225 offset:57344
  v_mfma_f32_32x32x16_bf16 v[48:63], v[212:215], a[236:239], v[48:63]
  ds_read_b64_tr_b16 v[198:199], v225 offset:58368
  s_waitcnt lgkmcnt(6)
  v_mfma_f32_32x32x16_bf16 v[64:79], v[216:219], a[232:235], v[64:79]
  ds_read_b64_tr_b16 v[200:201], v226 offset:57344
  v_mfma_f32_32x32x16_bf16 v[80:95], v[216:219], a[236:239], v[80:95]
  ds_read_b64_tr_b16 v[202:203], v226 offset:58368
  s_waitcnt lgkmcnt(6)
  v_mfma_f32_32x32x16_bf16 v[96:111], v[220:223], a[232:235], v[96:111]
  ds_read_b64_tr_b16 v[204:205], v227 offset:57344
  v_mfma_f32_32x32x16_bf16 v[112:127], v[220:223], a[236:239], v[112:127]
  ds_read_b64_tr_b16 v[206:207], v227 offset:58368
  s_waitcnt lgkmcnt(6)
  v_mfma_f32_32x32x16_bf16 v[0:15], v[192:195], a[240:243], v[0:15]
  ds_read_b64_tr_b16 v[208:209], v224 offset:61440
  v_mfma_f32_32x32x16_bf16 v[16:31], v[192:195], a[244:247], v[16:31]
  ds_read_b64_tr_b16 v[210:211], v224 offset:62464
  s_waitcnt lgkmcnt(6)
  v_mfma_f32_32x32x16_bf16 v[32:47], v[196:199], a[240:243], v[32:47]
  ds_read_b64_tr_b16 v[212:213], v225 offset:61440
  s_waitcnt vmcnt(8)
  s_barrier
  v_mfma_f32_32x32x16_bf16 v[48:63], v[196:199], a[244:247], v[48:63]
  ds_read_b64_tr_b16 v[214:215], v225 offset:62464
  s_add_u32 m0, s39, 32768
  s_mov_b32 s41, 2097152
  s_waitcnt lgkmcnt(6)
  v_mfma_f32_32x32x16_bf16 v[64:79], v[200:203], a[240:243], v[64:79]
  ds_read_b64_tr_b16 v[216:217], v226 offset:61440
  buffer_load_dwordx4 v234, s[24:27], s41 offen offset:0 lds
  v_mfma_f32_32x32x16_bf16 v[80:95], v[200:203], a[244:247], v[80:95]
  ds_read_b64_tr_b16 v[218:219], v226 offset:62464
  s_waitcnt lgkmcnt(6)
  v_mfma_f32_32x32x16_bf16 v[96:111], v[204:207], a[240:243], v[96:111]
  ds_read_b64_tr_b16 v[220:221], v227 offset:61440
  buffer_load_dwordx4 v235, s[24:27], s41 offen offset:1024 lds
  v_mfma_f32_32x32x16_bf16 v[112:127], v[204:207], a[244:247], v[112:127]
  ds_read_b64_tr_b16 v[222:223], v227 offset:62464
  s_waitcnt lgkmcnt(6)
  v_mfma_f32_32x32x16_bf16 v[0:15], v[208:211], a[248:251], v[0:15]
  ds_read_b64_tr_b16 v[192:193], v228 offset:0
  buffer_load_dwordx4 v236, s[24:27], s41 offen offset:2048 lds
  v_mfma_f32_32x32x16_bf16 v[16:31], v[208:211], a[252:255], v[16:31]
  ds_read_b64_tr_b16 v[194:195], v228 offset:512
  s_waitcnt lgkmcnt(6)
  v_mfma_f32_32x32x16_bf16 v[32:47], v[212:215], a[248:251], v[32:47]
  ds_read_b64_tr_b16 v[196:197], v229 offset:0
  buffer_load_dwordx4 v237, s[24:27], s41 offen offset:3072 lds
  v_mfma_f32_32x32x16_bf16 v[48:63], v[212:215], a[252:255], v[48:63]
  ds_read_b64_tr_b16 v[198:199], v229 offset:512
  s_waitcnt lgkmcnt(6)
  v_mfma_f32_32x32x16_bf16 v[64:79], v[216:219], a[248:251], v[64:79]
  ds_read_b64_tr_b16 v[200:201], v228 offset:2048
  v_mfma_f32_32x32x16_bf16 v[80:95], v[216:219], a[252:255], v[80:95]
  ds_read_b64_tr_b16 v[202:203], v228 offset:2560
  s_waitcnt lgkmcnt(6)
  v_mfma_f32_32x32x16_bf16 v[96:111], v[220:223], a[248:251], v[96:111]
  ds_read_b64_tr_b16 v[204:205], v229 offset:2048
  v_mfma_f32_32x32x16_bf16 v[112:127], v[220:223], a[252:255], v[112:127]
  ds_read_b64_tr_b16 v[206:207], v229 offset:2560
  s_waitcnt lgkmcnt(6)
  v_mfma_f32_32x32x16_bf16 v[128:143], a[0:3], v[192:195], 0
  ds_read_b64_tr_b16 v[208:209], v228 offset:4096
  v_mfma_f32_32x32x16_bf16 v[144:159], a[4:7], v[192:195], 0
  ds_read_b64_tr_b16 v[210:211], v228 offset:4608
  v_cvt_pk_bf16_f32 v240, v64, v65
  v_or_b32_sdwa v240, v64, 1 dst_sel:WORD_0 dst_unused:UNUSED_PRESERVE src0_sel:WORD_1 src1_sel:DWORD
  s_waitcnt lgkmcnt(6)
  v_mfma_f32_32x32x16_bf16 v[160:175], a[0:3], v[196:199], 0
  ds_read_b64_tr_b16 v[212:213], v229 offset:4096
  v_cvt_pk_bf16_f32 v241, v66, v67
  v_mfma_f32_32x32x16_bf16 v[176:191], a[4:7], v[196:199], 0
  ds_read_b64_tr_b16 v[214:215], v229 offset:4608
  v_cvt_pk_bf16_f32 v242, v68, v69
  s_waitcnt lgkmcnt(6)
  v_mfma_f32_32x32x16_bf16 v[128:143], a[8:11], v[200:203], v[128:143]
  ds_read_b64_tr_b16 v[216:217], v228 offset:6144
  v_cvt_pk_bf16_f32 v243, v70, v71
  v_mfma_f32_32x32x16_bf16 v[144:159], a[12:15], v[200:203], v[144:159]
  ds_read_b64_tr_b16 v[218:219], v228 offset:6656
  s_waitcnt lgkmcnt(6)
  v_mfma_f32_32x32x16_bf16 v[160:175], a[8:11], v[204:207], v[160:175]
  ds_read_b64_tr_b16 v[220:221], v229 offset:6144
  buffer_store_dwordx4 v[240:243], v238, s[32:35], s60 offen offset:0 sc1
  v_mfma_f32_32x32x16_bf16 v[176:191], a[12:15], v[204:207], v[176:191]
  ds_read_b64_tr_b16 v[222:223], v229 offset:6656
  s_waitcnt lgkmcnt(6)
  v_mfma_f32_32x32x16_bf16 v[128:143], a[16:19], v[208:211], v[128:143]
  ds_read_b64_tr_b16 v[192:193], v228 offset:8192
  v_mfma_f32_32x32x16_bf16 v[144:159], a[20:23], v[208:211], v[144:159]
  ds_read_b64_tr_b16 v[194:195], v228 offset:8704
  v_cvt_pk_bf16_f32 v244, v72, v73
  v_or_b32_sdwa v244, v72, 1 dst_sel:WORD_0 dst_unused:UNUSED_PRESERVE src0_sel:WORD_1 src1_sel:DWORD
  s_waitcnt lgkmcnt(6)
  v_mfma_f32_32x32x16_bf16 v[160:175], a[16:19], v[212:215], v[160:175]
  ds_read_b64_tr_b16 v[196:197], v229 offset:8192
  v_cvt_pk_bf16_f32 v245, v74, v75
  v_mfma_f32_32x32x16_bf16 v[176:191], a[20:23], v[212:215], v[176:191]
  ds_read_b64_tr_b16 v[198:199], v229 offset:8704
  v_cvt_pk_bf16_f32 v246, v76, v77
  s_waitcnt lgkmcnt(6)
  v_mfma_f32_32x32x16_bf16 v[128:143], a[24:27], v[216:219], v[128:143]
  ds_read_b64_tr_b16 v[200:201], v228 offset:10240
  v_cvt_pk_bf16_f32 v247, v78, v79
  v_mfma_f32_32x32x16_bf16 v[144:159], a[28:31], v[216:219], v[144:159]
  ds_read_b64_tr_b16 v[202:203], v228 offset:10752
  s_waitcnt lgkmcnt(6)
  v_mfma_f32_32x32x16_bf16 v[160:175], a[24:27], v[220:223], v[160:175]
  ds_read_b64_tr_b16 v[204:205], v229 offset:10240
  buffer_store_dwordx4 v[244:247], v238, s[32:35], s60 offen offset:1024 sc1
  v_mfma_f32_32x32x16_bf16 v[176:191], a[28:31], v[220:223], v[176:191]
  ds_read_b64_tr_b16 v[206:207], v229 offset:10752
  s_waitcnt lgkmcnt(6)
  v_mfma_f32_32x32x16_bf16 v[128:143], a[32:35], v[192:195], v[128:143]
  ds_read_b64_tr_b16 v[208:209], v228 offset:12288
  v_mfma_f32_32x32x16_bf16 v[144:159], a[36:39], v[192:195], v[144:159]
  ds_read_b64_tr_b16 v[210:211], v228 offset:12800
  v_cvt_pk_bf16_f32 v240, v80, v81
  v_or_b32_sdwa v240, v80, 1 dst_sel:WORD_0 dst_unused:UNUSED_PRESERVE src0_sel:WORD_1 src1_sel:DWORD
  s_waitcnt lgkmcnt(6)
  v_mfma_f32_32x32x16_bf16 v[160:175], a[32:35], v[196:199], v[160:175]
  ds_read_b64_tr_b16 v[212:213], v229 offset:12288
  v_cvt_pk_bf16_f32 v241, v82, v83
  s_waitcnt vmcnt(9)
  s_barrier
  v_mfma_f32_32x32x16_bf16 v[176:191], a[36:39], v[196:199], v[176:191]
  ds_read_b64_tr_b16 v[214:215], v229 offset:12800
  v_cvt_pk_bf16_f32 v242, v84, v85
  s_add_u32 m0, s39, 49152
  s_mov_b32 s41, 3145728
  s_waitcnt lgkmcnt(6)
  v_mfma_f32_32x32x16_bf16 v[128:143], a[40:43], v[200:203], v[128:143]
  ds_read_b64_tr_b16 v[216:217], v228 offset:14336
  buffer_load_dwordx4 v234, s[24:27], s41 offen offset:0 lds
  v_cvt_pk_bf16_f32 v243, v86, v87
  v_mfma_f32_32x32x16_bf16 v[144:159], a[44:47], v[200:203], v[144:159]
  ds_read_b64_tr_b16 v[218:219], v228 offset:14848
  s_waitcnt lgkmcnt(6)
  v_mfma_f32_32x32x16_bf16 v[160:175], a[40:43], v[204:207], v[160:175]
  ds_read_b64_tr_b16 v[220:221], v229 offset:14336
  buffer_load_dwordx4 v235, s[24:27], s41 offen offset:1024 lds
  buffer_store_dwordx4 v[240:243], v238, s[32:35], s62 offen offset:0 sc1
  v_mfma_f32_32x32x16_bf16 v[176:191], a[44:47], v[204:207], v[176:191]
  ds_read_b64_tr_b16 v[222:223], v229 offset:14848
  s_waitcnt lgkmcnt(6)
  v_mfma_f32_32x32x16_bf16 v[128:143], a[48:51], v[208:211], v[128:143]
  ds_read_b64_tr_b16 v[192:193], v228 offset:16384
  buffer_load_dwordx4 v236, s[24:27], s41 offen offset:2048 lds
  v_mfma_f32_32x32x16_bf16 v[144:159], a[52:55], v[208:211], v[144:159]
  ds_read_b64_tr_b16 v[194:195], v228 offset:16896
  v_cvt_pk_bf16_f32 v244, v88, v89
  v_or_b32_sdwa v244, v88, 1 dst_sel:WORD_0 dst_unused:UNUSED_PRESERVE src0_sel:WORD_1 src1_sel:DWORD
  s_waitcnt lgkmcnt(6)
  v_mfma_f32_32x32x16_bf16 v[160:175], a[48:51], v[212:215], v[160:175]
  ds_read_b64_tr_b16 v[196:197], v229 offset:16384
  buffer_load_dwordx4 v237, s[24:27], s41 offen offset:3072 lds
  v_cvt_pk_bf16_f32 v245, v90, v91
  v_mfma_f32_32x32x16_bf16 v[176:191], a[52:55], v[212:215], v[176:191]
  ds_read_b64_tr_b16 v[198:199], v229 offset:16896
  v_cvt_pk_bf16_f32 v246, v92, v93
  s_waitcnt lgkmcnt(6)
  v_mfma_f32_32x32x16_bf16 v[128:143], a[56:59], v[216:219], v[128:143]
  ds_read_b64_tr_b16 v[200:201], v228 offset:18432
  v_cvt_pk_bf16_f32 v247, v94, v95
  v_mfma_f32_32x32x16_bf16 v[144:159], a[60:63], v[216:219], v[144:159]
  ds_read_b64_tr_b16 v[202:203], v228 offset:18944
  s_waitcnt lgkmcnt(6)
  v_mfma_f32_32x32x16_bf16 v[160:175], a[56:59], v[220:223], v[160:175]
  ds_read_b64_tr_b16 v[204:205], v229 offset:18432
  buffer_store_dwordx4 v[244:247], v238, s[32:35], s62 offen offset:1024 sc1
  v_mfma_f32_32x32x16_bf16 v[176:191], a[60:63], v[220:223], v[176:191]
  ds_read_b64_tr_b16 v[206:207], v229 offset:18944
  s_waitcnt lgkmcnt(6)
  v_mfma_f32_32x32x16_bf16 v[128:143], a[64:67], v[192:195], v[128:143]
  ds_read_b64_tr_b16 v[208:209], v228 offset:20480
  v_mfma_f32_32x32x16_bf16 v[144:159], a[68:71], v[192:195], v[144:159]
  ds_read_b64_tr_b16 v[210:211], v228 offset:20992
  s_lshr_b32 s54, s2, 4
  s_lshr_b32 s55, s2, 5
  v_cvt_pk_bf16_f32 v240, v96, v97
  v_or_b32_sdwa v240, v96, 1 dst_sel:WORD_0 dst_unused:UNUSED_PRESERVE src0_sel:WORD_1 src1_sel:DWORD
  s_waitcnt lgkmcnt(6)
  v_mfma_f32_32x32x16_bf16 v[160:175], a[64:67], v[196:199], v[160:175]
  ds_read_b64_tr_b16 v[212:213], v229 offset:20480
  s_xor_b32 s54, s54, s55
  s_and_b32 s54, s54, 1
  s_lshl_b32 s54, s54, 7
  v_cvt_pk_bf16_f32 v241, v98, v99
  v_mfma_f32_32x32x16_bf16 v[176:191], a[68:71], v[196:199], v[176:191]
  ds_read_b64_tr_b16 v[214:215], v229 offset:20992
  s_lshl_b32 s55, s55, 4
  s_add_u32 s54, s54, s55
  s_and_b32 s55, s2, 15
  v_cvt_pk_bf16_f32 v242, v100, v101
  s_waitcnt lgkmcnt(6)
  v_mfma_f32_32x32x16_bf16 v[128:143], a[72:75], v[200:203], v[128:143]
  ds_read_b64_tr_b16 v[216:217], v228 offset:22528
  s_add_u32 s70, s54, s55
  v_cmp_eq_u32 vcc, 0, v255
  v_mov_b32 v64, 0x7f000000
  v_cvt_pk_bf16_f32 v243, v102, v103
  v_mfma_f32_32x32x16_bf16 v[144:159], a[76:79], v[200:203], v[144:159]
  ds_read_b64_tr_b16 v[218:219], v228 offset:23040
  v_mov_b32 v65, s70
  v_cndmask_b32 v64, v64, v65, vcc
  v_mov_b32 v65, 1
  s_lshr_b32 s54, s2, 5
  s_waitcnt lgkmcnt(6)
  v_mfma_f32_32x32x16_bf16 v[160:175], a[72:75], v[204:207], v[160:175]
  ds_read_b64_tr_b16 v[220:221], v229 offset:22528
  buffer_store_dwordx4 v[240:243], v238, s[32:35], s60 offen offset:2048 sc1
  s_lshr_b32 s55, s54, 1
  s_xor_b32 s54, s54, s55
  s_and_b32 s54, s54, 1
  v_mfma_f32_32x32x16_bf16 v[176:191], a[76:79], v[204:207], v[176:191]
  ds_read_b64_tr_b16 v[222:223], v229 offset:23040
  s_lshl_b32 s54, s54, 7
  s_lshl_b32 s55, s55, 4
  s_add_u32 s56, s54, s55
  v_mov_b32 v66, s56
  s_waitcnt lgkmcnt(6)
  v_mfma_f32_32x32x16_bf16 v[128:143], a[80:83], v[208:211], v[128:143]
  ds_read_b64_tr_b16 v[192:193], v228 offset:24576
  s_lshr_b32 s54, s2, 5
  s_sub_u32 s54, 15, s54
  s_lshr_b32 s55, s54, 1
  s_xor_b32 s54, s54, s55
  v_mfma_f32_32x32x16_bf16 v[144:159], a[84:87], v[208:211], v[144:159]
  ds_read_b64_tr_b16 v[194:195], v228 offset:25088
  s_and_b32 s54, s54, 1
  s_lshl_b32 s54, s54, 7
  v_cvt_pk_bf16_f32 v244, v104, v105
  v_or_b32_sdwa v244, v104, 1 dst_sel:WORD_0 dst_unused:UNUSED_PRESERVE src0_sel:WORD_1 src1_sel:DWORD
  s_waitcnt lgkmcnt(6)
  v_mfma_f32_32x32x16_bf16 v[160:175], a[80:83], v[212:215], v[160:175]
  ds_read_b64_tr_b16 v[196:197], v229 offset:24576
  s_lshl_b32 s55, s55, 4
  s_add_u32 s57, s54, s55
  v_mov_b32 v67, s57
  v_cvt_pk_bf16_f32 v245, v106, v107
  v_mfma_f32_32x32x16_bf16 v[176:191], a[84:87], v[212:215], v[176:191]
  ds_read_b64_tr_b16 v[198:199], v229 offset:25088
  v_and_b32 v68, 4, v248
  v_cmp_eq_u32 vcc, 0, v68
  s_nop 1
  v_cndmask_b32 v66, v67, v66, vcc
  v_cvt_pk_bf16_f32 v246, v108, v109
  s_waitcnt lgkmcnt(6)
  v_mfma_f32_32x32x16_bf16 v[128:143], a[88:91], v[216:219], v[128:143]
  ds_read_b64_tr_b16 v[200:201], v228 offset:26624
  v_and_b32 v68, 3, v248
  v_lshl_add_u32 v66, v68, 2, v66
  v_mov_b32 v68, 0x7f000000
  v_cvt_pk_bf16_f32 v247, v110, v111
  v_mfma_f32_32x32x16_bf16 v[144:159], a[92:95], v[216:219], v[144:159]
  ds_read_b64_tr_b16 v[202:203], v228 offset:27136
  v_cmp_gt_u32 vcc, 64, v255
  s_nop 1
  v_cndmask_b32 v66, v68, v66, vcc
  s_cmp_eq_u32 s36, 0
  s_cselect_b64 s[68:69], -1, 0
  s_waitcnt lgkmcnt(6)
  v_mfma_f32_32x32x16_bf16 v[160:175], a[88:91], v[220:223], v[160:175]
  ds_read_b64_tr_b16 v[204:205], v229 offset:26624
  buffer_store_dwordx4 v[244:247], v238, s[32:35], s60 offen offset:3072 sc1
  v_mfma_f32_32x32x16_bf16 v[176:191], a[92:95], v[220:223], v[176:191]
  ds_read_b64_tr_b16 v[206:207], v229 offset:27136
  s_waitcnt lgkmcnt(6)
  v_mfma_f32_32x32x16_bf16 v[128:143], a[96:99], v[192:195], v[128:143]
  ds_read_b64_tr_b16 v[208:209], v228 offset:28672
  v_mfma_f32_32x32x16_bf16 v[144:159], a[100:103], v[192:195], v[144:159]
  ds_read_b64_tr_b16 v[210:211], v228 offset:29184
  v_cvt_pk_bf16_f32 v240, v112, v113
  v_or_b32_sdwa v240, v112, 1 dst_sel:WORD_0 dst_unused:UNUSED_PRESERVE src0_sel:WORD_1 src1_sel:DWORD
  s_waitcnt lgkmcnt(6)
  v_mfma_f32_32x32x16_bf16 v[160:175], a[96:99], v[196:199], v[160:175]
  ds_read_b64_tr_b16 v[212:213], v229 offset:28672
  v_cvt_pk_bf16_f32 v241, v114, v115
  s_waitcnt vmcnt(14)
  s_waitcnt vmcnt(10)
  s_barrier
  v_mfma_f32_32x32x16_bf16 v[176:191], a[100:103], v[196:199], v[176:191]
  ds_read_b64_tr_b16 v[214:215], v229 offset:29184
  v_cvt_pk_bf16_f32 v242, v116, v117
  buffer_store_byte v65, v64, s[8:11], 0 offen sc1
  s_add_u32 m0, s39, 0
  s_mov_b32 s41, 2097280
  s_waitcnt lgkmcnt(6)
  v_mfma_f32_32x32x16_bf16 v[128:143], a[104:107], v[200:203], v[128:143]
  ds_read_b64_tr_b16 v[216:217], v228 offset:30720
  buffer_load_dwordx4 v234, s[24:27], s41 offen offset:0 lds
  v_cvt_pk_bf16_f32 v243, v118, v119
  v_mfma_f32_32x32x16_bf16 v[144:159], a[108:111], v[200:203], v[144:159]
  ds_read_b64_tr_b16 v[218:219], v228 offset:31232
  s_waitcnt lgkmcnt(6)
  v_mfma_f32_32x32x16_bf16 v[160:175], a[104:107], v[204:207], v[160:175]
  ds_read_b64_tr_b16 v[220:221], v229 offset:30720
  buffer_load_dwordx4 v235, s[24:27], s41 offen offset:1024 lds
  buffer_store_dwordx4 v[240:243], v238, s[32:35], s62 offen offset:2048 sc1
  v_mfma_f32_32x32x16_bf16 v[176:191], a[108:111], v[204:207], v[176:191]
  ds_read_b64_tr_b16 v[222:223], v229 offset:31232
  s_waitcnt lgkmcnt(6)
  v_mfma_f32_32x32x16_bf16 v[128:143], a[112:115], v[208:211], v[128:143]
  ds_read_b64_tr_b16 v[192:193], v228 offset:32768
  buffer_load_dwordx4 v236, s[24:27], s41 offen offset:2048 lds
  v_mfma_f32_32x32x16_bf16 v[144:159], a[116:119], v[208:211], v[144:159]
  ds_read_b64_tr_b16 v[194:195], v228 offset:33280
  v_cvt_pk_bf16_f32 v244, v120, v121
  v_or_b32_sdwa v244, v120, 1 dst_sel:WORD_0 dst_unused:UNUSED_PRESERVE src0_sel:WORD_1 src1_sel:DWORD
  s_waitcnt lgkmcnt(6)
  v_mfma_f32_32x32x16_bf16 v[160:175], a[112:115], v[212:215], v[160:175]
  ds_read_b64_tr_b16 v[196:197], v229 offset:32768
  buffer_load_dwordx4 v237, s[24:27], s41 offen offset:3072 lds
  v_cvt_pk_bf16_f32 v245, v122, v123
  v_mfma_f32_32x32x16_bf16 v[176:191], a[116:119], v[212:215], v[176:191]
  ds_read_b64_tr_b16 v[198:199], v229 offset:33280
  v_cvt_pk_bf16_f32 v246, v124, v125
  s_waitcnt lgkmcnt(6)
  v_mfma_f32_32x32x16_bf16 v[128:143], a[120:123], v[216:219], v[128:143]
  ds_read_b64_tr_b16 v[200:201], v228 offset:34816
  v_cvt_pk_bf16_f32 v247, v126, v127
  v_mfma_f32_32x32x16_bf16 v[144:159], a[124:127], v[216:219], v[144:159]
  ds_read_b64_tr_b16 v[202:203], v228 offset:35328
  s_waitcnt lgkmcnt(6)
  v_mfma_f32_32x32x16_bf16 v[160:175], a[120:123], v[220:223], v[160:175]
  ds_read_b64_tr_b16 v[204:205], v229 offset:34816
  buffer_store_dwordx4 v[244:247], v238, s[32:35], s62 offen offset:3072 sc1
  v_mfma_f32_32x32x16_bf16 v[176:191], a[124:127], v[220:223], v[176:191]
  ds_read_b64_tr_b16 v[206:207], v229 offset:35328
  s_waitcnt lgkmcnt(6)
  v_mfma_f32_32x32x16_bf16 v[128:143], a[128:131], v[192:195], v[128:143]
  ds_read_b64_tr_b16 v[208:209], v228 offset:36864
  v_mfma_f32_32x32x16_bf16 v[144:159], a[132:135], v[192:195], v[144:159]
  ds_read_b64_tr_b16 v[210:211], v228 offset:37376
  v_cvt_pk_bf16_f32 v240, v0, v1
  v_or_b32_sdwa v240, v0, 1 dst_sel:WORD_0 dst_unused:UNUSED_PRESERVE src0_sel:WORD_1 src1_sel:DWORD
  s_waitcnt lgkmcnt(6)
  v_mfma_f32_32x32x16_bf16 v[160:175], a[128:131], v[196:199], v[160:175]
  ds_read_b64_tr_b16 v[212:213], v229 offset:36864
  v_cvt_pk_bf16_f32 v241, v2, v3
  v_mfma_f32_32x32x16_bf16 v[176:191], a[132:135], v[196:199], v[176:191]
  ds_read_b64_tr_b16 v[214:215], v229 offset:37376
  v_cvt_pk_bf16_f32 v242, v4, v5
  s_waitcnt lgkmcnt(6)
  v_mfma_f32_32x32x16_bf16 v[128:143], a[136:139], v[200:203], v[128:143]
  ds_read_b64_tr_b16 v[216:217], v228 offset:38912
  v_cvt_pk_bf16_f32 v243, v6, v7
  v_mfma_f32_32x32x16_bf16 v[144:159], a[140:143], v[200:203], v[144:159]
  ds_read_b64_tr_b16 v[218:219], v228 offset:39424
  s_waitcnt lgkmcnt(6)
  v_mfma_f32_32x32x16_bf16 v[160:175], a[136:139], v[204:207], v[160:175]
  ds_read_b64_tr_b16 v[220:221], v229 offset:38912
  buffer_store_dwordx4 v[240:243], v238, s[32:35], 0 offen offset:0 sc1
  v_mfma_f32_32x32x16_bf16 v[176:191], a[140:143], v[204:207], v[176:191]
  ds_read_b64_tr_b16 v[222:223], v229 offset:39424
  s_waitcnt lgkmcnt(6)
  v_mfma_f32_32x32x16_bf16 v[128:143], a[144:147], v[208:211], v[128:143]
  ds_read_b64_tr_b16 v[192:193], v228 offset:40960
  v_mfma_f32_32x32x16_bf16 v[144:159], a[148:151], v[208:211], v[144:159]
  ds_read_b64_tr_b16 v[194:195], v228 offset:41472
  v_cvt_pk_bf16_f32 v244, v8, v9
  v_or_b32_sdwa v244, v8, 1 dst_sel:WORD_0 dst_unused:UNUSED_PRESERVE src0_sel:WORD_1 src1_sel:DWORD
  s_waitcnt lgkmcnt(6)
  v_mfma_f32_32x32x16_bf16 v[160:175], a[144:147], v[212:215], v[160:175]
  ds_read_b64_tr_b16 v[196:197], v229 offset:40960
  v_cvt_pk_bf16_f32 v245, v10, v11
  v_mfma_f32_32x32x16_bf16 v[176:191], a[148:151], v[212:215], v[176:191]
  ds_read_b64_tr_b16 v[198:199], v229 offset:41472
  v_cvt_pk_bf16_f32 v246, v12, v13
  s_waitcnt lgkmcnt(6)
  v_mfma_f32_32x32x16_bf16 v[128:143], a[152:155], v[216:219], v[128:143]
  ds_read_b64_tr_b16 v[200:201], v228 offset:43008
  v_cvt_pk_bf16_f32 v247, v14, v15
  v_mfma_f32_32x32x16_bf16 v[144:159], a[156:159], v[216:219], v[144:159]
  ds_read_b64_tr_b16 v[202:203], v228 offset:43520
  s_waitcnt lgkmcnt(6)
  v_mfma_f32_32x32x16_bf16 v[160:175], a[152:155], v[220:223], v[160:175]
  ds_read_b64_tr_b16 v[204:205], v229 offset:43008
  buffer_store_dwordx4 v[244:247], v238, s[32:35], 0 offen offset:1024 sc1
  v_mfma_f32_32x32x16_bf16 v[176:191], a[156:159], v[220:223], v[176:191]
  ds_read_b64_tr_b16 v[206:207], v229 offset:43520
  s_waitcnt lgkmcnt(6)
  v_mfma_f32_32x32x16_bf16 v[128:143], a[160:163], v[192:195], v[128:143]
  ds_read_b64_tr_b16 v[208:209], v228 offset:45056
  v_mfma_f32_32x32x16_bf16 v[144:159], a[164:167], v[192:195], v[144:159]
  ds_read_b64_tr_b16 v[210:211], v228 offset:45568
  v_cvt_pk_bf16_f32 v240, v16, v17
  v_or_b32_sdwa v240, v16, 1 dst_sel:WORD_0 dst_unused:UNUSED_PRESERVE src0_sel:WORD_1 src1_sel:DWORD
  s_waitcnt lgkmcnt(6)
  v_mfma_f32_32x32x16_bf16 v[160:175], a[160:163], v[196:199], v[160:175]
  ds_read_b64_tr_b16 v[212:213], v229 offset:45056
  v_cvt_pk_bf16_f32 v241, v18, v19
  s_waitcnt vmcnt(12)
  s_barrier
  v_mfma_f32_32x32x16_bf16 v[176:191], a[164:167], v[196:199], v[176:191]
  ds_read_b64_tr_b16 v[214:215], v229 offset:45568
  v_cvt_pk_bf16_f32 v242, v20, v21
  s_add_u32 m0, s39, 16384
  s_mov_b32 s41, 3145856
  s_waitcnt lgkmcnt(6)
  v_mfma_f32_32x32x16_bf16 v[128:143], a[168:171], v[200:203], v[128:143]
  ds_read_b64_tr_b16 v[216:217], v228 offset:47104
  buffer_load_dwordx4 v234, s[24:27], s41 offen offset:0 lds
  v_cvt_pk_bf16_f32 v243, v22, v23
  v_mfma_f32_32x32x16_bf16 v[144:159], a[172:175], v[200:203], v[144:159]
  ds_read_b64_tr_b16 v[218:219], v228 offset:47616
  s_waitcnt lgkmcnt(6)
  v_mfma_f32_32x32x16_bf16 v[160:175], a[168:171], v[204:207], v[160:175]
  ds_read_b64_tr_b16 v[220:221], v229 offset:47104
  buffer_load_dwordx4 v235, s[24:27], s41 offen offset:1024 lds
  buffer_store_dwordx4 v[240:243], v238, s[32:35], s61 offen offset:0 sc1
  v_mfma_f32_32x32x16_bf16 v[176:191], a[172:175], v[204:207], v[176:191]
  ds_read_b64_tr_b16 v[222:223], v229 offset:47616
  s_waitcnt lgkmcnt(6)
  v_mfma_f32_32x32x16_bf16 v[128:143], a[176:179], v[208:211], v[128:143]
  ds_read_b64_tr_b16 v[192:193], v228 offset:49152
  buffer_load_dwordx4 v236, s[24:27], s41 offen offset:2048 lds
  v_mfma_f32_32x32x16_bf16 v[144:159], a[180:183], v[208:211], v[144:159]
  ds_read_b64_tr_b16 v[194:195], v228 offset:49664
  v_cvt_pk_bf16_f32 v244, v24, v25
  v_or_b32_sdwa v244, v24, 1 dst_sel:WORD_0 dst_unused:UNUSED_PRESERVE src0_sel:WORD_1 src1_sel:DWORD
  s_waitcnt lgkmcnt(6)
  v_mfma_f32_32x32x16_bf16 v[160:175], a[176:179], v[212:215], v[160:175]
  ds_read_b64_tr_b16 v[196:197], v229 offset:49152
  buffer_load_dwordx4 v237, s[24:27], s41 offen offset:3072 lds
  v_cvt_pk_bf16_f32 v245, v26, v27
  v_mfma_f32_32x32x16_bf16 v[176:191], a[180:183], v[212:215], v[176:191]
  ds_read_b64_tr_b16 v[198:199], v229 offset:49664
  v_cvt_pk_bf16_f32 v246, v28, v29
  s_waitcnt lgkmcnt(6)
  v_mfma_f32_32x32x16_bf16 v[128:143], a[184:187], v[216:219], v[128:143]
  ds_read_b64_tr_b16 v[200:201], v228 offset:51200
  v_cvt_pk_bf16_f32 v247, v30, v31
  v_mfma_f32_32x32x16_bf16 v[144:159], a[188:191], v[216:219], v[144:159]
  ds_read_b64_tr_b16 v[202:203], v228 offset:51712
  s_waitcnt lgkmcnt(6)
  v_mfma_f32_32x32x16_bf16 v[160:175], a[184:187], v[220:223], v[160:175]
  ds_read_b64_tr_b16 v[204:205], v229 offset:51200
  buffer_store_dwordx4 v[244:247], v238, s[32:35], s61 offen offset:1024 sc1
  v_mfma_f32_32x32x16_bf16 v[176:191], a[188:191], v[220:223], v[176:191]
  ds_read_b64_tr_b16 v[206:207], v229 offset:51712
  s_waitcnt lgkmcnt(6)
  v_mfma_f32_32x32x16_bf16 v[128:143], a[192:195], v[192:195], v[128:143]
  ds_read_b64_tr_b16 v[208:209], v228 offset:53248
  v_mfma_f32_32x32x16_bf16 v[144:159], a[196:199], v[192:195], v[144:159]
  ds_read_b64_tr_b16 v[210:211], v228 offset:53760
  v_cvt_pk_bf16_f32 v240, v32, v33
  v_or_b32_sdwa v240, v32, 1 dst_sel:WORD_0 dst_unused:UNUSED_PRESERVE src0_sel:WORD_1 src1_sel:DWORD
  s_waitcnt lgkmcnt(6)
  v_mfma_f32_32x32x16_bf16 v[160:175], a[192:195], v[196:199], v[160:175]
  ds_read_b64_tr_b16 v[212:213], v229 offset:53248
  v_cvt_pk_bf16_f32 v241, v34, v35
  v_mfma_f32_32x32x16_bf16 v[176:191], a[196:199], v[196:199], v[176:191]
  ds_read_b64_tr_b16 v[214:215], v229 offset:53760
  v_cvt_pk_bf16_f32 v242, v36, v37
  s_waitcnt lgkmcnt(6)
  v_mfma_f32_32x32x16_bf16 v[128:143], a[200:203], v[200:203], v[128:143]
  ds_read_b64_tr_b16 v[216:217], v228 offset:55296
  v_cvt_pk_bf16_f32 v243, v38, v39
  v_mfma_f32_32x32x16_bf16 v[144:159], a[204:207], v[200:203], v[144:159]
  ds_read_b64_tr_b16 v[218:219], v228 offset:55808
  s_waitcnt lgkmcnt(6)
  v_mfma_f32_32x32x16_bf16 v[160:175], a[200:203], v[204:207], v[160:175]
  ds_read_b64_tr_b16 v[220:221], v229 offset:55296
  buffer_store_dwordx4 v[240:243], v238, s[32:35], 0 offen offset:2048 sc1
  v_mfma_f32_32x32x16_bf16 v[176:191], a[204:207], v[204:207], v[176:191]
  ds_read_b64_tr_b16 v[222:223], v229 offset:55808
  s_waitcnt lgkmcnt(6)
  v_mfma_f32_32x32x16_bf16 v[128:143], a[208:211], v[208:211], v[128:143]
  ds_read_b64_tr_b16 v[192:193], v228 offset:57344
  v_mfma_f32_32x32x16_bf16 v[144:159], a[212:215], v[208:211], v[144:159]
  ds_read_b64_tr_b16 v[194:195], v228 offset:57856
  v_cvt_pk_bf16_f32 v244, v40, v41
  v_or_b32_sdwa v244, v40, 1 dst_sel:WORD_0 dst_unused:UNUSED_PRESERVE src0_sel:WORD_1 src1_sel:DWORD
  s_waitcnt lgkmcnt(6)
  v_mfma_f32_32x32x16_bf16 v[160:175], a[208:211], v[212:215], v[160:175]
  ds_read_b64_tr_b16 v[196:197], v229 offset:57344
  v_cvt_pk_bf16_f32 v245, v42, v43
  v_mfma_f32_32x32x16_bf16 v[176:191], a[212:215], v[212:215], v[176:191]
  ds_read_b64_tr_b16 v[198:199], v229 offset:57856
  v_cvt_pk_bf16_f32 v246, v44, v45
  s_waitcnt lgkmcnt(6)
  v_mfma_f32_32x32x16_bf16 v[128:143], a[216:219], v[216:219], v[128:143]
  ds_read_b64_tr_b16 v[200:201], v228 offset:59392
  v_cvt_pk_bf16_f32 v247, v46, v47
  v_mfma_f32_32x32x16_bf16 v[144:159], a[220:223], v[216:219], v[144:159]
  ds_read_b64_tr_b16 v[202:203], v228 offset:59904
  s_waitcnt lgkmcnt(6)
  v_mfma_f32_32x32x16_bf16 v[160:175], a[216:219], v[220:223], v[160:175]
  ds_read_b64_tr_b16 v[204:205], v229 offset:59392
  buffer_store_dwordx4 v[244:247], v238, s[32:35], 0 offen offset:3072 sc1
  v_mfma_f32_32x32x16_bf16 v[176:191], a[220:223], v[220:223], v[176:191]
  ds_read_b64_tr_b16 v[206:207], v229 offset:59904
  s_waitcnt lgkmcnt(6)
  v_mfma_f32_32x32x16_bf16 v[128:143], a[224:227], v[192:195], v[128:143]
  ds_read_b64_tr_b16 v[208:209], v228 offset:61440
  v_mfma_f32_32x32x16_bf16 v[144:159], a[228:231], v[192:195], v[144:159]
  ds_read_b64_tr_b16 v[210:211], v228 offset:61952
  v_cvt_pk_bf16_f32 v240, v48, v49
  v_or_b32_sdwa v240, v48, 1 dst_sel:WORD_0 dst_unused:UNUSED_PRESERVE src0_sel:WORD_1 src1_sel:DWORD
  s_waitcnt lgkmcnt(6)
  v_mfma_f32_32x32x16_bf16 v[160:175], a[224:227], v[196:199], v[160:175]
  ds_read_b64_tr_b16 v[212:213], v229 offset:61440
  v_cvt_pk_bf16_f32 v241, v50, v51
  s_waitcnt vmcnt(11)
  s_barrier
  v_mfma_f32_32x32x16_bf16 v[176:191], a[228:231], v[196:199], v[176:191]
  ds_read_b64_tr_b16 v[214:215], v229 offset:61952
  v_cvt_pk_bf16_f32 v242, v52, v53
  s_add_u32 m0, s39, 32768
  s_mov_b32 s41, 128
  s_waitcnt lgkmcnt(6)
  v_mfma_f32_32x32x16_bf16 v[128:143], a[232:235], v[200:203], v[128:143]
  ds_read_b64_tr_b16 v[216:217], v228 offset:63488
  buffer_load_dwordx4 v234, s[24:27], s41 offen offset:0 lds
  v_cvt_pk_bf16_f32 v243, v54, v55
  v_mfma_f32_32x32x16_bf16 v[144:159], a[236:239], v[200:203], v[144:159]
  ds_read_b64_tr_b16 v[218:219], v228 offset:64000
  s_waitcnt lgkmcnt(6)
  v_mfma_f32_32x32x16_bf16 v[160:175], a[232:235], v[204:207], v[160:175]
  ds_read_b64_tr_b16 v[220:221], v229 offset:63488
  buffer_load_dwordx4 v235, s[24:27], s41 offen offset:1024 lds
  buffer_store_dwordx4 v[240:243], v238, s[32:35], s61 offen offset:2048 sc1
  v_mfma_f32_32x32x16_bf16 v[176:191], a[236:239], v[204:207], v[176:191]
  ds_read_b64_tr_b16 v[222:223], v229 offset:64000
  s_waitcnt lgkmcnt(6)
  v_mfma_f32_32x32x16_bf16 v[128:143], a[240:243], v[208:211], v[128:143]
  ds_read_b64_tr_b16 v[192:193], v228 offset:0
  buffer_load_dwordx4 v236, s[24:27], s41 offen offset:2048 lds
  v_mfma_f32_32x32x16_bf16 v[144:159], a[244:247], v[208:211], v[144:159]
  ds_read_b64_tr_b16 v[194:195], v228 offset:512
  v_cvt_pk_bf16_f32 v244, v56, v57
  v_or_b32_sdwa v244, v56, 1 dst_sel:WORD_0 dst_unused:UNUSED_PRESERVE src0_sel:WORD_1 src1_sel:DWORD
  s_waitcnt lgkmcnt(6)
  v_mfma_f32_32x32x16_bf16 v[160:175], a[240:243], v[212:215], v[160:175]
  ds_read_b64_tr_b16 v[196:197], v229 offset:0
  buffer_load_dwordx4 v237, s[24:27], s41 offen offset:3072 lds
  v_cvt_pk_bf16_f32 v245, v58, v59
  v_mfma_f32_32x32x16_bf16 v[176:191], a[244:247], v[212:215], v[176:191]
  ds_read_b64_tr_b16 v[198:199], v229 offset:512
  v_cvt_pk_bf16_f32 v246, v60, v61
  s_waitcnt lgkmcnt(6)
  v_mfma_f32_32x32x16_bf16 v[128:143], a[248:251], v[216:219], v[128:143]
  ds_read_b64_tr_b16 v[200:201], v228 offset:2048
  v_cvt_pk_bf16_f32 v247, v62, v63
  v_mfma_f32_32x32x16_bf16 v[144:159], a[252:255], v[216:219], v[144:159]
  ds_read_b64_tr_b16 v[202:203], v228 offset:2560
  s_waitcnt lgkmcnt(6)
  v_mfma_f32_32x32x16_bf16 v[160:175], a[248:251], v[220:223], v[160:175]
  ds_read_b64_tr_b16 v[204:205], v229 offset:2048
  buffer_store_dwordx4 v[244:247], v238, s[32:35], s61 offen offset:3072 sc1
  v_mfma_f32_32x32x16_bf16 v[176:191], a[252:255], v[220:223], v[176:191]
  ds_read_b64_tr_b16 v[206:207], v229 offset:2560
  s_waitcnt lgkmcnt(6)
  v_mfma_f32_32x32x16_bf16 v[0:15], a[128:131], v[192:195], 0
  ds_read_b64_tr_b16 v[208:209], v228 offset:4096
  v_mfma_f32_32x32x16_bf16 v[16:31], a[132:135], v[192:195], 0
  ds_read_b64_tr_b16 v[210:211], v228 offset:4608
  v_cvt_pk_bf16_f32 v112, v128, v129
  v_or_b32_sdwa v112, v128, 1 dst_sel:WORD_0 dst_unused:UNUSED_PRESERVE src0_sel:WORD_1 src1_sel:DWORD
  s_waitcnt lgkmcnt(6)
  v_mfma_f32_32x32x16_bf16 v[32:47], a[128:131], v[196:199], 0
  ds_read_b64_tr_b16 v[212:213], v229 offset:4096
  v_cvt_pk_bf16_f32 v113, v130, v131
  buffer_load_dword v67, v66, s[8:11], 0 offen sc1
  v_mfma_f32_32x32x16_bf16 v[48:63], a[132:135], v[196:199], 0
  ds_read_b64_tr_b16 v[214:215], v229 offset:4608
  v_cvt_pk_bf16_f32 v114, v132, v133
  s_waitcnt lgkmcnt(6)
  v_mfma_f32_32x32x16_bf16 v[0:15], a[136:139], v[200:203], v[0:15]
  ds_read_b64_tr_b16 v[216:217], v228 offset:6144
  v_cvt_pk_bf16_f32 v115, v134, v135
  v_mfma_f32_32x32x16_bf16 v[16:31], a[140:143], v[200:203], v[16:31]
  ds_read_b64_tr_b16 v[218:219], v228 offset:6656
  s_waitcnt lgkmcnt(6)
  v_mfma_f32_32x32x16_bf16 v[32:47], a[136:139], v[204:207], v[32:47]
  ds_read_b64_tr_b16 v[220:221], v229 offset:6144
  buffer_store_dwordx4 v[112:115], v238, s[32:35], s63 offen offset:0 sc1
  v_mfma_f32_32x32x16_bf16 v[48:63], a[140:143], v[204:207], v[48:63]
  ds_read_b64_tr_b16 v[222:223], v229 offset:6656
  s_waitcnt lgkmcnt(6)
  v_mfma_f32_32x32x16_bf16 v[0:15], a[144:147], v[208:211], v[0:15]
  ds_read_b64_tr_b16 v[192:193], v228 offset:8192
  v_mfma_f32_32x32x16_bf16 v[16:31], a[148:151], v[208:211], v[16:31]
  ds_read_b64_tr_b16 v[194:195], v228 offset:8704
  s_waitcnt lgkmcnt(6)
  v_mfma_f32_32x32x16_bf16 v[32:47], a[144:147], v[212:215], v[32:47]
  ds_read_b64_tr_b16 v[196:197], v229 offset:8192
  v_mfma_f32_32x32x16_bf16 v[48:63], a[148:151], v[212:215], v[48:63]
  ds_read_b64_tr_b16 v[198:199], v229 offset:8704
  s_waitcnt lgkmcnt(6)
  v_mfma_f32_32x32x16_bf16 v[0:15], a[152:155], v[216:219], v[0:15]
  ds_read_b64_tr_b16 v[200:201], v228 offset:10240
  v_mfma_f32_32x32x16_bf16 v[16:31], a[156:159], v[216:219], v[16:31]
  ds_read_b64_tr_b16 v[202:203], v228 offset:10752
  s_waitcnt lgkmcnt(6)
  v_mfma_f32_32x32x16_bf16 v[32:47], a[152:155], v[220:223], v[32:47]
  ds_read_b64_tr_b16 v[204:205], v229 offset:10240
  v_mfma_f32_32x32x16_bf16 v[48:63], a[156:159], v[220:223], v[48:63]
  ds_read_b64_tr_b16 v[206:207], v229 offset:10752
  v_cvt_pk_bf16_f32 v116, v136, v137
  v_or_b32_sdwa v116, v136, 1 dst_sel:WORD_0 dst_unused:UNUSED_PRESERVE src0_sel:WORD_1 src1_sel:DWORD
  s_waitcnt lgkmcnt(6)
  v_mfma_f32_32x32x16_bf16 v[0:15], a[160:163], v[192:195], v[0:15]
  ds_read_b64_tr_b16 v[208:209], v228 offset:12288
  v_cvt_pk_bf16_f32 v117, v138, v139
  v_mfma_f32_32x32x16_bf16 v[16:31], a[164:167], v[192:195], v[16:31]
  ds_read_b64_tr_b16 v[210:211], v228 offset:12800
  v_cvt_pk_bf16_f32 v118, v140, v141
  s_waitcnt lgkmcnt(6)
  v_mfma_f32_32x32x16_bf16 v[32:47], a[160:163], v[196:199], v[32:47]
  ds_read_b64_tr_b16 v[212:213], v229 offset:12288
  v_cvt_pk_bf16_f32 v119, v142, v143
  s_waitcnt vmcnt(11)
  s_barrier
  v_mfma_f32_32x32x16_bf16 v[48:63], a[164:167], v[196:199], v[48:63]
  ds_read_b64_tr_b16 v[214:215], v229 offset:12800
  s_add_u32 m0, s39, 49152
  s_mov_b32 s41, 1048704
  s_waitcnt lgkmcnt(6)
  v_mfma_f32_32x32x16_bf16 v[0:15], a[168:171], v[200:203], v[0:15]
  ds_read_b64_tr_b16 v[216:217], v228 offset:14336
  buffer_load_dwordx4 v234, s[24:27], s41 offen offset:0 lds
  buffer_store_dwordx4 v[116:119], v238, s[32:35], s63 offen offset:1024 sc1
  v_mfma_f32_32x32x16_bf16 v[16:31], a[172:175], v[200:203], v[16:31]
  ds_read_b64_tr_b16 v[218:219], v228 offset:14848
  s_waitcnt lgkmcnt(6)
  v_mfma_f32_32x32x16_bf16 v[32:47], a[168:171], v[204:207], v[32:47]
  ds_read_b64_tr_b16 v[220:221], v229 offset:14336
  buffer_load_dwordx4 v235, s[24:27], s41 offen offset:1024 lds
  v_mfma_f32_32x32x16_bf16 v[48:63], a[172:175], v[204:207], v[48:63]
  ds_read_b64_tr_b16 v[222:223], v229 offset:14848
  s_waitcnt lgkmcnt(6)
  v_mfma_f32_32x32x16_bf16 v[0:15], a[176:179], v[208:211], v[0:15]
  ds_read_b64_tr_b16 v[192:193], v228 offset:16384
  buffer_load_dwordx4 v236, s[24:27], s41 offen offset:2048 lds
  v_mfma_f32_32x32x16_bf16 v[16:31], a[180:183], v[208:211], v[16:31]
  ds_read_b64_tr_b16 v[194:195], v228 offset:16896
  s_waitcnt lgkmcnt(6)
  v_mfma_f32_32x32x16_bf16 v[32:47], a[176:179], v[212:215], v[32:47]
  ds_read_b64_tr_b16 v[196:197], v229 offset:16384
  buffer_load_dwordx4 v237, s[24:27], s41 offen offset:3072 lds
  v_mfma_f32_32x32x16_bf16 v[48:63], a[180:183], v[212:215], v[48:63]
  ds_read_b64_tr_b16 v[198:199], v229 offset:16896
  s_waitcnt lgkmcnt(6)
  v_mfma_f32_32x32x16_bf16 v[0:15], a[184:187], v[216:219], v[0:15]
  ds_read_b64_tr_b16 v[200:201], v228 offset:18432
  v_mfma_f32_32x32x16_bf16 v[16:31], a[188:191], v[216:219], v[16:31]
  ds_read_b64_tr_b16 v[202:203], v228 offset:18944
  v_cvt_pk_bf16_f32 v112, v144, v145
  v_or_b32_sdwa v112, v144, 1 dst_sel:WORD_0 dst_unused:UNUSED_PRESERVE src0_sel:WORD_1 src1_sel:DWORD
  s_waitcnt lgkmcnt(6)
  v_mfma_f32_32x32x16_bf16 v[32:47], a[184:187], v[220:223], v[32:47]
  ds_read_b64_tr_b16 v[204:205], v229 offset:18432
  v_cvt_pk_bf16_f32 v113, v146, v147
  v_mfma_f32_32x32x16_bf16 v[48:63], a[188:191], v[220:223], v[48:63]
  ds_read_b64_tr_b16 v[206:207], v229 offset:18944
  v_cvt_pk_bf16_f32 v114, v148, v149
  s_waitcnt lgkmcnt(6)
  v_mfma_f32_32x32x16_bf16 v[0:15], a[192:195], v[192:195], v[0:15]
  ds_read_b64_tr_b16 v[208:209], v228 offset:20480
  v_and_b32 v224, 63, v255
  s_and_b32 s48, s2, 7
  s_lshr_b32 s49, s2, 3
  s_lshl_b32 s37, s48, 2
  v_cvt_pk_bf16_f32 v115, v150, v151
  v_mfma_f32_32x32x16_bf16 v[16:31], a[196:199], v[192:195], v[16:31]
  ds_read_b64_tr_b16 v[210:211], v228 offset:20992
  s_and_b32 s50, s49, 3
  s_add_u32 s37, s37, s50
  s_lshr_b32 s38, s49, 2
  s_lshl_b32 s39, s36, 12
  s_add_u32 s39, s39, 98304
  s_waitcnt lgkmcnt(6)
  v_mfma_f32_32x32x16_bf16 v[32:47], a[192:195], v[196:199], v[32:47]
  ds_read_b64_tr_b16 v[212:213], v229 offset:20480
  buffer_store_dwordx4 v[112:115], v238, s[32:35], s63 offen offset:2048 sc1
  s_lshl_b32 s41, s36, 13
  s_movk_i32 s42, 4096
  s_mov_b32 s43, 32768
  s_lshl_b32 s50, s37, 8
  v_mfma_f32_32x32x16_bf16 v[48:63], a[196:199], v[196:199], v[48:63]
  ds_read_b64_tr_b16 v[214:215], v229 offset:20992
  s_lshl_b32 s51, s36, 17
  s_add_u32 s51, s51, s50
  v_lshrrev_b32 v232, 4, v224
  v_lshlrev_b32 v230, 13, v232
  v_add_u32 v230, s51, v230
  s_waitcnt lgkmcnt(6)
  v_mfma_f32_32x32x16_bf16 v[0:15], a[200:203], v[200:203], v[0:15]
  ds_read_b64_tr_b16 v[216:217], v228 offset:22528
  v_and_b32 v231, 15, v224
  v_lshlrev_b32 v233, 2, v232
  v_xor_b32 v231, v231, v233
  v_lshlrev_b32 v231, 4, v231
  v_add_u32 v244, v230, v231
  v_mfma_f32_32x32x16_bf16 v[16:31], a[204:207], v[200:203], v[16:31]
  ds_read_b64_tr_b16 v[218:219], v228 offset:23040
  v_add_u32 v245, 31744, v244
  v_add_u32 v246, 63488, v244
  v_add_u32 v247, 95232, v244
  s_lshl_b32 s50, s38, 2
  s_add_u32 s51, s50, s36
  s_waitcnt lgkmcnt(6)
  v_mfma_f32_32x32x16_bf16 v[32:47], a[200:203], v[204:207], v[32:47]
  ds_read_b64_tr_b16 v[220:221], v229 offset:22528
  s_sub_u32 s52, 60, s50
  s_add_u32 s52, s52, s36
  s_mul_i32 s53, s51, 36864
  s_mul_i32 s54, s52, 36864
  v_lshlrev_b32 v230, 4, v224
  v_mfma_f32_32x32x16_bf16 v[48:63], a[204:207], v[204:207], v[48:63]
  ds_read_b64_tr_b16 v[222:223], v229 offset:23040
  v_add_u32 v248, s53, v230
  v_add_u32 v249, s54, v230
  s_mov_b32 s16, s4
  s_mov_b32 s17, s5
  s_mov_b32 s18, 4718592
  s_waitcnt lgkmcnt(6)
  v_mfma_f32_32x32x16_bf16 v[0:15], a[208:211], v[208:211], v[0:15]
  ds_read_b64_tr_b16 v[192:193], v228 offset:24576
  s_mov_b32 s19, 0x00020000
  s_add_u32 s20, s6, 33554432
  s_addc_u32 s21, s7, 0
  s_mov_b32 s22, 2359296
  s_mov_b32 s23, 0x00020000
  v_mfma_f32_32x32x16_bf16 v[16:31], a[212:215], v[208:211], v[16:31]
  ds_read_b64_tr_b16 v[194:195], v228 offset:25088
  s_lshl_b32 s50, s37, 20
  s_add_u32 s24, s6, s50
  s_addc_u32 s25, s7, 0
  s_lshl_b32 s50, s38, 16
  s_sub_u32 s26, 1048576, s50
  s_waitcnt lgkmcnt(6)
  v_mfma_f32_32x32x16_bf16 v[32:47], a[208:211], v[212:215], v[32:47]
  ds_read_b64_tr_b16 v[196:197], v229 offset:24576
  s_mov_b32 s27, 0x00020000
  s_add_u32 s28, s6, 37748736
  s_addc_u32 s29, s7, 0
  s_mov_b32 s30, 16777216
  s_mov_b32 s31, 0x00020000
  v_mfma_f32_32x32x16_bf16 v[48:63], a[212:215], v[212:215], v[48:63]
  ds_read_b64_tr_b16 v[198:199], v229 offset:25088
  v_cvt_pk_bf16_f32 v116, v152, v153
  v_or_b32_sdwa v116, v152, 1 dst_sel:WORD_0 dst_unused:UNUSED_PRESERVE src0_sel:WORD_1 src1_sel:DWORD
  s_waitcnt lgkmcnt(6)
  v_mfma_f32_32x32x16_bf16 v[0:15], a[216:219], v[216:219], v[0:15]
  ds_read_b64_tr_b16 v[200:201], v228 offset:26624
  v_cvt_pk_bf16_f32 v117, v154, v155
  v_mfma_f32_32x32x16_bf16 v[16:31], a[220:223], v[216:219], v[16:31]
  ds_read_b64_tr_b16 v[202:203], v228 offset:27136
  v_cvt_pk_bf16_f32 v118, v156, v157
  s_waitcnt lgkmcnt(6)
  v_mfma_f32_32x32x16_bf16 v[32:47], a[216:219], v[220:223], v[32:47]
  ds_read_b64_tr_b16 v[204:205], v229 offset:26624
  v_cvt_pk_bf16_f32 v119, v158, v159
  v_mfma_f32_32x32x16_bf16 v[48:63], a[220:223], v[220:223], v[48:63]
  ds_read_b64_tr_b16 v[206:207], v229 offset:27136
  s_waitcnt lgkmcnt(6)
  v_mfma_f32_32x32x16_bf16 v[0:15], a[224:227], v[192:195], v[0:15]
  ds_read_b64_tr_b16 v[208:209], v228 offset:28672
  buffer_store_dwordx4 v[116:119], v238, s[32:35], s63 offen offset:3072 sc1
  s_waitcnt vmcnt(8)
  v_and_b32 v67, 0x01010101, v67
  v_cmp_ne_u32 vcc, 0x01010101, v67
  s_nop 3
  s_and_b64 vcc, vcc, s[68:69]
  s_cbranch_scc1 K12_XS
K12_XB:
  v_mfma_f32_32x32x16_bf16 v[16:31], a[228:231], v[192:195], v[16:31]
  ds_read_b64_tr_b16 v[210:211], v228 offset:29184
  s_waitcnt lgkmcnt(6)
  v_mfma_f32_32x32x16_bf16 v[32:47], a[224:227], v[196:199], v[32:47]
  ds_read_b64_tr_b16 v[212:213], v229 offset:28672
  s_barrier
  v_mfma_f32_32x32x16_bf16 v[48:63], a[228:231], v[196:199], v[48:63]
  ds_read_b64_tr_b16 v[214:215], v229 offset:29184
  s_mov_b32 s84, s76
  s_mov_b32 s85, s77
  s_mov_b32 s86, s78
  s_add_u32 m0, s39, 0
  s_mov_b32 s40, 0
  s_waitcnt lgkmcnt(6)
  v_mfma_f32_32x32x16_bf16 v[0:15], a[232:235], v[200:203], v[0:15]
  ds_read_b64_tr_b16 v[216:217], v228 offset:30720
  buffer_load_dwordx4 v244, s[16:19], s40 offen offset:0 lds
  s_mov_b32 s87, s79
  s_lshl_b32 s48, s2, 2
  s_add_u32 s48, s48, s36
  s_movk_i32 s56, 0
  v_mfma_f32_32x32x16_bf16 v[16:31], a[236:239], v[200:203], v[16:31]
  ds_read_b64_tr_b16 v[218:219], v228 offset:31232
  buffer_load_dwordx4 a[128:131], v248, s[20:23], s56 offen offset:0
  s_mul_i32 s49, s48, 3641
  s_lshr_b32 s49, s49, 16
  s_mul_i32 s50, s49, 18
  s_sub_u32 s50, s48, s50
  s_waitcnt lgkmcnt(6)
  v_mfma_f32_32x32x16_bf16 v[32:47], a[232:235], v[204:207], v[32:47]
  ds_read_b64_tr_b16 v[220:221], v229 offset:30720
  buffer_load_dwordx4 v245, s[16:19], s40 offen offset:1024 lds
  s_mul_i32 s50, s50, 294912
  s_lshr_b32 s51, s49, 2
  s_mul_i32 s51, s51, 1152
  s_add_u32 s50, s50, s51
  v_mfma_f32_32x32x16_bf16 v[48:63], a[236:239], v[204:207], v[48:63]
  ds_read_b64_tr_b16 v[222:223], v229 offset:31232
  buffer_load_dwordx4 a[132:135], v249, s[20:23], s56 offen offset:0
  s_and_b32 s51, s49, 3
  s_lshl_b32 s51, s51, 5
  s_add_u32 s50, s50, s51
  s_add_u32 s50, s50, 1024
  s_waitcnt lgkmcnt(6)
  v_mfma_f32_32x32x16_bf16 v[0:15], a[240:243], v[208:211], v[0:15]
  ds_read_b64_tr_b16 v[192:193], v228 offset:32768
  buffer_load_dwordx4 v246, s[16:19], s40 offen offset:2048 lds
  s_lshl_b32 s51, s48, 11
  s_cmp_lt_u32 s48, 576
  s_cselect_b32 s50, s50, 0x7f000000
  s_cselect_b32 s51, s51, 0x7f000000
  v_mfma_f32_32x32x16_bf16 v[16:31], a[244:247], v[208:211], v[16:31]
  ds_read_b64_tr_b16 v[194:195], v228 offset:33280
  buffer_load_dwordx4 a[136:139], v248, s[20:23], s56 offen offset:1024
  v_lshlrev_b32 v251, 4, v224
  v_add_u32 v251, s51, v251
  v_cvt_pk_bf16_f32 v112, v160, v161
  v_or_b32_sdwa v112, v160, 1 dst_sel:WORD_0 dst_unused:UNUSED_PRESERVE src0_sel:WORD_1 src1_sel:DWORD
  s_waitcnt lgkmcnt(6)
  v_mfma_f32_32x32x16_bf16 v[32:47], a[240:243], v[212:215], v[32:47]
  ds_read_b64_tr_b16 v[196:197], v229 offset:32768
  buffer_load_dwordx4 v247, s[16:19], s40 offen offset:3072 lds
  v_lshrrev_b32 v230, 1, v224
  v_and_b32 v231, 1, v224
  v_lshlrev_b32 v231, 4, v231
  v_cvt_pk_bf16_f32 v113, v162, v163
  v_mfma_f32_32x32x16_bf16 v[48:63], a[244:247], v[212:215], v[48:63]
  ds_read_b64_tr_b16 v[198:199], v229 offset:33280
  buffer_load_dwordx4 a[140:143], v249, s[20:23], s56 offen offset:1024
  v_add_u32 v231, s50, v231
  v_mul_u32_u24 v253, 9216, v230
  v_add_u32 v253, v253, v231
  v_cvt_pk_bf16_f32 v114, v164, v165
  s_waitcnt lgkmcnt(6)
  v_mfma_f32_32x32x16_bf16 v[0:15], a[248:251], v[216:219], v[0:15]
  ds_read_b64_tr_b16 v[200:201], v228 offset:34816
  v_xor_b32 v230, 4, v230
  v_mul_u32_u24 v254, 9216, v230
  v_add_u32 v254, v254, v231
  s_mov_b32 s88, s86
  v_cvt_pk_bf16_f32 v115, v166, v167
  v_mfma_f32_32x32x16_bf16 v[16:31], a[252:255], v[216:219], v[16:31]
  ds_read_b64_tr_b16 v[202:203], v228 offset:35328
  buffer_load_dwordx4 a[144:147], v248, s[20:23], s56 offen offset:2048
  s_mov_b32 s89, s87
  s_mov_b32 s86, 5308416
  s_mov_b32 s87, 0x00020000
  s_mov_b32 s90, 5308416
  s_waitcnt lgkmcnt(6)
  v_mfma_f32_32x32x16_bf16 v[32:47], a[248:251], v[220:223], v[32:47]
  ds_read_b64_tr_b16 v[204:205], v229 offset:34816
  buffer_store_dwordx4 v[112:115], v238, s[32:35], s64 offen offset:0 sc1
  buffer_load_dwordx4 a[148:151], v249, s[20:23], s56 offen offset:2048
  s_mov_b32 s91, 0x00020000
  s_add_u32 s92, s6, 62914560
  s_addc_u32 s93, s7, 0
  v_mfma_f32_32x32x16_bf16 v[48:63], a[252:255], v[220:223], v[48:63]
  ds_read_b64_tr_b16 v[206:207], v229 offset:35328
  buffer_load_dwordx4 a[152:155], v248, s[20:23], s56 offen offset:3072
  s_mov_b32 s94, 1179648
  s_mov_b32 s95, 0x00020000
  v_bfe_u32 v230, v224, 2, 2
  v_lshrrev_b32 v231, 5, v224
  s_waitcnt lgkmcnt(6)
  v_mfma_f32_32x32x16_bf16 v[0:15], a[0:3], v[192:195], v[0:15]
  ds_read_b64_tr_b16 v[208:209], v228 offset:36864
  buffer_load_dwordx4 a[156:159], v249, s[20:23], s56 offen offset:3072
  v_lshl_add_u32 v231, v231, 3, v230
  v_bfe_u32 v232, v224, 4, 1
  v_lshlrev_b32 v232, 5, v232
  v_and_b32 v233, 3, v224
  v_mfma_f32_32x32x16_bf16 v[16:31], a[4:7], v[192:195], v[16:31]
  ds_read_b64_tr_b16 v[210:211], v228 offset:37376
  v_lshl_add_u32 v232, v233, 3, v232
  v_lshl_add_u32 v233, v231, 8, v232
  v_add_u32 v233, 98304, v233
  v_xor_b32 v240, 0, v230
  v_lshl_add_u32 v240, v240, 6, v233
  s_waitcnt lgkmcnt(6)
  v_mfma_f32_32x32x16_bf16 v[32:47], a[0:3], v[196:199], v[32:47]
  ds_read_b64_tr_b16 v[212:213], v229 offset:36864
  v_xor_b32 v241, 1, v230
  v_lshl_add_u32 v241, v241, 6, v233
  v_xor_b32 v242, 2, v230
  v_lshl_add_u32 v242, v242, 6, v233
  v_xor_b32 v243, 3, v230
  v_mfma_f32_32x32x16_bf16 v[48:63], a[4:7], v[196:199], v[48:63]
  ds_read_b64_tr_b16 v[214:215], v229 offset:37376
  v_lshl_add_u32 v243, v243, 6, v233
  s_and_b32 s48, s37, 3
  s_waitcnt lgkmcnt(6)
  v_mfma_f32_32x32x16_bf16 v[0:15], a[8:11], v[200:203], v[0:15]
  ds_read_b64_tr_b16 v[216:217], v228 offset:38912
  s_cmp_eq_u32 s48, 0
  s_cselect_b32 s80, s72, s74
  s_cselect_b32 s81, s73, s75
  s_mov_b32 s82, 5308416
  s_cselect_b32 s82, 4718592, s82
  v_mfma_f32_32x32x16_bf16 v[16:31], a[12:15], v[200:203], v[16:31]
  ds_read_b64_tr_b16 v[218:219], v228 offset:39424
  s_cmp_eq_u32 s48, 2
  s_cselect_b32 s80, s76, s80
  s_cselect_b32 s81, s77, s81
  s_waitcnt lgkmcnt(6)
  v_mfma_f32_32x32x16_bf16 v[32:47], a[8:11], v[204:207], v[32:47]
  ds_read_b64_tr_b16 v[220:221], v229 offset:38912
  s_cmp_eq_u32 s48, 3
  s_cselect_b32 s80, s78, s80
  s_cselect_b32 s81, s79, s81
  s_mov_b32 s83, 0x00020000
  s_lshr_b32 s48, s37, 2
  v_mfma_f32_32x32x16_bf16 v[48:63], a[12:15], v[204:207], v[48:63]
  ds_read_b64_tr_b16 v[222:223], v229 offset:39424
  s_mul_i32 s48, s48, 3
  s_add_u32 s48, s48, s38
  s_sub_u32 s48, s48, 5
  v_cvt_pk_bf16_f32 v116, v168, v169
  v_or_b32_sdwa v116, v168, 1 dst_sel:WORD_0 dst_unused:UNUSED_PRESERVE src0_sel:WORD_1 src1_sel:DWORD
  s_waitcnt lgkmcnt(6)
  v_mfma_f32_32x32x16_bf16 v[0:15], a[16:19], v[208:211], v[0:15]
  ds_read_b64_tr_b16 v[192:193], v228 offset:40960
  s_lshl_b32 s48, s48, 2
  s_add_u32 s48, s48, s36
  v_cvt_pk_bf16_f32 v117, v170, v171
  s_add_u32 m0, s39, 16384
  s_mov_b32 s40, 524288
  v_mfma_f32_32x32x16_bf16 v[16:31], a[20:23], v[208:211], v[16:31]
  ds_read_b64_tr_b16 v[194:195], v228 offset:41472
  buffer_load_dwordx4 v244, s[16:19], s40 offen offset:0 lds
  s_mul_i32 s48, s48, 4480
  v_cvt_pk_bf16_f32 v118, v172, v173
  s_movk_i32 s56, 4096
  s_waitcnt lgkmcnt(6)
  v_mfma_f32_32x32x16_bf16 v[32:47], a[16:19], v[212:215], v[32:47]
  ds_read_b64_tr_b16 v[196:197], v229 offset:40960
  buffer_load_dwordx4 a[160:163], v248, s[20:23], s56 offen offset:0
  s_cmp_lt_u32 s38, 5
  s_cselect_b32 s48, 0x7f000000, s48
  v_lshlrev_b32 v250, 7, v224
  v_cvt_pk_bf16_f32 v119, v174, v175
  v_mfma_f32_32x32x16_bf16 v[48:63], a[20:23], v[212:215], v[48:63]
  ds_read_b64_tr_b16 v[198:199], v229 offset:41472
  buffer_load_dwordx4 v245, s[16:19], s40 offen offset:1024 lds
  v_add_u32 v250, s48, v250
  v_mov_b32 v252, 0x7f000000
  v_cmp_gt_u32 vcc, 35, v224
  s_nop 1
  v_cndmask_b32 v250, v252, v250, vcc
  s_waitcnt lgkmcnt(6)
  v_mfma_f32_32x32x16_bf16 v[0:15], a[24:27], v[216:219], v[0:15]
  ds_read_b64_tr_b16 v[200:201], v228 offset:43008
  buffer_store_dwordx4 v[116:119], v238, s[32:35], s64 offen offset:1024 sc1
  buffer_load_dwordx4 a[164:167], v249, s[20:23], s56 offen offset:0
  v_cmp_eq_u32 vcc, 0, v255
  v_mov_b32 v236, 0x7f000000
  v_mov_b32 v237, s70
  v_mfma_f32_32x32x16_bf16 v[16:31], a[28:31], v[216:219], v[16:31]
  ds_read_b64_tr_b16 v[202:203], v228 offset:43520
  buffer_load_dwordx4 v246, s[16:19], s40 offen offset:2048 lds
  v_cndmask_b32 v236, v236, v237, vcc
  v_mov_b32 v237, 3
  s_waitcnt lgkmcnt(6)
  v_mfma_f32_32x32x16_bf16 v[32:47], a[24:27], v[220:223], v[32:47]
  ds_read_b64_tr_b16 v[204:205], v229 offset:43008
  buffer_load_dwordx4 a[168:171], v248, s[20:23], s56 offen offset:1024
  v_mfma_f32_32x32x16_bf16 v[48:63], a[28:31], v[220:223], v[48:63]
  ds_read_b64_tr_b16 v[206:207], v229 offset:43520
  buffer_load_dwordx4 v247, s[16:19], s40 offen offset:3072 lds
  s_waitcnt lgkmcnt(6)
  v_mfma_f32_32x32x16_bf16 v[0:15], a[32:35], v[192:195], v[0:15]
  ds_read_b64_tr_b16 v[208:209], v228 offset:45056
  buffer_load_dwordx4 a[172:175], v249, s[20:23], s56 offen offset:1024
  v_mfma_f32_32x32x16_bf16 v[16:31], a[36:39], v[192:195], v[16:31]
  ds_read_b64_tr_b16 v[210:211], v228 offset:45568
  s_waitcnt lgkmcnt(6)
  v_mfma_f32_32x32x16_bf16 v[32:47], a[32:35], v[196:199], v[32:47]
  ds_read_b64_tr_b16 v[212:213], v229 offset:45056
  buffer_load_dwordx4 a[176:179], v248, s[20:23], s56 offen offset:2048
  s_waitcnt vmcnt(25)
  s_barrier
  v_mfma_f32_32x32x16_bf16 v[48:63], a[36:39], v[196:199], v[48:63]
  ds_read_b64_tr_b16 v[214:215], v229 offset:45568
  buffer_load_dwordx4 a[180:183], v249, s[20:23], s56 offen offset:2048
  s_waitcnt lgkmcnt(6)
  v_mfma_f32_32x32x16_bf16 v[0:15], a[40:43], v[200:203], v[0:15]
  ds_read_b64_tr_b16 v[216:217], v228 offset:47104
  buffer_load_dwordx4 a[184:187], v248, s[20:23], s56 offen offset:3072
  v_mfma_f32_32x32x16_bf16 v[16:31], a[44:47], v[200:203], v[16:31]
  ds_read_b64_tr_b16 v[218:219], v228 offset:47616
  buffer_load_dwordx4 a[188:191], v249, s[20:23], s56 offen offset:3072
  v_cvt_pk_bf16_f32 v112, v176, v177
  v_or_b32_sdwa v112, v176, 1 dst_sel:WORD_0 dst_unused:UNUSED_PRESERVE src0_sel:WORD_1 src1_sel:DWORD
  s_waitcnt lgkmcnt(6)
  v_mfma_f32_32x32x16_bf16 v[32:47], a[40:43], v[204:207], v[32:47]
  ds_read_b64_tr_b16 v[220:221], v229 offset:47104
  v_cvt_pk_bf16_f32 v113, v178, v179
  v_mfma_f32_32x32x16_bf16 v[48:63], a[44:47], v[204:207], v[48:63]
  ds_read_b64_tr_b16 v[222:223], v229 offset:47616
  v_cvt_pk_bf16_f32 v114, v180, v181
  s_waitcnt lgkmcnt(6)
  v_mfma_f32_32x32x16_bf16 v[0:15], a[48:51], v[208:211], v[0:15]
  ds_read_b64_tr_b16 v[192:193], v228 offset:49152
  v_cvt_pk_bf16_f32 v115, v182, v183
  v_mfma_f32_32x32x16_bf16 v[16:31], a[52:55], v[208:211], v[16:31]
  ds_read_b64_tr_b16 v[194:195], v228 offset:49664
  s_waitcnt lgkmcnt(6)
  v_mfma_f32_32x32x16_bf16 v[32:47], a[48:51], v[212:215], v[32:47]
  ds_read_b64_tr_b16 v[196:197], v229 offset:49152
  buffer_store_dwordx4 v[112:115], v238, s[32:35], s64 offen offset:2048 sc1
  v_mfma_f32_32x32x16_bf16 v[48:63], a[52:55], v[212:215], v[48:63]
  ds_read_b64_tr_b16 v[198:199], v229 offset:49664
  s_waitcnt lgkmcnt(6)
  v_mfma_f32_32x32x16_bf16 v[0:15], a[56:59], v[216:219], v[0:15]
  ds_read_b64_tr_b16 v[200:201], v228 offset:51200
  v_mfma_f32_32x32x16_bf16 v[16:31], a[60:63], v[216:219], v[16:31]
  ds_read_b64_tr_b16 v[202:203], v228 offset:51712
  s_waitcnt lgkmcnt(6)
  v_mfma_f32_32x32x16_bf16 v[32:47], a[56:59], v[220:223], v[32:47]
  ds_read_b64_tr_b16 v[204:205], v229 offset:51200
  v_mfma_f32_32x32x16_bf16 v[48:63], a[60:63], v[220:223], v[48:63]
  ds_read_b64_tr_b16 v[206:207], v229 offset:51712
  s_waitcnt lgkmcnt(6)
  v_mfma_f32_32x32x16_bf16 v[0:15], a[64:67], v[192:195], v[0:15]
  ds_read_b64_tr_b16 v[208:209], v228 offset:53248
  v_mfma_f32_32x32x16_bf16 v[16:31], a[68:71], v[192:195], v[16:31]
  ds_read_b64_tr_b16 v[210:211], v228 offset:53760
  s_waitcnt lgkmcnt(6)
  v_mfma_f32_32x32x16_bf16 v[32:47], a[64:67], v[196:199], v[32:47]
  ds_read_b64_tr_b16 v[212:213], v229 offset:53248
  v_mfma_f32_32x32x16_bf16 v[48:63], a[68:71], v[196:199], v[48:63]
  ds_read_b64_tr_b16 v[214:215], v229 offset:53760
  v_cvt_pk_bf16_f32 v116, v184, v185
  v_or_b32_sdwa v116, v184, 1 dst_sel:WORD_0 dst_unused:UNUSED_PRESERVE src0_sel:WORD_1 src1_sel:DWORD
  s_waitcnt lgkmcnt(6)
  v_mfma_f32_32x32x16_bf16 v[0:15], a[72:75], v[200:203], v[0:15]
  ds_read_b64_tr_b16 v[216:217], v228 offset:55296
  v_cvt_pk_bf16_f32 v117, v186, v187
  v_mfma_f32_32x32x16_bf16 v[16:31], a[76:79], v[200:203], v[16:31]
  ds_read_b64_tr_b16 v[218:219], v228 offset:55808
  v_cvt_pk_bf16_f32 v118, v188, v189
  s_waitcnt lgkmcnt(6)
  v_mfma_f32_32x32x16_bf16 v[32:47], a[72:75], v[204:207], v[32:47]
  ds_read_b64_tr_b16 v[220:221], v229 offset:55296
  v_cvt_pk_bf16_f32 v119, v190, v191
  v_mfma_f32_32x32x16_bf16 v[48:63], a[76:79], v[204:207], v[48:63]
  ds_read_b64_tr_b16 v[222:223], v229 offset:55808
  s_waitcnt lgkmcnt(6)
  v_mfma_f32_32x32x16_bf16 v[0:15], a[80:83], v[208:211], v[0:15]
  ds_read_b64_tr_b16 v[192:193], v228 offset:57344
  buffer_store_dwordx4 v[116:119], v238, s[32:35], s64 offen offset:3072 sc1
  v_mfma_f32_32x32x16_bf16 v[16:31], a[84:87], v[208:211], v[16:31]
  ds_read_b64_tr_b16 v[194:195], v228 offset:57856
  s_waitcnt lgkmcnt(6)
  v_mfma_f32_32x32x16_bf16 v[32:47], a[80:83], v[212:215], v[32:47]
  ds_read_b64_tr_b16 v[196:197], v229 offset:57344
  v_mfma_f32_32x32x16_bf16 v[48:63], a[84:87], v[212:215], v[48:63]
  ds_read_b64_tr_b16 v[198:199], v229 offset:57856
  s_waitcnt lgkmcnt(6)
  v_mfma_f32_32x32x16_bf16 v[0:15], a[88:91], v[216:219], v[0:15]
  ds_read_b64_tr_b16 v[200:201], v228 offset:59392
  v_mfma_f32_32x32x16_bf16 v[16:31], a[92:95], v[216:219], v[16:31]
  ds_read_b64_tr_b16 v[202:203], v228 offset:59904
  s_waitcnt lgkmcnt(6)
  v_mfma_f32_32x32x16_bf16 v[32:47], a[88:91], v[220:223], v[32:47]
  ds_read_b64_tr_b16 v[204:205], v229 offset:59392
  v_mfma_f32_32x32x16_bf16 v[48:63], a[92:95], v[220:223], v[48:63]
  ds_read_b64_tr_b16 v[206:207], v229 offset:59904
  s_waitcnt lgkmcnt(6)
  v_mfma_f32_32x32x16_bf16 v[0:15], a[96:99], v[192:195], v[0:15]
  ds_read_b64_tr_b16 v[208:209], v228 offset:61440
  v_mfma_f32_32x32x16_bf16 v[16:31], a[100:103], v[192:195], v[16:31]
  ds_read_b64_tr_b16 v[210:211], v228 offset:61952
  s_waitcnt lgkmcnt(6)
  v_mfma_f32_32x32x16_bf16 v[32:47], a[96:99], v[196:199], v[32:47]
  ds_read_b64_tr_b16 v[212:213], v229 offset:61440
  v_mfma_f32_32x32x16_bf16 v[48:63], a[100:103], v[196:199], v[48:63]
  ds_read_b64_tr_b16 v[214:215], v229 offset:61952
  s_waitcnt lgkmcnt(6)
  v_mfma_f32_32x32x16_bf16 v[0:15], a[104:107], v[200:203], v[0:15]
  ds_read_b64_tr_b16 v[216:217], v228 offset:63488
  v_mfma_f32_32x32x16_bf16 v[16:31], a[108:111], v[200:203], v[16:31]
  ds_read_b64_tr_b16 v[218:219], v228 offset:64000
  s_waitcnt lgkmcnt(6)
  v_mfma_f32_32x32x16_bf16 v[32:47], a[104:107], v[204:207], v[32:47]
  ds_read_b64_tr_b16 v[220:221], v229 offset:63488
  v_mfma_f32_32x32x16_bf16 v[48:63], a[108:111], v[204:207], v[48:63]
  ds_read_b64_tr_b16 v[222:223], v229 offset:64000
  s_waitcnt lgkmcnt(6)
  v_mfma_f32_32x32x16_bf16 v[0:15], a[112:115], v[208:211], v[0:15]
  v_mfma_f32_32x32x16_bf16 v[16:31], a[116:119], v[208:211], v[16:31]
  s_waitcnt lgkmcnt(4)
  v_mfma_f32_32x32x16_bf16 v[32:47], a[112:115], v[212:215], v[32:47]
  v_mfma_f32_32x32x16_bf16 v[48:63], a[116:119], v[212:215], v[48:63]
  s_waitcnt lgkmcnt(2)
  v_mfma_f32_32x32x16_bf16 v[0:15], a[120:123], v[216:219], v[0:15]
  v_mfma_f32_32x32x16_bf16 v[16:31], a[124:127], v[216:219], v[16:31]
  s_waitcnt lgkmcnt(0)
  v_mfma_f32_32x32x16_bf16 v[32:47], a[120:123], v[220:223], v[32:47]
  v_mfma_f32_32x32x16_bf16 v[48:63], a[124:127], v[220:223], v[48:63]
  s_nop 7
  v_cvt_pk_bf16_f32 v112, v0, v1
  v_or_b32_sdwa v112, v0, 1 dst_sel:WORD_0 dst_unused:UNUSED_PRESERVE src0_sel:WORD_1 src1_sel:DWORD
  v_cvt_pk_bf16_f32 v113, v2, v3
  v_cvt_pk_bf16_f32 v114, v4, v5
  v_cvt_pk_bf16_f32 v115, v6, v7
  buffer_store_dwordx4 v[112:115], v238, s[32:35], s65 offen offset:0 sc1
  v_cvt_pk_bf16_f32 v116, v8, v9
  v_or_b32_sdwa v116, v8, 1 dst_sel:WORD_0 dst_unused:UNUSED_PRESERVE src0_sel:WORD_1 src1_sel:DWORD
  v_cvt_pk_bf16_f32 v117, v10, v11
  v_cvt_pk_bf16_f32 v118, v12, v13
  v_cvt_pk_bf16_f32 v119, v14, v15
  buffer_store_dwordx4 v[116:119], v238, s[32:35], s65 offen offset:1024 sc1
  v_cvt_pk_bf16_f32 v112, v16, v17
  v_or_b32_sdwa v112, v16, 1 dst_sel:WORD_0 dst_unused:UNUSED_PRESERVE src0_sel:WORD_1 src1_sel:DWORD
  v_cvt_pk_bf16_f32 v113, v18, v19
  v_cvt_pk_bf16_f32 v114, v20, v21
  v_cvt_pk_bf16_f32 v115, v22, v23
  buffer_store_dwordx4 v[112:115], v238, s[32:35], s65 offen offset:2048 sc1
  v_cvt_pk_bf16_f32 v116, v24, v25
  v_or_b32_sdwa v116, v24, 1 dst_sel:WORD_0 dst_unused:UNUSED_PRESERVE src0_sel:WORD_1 src1_sel:DWORD
  v_cvt_pk_bf16_f32 v117, v26, v27
  v_cvt_pk_bf16_f32 v118, v28, v29
  v_cvt_pk_bf16_f32 v119, v30, v31
  buffer_store_dwordx4 v[116:119], v238, s[32:35], s65 offen offset:3072 sc1
  v_cvt_pk_bf16_f32 v112, v32, v33
  v_or_b32_sdwa v112, v32, 1 dst_sel:WORD_0 dst_unused:UNUSED_PRESERVE src0_sel:WORD_1 src1_sel:DWORD
  v_cvt_pk_bf16_f32 v113, v34, v35
  v_cvt_pk_bf16_f32 v114, v36, v37
  v_cvt_pk_bf16_f32 v115, v38, v39
  buffer_store_dwordx4 v[112:115], v238, s[32:35], s66 offen offset:0 sc1
  v_cvt_pk_bf16_f32 v116, v40, v41
  v_or_b32_sdwa v116, v40, 1 dst_sel:WORD_0 dst_unused:UNUSED_PRESERVE src0_sel:WORD_1 src1_sel:DWORD
  v_cvt_pk_bf16_f32 v117, v42, v43
  v_cvt_pk_bf16_f32 v118, v44, v45
  v_cvt_pk_bf16_f32 v119, v46, v47
  buffer_store_dwordx4 v[116:119], v238, s[32:35], s66 offen offset:1024 sc1
  v_cvt_pk_bf16_f32 v112, v48, v49
  v_or_b32_sdwa v112, v48, 1 dst_sel:WORD_0 dst_unused:UNUSED_PRESERVE src0_sel:WORD_1 src1_sel:DWORD
  v_cvt_pk_bf16_f32 v113, v50, v51
  v_cvt_pk_bf16_f32 v114, v52, v53
  v_cvt_pk_bf16_f32 v115, v54, v55
  buffer_store_dwordx4 v[112:115], v238, s[32:35], s66 offen offset:2048 sc1
  v_cvt_pk_bf16_f32 v116, v56, v57
  v_or_b32_sdwa v116, v56, 1 dst_sel:WORD_0 dst_unused:UNUSED_PRESERVE src0_sel:WORD_1 src1_sel:DWORD
  v_cvt_pk_bf16_f32 v117, v58, v59
  v_cvt_pk_bf16_f32 v118, v60, v61
  v_cvt_pk_bf16_f32 v119, v62, v63
  buffer_store_dwordx4 v[116:119], v238, s[32:35], s66 offen offset:3072 sc1
  v_lshlrev_b32 v228, 4, v224
  v_add_u32 v229, s41, v228
  v_mov_b32 v227, v228
  s_waitcnt vmcnt(29)
  s_barrier
  ds_read_b64_tr_b16 v[192:193], v240 offset:0
  ds_read_b64_tr_b16 v[194:195], v240 offset:1024
  ds_read_b64_tr_b16 v[196:197], v241 offset:0
  ds_read_b64_tr_b16 v[198:199], v241 offset:1024
  ds_read_b64_tr_b16 v[200:201], v242 offset:0
  ds_read_b64_tr_b16 v[202:203], v242 offset:1024
  ds_read_b64_tr_b16 v[204:205], v243 offset:0
  ds_read_b64_tr_b16 v[206:207], v243 offset:1024
  s_waitcnt lgkmcnt(6)
  v_mfma_f32_32x32x16_bf16 v[64:79], v[192:195], a[128:131], 0
  ds_read_b64_tr_b16 v[208:209], v240 offset:4096
  v_mfma_f32_32x32x16_bf16 v[80:95], v[192:195], a[132:135], 0
  ds_read_b64_tr_b16 v[210:211], v240 offset:5120
  s_lshl_b32 s48, s38, 1
  s_sub_u32 s48, 31, s48
  s_lshr_b32 s48, s48, 2
  s_movk_i32 s56, 8192
  s_waitcnt lgkmcnt(6)
  v_mfma_f32_32x32x16_bf16 v[96:111], v[196:199], a[128:131], 0
  ds_read_b64_tr_b16 v[212:213], v241 offset:4096
  buffer_load_dwordx4 a[192:195], v248, s[20:23], s56 offen offset:0
  v_and_b32 v230, 7, v224
  v_min_u32 v230, s48, v230
  v_lshrrev_b32 v231, 2, v230
  v_mfma_f32_32x32x16_bf16 v[112:127], v[196:199], a[132:135], 0
  ds_read_b64_tr_b16 v[214:215], v241 offset:5120
  v_lshlrev_b32 v231, 2, v231
  v_and_b32 v230, 3, v230
  v_lshl_add_u32 v231, v230, 6, v231
  s_waitcnt lgkmcnt(6)
  v_mfma_f32_32x32x16_bf16 v[128:143], v[200:203], a[128:131], 0
  ds_read_b64_tr_b16 v[216:217], v242 offset:4096
  buffer_load_dwordx4 a[196:199], v249, s[20:23], s56 offen offset:0
  s_lshr_b32 s48, s37, 3
  s_and_b32 s49, s37, 7
  s_lshl_b32 s49, s49, 3
  v_mfma_f32_32x32x16_bf16 v[144:159], v[200:203], a[132:135], 0
  ds_read_b64_tr_b16 v[218:219], v242 offset:5120
  s_add_u32 s48, s48, s49
  v_add_u32 v231, s48, v231
  v_lshrrev_b32 v230, 5, v231
  s_waitcnt lgkmcnt(6)
  v_mfma_f32_32x32x16_bf16 v[160:175], v[204:207], a[128:131], 0
  ds_read_b64_tr_b16 v[220:221], v243 offset:4096
  buffer_load_dwordx4 a[200:203], v248, s[20:23], s56 offen offset:1024
  v_lshrrev_b32 v232, 4, v231
  v_xor_b32 v232, v232, v230
  v_and_b32 v232, 1, v232
  v_mfma_f32_32x32x16_bf16 v[176:191], v[204:207], a[132:135], 0
  ds_read_b64_tr_b16 v[222:223], v243 offset:5120
  v_lshlrev_b32 v232, 7, v232
  v_lshl_add_u32 v232, v230, 4, v232
  v_and_b32 v231, 15, v231
  s_waitcnt lgkmcnt(6)
  v_mfma_f32_32x32x16_bf16 v[64:79], v[208:211], a[136:139], v[64:79]
  ds_read_b64_tr_b16 v[192:193], v240 offset:8192
  buffer_load_dwordx4 a[204:207], v249, s[20:23], s56 offen offset:1024
  v_add_u32 v231, v231, v232
  v_mov_b32 v232, 0x7f000000
  v_cndmask_b32 v238, v232, v231, s[68:69]
  s_waitcnt vmcnt(32)
  v_mfma_f32_32x32x16_bf16 v[80:95], v[208:211], a[140:143], v[80:95]
  ds_read_b64_tr_b16 v[194:195], v240 offset:9216
  s_waitcnt lgkmcnt(6)
  v_mfma_f32_32x32x16_bf16 v[96:111], v[212:215], a[136:139], v[96:111]
  ds_read_b64_tr_b16 v[196:197], v241 offset:8192
  buffer_load_dwordx4 a[208:211], v248, s[20:23], s56 offen offset:2048
  v_mfma_f32_32x32x16_bf16 v[112:127], v[212:215], a[140:143], v[112:127]
  ds_read_b64_tr_b16 v[198:199], v241 offset:9216
  s_waitcnt lgkmcnt(6)
  v_mfma_f32_32x32x16_bf16 v[128:143], v[216:219], a[136:139], v[128:143]
  ds_read_b64_tr_b16 v[200:201], v242 offset:8192
  buffer_load_dwordx4 a[212:215], v249, s[20:23], s56 offen offset:2048
  v_mfma_f32_32x32x16_bf16 v[144:159], v[216:219], a[140:143], v[144:159]
  ds_read_b64_tr_b16 v[202:203], v242 offset:9216
  s_waitcnt lgkmcnt(6)
  v_mfma_f32_32x32x16_bf16 v[160:175], v[220:223], a[136:139], v[160:175]
  ds_read_b64_tr_b16 v[204:205], v243 offset:8192
  buffer_load_dwordx4 a[216:219], v248, s[20:23], s56 offen offset:3072
  v_mfma_f32_32x32x16_bf16 v[176:191], v[220:223], a[140:143], v[176:191]
  ds_read_b64_tr_b16 v[206:207], v243 offset:9216
  s_waitcnt vmcnt(34) lgkmcnt(6)
  v_mfma_f32_32x32x16_bf16 v[64:79], v[192:195], a[144:147], v[64:79]
  ds_read_b64_tr_b16 v[208:209], v240 offset:12288
  buffer_load_dwordx4 a[220:223], v249, s[20:23], s56 offen offset:3072
  s_waitcnt vmcnt(33)
  v_mfma_f32_32x32x16_bf16 v[80:95], v[192:195], a[148:151], v[80:95]
  ds_read_b64_tr_b16 v[210:211], v240 offset:13312
  s_waitcnt lgkmcnt(6)
  v_mfma_f32_32x32x16_bf16 v[96:111], v[196:199], a[144:147], v[96:111]
  ds_read_b64_tr_b16 v[212:213], v241 offset:12288
  s_waitcnt vmcnt(23)
  s_barrier
  v_mfma_f32_32x32x16_bf16 v[112:127], v[196:199], a[148:151], v[112:127]
  ds_read_b64_tr_b16 v[214:215], v241 offset:13312
  s_add_u32 m0, s39, 32768
  s_mov_b32 s40, 1048576
  s_waitcnt lgkmcnt(6)
  v_mfma_f32_32x32x16_bf16 v[128:143], v[200:203], a[144:147], v[128:143]
  ds_read_b64_tr_b16 v[216:217], v242 offset:12288
  buffer_load_dwordx4 v244, s[16:19], s40 offen offset:0 lds
  v_mfma_f32_32x32x16_bf16 v[144:159], v[200:203], a[148:151], v[144:159]
  ds_read_b64_tr_b16 v[218:219], v242 offset:13312
  s_waitcnt lgkmcnt(6)
  v_mfma_f32_32x32x16_bf16 v[160:175], v[204:207], a[144:147], v[160:175]
  ds_read_b64_tr_b16 v[220:221], v243 offset:12288
  buffer_load_dwordx4 v245, s[16:19], s40 offen offset:1024 lds
  v_mfma_f32_32x32x16_bf16 v[176:191], v[204:207], a[148:151], v[176:191]
  ds_read_b64_tr_b16 v[222:223], v243 offset:13312
  s_waitcnt lgkmcnt(6)
  v_mfma_f32_32x32x16_bf16 v[64:79], v[208:211], a[152:155], v[64:79]
  ds_read_b64_tr_b16 v[192:193], v240 offset:16384
  buffer_load_dwordx4 v246, s[16:19], s40 offen offset:2048 lds
  v_mfma_f32_32x32x16_bf16 v[80:95], v[208:211], a[156:159], v[80:95]
  ds_read_b64_tr_b16 v[194:195], v240 offset:17408
  s_waitcnt lgkmcnt(6)
  v_mfma_f32_32x32x16_bf16 v[96:111], v[212:215], a[152:155], v[96:111]
  ds_read_b64_tr_b16 v[196:197], v241 offset:16384
  buffer_load_dwordx4 v247, s[16:19], s40 offen offset:3072 lds
  v_mfma_f32_32x32x16_bf16 v[112:127], v[212:215], a[156:159], v[112:127]
  ds_read_b64_tr_b16 v[198:199], v241 offset:17408
  s_waitcnt lgkmcnt(6)
  v_mfma_f32_32x32x16_bf16 v[128:143], v[216:219], a[152:155], v[128:143]
  ds_read_b64_tr_b16 v[200:201], v242 offset:16384
  v_mfma_f32_32x32x16_bf16 v[144:159], v[216:219], a[156:159], v[144:159]
  ds_read_b64_tr_b16 v[202:203], v242 offset:17408
  s_waitcnt lgkmcnt(6)
  v_mfma_f32_32x32x16_bf16 v[160:175], v[220:223], a[152:155], v[160:175]
  ds_read_b64_tr_b16 v[204:205], v243 offset:16384
  v_mfma_f32_32x32x16_bf16 v[176:191], v[220:223], a[156:159], v[176:191]
  ds_read_b64_tr_b16 v[206:207], v243 offset:17408
  s_waitcnt lgkmcnt(6)
  v_mfma_f32_32x32x16_bf16 v[64:79], v[192:195], a[160:163], v[64:79]
  ds_read_b64_tr_b16 v[208:209], v240 offset:20480
  v_mfma_f32_32x32x16_bf16 v[80:95], v[192:195], a[164:167], v[80:95]
  ds_read_b64_tr_b16 v[210:211], v240 offset:21504
  s_movk_i32 s56, 12288
  s_waitcnt lgkmcnt(6)
  v_mfma_f32_32x32x16_bf16 v[96:111], v[196:199], a[160:163], v[96:111]
  ds_read_b64_tr_b16 v[212:213], v241 offset:20480
  buffer_load_dwordx4 a[224:227], v248, s[20:23], s56 offen offset:0
  v_mfma_f32_32x32x16_bf16 v[112:127], v[196:199], a[164:167], v[112:127]
  ds_read_b64_tr_b16 v[214:215], v241 offset:21504
  s_waitcnt lgkmcnt(6)
  v_mfma_f32_32x32x16_bf16 v[128:143], v[200:203], a[160:163], v[128:143]
  ds_read_b64_tr_b16 v[216:217], v242 offset:20480
  buffer_load_dwordx4 a[228:231], v249, s[20:23], s56 offen offset:0
  v_mfma_f32_32x32x16_bf16 v[144:159], v[200:203], a[164:167], v[144:159]
  ds_read_b64_tr_b16 v[218:219], v242 offset:21504
  s_waitcnt lgkmcnt(6)
  v_mfma_f32_32x32x16_bf16 v[160:175], v[204:207], a[160:163], v[160:175]
  ds_read_b64_tr_b16 v[220:221], v243 offset:20480
  buffer_load_dwordx4 a[232:235], v248, s[20:23], s56 offen offset:1024
  v_mfma_f32_32x32x16_bf16 v[176:191], v[204:207], a[164:167], v[176:191]
  ds_read_b64_tr_b16 v[222:223], v243 offset:21504
  s_waitcnt lgkmcnt(6)
  v_mfma_f32_32x32x16_bf16 v[64:79], v[208:211], a[168:171], v[64:79]
  ds_read_b64_tr_b16 v[192:193], v240 offset:24576
  buffer_load_dwordx4 a[236:239], v249, s[20:23], s56 offen offset:1024
  s_waitcnt vmcnt(30)
  v_mfma_f32_32x32x16_bf16 v[80:95], v[208:211], a[172:175], v[80:95]
  ds_read_b64_tr_b16 v[194:195], v240 offset:25600
  s_waitcnt lgkmcnt(6)
  v_mfma_f32_32x32x16_bf16 v[96:111], v[212:215], a[168:171], v[96:111]
  ds_read_b64_tr_b16 v[196:197], v241 offset:24576
  buffer_load_dwordx4 a[240:243], v248, s[20:23], s56 offen offset:2048
  v_mfma_f32_32x32x16_bf16 v[112:127], v[212:215], a[172:175], v[112:127]
  ds_read_b64_tr_b16 v[198:199], v241 offset:25600
  s_waitcnt lgkmcnt(6)
  v_mfma_f32_32x32x16_bf16 v[128:143], v[216:219], a[168:171], v[128:143]
  ds_read_b64_tr_b16 v[200:201], v242 offset:24576
  buffer_load_dwordx4 a[244:247], v249, s[20:23], s56 offen offset:2048
  v_mfma_f32_32x32x16_bf16 v[144:159], v[216:219], a[172:175], v[144:159]
  ds_read_b64_tr_b16 v[202:203], v242 offset:25600
  s_waitcnt lgkmcnt(6)
  v_mfma_f32_32x32x16_bf16 v[160:175], v[220:223], a[168:171], v[160:175]
  ds_read_b64_tr_b16 v[204:205], v243 offset:24576
  buffer_load_dwordx4 a[248:251], v248, s[20:23], s56 offen offset:3072
  v_mfma_f32_32x32x16_bf16 v[176:191], v[220:223], a[172:175], v[176:191]
  ds_read_b64_tr_b16 v[206:207], v243 offset:25600
  s_waitcnt vmcnt(32) lgkmcnt(6)
  v_mfma_f32_32x32x16_bf16 v[64:79], v[192:195], a[176:179], v[64:79]
  ds_read_b64_tr_b16 v[208:209], v240 offset:28672
  buffer_load_dwordx4 a[252:255], v249, s[20:23], s56 offen offset:3072
  s_waitcnt vmcnt(32)
  v_mfma_f32_32x32x16_bf16 v[80:95], v[192:195], a[180:183], v[80:95]
  ds_read_b64_tr_b16 v[210:211], v240 offset:29696
  s_waitcnt lgkmcnt(6)
  v_mfma_f32_32x32x16_bf16 v[96:111], v[196:199], a[176:179], v[96:111]
  ds_read_b64_tr_b16 v[212:213], v241 offset:28672
  s_waitcnt vmcnt(20)
  s_waitcnt vmcnt(8)
  s_barrier
  v_mfma_f32_32x32x16_bf16 v[112:127], v[196:199], a[180:183], v[112:127]
  ds_read_b64_tr_b16 v[214:215], v241 offset:29696
  buffer_store_byte v237, v236, s[8:11], 0 offen sc1
  s_add_u32 m0, s39, 49152
  s_mov_b32 s40, 1572864
  s_waitcnt lgkmcnt(6)
  v_mfma_f32_32x32x16_bf16 v[128:143], v[200:203], a[176:179], v[128:143]
  ds_read_b64_tr_b16 v[216:217], v242 offset:28672
  buffer_load_dwordx4 v244, s[16:19], s40 offen offset:0 lds
  v_mfma_f32_32x32x16_bf16 v[144:159], v[200:203], a[180:183], v[144:159]
  ds_read_b64_tr_b16 v[218:219], v242 offset:29696
  s_waitcnt lgkmcnt(6)
  v_mfma_f32_32x32x16_bf16 v[160:175], v[204:207], a[176:179], v[160:175]
  ds_read_b64_tr_b16 v[220:221], v243 offset:28672
  buffer_load_dwordx4 v245, s[16:19], s40 offen offset:1024 lds
  v_mfma_f32_32x32x16_bf16 v[176:191], v[204:207], a[180:183], v[176:191]
  ds_read_b64_tr_b16 v[222:223], v243 offset:29696
  s_waitcnt lgkmcnt(6)
  v_mfma_f32_32x32x16_bf16 v[64:79], v[208:211], a[184:187], v[64:79]
  ds_read_b64_tr_b16 v[192:193], v240 offset:32768
  buffer_load_dwordx4 v246, s[16:19], s40 offen offset:2048 lds
  v_mfma_f32_32x32x16_bf16 v[80:95], v[208:211], a[188:191], v[80:95]
  ds_read_b64_tr_b16 v[194:195], v240 offset:33792
  s_waitcnt lgkmcnt(6)
  v_mfma_f32_32x32x16_bf16 v[96:111], v[212:215], a[184:187], v[96:111]
  ds_read_b64_tr_b16 v[196:197], v241 offset:32768
  buffer_load_dwordx4 v247, s[16:19], s40 offen offset:3072 lds
  v_mfma_f32_32x32x16_bf16 v[112:127], v[212:215], a[188:191], v[112:127]
  ds_read_b64_tr_b16 v[198:199], v241 offset:33792
  s_waitcnt lgkmcnt(6)
  v_mfma_f32_32x32x16_bf16 v[128:143], v[216:219], a[184:187], v[128:143]
  ds_read_b64_tr_b16 v[200:201], v242 offset:32768
  v_mfma_f32_32x32x16_bf16 v[144:159], v[216:219], a[188:191], v[144:159]
  ds_read_b64_tr_b16 v[202:203], v242 offset:33792
  s_waitcnt lgkmcnt(6)
  v_mfma_f32_32x32x16_bf16 v[160:175], v[220:223], a[184:187], v[160:175]
  ds_read_b64_tr_b16 v[204:205], v243 offset:32768
  v_mfma_f32_32x32x16_bf16 v[176:191], v[220:223], a[188:191], v[176:191]
  ds_read_b64_tr_b16 v[206:207], v243 offset:33792
  s_waitcnt lgkmcnt(6)
  v_mfma_f32_32x32x16_bf16 v[64:79], v[192:195], a[192:195], v[64:79]
  ds_read_b64_tr_b16 v[208:209], v240 offset:36864
  v_mfma_f32_32x32x16_bf16 v[80:95], v[192:195], a[196:199], v[80:95]
  ds_read_b64_tr_b16 v[210:211], v240 offset:37888
  s_movk_i32 s56, 16384
  s_waitcnt lgkmcnt(6)
  v_mfma_f32_32x32x16_bf16 v[96:111], v[196:199], a[192:195], v[96:111]
  ds_read_b64_tr_b16 v[212:213], v241 offset:36864
  buffer_load_dwordx4 a[128:131], v248, s[20:23], s56 offen offset:0
  v_mfma_f32_32x32x16_bf16 v[112:127], v[196:199], a[196:199], v[112:127]
  ds_read_b64_tr_b16 v[214:215], v241 offset:37888
  s_waitcnt lgkmcnt(6)
  v_mfma_f32_32x32x16_bf16 v[128:143], v[200:203], a[192:195], v[128:143]
  ds_read_b64_tr_b16 v[216:217], v242 offset:36864
  buffer_load_dwordx4 a[132:135], v249, s[20:23], s56 offen offset:0
  v_mfma_f32_32x32x16_bf16 v[144:159], v[200:203], a[196:199], v[144:159]
  ds_read_b64_tr_b16 v[218:219], v242 offset:37888
  s_waitcnt lgkmcnt(6)
  v_mfma_f32_32x32x16_bf16 v[160:175], v[204:207], a[192:195], v[160:175]
  ds_read_b64_tr_b16 v[220:221], v243 offset:36864
  buffer_load_dwordx4 a[136:139], v248, s[20:23], s56 offen offset:1024
  v_mfma_f32_32x32x16_bf16 v[176:191], v[204:207], a[196:199], v[176:191]
  ds_read_b64_tr_b16 v[222:223], v243 offset:37888
  s_waitcnt lgkmcnt(6)
  v_mfma_f32_32x32x16_bf16 v[64:79], v[208:211], a[200:203], v[64:79]
  ds_read_b64_tr_b16 v[192:193], v240 offset:40960
  buffer_load_dwordx4 a[140:143], v249, s[20:23], s56 offen offset:1024
  v_mfma_f32_32x32x16_bf16 v[80:95], v[208:211], a[204:207], v[80:95]
  ds_read_b64_tr_b16 v[194:195], v240 offset:41984
  s_waitcnt lgkmcnt(6)
  v_mfma_f32_32x32x16_bf16 v[96:111], v[212:215], a[200:203], v[96:111]
  ds_read_b64_tr_b16 v[196:197], v241 offset:40960
  buffer_load_dwordx4 a[144:147], v248, s[20:23], s56 offen offset:2048
  v_mfma_f32_32x32x16_bf16 v[112:127], v[212:215], a[204:207], v[112:127]
  ds_read_b64_tr_b16 v[198:199], v241 offset:41984
  s_waitcnt lgkmcnt(6)
  v_mfma_f32_32x32x16_bf16 v[128:143], v[216:219], a[200:203], v[128:143]
  ds_read_b64_tr_b16 v[200:201], v242 offset:40960
  buffer_load_dwordx4 a[148:151], v249, s[20:23], s56 offen offset:2048
  v_mfma_f32_32x32x16_bf16 v[144:159], v[216:219], a[204:207], v[144:159]
  ds_read_b64_tr_b16 v[202:203], v242 offset:41984
  s_waitcnt lgkmcnt(6)
  v_mfma_f32_32x32x16_bf16 v[160:175], v[220:223], a[200:203], v[160:175]
  ds_read_b64_tr_b16 v[204:205], v243 offset:40960
  buffer_load_dwordx4 a[152:155], v248, s[20:23], s56 offen offset:3072
  v_mfma_f32_32x32x16_bf16 v[176:191], v[220:223], a[204:207], v[176:191]
  ds_read_b64_tr_b16 v[206:207], v243 offset:41984
  s_waitcnt lgkmcnt(6)
  v_mfma_f32_32x32x16_bf16 v[64:79], v[192:195], a[208:211], v[64:79]
  ds_read_b64_tr_b16 v[208:209], v240 offset:45056
  buffer_load_dwordx4 a[156:159], v249, s[20:23], s56 offen offset:3072
  v_mfma_f32_32x32x16_bf16 v[80:95], v[192:195], a[212:215], v[80:95]
  ds_read_b64_tr_b16 v[210:211], v240 offset:46080
  s_waitcnt lgkmcnt(6)
  v_mfma_f32_32x32x16_bf16 v[96:111], v[196:199], a[208:211], v[96:111]
  ds_read_b64_tr_b16 v[212:213], v241 offset:45056
  s_waitcnt vmcnt(8)
  s_barrier
  v_mfma_f32_32x32x16_bf16 v[112:127], v[196:199], a[212:215], v[112:127]
  ds_read_b64_tr_b16 v[214:215], v241 offset:46080
  s_add_u32 m0, s39, 0
  s_mov_b32 s40, 2097152
  s_waitcnt lgkmcnt(6)
  v_mfma_f32_32x32x16_bf16 v[128:143], v[200:203], a[208:211], v[128:143]
  ds_read_b64_tr_b16 v[216:217], v242 offset:45056
  buffer_load_dwordx4 v244, s[16:19], s40 offen offset:0 lds
  v_mfma_f32_32x32x16_bf16 v[144:159], v[200:203], a[212:215], v[144:159]
  ds_read_b64_tr_b16 v[218:219], v242 offset:46080
  s_waitcnt lgkmcnt(6)
  v_mfma_f32_32x32x16_bf16 v[160:175], v[204:207], a[208:211], v[160:175]
  ds_read_b64_tr_b16 v[220:221], v243 offset:45056
  buffer_load_dwordx4 v245, s[16:19], s40 offen offset:1024 lds
  v_mfma_f32_32x32x16_bf16 v[176:191], v[204:207], a[212:215], v[176:191]
  ds_read_b64_tr_b16 v[222:223], v243 offset:46080
  s_waitcnt lgkmcnt(6)
  v_mfma_f32_32x32x16_bf16 v[64:79], v[208:211], a[216:219], v[64:79]
  ds_read_b64_tr_b16 v[192:193], v240 offset:49152
  buffer_load_dwordx4 v246, s[16:19], s40 offen offset:2048 lds
  v_mfma_f32_32x32x16_bf16 v[80:95], v[208:211], a[220:223], v[80:95]
  ds_read_b64_tr_b16 v[194:195], v240 offset:50176
  s_waitcnt lgkmcnt(6)
  v_mfma_f32_32x32x16_bf16 v[96:111], v[212:215], a[216:219], v[96:111]
  ds_read_b64_tr_b16 v[196:197], v241 offset:49152
  buffer_load_dwordx4 v247, s[16:19], s40 offen offset:3072 lds
  v_mfma_f32_32x32x16_bf16 v[112:127], v[212:215], a[220:223], v[112:127]
  ds_read_b64_tr_b16 v[198:199], v241 offset:50176
  s_waitcnt lgkmcnt(6)
  v_mfma_f32_32x32x16_bf16 v[128:143], v[216:219], a[216:219], v[128:143]
  ds_read_b64_tr_b16 v[200:201], v242 offset:49152
  v_mfma_f32_32x32x16_bf16 v[144:159], v[216:219], a[220:223], v[144:159]
  ds_read_b64_tr_b16 v[202:203], v242 offset:50176
  s_waitcnt lgkmcnt(6)
  v_mfma_f32_32x32x16_bf16 v[160:175], v[220:223], a[216:219], v[160:175]
  ds_read_b64_tr_b16 v[204:205], v243 offset:49152
  v_mfma_f32_32x32x16_bf16 v[176:191], v[220:223], a[220:223], v[176:191]
  ds_read_b64_tr_b16 v[206:207], v243 offset:50176
  s_waitcnt lgkmcnt(6)
  v_mfma_f32_32x32x16_bf16 v[64:79], v[192:195], a[224:227], v[64:79]
  ds_read_b64_tr_b16 v[208:209], v240 offset:53248
  v_mfma_f32_32x32x16_bf16 v[80:95], v[192:195], a[228:231], v[80:95]
  ds_read_b64_tr_b16 v[210:211], v240 offset:54272
  s_movk_i32 s56, 20480
  s_waitcnt lgkmcnt(6)
  v_mfma_f32_32x32x16_bf16 v[96:111], v[196:199], a[224:227], v[96:111]
  ds_read_b64_tr_b16 v[212:213], v241 offset:53248
  buffer_load_dwordx4 a[160:163], v248, s[20:23], s56 offen offset:0
  v_mfma_f32_32x32x16_bf16 v[112:127], v[196:199], a[228:231], v[112:127]
  ds_read_b64_tr_b16 v[214:215], v241 offset:54272
  s_waitcnt lgkmcnt(6)
  v_mfma_f32_32x32x16_bf16 v[128:143], v[200:203], a[224:227], v[128:143]
  ds_read_b64_tr_b16 v[216:217], v242 offset:53248
  buffer_load_dwordx4 a[164:167], v249, s[20:23], s56 offen offset:0
  v_mfma_f32_32x32x16_bf16 v[144:159], v[200:203], a[228:231], v[144:159]
  ds_read_b64_tr_b16 v[218:219], v242 offset:54272
  s_waitcnt lgkmcnt(6)
  v_mfma_f32_32x32x16_bf16 v[160:175], v[204:207], a[224:227], v[160:175]
  ds_read_b64_tr_b16 v[220:221], v243 offset:53248
  buffer_load_dwordx4 a[168:171], v248, s[20:23], s56 offen offset:1024
  v_mfma_f32_32x32x16_bf16 v[176:191], v[204:207], a[228:231], v[176:191]
  ds_read_b64_tr_b16 v[222:223], v243 offset:54272
  s_waitcnt lgkmcnt(6)
  v_mfma_f32_32x32x16_bf16 v[64:79], v[208:211], a[232:235], v[64:79]
  ds_read_b64_tr_b16 v[192:193], v240 offset:57344
  buffer_load_dwordx4 a[172:175], v249, s[20:23], s56 offen offset:1024
  v_mfma_f32_32x32x16_bf16 v[80:95], v[208:211], a[236:239], v[80:95]
  ds_read_b64_tr_b16 v[194:195], v240 offset:58368
  s_waitcnt lgkmcnt(6)
  v_mfma_f32_32x32x16_bf16 v[96:111], v[212:215], a[232:235], v[96:111]
  ds_read_b64_tr_b16 v[196:197], v241 offset:57344
  buffer_load_dwordx4 a[176:179], v248, s[20:23], s56 offen offset:2048
  v_mfma_f32_32x32x16_bf16 v[112:127], v[212:215], a[236:239], v[112:127]
  ds_read_b64_tr_b16 v[198:199], v241 offset:58368
  s_waitcnt lgkmcnt(6)
  v_mfma_f32_32x32x16_bf16 v[128:143], v[216:219], a[232:235], v[128:143]
  ds_read_b64_tr_b16 v[200:201], v242 offset:57344
  buffer_load_dwordx4 a[180:183], v249, s[20:23], s56 offen offset:2048
  v_mfma_f32_32x32x16_bf16 v[144:159], v[216:219], a[236:239], v[144:159]
  ds_read_b64_tr_b16 v[202:203], v242 offset:58368
  s_waitcnt lgkmcnt(6)
  v_mfma_f32_32x32x16_bf16 v[160:175], v[220:223], a[232:235], v[160:175]
  ds_read_b64_tr_b16 v[204:205], v243 offset:57344
  buffer_load_dwordx4 a[184:187], v248, s[20:23], s56 offen offset:3072
  v_mfma_f32_32x32x16_bf16 v[176:191], v[220:223], a[236:239], v[176:191]
  ds_read_b64_tr_b16 v[206:207], v243 offset:58368
  s_waitcnt lgkmcnt(6)
  v_mfma_f32_32x32x16_bf16 v[64:79], v[192:195], a[240:243], v[64:79]
  ds_read_b64_tr_b16 v[208:209], v240 offset:61440
  buffer_load_dwordx4 a[188:191], v249, s[20:23], s56 offen offset:3072
  v_mfma_f32_32x32x16_bf16 v[80:95], v[192:195], a[244:247], v[80:95]
  ds_read_b64_tr_b16 v[210:211], v240 offset:62464
  s_waitcnt lgkmcnt(6)
  v_mfma_f32_32x32x16_bf16 v[96:111], v[196:199], a[240:243], v[96:111]
  ds_read_b64_tr_b16 v[212:213], v241 offset:61440
  s_waitcnt vmcnt(8)
  s_barrier
  v_mfma_f32_32x32x16_bf16 v[112:127], v[196:199], a[244:247], v[112:127]
  ds_read_b64_tr_b16 v[214:215], v241 offset:62464
  s_add_u32 m0, s39, 16384
  s_mov_b32 s40, 2621440
  s_waitcnt lgkmcnt(6)
  v_mfma_f32_32x32x16_bf16 v[128:143], v[200:203], a[240:243], v[128:143]
  ds_read_b64_tr_b16 v[216:217], v242 offset:61440
  buffer_load_dwordx4 v244, s[16:19], s40 offen offset:0 lds
  v_mfma_f32_32x32x16_bf16 v[144:159], v[200:203], a[244:247], v[144:159]
  ds_read_b64_tr_b16 v[218:219], v242 offset:62464
  s_waitcnt lgkmcnt(6)
  v_mfma_f32_32x32x16_bf16 v[160:175], v[204:207], a[240:243], v[160:175]
  ds_read_b64_tr_b16 v[220:221], v243 offset:61440
  buffer_load_dwordx4 v245, s[16:19], s40 offen offset:1024 lds
  v_mfma_f32_32x32x16_bf16 v[176:191], v[204:207], a[244:247], v[176:191]
  ds_read_b64_tr_b16 v[222:223], v243 offset:62464
  s_waitcnt lgkmcnt(6)
  v_mfma_f32_32x32x16_bf16 v[64:79], v[208:211], a[248:251], v[64:79]
  ds_read_b64_tr_b16 v[192:193], v240 offset:0
  buffer_load_dwordx4 v246, s[16:19], s40 offen offset:2048 lds
  v_mfma_f32_32x32x16_bf16 v[80:95], v[208:211], a[252:255], v[80:95]
  ds_read_b64_tr_b16 v[194:195], v240 offset:1024
  s_waitcnt lgkmcnt(6)
  v_mfma_f32_32x32x16_bf16 v[96:111], v[212:215], a[248:251], v[96:111]
  ds_read_b64_tr_b16 v[196:197], v241 offset:0
  buffer_load_dwordx4 v247, s[16:19], s40 offen offset:3072 lds
  v_mfma_f32_32x32x16_bf16 v[112:127], v[212:215], a[252:255], v[112:127]
  ds_read_b64_tr_b16 v[198:199], v241 offset:1024
  s_waitcnt lgkmcnt(6)
  v_mfma_f32_32x32x16_bf16 v[128:143], v[216:219], a[248:251], v[128:143]
  ds_read_b64_tr_b16 v[200:201], v242 offset:0
  v_mfma_f32_32x32x16_bf16 v[144:159], v[216:219], a[252:255], v[144:159]
  ds_read_b64_tr_b16 v[202:203], v242 offset:1024
  s_waitcnt lgkmcnt(6)
  v_mfma_f32_32x32x16_bf16 v[160:175], v[220:223], a[248:251], v[160:175]
  ds_read_b64_tr_b16 v[204:205], v243 offset:0
  v_mfma_f32_32x32x16_bf16 v[176:191], v[220:223], a[252:255], v[176:191]
  ds_read_b64_tr_b16 v[206:207], v243 offset:1024
  s_waitcnt lgkmcnt(6)
  v_mfma_f32_32x32x16_bf16 v[64:79], v[192:195], a[128:131], v[64:79]
  ds_read_b64_tr_b16 v[208:209], v240 offset:4096
  buffer_load_ubyte v239, v238, s[8:11], 0 offen sc1
  v_mfma_f32_32x32x16_bf16 v[80:95], v[192:195], a[132:135], v[80:95]
  ds_read_b64_tr_b16 v[210:211], v240 offset:5120
  s_movk_i32 s56, 24576
  s_waitcnt lgkmcnt(6)
  v_mfma_f32_32x32x16_bf16 v[96:111], v[196:199], a[128:131], v[96:111]
  ds_read_b64_tr_b16 v[212:213], v241 offset:4096
  buffer_load_dwordx4 a[192:195], v248, s[20:23], s56 offen offset:0
  v_mfma_f32_32x32x16_bf16 v[112:127], v[196:199], a[132:135], v[112:127]
  ds_read_b64_tr_b16 v[214:215], v241 offset:5120
  s_waitcnt lgkmcnt(6)
  v_mfma_f32_32x32x16_bf16 v[128:143], v[200:203], a[128:131], v[128:143]
  ds_read_b64_tr_b16 v[216:217], v242 offset:4096
  buffer_load_dwordx4 a[196:199], v249, s[20:23], s56 offen offset:0
  v_mfma_f32_32x32x16_bf16 v[144:159], v[200:203], a[132:135], v[144:159]
  ds_read_b64_tr_b16 v[218:219], v242 offset:5120
  s_waitcnt lgkmcnt(6)
  v_mfma_f32_32x32x16_bf16 v[160:175], v[204:207], a[128:131], v[160:175]
  ds_read_b64_tr_b16 v[220:221], v243 offset:4096
  buffer_load_dwordx4 a[200:203], v248, s[20:23], s56 offen offset:1024
  v_mfma_f32_32x32x16_bf16 v[176:191], v[204:207], a[132:135], v[176:191]
  ds_read_b64_tr_b16 v[222:223], v243 offset:5120
  s_waitcnt lgkmcnt(6)
  v_mfma_f32_32x32x16_bf16 v[64:79], v[208:211], a[136:139], v[64:79]
  ds_read_b64_tr_b16 v[192:193], v240 offset:8192
  buffer_load_dwordx4 a[204:207], v249, s[20:23], s56 offen offset:1024
  v_mfma_f32_32x32x16_bf16 v[80:95], v[208:211], a[140:143], v[80:95]
  ds_read_b64_tr_b16 v[194:195], v240 offset:9216
  s_waitcnt lgkmcnt(6)
  v_mfma_f32_32x32x16_bf16 v[96:111], v[212:215], a[136:139], v[96:111]
  ds_read_b64_tr_b16 v[196:197], v241 offset:8192
  buffer_load_dwordx4 a[208:211], v248, s[20:23], s56 offen offset:2048
  v_mfma_f32_32x32x16_bf16 v[112:127], v[212:215], a[140:143], v[112:127]
  ds_read_b64_tr_b16 v[198:199], v241 offset:9216
  s_waitcnt lgkmcnt(6)
  v_mfma_f32_32x32x16_bf16 v[128:143], v[216:219], a[136:139], v[128:143]
  ds_read_b64_tr_b16 v[200:201], v242 offset:8192
  buffer_load_dwordx4 a[212:215], v249, s[20:23], s56 offen offset:2048
  v_mfma_f32_32x32x16_bf16 v[144:159], v[216:219], a[140:143], v[144:159]
  ds_read_b64_tr_b16 v[202:203], v242 offset:9216
  s_waitcnt lgkmcnt(6)
  v_mfma_f32_32x32x16_bf16 v[160:175], v[220:223], a[136:139], v[160:175]
  ds_read_b64_tr_b16 v[204:205], v243 offset:8192
  buffer_load_dwordx4 a[216:219], v248, s[20:23], s56 offen offset:3072
  v_mfma_f32_32x32x16_bf16 v[176:191], v[220:223], a[140:143], v[176:191]
  ds_read_b64_tr_b16 v[206:207], v243 offset:9216
  s_waitcnt lgkmcnt(6)
  v_mfma_f32_32x32x16_bf16 v[64:79], v[192:195], a[144:147], v[64:79]
  ds_read_b64_tr_b16 v[208:209], v240 offset:12288
  buffer_load_dwordx4 a[220:223], v249, s[20:23], s56 offen offset:3072
  v_mfma_f32_32x32x16_bf16 v[80:95], v[192:195], a[148:151], v[80:95]
  ds_read_b64_tr_b16 v[210:211], v240 offset:13312
  s_waitcnt lgkmcnt(6)
  v_mfma_f32_32x32x16_bf16 v[96:111], v[196:199], a[144:147], v[96:111]
  ds_read_b64_tr_b16 v[212:213], v241 offset:12288
  s_waitcnt vmcnt(9)
  s_barrier
  v_mfma_f32_32x32x16_bf16 v[112:127], v[196:199], a[148:151], v[112:127]
  ds_read_b64_tr_b16 v[214:215], v241 offset:13312
  s_add_u32 m0, s39, 32768
  s_mov_b32 s40, 3145728
  s_waitcnt lgkmcnt(6)
  v_mfma_f32_32x32x16_bf16 v[128:143], v[200:203], a[144:147], v[128:143]
  ds_read_b64_tr_b16 v[216:217], v242 offset:12288
  buffer_load_dwordx4 v244, s[16:19], s40 offen offset:0 lds
  v_mfma_f32_32x32x16_bf16 v[144:159], v[200:203], a[148:151], v[144:159]
  ds_read_b64_tr_b16 v[218:219], v242 offset:13312
  s_waitcnt lgkmcnt(6)
  v_mfma_f32_32x32x16_bf16 v[160:175], v[204:207], a[144:147], v[160:175]
  ds_read_b64_tr_b16 v[220:221], v243 offset:12288
  buffer_load_dwordx4 v245, s[16:19], s40 offen offset:1024 lds
  v_mfma_f32_32x32x16_bf16 v[176:191], v[204:207], a[148:151], v[176:191]
  ds_read_b64_tr_b16 v[222:223], v243 offset:13312
  s_waitcnt lgkmcnt(6)
  v_mfma_f32_32x32x16_bf16 v[64:79], v[208:211], a[152:155], v[64:79]
  ds_read_b64_tr_b16 v[192:193], v240 offset:16384
  buffer_load_dwordx4 v246, s[16:19], s40 offen offset:2048 lds
  v_mfma_f32_32x32x16_bf16 v[80:95], v[208:211], a[156:159], v[80:95]
  ds_read_b64_tr_b16 v[194:195], v240 offset:17408
  s_waitcnt lgkmcnt(6)
  v_mfma_f32_32x32x16_bf16 v[96:111], v[212:215], a[152:155], v[96:111]
  ds_read_b64_tr_b16 v[196:197], v241 offset:16384
  buffer_load_dwordx4 v247, s[16:19], s40 offen offset:3072 lds
  v_mfma_f32_32x32x16_bf16 v[112:127], v[212:215], a[156:159], v[112:127]
  ds_read_b64_tr_b16 v[198:199], v241 offset:17408
  s_waitcnt lgkmcnt(6)
  v_mfma_f32_32x32x16_bf16 v[128:143], v[216:219], a[152:155], v[128:143]
  ds_read_b64_tr_b16 v[200:201], v242 offset:16384
  v_mfma_f32_32x32x16_bf16 v[144:159], v[216:219], a[156:159], v[144:159]
  ds_read_b64_tr_b16 v[202:203], v242 offset:17408
  s_waitcnt lgkmcnt(6)
  v_mfma_f32_32x32x16_bf16 v[160:175], v[220:223], a[152:155], v[160:175]
  ds_read_b64_tr_b16 v[204:205], v243 offset:16384
  v_mfma_f32_32x32x16_bf16 v[176:191], v[220:223], a[156:159], v[176:191]
  ds_read_b64_tr_b16 v[206:207], v243 offset:17408
  s_waitcnt lgkmcnt(6)
  v_mfma_f32_32x32x16_bf16 v[64:79], v[192:195], a[160:163], v[64:79]
  ds_read_b64_tr_b16 v[208:209], v240 offset:20480
  v_mfma_f32_32x32x16_bf16 v[80:95], v[192:195], a[164:167], v[80:95]
  ds_read_b64_tr_b16 v[210:211], v240 offset:21504
  s_movk_i32 s56, 28672
  s_waitcnt lgkmcnt(6)
  v_mfma_f32_32x32x16_bf16 v[96:111], v[196:199], a[160:163], v[96:111]
  ds_read_b64_tr_b16 v[212:213], v241 offset:20480
  buffer_load_dwordx4 a[224:227], v248, s[20:23], s56 offen offset:0
  v_mfma_f32_32x32x16_bf16 v[112:127], v[196:199], a[164:167], v[112:127]
  ds_read_b64_tr_b16 v[214:215], v241 offset:21504
  s_waitcnt lgkmcnt(6)
  v_mfma_f32_32x32x16_bf16 v[128:143], v[200:203], a[160:163], v[128:143]
  ds_read_b64_tr_b16 v[216:217], v242 offset:20480
  buffer_load_dwordx4 a[228:231], v249, s[20:23], s56 offen offset:0
  v_mfma_f32_32x32x16_bf16 v[144:159], v[200:203], a[164:167], v[144:159]
  ds_read_b64_tr_b16 v[218:219], v242 offset:21504
  s_waitcnt lgkmcnt(6)
  v_mfma_f32_32x32x16_bf16 v[160:175], v[204:207], a[160:163], v[160:175]
  ds_read_b64_tr_b16 v[220:221], v243 offset:20480
  buffer_load_dwordx4 a[232:235], v248, s[20:23], s56 offen offset:1024
  v_mfma_f32_32x32x16_bf16 v[176:191], v[204:207], a[164:167], v[176:191]
  ds_read_b64_tr_b16 v[222:223], v243 offset:21504
  s_waitcnt lgkmcnt(6)
  v_mfma_f32_32x32x16_bf16 v[64:79], v[208:211], a[168:171], v[64:79]
  ds_read_b64_tr_b16 v[192:193], v240 offset:24576
  buffer_load_dwordx4 a[236:239], v249, s[20:23], s56 offen offset:1024
  v_mfma_f32_32x32x16_bf16 v[80:95], v[208:211], a[172:175], v[80:95]
  ds_read_b64_tr_b16 v[194:195], v240 offset:25600
  s_waitcnt lgkmcnt(6)
  v_mfma_f32_32x32x16_bf16 v[96:111], v[212:215], a[168:171], v[96:111]
  ds_read_b64_tr_b16 v[196:197], v241 offset:24576
  buffer_load_dwordx4 a[240:243], v248, s[20:23], s56 offen offset:2048
  v_mfma_f32_32x32x16_bf16 v[112:127], v[212:215], a[172:175], v[112:127]
  ds_read_b64_tr_b16 v[198:199], v241 offset:25600
  s_waitcnt lgkmcnt(6)
  v_mfma_f32_32x32x16_bf16 v[128:143], v[216:219], a[168:171], v[128:143]
  ds_read_b64_tr_b16 v[200:201], v242 offset:24576
  buffer_load_dwordx4 a[244:247], v249, s[20:23], s56 offen offset:2048
  v_mfma_f32_32x32x16_bf16 v[144:159], v[216:219], a[172:175], v[144:159]
  ds_read_b64_tr_b16 v[202:203], v242 offset:25600
  s_waitcnt lgkmcnt(6)
  v_mfma_f32_32x32x16_bf16 v[160:175], v[220:223], a[168:171], v[160:175]
  ds_read_b64_tr_b16 v[204:205], v243 offset:24576
  buffer_load_dwordx4 a[248:251], v248, s[20:23], s56 offen offset:3072
  v_mfma_f32_32x32x16_bf16 v[176:191], v[220:223], a[172:175], v[176:191]
  ds_read_b64_tr_b16 v[206:207], v243 offset:25600
  s_waitcnt lgkmcnt(6)
  v_mfma_f32_32x32x16_bf16 v[64:79], v[192:195], a[176:179], v[64:79]
  ds_read_b64_tr_b16 v[208:209], v240 offset:28672
  buffer_load_dwordx4 a[252:255], v249, s[20:23], s56 offen offset:3072
  v_mfma_f32_32x32x16_bf16 v[80:95], v[192:195], a[180:183], v[80:95]
  ds_read_b64_tr_b16 v[210:211], v240 offset:29696
  s_waitcnt lgkmcnt(6)
  v_mfma_f32_32x32x16_bf16 v[96:111], v[196:199], a[176:179], v[96:111]
  ds_read_b64_tr_b16 v[212:213], v241 offset:28672
  s_waitcnt vmcnt(8)
  s_barrier
  v_mfma_f32_32x32x16_bf16 v[112:127], v[196:199], a[180:183], v[112:127]
  ds_read_b64_tr_b16 v[214:215], v241 offset:29696
  s_add_u32 m0, s39, 49152
  s_mov_b32 s40, 3670016
  s_waitcnt lgkmcnt(6)
  v_mfma_f32_32x32x16_bf16 v[128:143], v[200:203], a[176:179], v[128:143]
  ds_read_b64_tr_b16 v[216:217], v242 offset:28672
  buffer_load_dwordx4 v244, s[16:19], s40 offen offset:0 lds
  v_mfma_f32_32x32x16_bf16 v[144:159], v[200:203], a[180:183], v[144:159]
  ds_read_b64_tr_b16 v[218:219], v242 offset:29696
  s_waitcnt lgkmcnt(6)
  v_mfma_f32_32x32x16_bf16 v[160:175], v[204:207], a[176:179], v[160:175]
  ds_read_b64_tr_b16 v[220:221], v243 offset:28672
  buffer_load_dwordx4 v245, s[16:19], s40 offen offset:1024 lds
  v_mfma_f32_32x32x16_bf16 v[176:191], v[204:207], a[180:183], v[176:191]
  ds_read_b64_tr_b16 v[222:223], v243 offset:29696
  s_waitcnt lgkmcnt(6)
  v_mfma_f32_32x32x16_bf16 v[64:79], v[208:211], a[184:187], v[64:79]
  ds_read_b64_tr_b16 v[192:193], v240 offset:32768
  buffer_load_dwordx4 v246, s[16:19], s40 offen offset:2048 lds
  v_mfma_f32_32x32x16_bf16 v[80:95], v[208:211], a[188:191], v[80:95]
  ds_read_b64_tr_b16 v[194:195], v240 offset:33792
  s_waitcnt lgkmcnt(6)
  v_mfma_f32_32x32x16_bf16 v[96:111], v[212:215], a[184:187], v[96:111]
  ds_read_b64_tr_b16 v[196:197], v241 offset:32768
  buffer_load_dwordx4 v247, s[16:19], s40 offen offset:3072 lds
  v_mfma_f32_32x32x16_bf16 v[112:127], v[212:215], a[188:191], v[112:127]
  ds_read_b64_tr_b16 v[198:199], v241 offset:33792
  s_waitcnt lgkmcnt(6)
  v_mfma_f32_32x32x16_bf16 v[128:143], v[216:219], a[184:187], v[128:143]
  ds_read_b64_tr_b16 v[200:201], v242 offset:32768
  v_mfma_f32_32x32x16_bf16 v[144:159], v[216:219], a[188:191], v[144:159]
  ds_read_b64_tr_b16 v[202:203], v242 offset:33792
  s_waitcnt lgkmcnt(6)
  v_mfma_f32_32x32x16_bf16 v[160:175], v[220:223], a[184:187], v[160:175]
  ds_read_b64_tr_b16 v[204:205], v243 offset:32768
  v_mfma_f32_32x32x16_bf16 v[176:191], v[220:223], a[188:191], v[176:191]
  ds_read_b64_tr_b16 v[206:207], v243 offset:33792
  s_waitcnt lgkmcnt(6)
  v_mfma_f32_32x32x16_bf16 v[64:79], v[192:195], a[192:195], v[64:79]
  ds_read_b64_tr_b16 v[208:209], v240 offset:36864
  v_mfma_f32_32x32x16_bf16 v[80:95], v[192:195], a[196:199], v[80:95]
  ds_read_b64_tr_b16 v[210:211], v240 offset:37888
  s_mov_b32 s56, 32768
  s_waitcnt lgkmcnt(6)
  v_mfma_f32_32x32x16_bf16 v[96:111], v[196:199], a[192:195], v[96:111]
  ds_read_b64_tr_b16 v[212:213], v241 offset:36864
  buffer_load_dwordx4 a[128:131], v248, s[20:23], s56 offen offset:0
  v_mfma_f32_32x32x16_bf16 v[112:127], v[196:199], a[196:199], v[112:127]
  ds_read_b64_tr_b16 v[214:215], v241 offset:37888
  s_waitcnt lgkmcnt(6)
  v_mfma_f32_32x32x16_bf16 v[128:143], v[200:203], a[192:195], v[128:143]
  ds_read_b64_tr_b16 v[216:217], v242 offset:36864
  buffer_load_dwordx4 a[132:135], v249, s[20:23], s56 offen offset:0
  v_mfma_f32_32x32x16_bf16 v[144:159], v[200:203], a[196:199], v[144:159]
  ds_read_b64_tr_b16 v[218:219], v242 offset:37888
  s_waitcnt lgkmcnt(6)
  v_mfma_f32_32x32x16_bf16 v[160:175], v[204:207], a[192:195], v[160:175]
  ds_read_b64_tr_b16 v[220:221], v243 offset:36864
  buffer_load_dwordx4 a[136:139], v248, s[20:23], s56 offen offset:1024
  v_mfma_f32_32x32x16_bf16 v[176:191], v[204:207], a[196:199], v[176:191]
  ds_read_b64_tr_b16 v[222:223], v243 offset:37888
  s_waitcnt lgkmcnt(6)
  v_mfma_f32_32x32x16_bf16 v[64:79], v[208:211], a[200:203], v[64:79]
  ds_read_b64_tr_b16 v[192:193], v240 offset:40960
  buffer_load_dwordx4 a[140:143], v249, s[20:23], s56 offen offset:1024
  v_mfma_f32_32x32x16_bf16 v[80:95], v[208:211], a[204:207], v[80:95]
  ds_read_b64_tr_b16 v[194:195], v240 offset:41984
  s_waitcnt lgkmcnt(6)
  v_mfma_f32_32x32x16_bf16 v[96:111], v[212:215], a[200:203], v[96:111]
  ds_read_b64_tr_b16 v[196:197], v241 offset:40960
  buffer_load_dwordx4 a[144:147], v248, s[20:23], s56 offen offset:2048
  v_mfma_f32_32x32x16_bf16 v[112:127], v[212:215], a[204:207], v[112:127]
  ds_read_b64_tr_b16 v[198:199], v241 offset:41984
  s_waitcnt lgkmcnt(6)
  v_mfma_f32_32x32x16_bf16 v[128:143], v[216:219], a[200:203], v[128:143]
  ds_read_b64_tr_b16 v[200:201], v242 offset:40960
  buffer_load_dwordx4 a[148:151], v249, s[20:23], s56 offen offset:2048
  v_mfma_f32_32x32x16_bf16 v[144:159], v[216:219], a[204:207], v[144:159]
  ds_read_b64_tr_b16 v[202:203], v242 offset:41984
  s_waitcnt lgkmcnt(6)
  v_mfma_f32_32x32x16_bf16 v[160:175], v[220:223], a[200:203], v[160:175]
  ds_read_b64_tr_b16 v[204:205], v243 offset:40960
  buffer_load_dwordx4 a[152:155], v248, s[20:23], s56 offen offset:3072
  v_mfma_f32_32x32x16_bf16 v[176:191], v[220:223], a[204:207], v[176:191]
  ds_read_b64_tr_b16 v[206:207], v243 offset:41984
  s_waitcnt lgkmcnt(6)
  v_mfma_f32_32x32x16_bf16 v[64:79], v[192:195], a[208:211], v[64:79]
  ds_read_b64_tr_b16 v[208:209], v240 offset:45056
  buffer_load_dwordx4 a[156:159], v249, s[20:23], s56 offen offset:3072
  v_and_b32 v239, 2, v239
  v_cmp_eq_u32 vcc, 0, v239
  s_nop 3
  s_and_b64 vcc, vcc, s[68:69]
  s_cbranch_scc1 K12_KS
K12_KB:
  v_mfma_f32_32x32x16_bf16 v[80:95], v[192:195], a[212:215], v[80:95]
  ds_read_b64_tr_b16 v[210:211], v240 offset:46080
  s_waitcnt lgkmcnt(6)
  v_mfma_f32_32x32x16_bf16 v[96:111], v[196:199], a[208:211], v[96:111]
  ds_read_b64_tr_b16 v[212:213], v241 offset:45056
  s_waitcnt vmcnt(8)
  s_barrier
  v_mfma_f32_32x32x16_bf16 v[112:127], v[196:199], a[212:215], v[112:127]
  ds_read_b64_tr_b16 v[214:215], v241 offset:46080
  s_add_u32 m0, s39, 0
  s_mov_b32 s40, 4194304
  s_waitcnt lgkmcnt(6)
  v_mfma_f32_32x32x16_bf16 v[128:143], v[200:203], a[208:211], v[128:143]
  ds_read_b64_tr_b16 v[216:217], v242 offset:45056
  buffer_load_dwordx4 v244, s[16:19], s40 offen offset:0 lds
  v_mfma_f32_32x32x16_bf16 v[144:159], v[200:203], a[212:215], v[144:159]
  ds_read_b64_tr_b16 v[218:219], v242 offset:46080
  s_waitcnt lgkmcnt(6)
  v_mfma_f32_32x32x16_bf16 v[160:175], v[204:207], a[208:211], v[160:175]
  ds_read_b64_tr_b16 v[220:221], v243 offset:45056
  buffer_load_dwordx4 v245, s[16:19], s40 offen offset:1024 lds
  v_mfma_f32_32x32x16_bf16 v[176:191], v[204:207], a[212:215], v[176:191]
  ds_read_b64_tr_b16 v[222:223], v243 offset:46080
  s_waitcnt lgkmcnt(6)
  v_mfma_f32_32x32x16_bf16 v[64:79], v[208:211], a[216:219], v[64:79]
  ds_read_b64_tr_b16 v[192:193], v240 offset:49152
  buffer_load_dwordx4 v246, s[16:19], s40 offen offset:2048 lds
  v_mfma_f32_32x32x16_bf16 v[80:95], v[208:211], a[220:223], v[80:95]
  ds_read_b64_tr_b16 v[194:195], v240 offset:50176
  s_waitcnt lgkmcnt(6)
  v_mfma_f32_32x32x16_bf16 v[96:111], v[212:215], a[216:219], v[96:111]
  ds_read_b64_tr_b16 v[196:197], v241 offset:49152
  buffer_load_dwordx4 v247, s[16:19], s40 offen offset:3072 lds
  v_mfma_f32_32x32x16_bf16 v[112:127], v[212:215], a[220:223], v[112:127]
  ds_read_b64_tr_b16 v[198:199], v241 offset:50176
  s_mov_b32 m0, s41
  s_nop 0
  buffer_load_dwordx4 v229, s[24:27], 0 offen offset:0 lds
  s_waitcnt lgkmcnt(6)
  v_mfma_f32_32x32x16_bf16 v[128:143], v[216:219], a[216:219], v[128:143]
  ds_read_b64_tr_b16 v[200:201], v242 offset:49152
  v_mfma_f32_32x32x16_bf16 v[144:159], v[216:219], a[220:223], v[144:159]
  ds_read_b64_tr_b16 v[202:203], v242 offset:50176
  buffer_load_dwordx4 v229, s[24:27], 0 offen offset:1024 lds
  s_waitcnt lgkmcnt(6)
  v_mfma_f32_32x32x16_bf16 v[160:175], v[220:223], a[216:219], v[160:175]
  ds_read_b64_tr_b16 v[204:205], v243 offset:49152
  v_mfma_f32_32x32x16_bf16 v[176:191], v[220:223], a[220:223], v[176:191]
  ds_read_b64_tr_b16 v[206:207], v243 offset:50176
  buffer_load_dwordx4 v229, s[24:27], 0 offen offset:2048 lds
  s_waitcnt lgkmcnt(6)
  v_mfma_f32_32x32x16_bf16 v[64:79], v[192:195], a[224:227], v[64:79]
  ds_read_b64_tr_b16 v[208:209], v240 offset:53248
  v_mfma_f32_32x32x16_bf16 v[80:95], v[192:195], a[228:231], v[80:95]
  ds_read_b64_tr_b16 v[210:211], v240 offset:54272
  buffer_load_dwordx4 v229, s[24:27], 0 offen offset:3072 lds
  s_waitcnt lgkmcnt(6)
  v_mfma_f32_32x32x16_bf16 v[96:111], v[196:199], a[224:227], v[96:111]
  ds_read_b64_tr_b16 v[212:213], v241 offset:53248
  v_mfma_f32_32x32x16_bf16 v[112:127], v[196:199], a[228:231], v[112:127]
  ds_read_b64_tr_b16 v[214:215], v241 offset:54272
  s_add_u32 m0, s41, 4096
  s_nop 0
  buffer_load_dwordx4 v229, s[24:27], s42 offen offset:0 lds
  s_waitcnt lgkmcnt(6)
  v_mfma_f32_32x32x16_bf16 v[128:143], v[200:203], a[224:227], v[128:143]
  ds_read_b64_tr_b16 v[216:217], v242 offset:53248
  v_mfma_f32_32x32x16_bf16 v[144:159], v[200:203], a[228:231], v[144:159]
  ds_read_b64_tr_b16 v[218:219], v242 offset:54272
  buffer_load_dwordx4 v229, s[24:27], s42 offen offset:1024 lds
  s_waitcnt lgkmcnt(6)
  v_mfma_f32_32x32x16_bf16 v[160:175], v[204:207], a[224:227], v[160:175]
  ds_read_b64_tr_b16 v[220:221], v243 offset:53248
  v_mfma_f32_32x32x16_bf16 v[176:191], v[204:207], a[228:231], v[176:191]
  ds_read_b64_tr_b16 v[222:223], v243 offset:54272
  buffer_load_dwordx4 v229, s[24:27], s42 offen offset:2048 lds
  s_waitcnt lgkmcnt(6)
  v_mfma_f32_32x32x16_bf16 v[64:79], v[208:211], a[232:235], v[64:79]
  ds_read_b64_tr_b16 v[192:193], v240 offset:57344
  v_mfma_f32_32x32x16_bf16 v[80:95], v[208:211], a[236:239], v[80:95]
  ds_read_b64_tr_b16 v[194:195], v240 offset:58368
  buffer_load_dwordx4 v229, s[24:27], s42 offen offset:3072 lds
  s_waitcnt lgkmcnt(6)
  v_mfma_f32_32x32x16_bf16 v[96:111], v[212:215], a[232:235], v[96:111]
  ds_read_b64_tr_b16 v[196:197], v241 offset:57344
  v_mfma_f32_32x32x16_bf16 v[112:127], v[212:215], a[236:239], v[112:127]
  ds_read_b64_tr_b16 v[198:199], v241 offset:58368
  v_add_u32 v229, s43, v229
  s_add_u32 s41, s41, s43
  s_and_b32 s41, s41, 0x1ffff
  s_waitcnt lgkmcnt(6)
  v_mfma_f32_32x32x16_bf16 v[128:143], v[216:219], a[232:235], v[128:143]
  ds_read_b64_tr_b16 v[200:201], v242 offset:57344
  s_mov_b32 m0, s41
  s_nop 0
  buffer_load_dwordx4 v229, s[24:27], 0 offen offset:0 lds
  v_mfma_f32_32x32x16_bf16 v[144:159], v[216:219], a[236:239], v[144:159]
  ds_read_b64_tr_b16 v[202:203], v242 offset:58368
  s_waitcnt lgkmcnt(6)
  v_mfma_f32_32x32x16_bf16 v[160:175], v[220:223], a[232:235], v[160:175]
  ds_read_b64_tr_b16 v[204:205], v243 offset:57344
  buffer_load_dwordx4 v229, s[24:27], 0 offen offset:1024 lds
  v_mfma_f32_32x32x16_bf16 v[176:191], v[220:223], a[236:239], v[176:191]
  ds_read_b64_tr_b16 v[206:207], v243 offset:58368
  s_waitcnt lgkmcnt(6)
  v_mfma_f32_32x32x16_bf16 v[64:79], v[192:195], a[240:243], v[64:79]
  ds_read_b64_tr_b16 v[208:209], v240 offset:61440
  buffer_load_dwordx4 v229, s[24:27], 0 offen offset:2048 lds
  v_mfma_f32_32x32x16_bf16 v[80:95], v[192:195], a[244:247], v[80:95]
  ds_read_b64_tr_b16 v[210:211], v240 offset:62464
  s_waitcnt lgkmcnt(6)
  v_mfma_f32_32x32x16_bf16 v[96:111], v[196:199], a[240:243], v[96:111]
  ds_read_b64_tr_b16 v[212:213], v241 offset:61440
  buffer_load_dwordx4 v229, s[24:27], 0 offen offset:3072 lds
  s_waitcnt vmcnt(12)
  s_barrier
  v_mfma_f32_32x32x16_bf16 v[112:127], v[196:199], a[244:247], v[112:127]
  ds_read_b64_tr_b16 v[214:215], v241 offset:62464
  s_waitcnt lgkmcnt(6)
  v_mfma_f32_32x32x16_bf16 v[128:143], v[200:203], a[240:243], v[128:143]
  ds_read_b64_tr_b16 v[216:217], v242 offset:61440
  s_add_u32 m0, s41, 4096
  s_nop 0
  buffer_load_dwordx4 v229, s[24:27], s42 offen offset:0 lds
  v_mfma_f32_32x32x16_bf16 v[144:159], v[200:203], a[244:247], v[144:159]
  ds_read_b64_tr_b16 v[218:219], v242 offset:62464
  s_waitcnt lgkmcnt(6)
  v_mfma_f32_32x32x16_bf16 v[160:175], v[204:207], a[240:243], v[160:175]
  ds_read_b64_tr_b16 v[220:221], v243 offset:61440
  buffer_load_dwordx4 v229, s[24:27], s42 offen offset:1024 lds
  v_mfma_f32_32x32x16_bf16 v[176:191], v[204:207], a[244:247], v[176:191]
  ds_read_b64_tr_b16 v[222:223], v243 offset:62464
  s_waitcnt lgkmcnt(6)
  v_mfma_f32_32x32x16_bf16 v[64:79], v[208:211], a[248:251], v[64:79]
  ds_read_b64_tr_b16 v[192:193], v240 offset:0
  buffer_load_dwordx4 v229, s[24:27], s42 offen offset:2048 lds
  v_mfma_f32_32x32x16_bf16 v[80:95], v[208:211], a[252:255], v[80:95]
  ds_read_b64_tr_b16 v[194:195], v240 offset:1024
  s_waitcnt lgkmcnt(6)
  v_mfma_f32_32x32x16_bf16 v[96:111], v[212:215], a[248:251], v[96:111]
  ds_read_b64_tr_b16 v[196:197], v241 offset:0
  buffer_load_dwordx4 v229, s[24:27], s42 offen offset:3072 lds
  v_mfma_f32_32x32x16_bf16 v[112:127], v[212:215], a[252:255], v[112:127]
  ds_read_b64_tr_b16 v[198:199], v241 offset:1024
  s_waitcnt lgkmcnt(6)
  v_mfma_f32_32x32x16_bf16 v[128:143], v[216:219], a[248:251], v[128:143]
  ds_read_b64_tr_b16 v[200:201], v242 offset:0
  v_add_u32 v229, s43, v229
  s_add_u32 s41, s41, s43
  s_and_b32 s41, s41, 0x1ffff
  v_mfma_f32_32x32x16_bf16 v[144:159], v[216:219], a[252:255], v[144:159]
  ds_read_b64_tr_b16 v[202:203], v242 offset:1024
  s_waitcnt lgkmcnt(6)
  v_mfma_f32_32x32x16_bf16 v[160:175], v[220:223], a[248:251], v[160:175]
  ds_read_b64_tr_b16 v[204:205], v243 offset:0
  v_mfma_f32_32x32x16_bf16 v[176:191], v[220:223], a[252:255], v[176:191]
  ds_read_b64_tr_b16 v[206:207], v243 offset:1024
  s_waitcnt lgkmcnt(6)
  v_mfma_f32_32x32x16_bf16 v[64:79], v[192:195], a[128:131], v[64:79]
  ds_read_b64_tr_b16 v[208:209], v240 offset:4096
  v_mfma_f32_32x32x16_bf16 v[80:95], v[192:195], a[132:135], v[80:95]
  ds_read_b64_tr_b16 v[210:211], v240 offset:5120
  s_mov_b32 m0, s41
  s_nop 0
  buffer_load_dwordx4 v229, s[24:27], 0 offen offset:0 lds
  s_waitcnt lgkmcnt(6)
  v_mfma_f32_32x32x16_bf16 v[96:111], v[196:199], a[128:131], v[96:111]
  ds_read_b64_tr_b16 v[212:213], v241 offset:4096
  v_mfma_f32_32x32x16_bf16 v[112:127], v[196:199], a[132:135], v[112:127]
  ds_read_b64_tr_b16 v[214:215], v241 offset:5120
  buffer_load_dwordx4 v229, s[24:27], 0 offen offset:1024 lds
  s_waitcnt lgkmcnt(6)
  v_mfma_f32_32x32x16_bf16 v[128:143], v[200:203], a[128:131], v[128:143]
  ds_read_b64_tr_b16 v[216:217], v242 offset:4096
  v_mfma_f32_32x32x16_bf16 v[144:159], v[200:203], a[132:135], v[144:159]
  ds_read_b64_tr_b16 v[218:219], v242 offset:5120
  buffer_load_dwordx4 v229, s[24:27], 0 offen offset:2048 lds
  s_waitcnt lgkmcnt(6)
  v_mfma_f32_32x32x16_bf16 v[160:175], v[204:207], a[128:131], v[160:175]
  ds_read_b64_tr_b16 v[220:221], v243 offset:4096
  v_mfma_f32_32x32x16_bf16 v[176:191], v[204:207], a[132:135], v[176:191]
  ds_read_b64_tr_b16 v[222:223], v243 offset:5120
  buffer_load_dwordx4 v229, s[24:27], 0 offen offset:3072 lds
  s_waitcnt lgkmcnt(6)
  v_mfma_f32_32x32x16_bf16 v[64:79], v[208:211], a[136:139], v[64:79]
  ds_read_b64_tr_b16 v[192:193], v240 offset:8192
  v_mfma_f32_32x32x16_bf16 v[80:95], v[208:211], a[140:143], v[80:95]
  ds_read_b64_tr_b16 v[194:195], v240 offset:9216
  s_add_u32 m0, s41, 4096
  s_nop 0
  buffer_load_dwordx4 v229, s[24:27], s42 offen offset:0 lds
  s_waitcnt lgkmcnt(6)
  v_mfma_f32_32x32x16_bf16 v[96:111], v[212:215], a[136:139], v[96:111]
  ds_read_b64_tr_b16 v[196:197], v241 offset:8192
  v_mfma_f32_32x32x16_bf16 v[112:127], v[212:215], a[140:143], v[112:127]
  ds_read_b64_tr_b16 v[198:199], v241 offset:9216
  buffer_load_dwordx4 v229, s[24:27], s42 offen offset:1024 lds
  s_waitcnt lgkmcnt(6)
  v_mfma_f32_32x32x16_bf16 v[128:143], v[216:219], a[136:139], v[128:143]
  ds_read_b64_tr_b16 v[200:201], v242 offset:8192
  v_mfma_f32_32x32x16_bf16 v[144:159], v[216:219], a[140:143], v[144:159]
  ds_read_b64_tr_b16 v[202:203], v242 offset:9216
  buffer_load_dwordx4 v229, s[24:27], s42 offen offset:2048 lds
  s_waitcnt lgkmcnt(6)
  v_mfma_f32_32x32x16_bf16 v[160:175], v[220:223], a[136:139], v[160:175]
  ds_read_b64_tr_b16 v[204:205], v243 offset:8192
  v_mfma_f32_32x32x16_bf16 v[176:191], v[220:223], a[140:143], v[176:191]
  ds_read_b64_tr_b16 v[206:207], v243 offset:9216
  buffer_load_dwordx4 v229, s[24:27], s42 offen offset:3072 lds
  s_waitcnt lgkmcnt(6)
  v_mfma_f32_32x32x16_bf16 v[64:79], v[192:195], a[144:147], v[64:79]
  ds_read_b64_tr_b16 v[208:209], v240 offset:12288
  v_mfma_f32_32x32x16_bf16 v[80:95], v[192:195], a[148:151], v[80:95]
  ds_read_b64_tr_b16 v[210:211], v240 offset:13312
  v_add_u32 v229, s43, v229
  s_add_u32 s41, s41, s43
  s_and_b32 s41, s41, 0x1ffff
  s_waitcnt lgkmcnt(6)
  v_mfma_f32_32x32x16_bf16 v[96:111], v[196:199], a[144:147], v[96:111]
  ds_read_b64_tr_b16 v[212:213], v241 offset:12288
  s_waitcnt vmcnt(16)
  s_barrier
  v_mfma_f32_32x32x16_bf16 v[112:127], v[196:199], a[148:151], v[112:127]
  ds_read_b64_tr_b16 v[214:215], v241 offset:13312
  s_waitcnt lgkmcnt(6)
  v_mfma_f32_32x32x16_bf16 v[128:143], v[200:203], a[144:147], v[128:143]
  ds_read_b64_tr_b16 v[216:217], v242 offset:12288
  v_mfma_f32_32x32x16_bf16 v[144:159], v[200:203], a[148:151], v[144:159]
  ds_read_b64_tr_b16 v[218:219], v242 offset:13312
  s_waitcnt lgkmcnt(6)
  v_mfma_f32_32x32x16_bf16 v[160:175], v[204:207], a[144:147], v[160:175]
  ds_read_b64_tr_b16 v[220:221], v243 offset:12288
  v_mfma_f32_32x32x16_bf16 v[176:191], v[204:207], a[148:151], v[176:191]
  ds_read_b64_tr_b16 v[222:223], v243 offset:13312
  s_waitcnt lgkmcnt(6)
  v_mfma_f32_32x32x16_bf16 v[64:79], v[208:211], a[152:155], v[64:79]
  v_mfma_f32_32x32x16_bf16 v[80:95], v[208:211], a[156:159], v[80:95]
  s_waitcnt lgkmcnt(4)
  v_mfma_f32_32x32x16_bf16 v[96:111], v[212:215], a[152:155], v[96:111]
  v_mfma_f32_32x32x16_bf16 v[112:127], v[212:215], a[156:159], v[112:127]
  s_waitcnt lgkmcnt(2)
  v_mfma_f32_32x32x16_bf16 v[128:143], v[216:219], a[152:155], v[128:143]
  v_mfma_f32_32x32x16_bf16 v[144:159], v[216:219], a[156:159], v[144:159]
  s_waitcnt lgkmcnt(0)
  v_mfma_f32_32x32x16_bf16 v[160:175], v[220:223], a[152:155], v[160:175]
  v_mfma_f32_32x32x16_bf16 v[176:191], v[220:223], a[156:159], v[176:191]
  ds_read_b128 a[128:131], v228 offset:0
  ds_read_b128 a[132:135], v228 offset:1024
  ds_read_b128 a[136:139], v228 offset:2048
  ds_read_b128 a[140:143], v228 offset:3072
  ds_read_b128 a[144:147], v228 offset:4096
  ds_read_b128 a[148:151], v228 offset:5120
  ds_read_b128 a[152:155], v228 offset:6144
  ds_read_b128 a[156:159], v228 offset:7168
  v_cvt_pk_bf16_f32 v0, v64, v65
  v_cvt_pk_bf16_f32 v1, v66, v67
  v_cvt_pk_bf16_f32 v2, v68, v69
  v_cvt_pk_bf16_f32 v3, v70, v71
  v_cvt_pk_bf16_f32 v4, v72, v73
  v_cvt_pk_bf16_f32 v5, v74, v75
  v_cvt_pk_bf16_f32 v6, v76, v77
  v_cvt_pk_bf16_f32 v7, v78, v79
  v_cvt_pk_bf16_f32 v8, v96, v97
  v_cvt_pk_bf16_f32 v9, v98, v99
  v_cvt_pk_bf16_f32 v10, v100, v101
  v_cvt_pk_bf16_f32 v11, v102, v103
  v_cvt_pk_bf16_f32 v12, v104, v105
  v_cvt_pk_bf16_f32 v13, v106, v107
  v_cvt_pk_bf16_f32 v14, v108, v109
  v_cvt_pk_bf16_f32 v15, v110, v111
  v_cvt_pk_bf16_f32 v16, v128, v129
  v_cvt_pk_bf16_f32 v17, v130, v131
  v_cvt_pk_bf16_f32 v18, v132, v133
  v_cvt_pk_bf16_f32 v19, v134, v135
  v_cvt_pk_bf16_f32 v20, v136, v137
  v_cvt_pk_bf16_f32 v21, v138, v139
  v_cvt_pk_bf16_f32 v22, v140, v141
  v_cvt_pk_bf16_f32 v23, v142, v143
  v_cvt_pk_bf16_f32 v24, v160, v161
  v_cvt_pk_bf16_f32 v25, v162, v163
  v_cvt_pk_bf16_f32 v26, v164, v165
  v_cvt_pk_bf16_f32 v27, v166, v167
  v_cvt_pk_bf16_f32 v28, v168, v169
  v_cvt_pk_bf16_f32 v29, v170, v171
  v_cvt_pk_bf16_f32 v30, v172, v173
  v_cvt_pk_bf16_f32 v31, v174, v175
  v_cvt_pk_bf16_f32 v32, v80, v81
  v_cvt_pk_bf16_f32 v33, v82, v83
  v_cvt_pk_bf16_f32 v34, v84, v85
  v_cvt_pk_bf16_f32 v35, v86, v87
  v_cvt_pk_bf16_f32 v36, v88, v89
  v_cvt_pk_bf16_f32 v37, v90, v91
  v_cvt_pk_bf16_f32 v38, v92, v93
  v_cvt_pk_bf16_f32 v39, v94, v95
  v_cvt_pk_bf16_f32 v40, v112, v113
  v_cvt_pk_bf16_f32 v41, v114, v115
  v_cvt_pk_bf16_f32 v42, v116, v117
  v_cvt_pk_bf16_f32 v43, v118, v119
  v_cvt_pk_bf16_f32 v44, v120, v121
  v_cvt_pk_bf16_f32 v45, v122, v123
  v_cvt_pk_bf16_f32 v46, v124, v125
  v_cvt_pk_bf16_f32 v47, v126, v127
  v_cvt_pk_bf16_f32 v48, v144, v145
  v_cvt_pk_bf16_f32 v49, v146, v147
  v_cvt_pk_bf16_f32 v50, v148, v149
  v_cvt_pk_bf16_f32 v51, v150, v151
  v_cvt_pk_bf16_f32 v52, v152, v153
  v_cvt_pk_bf16_f32 v53, v154, v155
  v_cvt_pk_bf16_f32 v54, v156, v157
  v_cvt_pk_bf16_f32 v55, v158, v159
  v_cvt_pk_bf16_f32 v56, v176, v177
  v_cvt_pk_bf16_f32 v57, v178, v179
  v_cvt_pk_bf16_f32 v58, v180, v181
  v_cvt_pk_bf16_f32 v59, v182, v183
  v_cvt_pk_bf16_f32 v60, v184, v185
  v_cvt_pk_bf16_f32 v61, v186, v187
  v_cvt_pk_bf16_f32 v62, v188, v189
  v_cvt_pk_bf16_f32 v63, v190, v191
  v_and_b32 v230, 31, v224
  v_lshrrev_b32 v231, 5, v224
  v_lshlrev_b32 v231, 2, v231
  v_sub_u32 v230, v230, v231
  v_mov_b32 v231, -1e+30
  v_cmp_gt_i32 vcc, 0, v230
  s_nop 1
  v_cndmask_b32 v192, 0, v231, vcc
  v_cmp_gt_i32 vcc, 1, v230
  s_nop 1
  v_cndmask_b32 v193, 0, v231, vcc
  v_cmp_gt_i32 vcc, 2, v230
  s_nop 1
  v_cndmask_b32 v194, 0, v231, vcc
  v_cmp_gt_i32 vcc, 3, v230
  s_nop 1
  v_cndmask_b32 v195, 0, v231, vcc
  v_cmp_gt_i32 vcc, 8, v230
  s_nop 1
  v_cndmask_b32 v196, 0, v231, vcc
  v_cmp_gt_i32 vcc, 9, v230
  s_nop 1
  v_cndmask_b32 v197, 0, v231, vcc
  v_cmp_gt_i32 vcc, 10, v230
  s_nop 1
  v_cndmask_b32 v198, 0, v231, vcc
  v_cmp_gt_i32 vcc, 11, v230
  s_nop 1
  v_cndmask_b32 v199, 0, v231, vcc
  v_cmp_gt_i32 vcc, 16, v230
  s_nop 1
  v_cndmask_b32 v200, 0, v231, vcc
  v_cmp_gt_i32 vcc, 17, v230
  s_nop 1
  v_cndmask_b32 v201, 0, v231, vcc
  v_cmp_gt_i32 vcc, 18, v230
  s_nop 1
  v_cndmask_b32 v202, 0, v231, vcc
  v_cmp_gt_i32 vcc, 19, v230
  s_nop 1
  v_cndmask_b32 v203, 0, v231, vcc
  v_cmp_gt_i32 vcc, 24, v230
  s_nop 1
  v_cndmask_b32 v204, 0, v231, vcc
  v_cmp_gt_i32 vcc, 25, v230
  s_nop 1
  v_cndmask_b32 v205, 0, v231, vcc
  v_cmp_gt_i32 vcc, 26, v230
  s_nop 1
  v_cndmask_b32 v206, 0, v231, vcc
  v_cmp_gt_i32 vcc, 27, v230
  s_nop 1
  v_cndmask_b32 v207, 0, v231, vcc
  s_or_b32 s48, s38, s36
  s_cmp_eq_u32 s48, 0
  s_cselect_b32 s45, 1.0, 0
  v_mul_f32 v208, s45, v192
  v_mul_f32 v209, s45, v193
  v_mul_f32 v210, s45, v194
  v_mul_f32 v211, s45, v195
  v_mul_f32 v212, s45, v196
  v_mul_f32 v213, s45, v197
  v_mul_f32 v214, s45, v198
  v_mul_f32 v215, s45, v199
  v_mul_f32 v216, s45, v200
  v_mul_f32 v217, s45, v201
  v_mul_f32 v218, s45, v202
  v_mul_f32 v219, s45, v203
  v_mul_f32 v220, s45, v204
  v_mul_f32 v221, s45, v205
  v_mul_f32 v222, s45, v206
  v_mul_f32 v223, s45, v207
  s_waitcnt lgkmcnt(7)
  s_nop 0
  v_mfma_f32_32x32x16_bf16 v[64:79], a[128:131], v[0:3], v[208:223]
  v_mfma_f32_32x32x16_bf16 v[80:95], a[128:131], v[32:35], 0
  s_waitcnt lgkmcnt(6)
  v_mfma_f32_32x32x16_bf16 v[64:79], a[132:135], v[4:7], v[64:79]
  v_mfma_f32_32x32x16_bf16 v[80:95], a[132:135], v[36:39], v[80:95]
  s_waitcnt lgkmcnt(5)
  v_mfma_f32_32x32x16_bf16 v[64:79], a[136:139], v[8:11], v[64:79]
  v_mfma_f32_32x32x16_bf16 v[80:95], a[136:139], v[40:43], v[80:95]
  s_waitcnt lgkmcnt(4)
  v_mfma_f32_32x32x16_bf16 v[64:79], a[140:143], v[12:15], v[64:79]
  v_mfma_f32_32x32x16_bf16 v[80:95], a[140:143], v[44:47], v[80:95]
  s_waitcnt lgkmcnt(3)
  v_mfma_f32_32x32x16_bf16 v[64:79], a[144:147], v[16:19], v[64:79]
  v_mfma_f32_32x32x16_bf16 v[80:95], a[144:147], v[48:51], v[80:95]
  s_waitcnt lgkmcnt(2)
  v_mfma_f32_32x32x16_bf16 v[64:79], a[148:151], v[20:23], v[64:79]
  v_mfma_f32_32x32x16_bf16 v[80:95], a[148:151], v[52:55], v[80:95]
  s_waitcnt lgkmcnt(1)
  v_mfma_f32_32x32x16_bf16 v[64:79], a[152:155], v[24:27], v[64:79]
  v_mfma_f32_32x32x16_bf16 v[80:95], a[152:155], v[56:59], v[80:95]
  s_waitcnt lgkmcnt(0)
  v_mfma_f32_32x32x16_bf16 v[64:79], a[156:159], v[28:31], v[64:79]
  v_mfma_f32_32x32x16_bf16 v[80:95], a[156:159], v[60:63], v[80:95]
  s_nop 10
  v_max3_f32 v234, v64, v65, v66
  v_max3_f32 v234, v234, v67, v68
  v_max3_f32 v234, v234, v69, v70
  v_max3_f32 v234, v234, v71, v72
  v_max3_f32 v234, v234, v73, v74
  v_max3_f32 v234, v234, v75, v76
  v_max3_f32 v234, v234, v77, v78
  v_max_f32 v234, v234, v79
  v_max3_f32 v235, v80, v81, v82
  v_max3_f32 v235, v235, v83, v84
  v_max3_f32 v235, v235, v85, v86
  v_max3_f32 v235, v235, v87, v88
  v_max3_f32 v235, v235, v89, v90
  v_max3_f32 v235, v235, v91, v92
  v_max3_f32 v235, v235, v93, v94
  v_max_f32 v235, v235, v95
  v_mov_b32 v230, v234
  v_mov_b32 v231, v235
  s_nop 0
  v_permlane32_swap_b32 v230, v234
  v_permlane32_swap_b32 v231, v235
  v_max_f32 v230, v230, v234
  v_max_f32 v231, v231, v235
  v_xor_b32 v160, 0x80000000, v230
  v_mov_b32 v161, v160
  v_mov_b32 v162, v160
  v_mov_b32 v163, v160
  v_mov_b32 v164, v160
  v_mov_b32 v165, v160
  v_mov_b32 v166, v160
  v_mov_b32 v167, v160
  v_mov_b32 v168, v160
  v_mov_b32 v169, v160
  v_mov_b32 v170, v160
  v_mov_b32 v171, v160
  v_mov_b32 v172, v160
  v_mov_b32 v173, v160
  v_mov_b32 v174, v160
  v_mov_b32 v175, v160
  v_xor_b32 v176, 0x80000000, v231
  v_mov_b32 v177, v176
  v_mov_b32 v178, v176
  v_mov_b32 v179, v176
  v_mov_b32 v180, v176
  v_mov_b32 v181, v176
  v_mov_b32 v182, v176
  v_mov_b32 v183, v176
  v_mov_b32 v184, v176
  v_mov_b32 v185, v176
  v_mov_b32 v186, v176
  v_mov_b32 v187, v176
  v_mov_b32 v188, v176
  v_mov_b32 v189, v176
  v_mov_b32 v190, v176
  v_mov_b32 v191, v176
  v_mov_b32 v225, 0
  v_mov_b32 v226, 0
  s_cmp_eq_u32 s38, 0
  s_cselect_b32 s44, 0, -4
  s_add_i32 s48, s44, 0
  s_cmp_eq_i32 s48, s36
  s_cselect_b32 s45, 1.0, 0
  s_cmp_gt_i32 s48, s36
  s_cselect_b32 s46, -1e+30, 0
  v_add_f32 v230, s46, v160
  v_fma_f32 v208, v192, s45, v230
  v_fma_f32 v209, v193, s45, v230
  v_fma_f32 v210, v194, s45, v230
  v_fma_f32 v211, v195, s45, v230
  v_fma_f32 v212, v196, s45, v230
  v_fma_f32 v213, v197, s45, v230
  v_fma_f32 v214, v198, s45, v230
  v_fma_f32 v215, v199, s45, v230
  v_fma_f32 v216, v200, s45, v230
  v_fma_f32 v217, v201, s45, v230
  v_fma_f32 v218, v202, s45, v230
  v_fma_f32 v219, v203, s45, v230
  v_fma_f32 v220, v204, s45, v230
  v_fma_f32 v221, v205, s45, v230
  v_fma_f32 v222, v206, s45, v230
  v_fma_f32 v223, v207, s45, v230
  s_nop 1
  v_mfma_f32_32x32x16_bf16 v[64:79], a[128:131], v[0:3], v[208:223]
  v_mfma_f32_32x32x16_bf16 v[80:95], a[128:131], v[32:35], v[176:191]
  ds_read_b128 a[128:131], v228 offset:8192
  v_add_u32 v227, s43, v228
  v_mfma_f32_32x32x16_bf16 v[64:79], a[132:135], v[4:7], v[64:79]
  v_and_b32 v227, 0x1ffff, v227
  v_mfma_f32_32x32x16_bf16 v[80:95], a[132:135], v[36:39], v[80:95]
  ds_read_b128 a[132:135], v228 offset:9216
  s_add_i32 s48, s44, 1
  s_cmp_eq_i32 s48, s36
  s_cselect_b32 s45, 1.0, 0
  s_cmp_gt_i32 s48, s36
  s_cselect_b32 s46, -1e+30, 0
  v_mfma_f32_32x32x16_bf16 v[64:79], a[136:139], v[8:11], v[64:79]
  v_add_f32 v230, s46, v160
  v_fma_f32 v208, v192, s45, v230
  v_fma_f32 v209, v193, s45, v230
  v_fma_f32 v210, v194, s45, v230
  v_fma_f32 v211, v195, s45, v230
  v_fma_f32 v212, v196, s45, v230
  v_mfma_f32_32x32x16_bf16 v[80:95], a[136:139], v[40:43], v[80:95]
  ds_read_b128 a[136:139], v228 offset:10240
  v_fma_f32 v213, v197, s45, v230
  v_fma_f32 v214, v198, s45, v230
  v_fma_f32 v215, v199, s45, v230
  v_fma_f32 v216, v200, s45, v230
  v_fma_f32 v217, v201, s45, v230
  v_mfma_f32_32x32x16_bf16 v[64:79], a[140:143], v[12:15], v[64:79]
  v_fma_f32 v218, v202, s45, v230
  v_fma_f32 v219, v203, s45, v230
  v_fma_f32 v220, v204, s45, v230
  v_fma_f32 v221, v205, s45, v230
  v_fma_f32 v222, v206, s45, v230
  v_fma_f32 v223, v207, s45, v230
  v_mfma_f32_32x32x16_bf16 v[80:95], a[140:143], v[44:47], v[80:95]
  ds_read_b128 a[140:143], v228 offset:11264
  v_mfma_f32_32x32x16_bf16 v[64:79], a[144:147], v[16:19], v[64:79]
  v_mfma_f32_32x32x16_bf16 v[80:95], a[144:147], v[48:51], v[80:95]
  ds_read_b128 a[144:147], v228 offset:12288
  v_mfma_f32_32x32x16_bf16 v[64:79], a[148:151], v[20:23], v[64:79]
  v_mfma_f32_32x32x16_bf16 v[80:95], a[148:151], v[52:55], v[80:95]
  ds_read_b128 a[148:151], v228 offset:13312
  v_mfma_f32_32x32x16_bf16 v[64:79], a[152:155], v[24:27], v[64:79]
  v_mfma_f32_32x32x16_bf16 v[80:95], a[152:155], v[56:59], v[80:95]
  ds_read_b128 a[152:155], v228 offset:14336
  v_mfma_f32_32x32x16_bf16 v[64:79], a[156:159], v[28:31], v[64:79]
  v_mfma_f32_32x32x16_bf16 v[80:95], a[156:159], v[60:63], v[80:95]
  ds_read_b128 a[156:159], v228 offset:15360
  s_waitcnt lgkmcnt(7)
  v_mfma_f32_32x32x16_bf16 v[96:111], a[128:131], v[0:3], v[208:223]
  ds_read_b128 a[160:163], v228 offset:16384
  v_mfma_f32_32x32x16_bf16 v[112:127], a[128:131], v[32:35], v[176:191]
  s_waitcnt vmcnt(8)
  s_barrier
  s_waitcnt lgkmcnt(7)
  v_mfma_f32_32x32x16_bf16 v[96:111], a[132:135], v[4:7], v[96:111]
  ds_read_b128 a[164:167], v228 offset:20480
  s_mov_b32 m0, s41
  s_nop 0
  buffer_load_dwordx4 v229, s[24:27], 0 offen offset:0 lds
  v_exp_f32 v64, v64
  v_exp_f32 v65, v65
  v_add_f32 v225, v225, v64
  v_add_f32 v225, v225, v65
  v_cvt_pk_bf16_f32 v128, v64, v65
  v_mfma_f32_32x32x16_bf16 v[112:127], a[132:135], v[36:39], v[112:127]
  v_exp_f32 v66, v66
  v_exp_f32 v67, v67
  s_waitcnt lgkmcnt(7)
  v_mfma_f32_32x32x16_bf16 v[96:111], a[136:139], v[8:11], v[96:111]
  ds_read_b128 a[168:171], v228 offset:24576
  v_add_f32 v225, v225, v66
  v_add_f32 v225, v225, v67
  v_cvt_pk_bf16_f32 v129, v66, v67
  v_exp_f32 v68, v68
  v_exp_f32 v69, v69
  v_mfma_f32_32x32x16_bf16 v[112:127], a[136:139], v[40:43], v[112:127]
  buffer_load_dwordx4 v229, s[24:27], 0 offen offset:1024 lds
  v_add_f32 v225, v225, v68
  v_add_f32 v225, v225, v69
  v_cvt_pk_bf16_f32 v130, v68, v69
  s_waitcnt lgkmcnt(7)
  v_mfma_f32_32x32x16_bf16 v[96:111], a[140:143], v[12:15], v[96:111]
  ds_read_b128 a[172:175], v228 offset:28672
  v_exp_f32 v70, v70
  v_exp_f32 v71, v71
  v_add_f32 v225, v225, v70
  v_add_f32 v225, v225, v71
  v_cvt_pk_bf16_f32 v131, v70, v71
  v_mfma_f32_32x32x16_bf16 v[112:127], a[140:143], v[44:47], v[112:127]
  v_exp_f32 v80, v80
  v_exp_f32 v81, v81
  s_waitcnt lgkmcnt(7)
  v_mfma_f32_32x32x16_bf16 v[96:111], a[144:147], v[16:19], v[96:111]
  ds_read_b128 a[176:179], v228 offset:17408
  buffer_load_dwordx4 v229, s[24:27], 0 offen offset:2048 lds
  v_add_f32 v226, v226, v80
  v_add_f32 v226, v226, v81
  v_cvt_pk_bf16_f32 v136, v80, v81
  v_exp_f32 v82, v82
  v_exp_f32 v83, v83
  v_mfma_f32_32x32x16_bf16 v[112:127], a[144:147], v[48:51], v[112:127]
  v_add_f32 v226, v226, v82
  v_add_f32 v226, v226, v83
  v_cvt_pk_bf16_f32 v137, v82, v83
  s_waitcnt lgkmcnt(7)
  v_mfma_f32_32x32x16_bf16 v[96:111], a[148:151], v[20:23], v[96:111]
  ds_read_b128 a[180:183], v228 offset:21504
  v_exp_f32 v84, v84
  v_exp_f32 v85, v85
  v_add_f32 v226, v226, v84
  v_add_f32 v226, v226, v85
  v_cvt_pk_bf16_f32 v138, v84, v85
  v_mfma_f32_32x32x16_bf16 v[112:127], a[148:151], v[52:55], v[112:127]
  buffer_load_dwordx4 v229, s[24:27], 0 offen offset:3072 lds
  v_exp_f32 v86, v86
  v_exp_f32 v87, v87
  s_waitcnt lgkmcnt(7)
  v_mfma_f32_32x32x16_bf16 v[96:111], a[152:155], v[24:27], v[96:111]
  ds_read_b128 a[184:187], v228 offset:25600
  v_add_f32 v226, v226, v86
  v_add_f32 v226, v226, v87
  v_cvt_pk_bf16_f32 v139, v86, v87
  v_mfma_f32_32x32x16_bf16 v[112:127], a[152:155], v[56:59], v[112:127]
  v_exp_f32 v72, v72
  v_exp_f32 v73, v73
  v_add_f32 v225, v225, v72
  v_add_f32 v225, v225, v73
  v_cvt_pk_bf16_f32 v132, v72, v73
  s_waitcnt lgkmcnt(7)
  v_mfma_f32_32x32x16_bf16 v[96:111], a[156:159], v[28:31], v[96:111]
  ds_read_b128 a[188:191], v228 offset:29696
  s_add_u32 m0, s41, 4096
  s_nop 0
  buffer_load_dwordx4 v229, s[24:27], s42 offen offset:0 lds
  v_exp_f32 v74, v74
  v_exp_f32 v75, v75
  v_mfma_f32_32x32x16_bf16 v[112:127], a[156:159], v[60:63], v[112:127]
  v_add_f32 v225, v225, v74
  v_add_f32 v225, v225, v75
  v_cvt_pk_bf16_f32 v133, v74, v75
  v_exp_f32 v76, v76
  v_exp_f32 v77, v77
  s_waitcnt lgkmcnt(7)
  v_mfma_f32_32x32x16_bf16 a[0:15], a[160:163], v[128:131], 0
  ds_read_b128 a[128:131], v227 offset:0
  v_add_f32 v225, v225, v76
  v_add_f32 v225, v225, v77
  v_cvt_pk_bf16_f32 v134, v76, v77
  v_mfma_f32_32x32x16_bf16 a[64:79], a[160:163], v[136:139], 0
  buffer_load_dwordx4 v229, s[24:27], s42 offen offset:1024 lds
  v_exp_f32 v78, v78
  v_exp_f32 v79, v79
  v_add_f32 v225, v225, v78
  v_add_f32 v225, v225, v79
  v_cvt_pk_bf16_f32 v135, v78, v79
  s_waitcnt lgkmcnt(7)
  v_mfma_f32_32x32x16_bf16 a[16:31], a[164:167], v[128:131], 0
  ds_read_b128 a[132:135], v227 offset:1024
  v_exp_f32 v88, v88
  v_exp_f32 v89, v89
  v_mfma_f32_32x32x16_bf16 a[80:95], a[164:167], v[136:139], 0
  v_add_f32 v226, v226, v88
  v_add_f32 v226, v226, v89
  v_cvt_pk_bf16_f32 v140, v88, v89
  v_exp_f32 v90, v90
  v_exp_f32 v91, v91
  s_waitcnt lgkmcnt(7)
  v_mfma_f32_32x32x16_bf16 a[32:47], a[168:171], v[128:131], 0
  ds_read_b128 a[136:139], v227 offset:2048
  buffer_load_dwordx4 v229, s[24:27], s42 offen offset:2048 lds
  v_add_f32 v226, v226, v90
  v_add_f32 v226, v226, v91
  v_cvt_pk_bf16_f32 v141, v90, v91
  v_mfma_f32_32x32x16_bf16 a[96:111], a[168:171], v[136:139], 0
  v_exp_f32 v92, v92
  v_exp_f32 v93, v93
  v_add_f32 v226, v226, v92
  v_add_f32 v226, v226, v93
  v_cvt_pk_bf16_f32 v142, v92, v93
  s_waitcnt lgkmcnt(7)
  v_mfma_f32_32x32x16_bf16 a[48:63], a[172:175], v[128:131], 0
  ds_read_b128 a[140:143], v227 offset:3072
  v_exp_f32 v94, v94
  v_exp_f32 v95, v95
  v_mfma_f32_32x32x16_bf16 a[112:127], a[172:175], v[136:139], 0
  buffer_load_dwordx4 v229, s[24:27], s42 offen offset:3072 lds
  v_add_f32 v226, v226, v94
  v_add_f32 v226, v226, v95
  v_cvt_pk_bf16_f32 v143, v94, v95
  s_waitcnt lgkmcnt(7)
  v_mfma_f32_32x32x16_bf16 a[0:15], a[176:179], v[132:135], a[0:15]
  ds_read_b128 a[144:147], v227 offset:4096
  v_exp_f32 v96, v96
  v_exp_f32 v97, v97
  v_add_f32 v225, v225, v96
  v_add_f32 v225, v225, v97
  v_cvt_pk_bf16_f32 v144, v96, v97
  v_mfma_f32_32x32x16_bf16 a[64:79], a[176:179], v[140:143], a[64:79]
  v_exp_f32 v98, v98
  v_exp_f32 v99, v99
  v_add_f32 v225, v225, v98
  v_add_f32 v225, v225, v99
  v_cvt_pk_bf16_f32 v145, v98, v99
  s_waitcnt lgkmcnt(7)
  v_mfma_f32_32x32x16_bf16 a[16:31], a[180:183], v[132:135], a[16:31]
  ds_read_b128 a[148:151], v227 offset:5120
  v_add_u32 v229, s43, v229
  s_add_u32 s41, s41, s43
  s_and_b32 s41, s41, 0x1ffff
  v_exp_f32 v100, v100
  v_exp_f32 v101, v101
  v_add_f32 v225, v225, v100
  v_add_f32 v225, v225, v101
  v_cvt_pk_bf16_f32 v146, v100, v101
  v_mfma_f32_32x32x16_bf16 a[80:95], a[180:183], v[140:143], a[80:95]
  v_exp_f32 v102, v102
  v_exp_f32 v103, v103
  s_waitcnt lgkmcnt(7)
  v_mfma_f32_32x32x16_bf16 a[32:47], a[184:187], v[132:135], a[32:47]
  ds_read_b128 a[152:155], v227 offset:6144
  v_add_f32 v225, v225, v102
  v_add_f32 v225, v225, v103
  v_cvt_pk_bf16_f32 v147, v102, v103
  v_exp_f32 v112, v112
  v_exp_f32 v113, v113
  v_mfma_f32_32x32x16_bf16 a[96:111], a[184:187], v[140:143], a[96:111]
  v_add_f32 v226, v226, v112
  v_add_f32 v226, v226, v113
  v_cvt_pk_bf16_f32 v152, v112, v113
  v_exp_f32 v114, v114
  v_exp_f32 v115, v115
  s_waitcnt lgkmcnt(7)
  v_mfma_f32_32x32x16_bf16 a[48:63], a[188:191], v[132:135], a[48:63]
  ds_read_b128 a[156:159], v227 offset:7168
  v_add_f32 v226, v226, v114
  v_add_f32 v226, v226, v115
  v_cvt_pk_bf16_f32 v153, v114, v115
  v_exp_f32 v116, v116
  v_exp_f32 v117, v117
  v_mfma_f32_32x32x16_bf16 a[112:127], a[188:191], v[140:143], a[112:127]
  v_add_f32 v226, v226, v116
  v_add_f32 v226, v226, v117
  v_cvt_pk_bf16_f32 v154, v116, v117
  buffer_load_dwordx4 a[192:195], v253, s[84:87], 0 offen
  buffer_load_dwordx4 a[196:199], v254, s[88:91], 0 offen
  v_swap_b32 v227, v228
  s_add_i32 s44, s44, 2
  s_lshl_b32 s47, s38, 1
  s_cmp_eq_u32 s38, 0
  s_cbranch_scc1 K2_DM_J0
  s_sub_u32 s47, s47, 1
K2_D:
  s_waitcnt lgkmcnt(7)
  v_mfma_f32_32x32x16_bf16 v[64:79], a[128:131], v[0:3], v[160:175]
  ds_read_b128 a[160:163], v227 offset:18432
  v_exp_f32 v118, v118
  v_exp_f32 v119, v119
  v_mfma_f32_32x32x16_bf16 v[80:95], a[128:131], v[32:35], v[176:191]
  buffer_load_dword v252, v250, s[80:83], 0 offen
  v_add_f32 v226, v226, v118
  v_add_f32 v226, v226, v119
  v_cvt_pk_bf16_f32 v155, v118, v119
  s_waitcnt lgkmcnt(7)
  v_mfma_f32_32x32x16_bf16 v[64:79], a[132:135], v[4:7], v[64:79]
  ds_read_b128 a[164:167], v227 offset:22528
  v_exp_f32 v104, v104
  v_exp_f32 v105, v105
  v_add_u32 v250, 430080, v250
  v_mfma_f32_32x32x16_bf16 v[80:95], a[132:135], v[36:39], v[80:95]
  v_add_f32 v225, v225, v104
  v_add_f32 v225, v225, v105
  v_cvt_pk_bf16_f32 v148, v104, v105
  s_waitcnt lgkmcnt(7)
  v_mfma_f32_32x32x16_bf16 v[64:79], a[136:139], v[8:11], v[64:79]
  ds_read_b128 a[168:171], v227 offset:26624
  v_exp_f32 v106, v106
  v_exp_f32 v107, v107
  v_mfma_f32_32x32x16_bf16 v[80:95], a[136:139], v[40:43], v[80:95]
  v_add_f32 v225, v225, v106
  v_add_f32 v225, v225, v107
  v_cvt_pk_bf16_f32 v149, v106, v107
  s_waitcnt lgkmcnt(7)
  v_mfma_f32_32x32x16_bf16 v[64:79], a[140:143], v[12:15], v[64:79]
  ds_read_b128 a[172:175], v227 offset:30720
  v_exp_f32 v108, v108
  v_exp_f32 v109, v109
  v_mfma_f32_32x32x16_bf16 v[80:95], a[140:143], v[44:47], v[80:95]
  v_add_f32 v225, v225, v108
  v_add_f32 v225, v225, v109
  v_cvt_pk_bf16_f32 v150, v108, v109
  s_waitcnt lgkmcnt(7)
  v_mfma_f32_32x32x16_bf16 v[64:79], a[144:147], v[16:19], v[64:79]
  ds_read_b128 a[176:179], v227 offset:19456
  v_exp_f32 v110, v110
  v_exp_f32 v111, v111
  v_mfma_f32_32x32x16_bf16 v[80:95], a[144:147], v[48:51], v[80:95]
  v_add_f32 v225, v225, v110
  v_add_f32 v225, v225, v111
  v_cvt_pk_bf16_f32 v151, v110, v111
  s_waitcnt lgkmcnt(7)
  v_mfma_f32_32x32x16_bf16 v[64:79], a[148:151], v[20:23], v[64:79]
  ds_read_b128 a[180:183], v227 offset:23552
  v_exp_f32 v120, v120
  v_exp_f32 v121, v121
  v_mfma_f32_32x32x16_bf16 v[80:95], a[148:151], v[52:55], v[80:95]
  v_add_f32 v226, v226, v120
  v_add_f32 v226, v226, v121
  v_cvt_pk_bf16_f32 v156, v120, v121
  s_waitcnt lgkmcnt(7)
  v_mfma_f32_32x32x16_bf16 v[64:79], a[152:155], v[24:27], v[64:79]
  ds_read_b128 a[184:187], v227 offset:27648
  v_exp_f32 v122, v122
  v_exp_f32 v123, v123
  v_mfma_f32_32x32x16_bf16 v[80:95], a[152:155], v[56:59], v[80:95]
  v_add_f32 v226, v226, v122
  v_add_f32 v226, v226, v123
  v_cvt_pk_bf16_f32 v157, v122, v123
  s_waitcnt lgkmcnt(7)
  v_mfma_f32_32x32x16_bf16 v[64:79], a[156:159], v[28:31], v[64:79]
  ds_read_b128 a[188:191], v227 offset:31744
  v_exp_f32 v124, v124
  v_exp_f32 v125, v125
  v_mfma_f32_32x32x16_bf16 v[80:95], a[156:159], v[60:63], v[80:95]
  v_add_f32 v226, v226, v124
  v_add_f32 v226, v226, v125
  v_cvt_pk_bf16_f32 v158, v124, v125
  s_waitcnt lgkmcnt(7)
  v_mfma_f32_32x32x16_bf16 a[0:15], a[160:163], v[144:147], a[0:15]
  ds_read_b128 a[128:131], v228 offset:8192
  v_exp_f32 v126, v126
  v_exp_f32 v127, v127
  v_mfma_f32_32x32x16_bf16 a[64:79], a[160:163], v[152:155], a[64:79]
  v_add_u32 v227, s43, v228
  v_add_f32 v226, v226, v126
  v_add_f32 v226, v226, v127
  v_cvt_pk_bf16_f32 v159, v126, v127
  s_waitcnt lgkmcnt(7)
  v_mfma_f32_32x32x16_bf16 a[16:31], a[164:167], v[144:147], a[16:31]
  ds_read_b128 a[132:135], v228 offset:9216
  v_and_b32 v227, 0x1ffff, v227
  v_exp_f32 v64, v64
  v_exp_f32 v65, v65
  v_mfma_f32_32x32x16_bf16 a[80:95], a[164:167], v[152:155], a[80:95]
  v_add_f32 v225, v225, v64
  v_add_f32 v225, v225, v65
  v_cvt_pk_bf16_f32 v128, v64, v65
  s_waitcnt lgkmcnt(7)
  v_mfma_f32_32x32x16_bf16 a[32:47], a[168:171], v[144:147], a[32:47]
  ds_read_b128 a[136:139], v228 offset:10240
  v_exp_f32 v66, v66
  v_exp_f32 v67, v67
  v_mfma_f32_32x32x16_bf16 a[96:111], a[168:171], v[152:155], a[96:111]
  v_add_f32 v225, v225, v66
  v_add_f32 v225, v225, v67
  v_cvt_pk_bf16_f32 v129, v66, v67
  s_waitcnt lgkmcnt(7)
  v_mfma_f32_32x32x16_bf16 a[48:63], a[172:175], v[144:147], a[48:63]
  ds_read_b128 a[140:143], v228 offset:11264
  v_exp_f32 v68, v68
  v_exp_f32 v69, v69
  v_mfma_f32_32x32x16_bf16 a[112:127], a[172:175], v[152:155], a[112:127]
  v_add_f32 v225, v225, v68
  v_add_f32 v225, v225, v69
  v_cvt_pk_bf16_f32 v130, v68, v69
  s_waitcnt lgkmcnt(7)
  v_mfma_f32_32x32x16_bf16 a[0:15], a[176:179], v[148:151], a[0:15]
  ds_read_b128 a[144:147], v228 offset:12288
  v_exp_f32 v70, v70
  v_exp_f32 v71, v71
  v_mfma_f32_32x32x16_bf16 a[64:79], a[176:179], v[156:159], a[64:79]
  v_add_f32 v225, v225, v70
  v_add_f32 v225, v225, v71
  v_cvt_pk_bf16_f32 v131, v70, v71
  s_waitcnt lgkmcnt(7)
  v_mfma_f32_32x32x16_bf16 a[16:31], a[180:183], v[148:151], a[16:31]
  ds_read_b128 a[148:151], v228 offset:13312
  v_exp_f32 v80, v80
  v_exp_f32 v81, v81
  v_mfma_f32_32x32x16_bf16 a[80:95], a[180:183], v[156:159], a[80:95]
  v_add_f32 v226, v226, v80
  v_add_f32 v226, v226, v81
  v_cvt_pk_bf16_f32 v136, v80, v81
  s_waitcnt lgkmcnt(7)
  v_mfma_f32_32x32x16_bf16 a[32:47], a[184:187], v[148:151], a[32:47]
  ds_read_b128 a[152:155], v228 offset:14336
  v_exp_f32 v82, v82
  v_exp_f32 v83, v83
  v_mfma_f32_32x32x16_bf16 a[96:111], a[184:187], v[156:159], a[96:111]
  v_add_f32 v226, v226, v82
  v_add_f32 v226, v226, v83
  v_cvt_pk_bf16_f32 v137, v82, v83
  s_waitcnt lgkmcnt(7)
  v_mfma_f32_32x32x16_bf16 a[48:63], a[188:191], v[148:151], a[48:63]
  ds_read_b128 a[156:159], v228 offset:15360
  v_exp_f32 v84, v84
  v_exp_f32 v85, v85
  v_mfma_f32_32x32x16_bf16 a[112:127], a[188:191], v[156:159], a[112:127]
  v_add_f32 v226, v226, v84
  v_add_f32 v226, v226, v85
  v_cvt_pk_bf16_f32 v138, v84, v85
  s_waitcnt lgkmcnt(7)
  v_mfma_f32_32x32x16_bf16 v[96:111], a[128:131], v[0:3], v[160:175]
  ds_read_b128 a[160:163], v228 offset:16384
  v_exp_f32 v86, v86
  v_exp_f32 v87, v87
  v_mfma_f32_32x32x16_bf16 v[112:127], a[128:131], v[32:35], v[176:191]
  v_add_f32 v226, v226, v86
  v_add_f32 v226, v226, v87
  v_cvt_pk_bf16_f32 v139, v86, v87
  s_waitcnt vmcnt(10)
  s_barrier
  s_waitcnt lgkmcnt(7)
  v_mfma_f32_32x32x16_bf16 v[96:111], a[132:135], v[4:7], v[96:111]
  ds_read_b128 a[164:167], v228 offset:20480
  s_mov_b32 m0, s41
  s_nop 0
  buffer_load_dwordx4 v229, s[24:27], 0 offen offset:0 lds
  v_exp_f32 v72, v72
  v_exp_f32 v73, v73
  v_mfma_f32_32x32x16_bf16 v[112:127], a[132:135], v[36:39], v[112:127]
  v_add_f32 v225, v225, v72
  v_add_f32 v225, v225, v73
  v_cvt_pk_bf16_f32 v132, v72, v73
  s_waitcnt lgkmcnt(7)
  v_mfma_f32_32x32x16_bf16 v[96:111], a[136:139], v[8:11], v[96:111]
  ds_read_b128 a[168:171], v228 offset:24576
  v_exp_f32 v74, v74
  v_exp_f32 v75, v75
  v_mfma_f32_32x32x16_bf16 v[112:127], a[136:139], v[40:43], v[112:127]
  buffer_load_dwordx4 v229, s[24:27], 0 offen offset:1024 lds
  v_add_f32 v225, v225, v74
  v_add_f32 v225, v225, v75
  v_cvt_pk_bf16_f32 v133, v74, v75
  s_waitcnt lgkmcnt(7)
  v_mfma_f32_32x32x16_bf16 v[96:111], a[140:143], v[12:15], v[96:111]
  ds_read_b128 a[172:175], v228 offset:28672
  v_exp_f32 v76, v76
  v_exp_f32 v77, v77
  v_mfma_f32_32x32x16_bf16 v[112:127], a[140:143], v[44:47], v[112:127]
  v_add_f32 v225, v225, v76
  v_add_f32 v225, v225, v77
  v_cvt_pk_bf16_f32 v134, v76, v77
  s_waitcnt lgkmcnt(7)
  v_mfma_f32_32x32x16_bf16 v[96:111], a[144:147], v[16:19], v[96:111]
  ds_read_b128 a[176:179], v228 offset:17408
  buffer_load_dwordx4 v229, s[24:27], 0 offen offset:2048 lds
  v_exp_f32 v78, v78
  v_exp_f32 v79, v79
  v_mfma_f32_32x32x16_bf16 v[112:127], a[144:147], v[48:51], v[112:127]
  v_add_f32 v225, v225, v78
  v_add_f32 v225, v225, v79
  v_cvt_pk_bf16_f32 v135, v78, v79
  s_waitcnt lgkmcnt(7)
  v_mfma_f32_32x32x16_bf16 v[96:111], a[148:151], v[20:23], v[96:111]
  ds_read_b128 a[180:183], v228 offset:21504
  v_exp_f32 v88, v88
  v_exp_f32 v89, v89
  v_mfma_f32_32x32x16_bf16 v[112:127], a[148:151], v[52:55], v[112:127]
  buffer_load_dwordx4 v229, s[24:27], 0 offen offset:3072 lds
  v_add_f32 v226, v226, v88
  v_add_f32 v226, v226, v89
  v_cvt_pk_bf16_f32 v140, v88, v89
  s_waitcnt lgkmcnt(7)
  v_mfma_f32_32x32x16_bf16 v[96:111], a[152:155], v[24:27], v[96:111]
  ds_read_b128 a[184:187], v228 offset:25600
  v_exp_f32 v90, v90
  v_exp_f32 v91, v91
  v_mfma_f32_32x32x16_bf16 v[112:127], a[152:155], v[56:59], v[112:127]
  v_add_f32 v226, v226, v90
  v_add_f32 v226, v226, v91
  v_cvt_pk_bf16_f32 v141, v90, v91
  s_waitcnt lgkmcnt(7)
  v_mfma_f32_32x32x16_bf16 v[96:111], a[156:159], v[28:31], v[96:111]
  ds_read_b128 a[188:191], v228 offset:29696
  s_add_u32 m0, s41, 4096
  s_nop 0
  buffer_load_dwordx4 v229, s[24:27], s42 offen offset:0 lds
  v_exp_f32 v92, v92
  v_exp_f32 v93, v93
  v_mfma_f32_32x32x16_bf16 v[112:127], a[156:159], v[60:63], v[112:127]
  v_add_f32 v226, v226, v92
  v_add_f32 v226, v226, v93
  v_cvt_pk_bf16_f32 v142, v92, v93
  s_waitcnt lgkmcnt(7)
  v_mfma_f32_32x32x16_bf16 a[0:15], a[160:163], v[128:131], a[0:15]
  ds_read_b128 a[128:131], v227 offset:0
  v_exp_f32 v94, v94
  v_exp_f32 v95, v95
  v_mfma_f32_32x32x16_bf16 a[64:79], a[160:163], v[136:139], a[64:79]
  buffer_load_dwordx4 v229, s[24:27], s42 offen offset:1024 lds
  v_add_f32 v226, v226, v94
  v_add_f32 v226, v226, v95
  v_cvt_pk_bf16_f32 v143, v94, v95
  s_waitcnt lgkmcnt(7)
  v_mfma_f32_32x32x16_bf16 a[16:31], a[164:167], v[128:131], a[16:31]
  ds_read_b128 a[132:135], v227 offset:1024
  v_exp_f32 v96, v96
  v_exp_f32 v97, v97
  v_mfma_f32_32x32x16_bf16 a[80:95], a[164:167], v[136:139], a[80:95]
  v_add_f32 v225, v225, v96
  v_add_f32 v225, v225, v97
  v_cvt_pk_bf16_f32 v144, v96, v97
  s_waitcnt lgkmcnt(7)
  v_mfma_f32_32x32x16_bf16 a[32:47], a[168:171], v[128:131], a[32:47]
  ds_read_b128 a[136:139], v227 offset:2048
  buffer_load_dwordx4 v229, s[24:27], s42 offen offset:2048 lds
  v_exp_f32 v98, v98
  v_exp_f32 v99, v99
  v_mfma_f32_32x32x16_bf16 a[96:111], a[168:171], v[136:139], a[96:111]
  v_add_f32 v225, v225, v98
  v_add_f32 v225, v225, v99
  v_cvt_pk_bf16_f32 v145, v98, v99
  s_waitcnt lgkmcnt(7)
  v_mfma_f32_32x32x16_bf16 a[48:63], a[172:175], v[128:131], a[48:63]
  ds_read_b128 a[140:143], v227 offset:3072
  v_exp_f32 v100, v100
  v_exp_f32 v101, v101
  v_mfma_f32_32x32x16_bf16 a[112:127], a[172:175], v[136:139], a[112:127]
  buffer_load_dwordx4 v229, s[24:27], s42 offen offset:3072 lds
  v_add_f32 v225, v225, v100
  v_add_f32 v225, v225, v101
  v_cvt_pk_bf16_f32 v146, v100, v101
  s_waitcnt lgkmcnt(7)
  v_mfma_f32_32x32x16_bf16 a[0:15], a[176:179], v[132:135], a[0:15]
  ds_read_b128 a[144:147], v227 offset:4096
  v_exp_f32 v102, v102
  v_exp_f32 v103, v103
  v_mfma_f32_32x32x16_bf16 a[64:79], a[176:179], v[140:143], a[64:79]
  v_add_f32 v225, v225, v102
  v_add_f32 v225, v225, v103
  v_cvt_pk_bf16_f32 v147, v102, v103
  s_waitcnt lgkmcnt(7)
  v_mfma_f32_32x32x16_bf16 a[16:31], a[180:183], v[132:135], a[16:31]
  ds_read_b128 a[148:151], v227 offset:5120
  v_add_u32 v229, s43, v229
  s_add_u32 s41, s41, s43
  s_and_b32 s41, s41, 0x1ffff
  v_exp_f32 v112, v112
  v_exp_f32 v113, v113
  v_mfma_f32_32x32x16_bf16 a[80:95], a[180:183], v[140:143], a[80:95]
  v_add_f32 v226, v226, v112
  v_add_f32 v226, v226, v113
  v_cvt_pk_bf16_f32 v152, v112, v113
  s_waitcnt lgkmcnt(7)
  v_mfma_f32_32x32x16_bf16 a[32:47], a[184:187], v[132:135], a[32:47]
  ds_read_b128 a[152:155], v227 offset:6144
  v_exp_f32 v114, v114
  v_exp_f32 v115, v115
  v_mfma_f32_32x32x16_bf16 a[96:111], a[184:187], v[140:143], a[96:111]
  v_add_f32 v226, v226, v114
  v_add_f32 v226, v226, v115
  v_cvt_pk_bf16_f32 v153, v114, v115
  s_waitcnt lgkmcnt(7)
  v_mfma_f32_32x32x16_bf16 a[48:63], a[188:191], v[132:135], a[48:63]
  ds_read_b128 a[156:159], v227 offset:7168
  v_exp_f32 v116, v116
  v_exp_f32 v117, v117
  v_mfma_f32_32x32x16_bf16 a[112:127], a[188:191], v[140:143], a[112:127]
  v_add_f32 v226, v226, v116
  v_add_f32 v226, v226, v117
  v_cvt_pk_bf16_f32 v154, v116, v117
  v_swap_b32 v227, v228
  s_sub_u32 s47, s47, 1
  s_cmp_lg_u32 s47, 0
  s_cbranch_scc1 K2_D
  s_mov_b32 s44, 0
K2_DM_J0:
K2_DM:
  s_add_i32 s48, s44, 0
  s_cmp_eq_i32 s48, s36
  s_cselect_b32 s45, 1.0, 0
  s_cmp_gt_i32 s48, s36
  s_cselect_b32 s46, -1e+30, 0
  v_add_f32 v230, s46, v160
  v_fma_f32 v208, v192, s45, v230
  v_fma_f32 v209, v193, s45, v230
  v_fma_f32 v210, v194, s45, v230
  v_fma_f32 v211, v195, s45, v230
  v_fma_f32 v212, v196, s45, v230
  v_fma_f32 v213, v197, s45, v230
  v_fma_f32 v214, v198, s45, v230
  v_fma_f32 v215, v199, s45, v230
  v_fma_f32 v216, v200, s45, v230
  v_fma_f32 v217, v201, s45, v230
  v_fma_f32 v218, v202, s45, v230
  v_fma_f32 v219, v203, s45, v230
  v_fma_f32 v220, v204, s45, v230
  v_fma_f32 v221, v205, s45, v230
  v_fma_f32 v222, v206, s45, v230
  v_fma_f32 v223, v207, s45, v230
  s_waitcnt lgkmcnt(7)
  s_nop 0
  v_mfma_f32_32x32x16_bf16 v[64:79], a[128:131], v[0:3], v[208:223]
  ds_read_b128 a[160:163], v227 offset:18432
  v_exp_f32 v118, v118
  v_exp_f32 v119, v119
  v_mfma_f32_32x32x16_bf16 v[80:95], a[128:131], v[32:35], v[176:191]
  v_add_f32 v226, v226, v118
  v_add_f32 v226, v226, v119
  v_cvt_pk_bf16_f32 v155, v118, v119
  s_waitcnt lgkmcnt(7)
  v_mfma_f32_32x32x16_bf16 v[64:79], a[132:135], v[4:7], v[64:79]
  ds_read_b128 a[164:167], v227 offset:22528
  v_exp_f32 v104, v104
  v_exp_f32 v105, v105
  v_mfma_f32_32x32x16_bf16 v[80:95], a[132:135], v[36:39], v[80:95]
  s_add_i32 s48, s44, 1
  s_cmp_eq_i32 s48, s36
  s_cselect_b32 s45, 1.0, 0
  v_add_f32 v225, v225, v104
  v_add_f32 v225, v225, v105
  v_cvt_pk_bf16_f32 v148, v104, v105
  s_waitcnt lgkmcnt(7)
  v_mfma_f32_32x32x16_bf16 v[64:79], a[136:139], v[8:11], v[64:79]
  ds_read_b128 a[168:171], v227 offset:26624
  s_cmp_gt_i32 s48, s36
  v_exp_f32 v106, v106
  v_exp_f32 v107, v107
  v_mfma_f32_32x32x16_bf16 v[80:95], a[136:139], v[40:43], v[80:95]
  s_cselect_b32 s46, -1e+30, 0
  v_add_f32 v230, s46, v160
  v_fma_f32 v208, v192, s45, v230
  v_add_f32 v225, v225, v106
  v_add_f32 v225, v225, v107
  v_cvt_pk_bf16_f32 v149, v106, v107
  s_waitcnt lgkmcnt(7)
  v_mfma_f32_32x32x16_bf16 v[64:79], a[140:143], v[12:15], v[64:79]
  ds_read_b128 a[172:175], v227 offset:30720
  v_fma_f32 v209, v193, s45, v230
  v_exp_f32 v108, v108
  v_exp_f32 v109, v109
  v_mfma_f32_32x32x16_bf16 v[80:95], a[140:143], v[44:47], v[80:95]
  v_fma_f32 v210, v194, s45, v230
  v_fma_f32 v211, v195, s45, v230
  v_fma_f32 v212, v196, s45, v230
  v_add_f32 v225, v225, v108
  v_add_f32 v225, v225, v109
  v_cvt_pk_bf16_f32 v150, v108, v109
  s_waitcnt lgkmcnt(7)
  v_mfma_f32_32x32x16_bf16 v[64:79], a[144:147], v[16:19], v[64:79]
  ds_read_b128 a[176:179], v227 offset:19456
  v_fma_f32 v213, v197, s45, v230
  v_exp_f32 v110, v110
  v_exp_f32 v111, v111
  v_mfma_f32_32x32x16_bf16 v[80:95], a[144:147], v[48:51], v[80:95]
  v_fma_f32 v214, v198, s45, v230
  v_fma_f32 v215, v199, s45, v230
  v_fma_f32 v216, v200, s45, v230
  v_add_f32 v225, v225, v110
  v_add_f32 v225, v225, v111
  v_cvt_pk_bf16_f32 v151, v110, v111
  s_waitcnt lgkmcnt(7)
  v_mfma_f32_32x32x16_bf16 v[64:79], a[148:151], v[20:23], v[64:79]
  ds_read_b128 a[180:183], v227 offset:23552
  v_fma_f32 v217, v201, s45, v230
  v_exp_f32 v120, v120
  v_exp_f32 v121, v121
  v_mfma_f32_32x32x16_bf16 v[80:95], a[148:151], v[52:55], v[80:95]
  v_fma_f32 v218, v202, s45, v230
  v_fma_f32 v219, v203, s45, v230
  v_fma_f32 v220, v204, s45, v230
  v_add_f32 v226, v226, v120
  v_add_f32 v226, v226, v121
  v_cvt_pk_bf16_f32 v156, v120, v121
  s_waitcnt lgkmcnt(7)
  v_mfma_f32_32x32x16_bf16 v[64:79], a[152:155], v[24:27], v[64:79]
  ds_read_b128 a[184:187], v227 offset:27648
  v_fma_f32 v221, v205, s45, v230
  v_exp_f32 v122, v122
  v_exp_f32 v123, v123
  v_mfma_f32_32x32x16_bf16 v[80:95], a[152:155], v[56:59], v[80:95]
  v_fma_f32 v222, v206, s45, v230
  v_fma_f32 v223, v207, s45, v230
  v_add_f32 v226, v226, v122
  v_add_f32 v226, v226, v123
  v_cvt_pk_bf16_f32 v157, v122, v123
  s_waitcnt lgkmcnt(7)
  v_mfma_f32_32x32x16_bf16 v[64:79], a[156:159], v[28:31], v[64:79]
  ds_read_b128 a[188:191], v227 offset:31744
  v_exp_f32 v124, v124
  v_exp_f32 v125, v125
  v_mfma_f32_32x32x16_bf16 v[80:95], a[156:159], v[60:63], v[80:95]
  v_add_f32 v226, v226, v124
  v_add_f32 v226, v226, v125
  v_cvt_pk_bf16_f32 v158, v124, v125
  s_waitcnt lgkmcnt(7)
  v_mfma_f32_32x32x16_bf16 a[0:15], a[160:163], v[144:147], a[0:15]
  ds_read_b128 a[128:131], v228 offset:8192
  v_exp_f32 v126, v126
  v_exp_f32 v127, v127
  v_mfma_f32_32x32x16_bf16 a[64:79], a[160:163], v[152:155], a[64:79]
  v_add_u32 v227, s43, v228
  v_add_f32 v226, v226, v126
  v_add_f32 v226, v226, v127
  v_cvt_pk_bf16_f32 v159, v126, v127
  s_waitcnt lgkmcnt(7)
  v_mfma_f32_32x32x16_bf16 a[16:31], a[164:167], v[144:147], a[16:31]
  ds_read_b128 a[132:135], v228 offset:9216
  v_and_b32 v227, 0x1ffff, v227
  v_exp_f32 v64, v64
  v_exp_f32 v65, v65
  v_mfma_f32_32x32x16_bf16 a[80:95], a[164:167], v[152:155], a[80:95]
  v_add_f32 v225, v225, v64
  v_add_f32 v225, v225, v65
  v_cvt_pk_bf16_f32 v128, v64, v65
  s_waitcnt lgkmcnt(7)
  v_mfma_f32_32x32x16_bf16 a[32:47], a[168:171], v[144:147], a[32:47]
  ds_read_b128 a[136:139], v228 offset:10240
  v_exp_f32 v66, v66
  v_exp_f32 v67, v67
  v_mfma_f32_32x32x16_bf16 a[96:111], a[168:171], v[152:155], a[96:111]
  v_add_f32 v225, v225, v66
  v_add_f32 v225, v225, v67
  v_cvt_pk_bf16_f32 v129, v66, v67
  s_waitcnt lgkmcnt(7)
  v_mfma_f32_32x32x16_bf16 a[48:63], a[172:175], v[144:147], a[48:63]
  ds_read_b128 a[140:143], v228 offset:11264
  v_exp_f32 v68, v68
  v_exp_f32 v69, v69
  v_mfma_f32_32x32x16_bf16 a[112:127], a[172:175], v[152:155], a[112:127]
  v_add_f32 v225, v225, v68
  v_add_f32 v225, v225, v69
  v_cvt_pk_bf16_f32 v130, v68, v69
  s_waitcnt lgkmcnt(7)
  v_mfma_f32_32x32x16_bf16 a[0:15], a[176:179], v[148:151], a[0:15]
  ds_read_b128 a[144:147], v228 offset:12288
  v_exp_f32 v70, v70
  v_exp_f32 v71, v71
  v_mfma_f32_32x32x16_bf16 a[64:79], a[176:179], v[156:159], a[64:79]
  v_add_f32 v225, v225, v70
  v_add_f32 v225, v225, v71
  v_cvt_pk_bf16_f32 v131, v70, v71
  s_waitcnt lgkmcnt(7)
  v_mfma_f32_32x32x16_bf16 a[16:31], a[180:183], v[148:151], a[16:31]
  ds_read_b128 a[148:151], v228 offset:13312
  v_exp_f32 v80, v80
  v_exp_f32 v81, v81
  v_mfma_f32_32x32x16_bf16 a[80:95], a[180:183], v[156:159], a[80:95]
  v_add_f32 v226, v226, v80
  v_add_f32 v226, v226, v81
  v_cvt_pk_bf16_f32 v136, v80, v81
  s_waitcnt lgkmcnt(7)
  v_mfma_f32_32x32x16_bf16 a[32:47], a[184:187], v[148:151], a[32:47]
  ds_read_b128 a[152:155], v228 offset:14336
  v_exp_f32 v82, v82
  v_exp_f32 v83, v83
  v_mfma_f32_32x32x16_bf16 a[96:111], a[184:187], v[156:159], a[96:111]
  v_add_f32 v226, v226, v82
  v_add_f32 v226, v226, v83
  v_cvt_pk_bf16_f32 v137, v82, v83
  s_waitcnt lgkmcnt(7)
  v_mfma_f32_32x32x16_bf16 a[48:63], a[188:191], v[148:151], a[48:63]
  ds_read_b128 a[156:159], v228 offset:15360
  v_exp_f32 v84, v84
  v_exp_f32 v85, v85
  v_mfma_f32_32x32x16_bf16 a[112:127], a[188:191], v[156:159], a[112:127]
  v_add_f32 v226, v226, v84
  v_add_f32 v226, v226, v85
  v_cvt_pk_bf16_f32 v138, v84, v85
  s_waitcnt lgkmcnt(7)
  v_mfma_f32_32x32x16_bf16 v[96:111], a[128:131], v[0:3], v[208:223]
  ds_read_b128 a[160:163], v228 offset:16384
  v_exp_f32 v86, v86
  v_exp_f32 v87, v87
  v_mfma_f32_32x32x16_bf16 v[112:127], a[128:131], v[32:35], v[176:191]
  v_add_f32 v226, v226, v86
  v_add_f32 v226, v226, v87
  v_cvt_pk_bf16_f32 v139, v86, v87
  s_waitcnt vmcnt(8)
  s_barrier
  s_waitcnt lgkmcnt(7)
  v_mfma_f32_32x32x16_bf16 v[96:111], a[132:135], v[4:7], v[96:111]
  ds_read_b128 a[164:167], v228 offset:20480
  s_mov_b32 m0, s41
  s_nop 0
  buffer_load_dwordx4 v229, s[24:27], 0 offen offset:0 lds
  v_exp_f32 v72, v72
  v_exp_f32 v73, v73
  v_mfma_f32_32x32x16_bf16 v[112:127], a[132:135], v[36:39], v[112:127]
  v_add_f32 v225, v225, v72
  v_add_f32 v225, v225, v73
  v_cvt_pk_bf16_f32 v132, v72, v73
  s_waitcnt lgkmcnt(7)
  v_mfma_f32_32x32x16_bf16 v[96:111], a[136:139], v[8:11], v[96:111]
  ds_read_b128 a[168:171], v228 offset:24576
  v_exp_f32 v74, v74
  v_exp_f32 v75, v75
  v_mfma_f32_32x32x16_bf16 v[112:127], a[136:139], v[40:43], v[112:127]
  buffer_load_dwordx4 v229, s[24:27], 0 offen offset:1024 lds
  v_add_f32 v225, v225, v74
  v_add_f32 v225, v225, v75
  v_cvt_pk_bf16_f32 v133, v74, v75
  s_waitcnt lgkmcnt(7)
  v_mfma_f32_32x32x16_bf16 v[96:111], a[140:143], v[12:15], v[96:111]
  ds_read_b128 a[172:175], v228 offset:28672
  v_exp_f32 v76, v76
  v_exp_f32 v77, v77
  v_mfma_f32_32x32x16_bf16 v[112:127], a[140:143], v[44:47], v[112:127]
  v_add_f32 v225, v225, v76
  v_add_f32 v225, v225, v77
  v_cvt_pk_bf16_f32 v134, v76, v77
  s_waitcnt lgkmcnt(7)
  v_mfma_f32_32x32x16_bf16 v[96:111], a[144:147], v[16:19], v[96:111]
  ds_read_b128 a[176:179], v228 offset:17408
  buffer_load_dwordx4 v229, s[24:27], 0 offen offset:2048 lds
  v_exp_f32 v78, v78
  v_exp_f32 v79, v79
  v_mfma_f32_32x32x16_bf16 v[112:127], a[144:147], v[48:51], v[112:127]
  v_add_f32 v225, v225, v78
  v_add_f32 v225, v225, v79
  v_cvt_pk_bf16_f32 v135, v78, v79
  s_waitcnt lgkmcnt(7)
  v_mfma_f32_32x32x16_bf16 v[96:111], a[148:151], v[20:23], v[96:111]
  ds_read_b128 a[180:183], v228 offset:21504
  v_exp_f32 v88, v88
  v_exp_f32 v89, v89
  v_mfma_f32_32x32x16_bf16 v[112:127], a[148:151], v[52:55], v[112:127]
  buffer_load_dwordx4 v229, s[24:27], 0 offen offset:3072 lds
  v_add_f32 v226, v226, v88
  v_add_f32 v226, v226, v89
  v_cvt_pk_bf16_f32 v140, v88, v89
  s_waitcnt lgkmcnt(7)
  v_mfma_f32_32x32x16_bf16 v[96:111], a[152:155], v[24:27], v[96:111]
  ds_read_b128 a[184:187], v228 offset:25600
  v_exp_f32 v90, v90
  v_exp_f32 v91, v91
  v_mfma_f32_32x32x16_bf16 v[112:127], a[152:155], v[56:59], v[112:127]
  v_add_f32 v226, v226, v90
  v_add_f32 v226, v226, v91
  v_cvt_pk_bf16_f32 v141, v90, v91
  s_waitcnt lgkmcnt(7)
  v_mfma_f32_32x32x16_bf16 v[96:111], a[156:159], v[28:31], v[96:111]
  ds_read_b128 a[188:191], v228 offset:29696
  s_add_u32 m0, s41, 4096
  s_nop 0
  buffer_load_dwordx4 v229, s[24:27], s42 offen offset:0 lds
  v_exp_f32 v92, v92
  v_exp_f32 v93, v93
  v_mfma_f32_32x32x16_bf16 v[112:127], a[156:159], v[60:63], v[112:127]
  v_add_f32 v226, v226, v92
  v_add_f32 v226, v226, v93
  v_cvt_pk_bf16_f32 v142, v92, v93
  s_waitcnt lgkmcnt(7)
  v_mfma_f32_32x32x16_bf16 a[0:15], a[160:163], v[128:131], a[0:15]
  ds_read_b128 a[128:131], v227 offset:0
  v_exp_f32 v94, v94
  v_exp_f32 v95, v95
  v_mfma_f32_32x32x16_bf16 a[64:79], a[160:163], v[136:139], a[64:79]
  buffer_load_dwordx4 v229, s[24:27], s42 offen offset:1024 lds
  v_add_f32 v226, v226, v94
  v_add_f32 v226, v226, v95
  v_cvt_pk_bf16_f32 v143, v94, v95
  s_waitcnt lgkmcnt(7)
  v_mfma_f32_32x32x16_bf16 a[16:31], a[164:167], v[128:131], a[16:31]
  ds_read_b128 a[132:135], v227 offset:1024
  v_exp_f32 v96, v96
  v_exp_f32 v97, v97
  v_mfma_f32_32x32x16_bf16 a[80:95], a[164:167], v[136:139], a[80:95]
  v_add_f32 v225, v225, v96
  v_add_f32 v225, v225, v97
  v_cvt_pk_bf16_f32 v144, v96, v97
  s_waitcnt lgkmcnt(7)
  v_mfma_f32_32x32x16_bf16 a[32:47], a[168:171], v[128:131], a[32:47]
  ds_read_b128 a[136:139], v227 offset:2048
  buffer_load_dwordx4 v229, s[24:27], s42 offen offset:2048 lds
  v_exp_f32 v98, v98
  v_exp_f32 v99, v99
  v_mfma_f32_32x32x16_bf16 a[96:111], a[168:171], v[136:139], a[96:111]
  v_add_f32 v225, v225, v98
  v_add_f32 v225, v225, v99
  v_cvt_pk_bf16_f32 v145, v98, v99
  s_waitcnt lgkmcnt(7)
  v_mfma_f32_32x32x16_bf16 a[48:63], a[172:175], v[128:131], a[48:63]
  ds_read_b128 a[140:143], v227 offset:3072
  v_exp_f32 v100, v100
  v_exp_f32 v101, v101
  v_mfma_f32_32x32x16_bf16 a[112:127], a[172:175], v[136:139], a[112:127]
  buffer_load_dwordx4 v229, s[24:27], s42 offen offset:3072 lds
  v_add_f32 v225, v225, v100
  v_add_f32 v225, v225, v101
  v_cvt_pk_bf16_f32 v146, v100, v101
  s_waitcnt lgkmcnt(7)
  v_mfma_f32_32x32x16_bf16 a[0:15], a[176:179], v[132:135], a[0:15]
  ds_read_b128 a[144:147], v227 offset:4096
  v_exp_f32 v102, v102
  v_exp_f32 v103, v103
  v_mfma_f32_32x32x16_bf16 a[64:79], a[176:179], v[140:143], a[64:79]
  v_add_f32 v225, v225, v102
  v_add_f32 v225, v225, v103
  v_cvt_pk_bf16_f32 v147, v102, v103
  s_waitcnt lgkmcnt(7)
  v_mfma_f32_32x32x16_bf16 a[16:31], a[180:183], v[132:135], a[16:31]
  ds_read_b128 a[148:151], v227 offset:5120
  v_add_u32 v229, s43, v229
  s_add_u32 s41, s41, s43
  s_and_b32 s41, s41, 0x1ffff
  v_exp_f32 v112, v112
  v_exp_f32 v113, v113
  v_mfma_f32_32x32x16_bf16 a[80:95], a[180:183], v[140:143], a[80:95]
  v_add_f32 v226, v226, v112
  v_add_f32 v226, v226, v113
  v_cvt_pk_bf16_f32 v152, v112, v113
  s_waitcnt lgkmcnt(7)
  v_mfma_f32_32x32x16_bf16 a[32:47], a[184:187], v[132:135], a[32:47]
  ds_read_b128 a[152:155], v227 offset:6144
  v_exp_f32 v114, v114
  v_exp_f32 v115, v115
  v_mfma_f32_32x32x16_bf16 a[96:111], a[184:187], v[140:143], a[96:111]
  v_add_f32 v226, v226, v114
  v_add_f32 v226, v226, v115
  v_cvt_pk_bf16_f32 v153, v114, v115
  s_waitcnt lgkmcnt(7)
  v_mfma_f32_32x32x16_bf16 a[48:63], a[188:191], v[132:135], a[48:63]
  ds_read_b128 a[156:159], v227 offset:7168
  v_exp_f32 v116, v116
  v_exp_f32 v117, v117
  v_mfma_f32_32x32x16_bf16 a[112:127], a[188:191], v[140:143], a[112:127]
  v_add_f32 v226, v226, v116
  v_add_f32 v226, v226, v117
  v_cvt_pk_bf16_f32 v154, v116, v117
  v_swap_b32 v227, v228
  s_add_i32 s44, s44, 2
  s_cmp_lt_i32 s44, 4
  s_cbranch_scc1 K2_DM
  s_cmp_eq_u32 s38, 7
  s_cselect_b32 s44, 0, -4
  s_add_i32 s48, s44, 0
  s_cmp_eq_i32 s48, s36
  s_cselect_b32 s45, 1.0, 0
  s_cmp_gt_i32 s48, s36
  s_cselect_b32 s46, -1e+30, 0
  v_add_f32 v230, s46, v176
  v_fma_f32 v208, v192, s45, v230
  v_fma_f32 v209, v193, s45, v230
  v_fma_f32 v210, v194, s45, v230
  v_fma_f32 v211, v195, s45, v230
  v_fma_f32 v212, v196, s45, v230
  v_fma_f32 v213, v197, s45, v230
  v_fma_f32 v214, v198, s45, v230
  v_fma_f32 v215, v199, s45, v230
  v_fma_f32 v216, v200, s45, v230
  v_fma_f32 v217, v201, s45, v230
  v_fma_f32 v218, v202, s45, v230
  v_fma_f32 v219, v203, s45, v230
  v_fma_f32 v220, v204, s45, v230
  v_fma_f32 v221, v205, s45, v230
  v_fma_f32 v222, v206, s45, v230
  v_fma_f32 v223, v207, s45, v230
  s_waitcnt lgkmcnt(7)
  s_nop 0
  v_mfma_f32_32x32x16_bf16 v[80:95], a[128:131], v[32:35], v[208:223]
  ds_read_b128 a[160:163], v227 offset:18432
  v_exp_f32 v118, v118
  v_exp_f32 v119, v119
  v_add_f32 v226, v226, v118
  v_add_f32 v226, v226, v119
  v_cvt_pk_bf16_f32 v155, v118, v119
  s_waitcnt lgkmcnt(7)
  v_mfma_f32_32x32x16_bf16 v[80:95], a[132:135], v[36:39], v[80:95]
  ds_read_b128 a[164:167], v227 offset:22528
  v_exp_f32 v104, v104
  v_exp_f32 v105, v105
  s_waitcnt lgkmcnt(7)
  v_mfma_f32_32x32x16_bf16 v[80:95], a[136:139], v[40:43], v[80:95]
  ds_read_b128 a[168:171], v227 offset:26624
  v_add_f32 v225, v225, v104
  v_add_f32 v225, v225, v105
  v_cvt_pk_bf16_f32 v148, v104, v105
  s_waitcnt lgkmcnt(7)
  v_mfma_f32_32x32x16_bf16 v[80:95], a[140:143], v[44:47], v[80:95]
  ds_read_b128 a[172:175], v227 offset:30720
  s_add_i32 s48, s44, 1
  v_exp_f32 v106, v106
  v_exp_f32 v107, v107
  s_waitcnt lgkmcnt(7)
  v_mfma_f32_32x32x16_bf16 v[80:95], a[144:147], v[48:51], v[80:95]
  ds_read_b128 a[176:179], v227 offset:19456
  s_cmp_eq_i32 s48, s36
  s_cselect_b32 s45, 1.0, 0
  v_add_f32 v225, v225, v106
  v_add_f32 v225, v225, v107
  v_cvt_pk_bf16_f32 v149, v106, v107
  s_waitcnt lgkmcnt(7)
  v_mfma_f32_32x32x16_bf16 v[80:95], a[148:151], v[52:55], v[80:95]
  ds_read_b128 a[180:183], v227 offset:23552
  v_exp_f32 v108, v108
  v_exp_f32 v109, v109
  v_add_f32 v225, v225, v108
  v_add_f32 v225, v225, v109
  v_cvt_pk_bf16_f32 v150, v108, v109
  s_waitcnt lgkmcnt(7)
  v_mfma_f32_32x32x16_bf16 v[80:95], a[152:155], v[56:59], v[80:95]
  ds_read_b128 a[184:187], v227 offset:27648
  s_cmp_gt_i32 s48, s36
  v_exp_f32 v110, v110
  v_exp_f32 v111, v111
  s_waitcnt lgkmcnt(7)
  v_mfma_f32_32x32x16_bf16 v[80:95], a[156:159], v[60:63], v[80:95]
  ds_read_b128 a[188:191], v227 offset:31744
  s_cselect_b32 s46, -1e+30, 0
  v_add_f32 v230, s46, v176
  v_add_f32 v225, v225, v110
  v_add_f32 v225, v225, v111
  v_cvt_pk_bf16_f32 v151, v110, v111
  s_waitcnt lgkmcnt(7)
  v_mfma_f32_32x32x16_bf16 a[0:15], a[160:163], v[144:147], a[0:15]
  ds_read_b128 a[128:131], v228 offset:8192
  v_fma_f32 v208, v192, s45, v230
  v_exp_f32 v120, v120
  v_exp_f32 v121, v121
  v_mfma_f32_32x32x16_bf16 a[64:79], a[160:163], v[152:155], a[64:79]
  v_fma_f32 v209, v193, s45, v230
  v_fma_f32 v210, v194, s45, v230
  v_add_u32 v227, s43, v228
  v_add_f32 v226, v226, v120
  v_add_f32 v226, v226, v121
  v_cvt_pk_bf16_f32 v156, v120, v121
  s_waitcnt lgkmcnt(7)
  v_mfma_f32_32x32x16_bf16 a[16:31], a[164:167], v[144:147], a[16:31]
  ds_read_b128 a[132:135], v228 offset:9216
  v_and_b32 v227, 0x1ffff, v227
  v_exp_f32 v122, v122
  v_exp_f32 v123, v123
  v_add_f32 v226, v226, v122
  v_add_f32 v226, v226, v123
  v_cvt_pk_bf16_f32 v157, v122, v123
  v_mfma_f32_32x32x16_bf16 a[80:95], a[164:167], v[152:155], a[80:95]
  v_fma_f32 v211, v195, s45, v230
  v_fma_f32 v212, v196, s45, v230
  v_exp_f32 v124, v124
  v_exp_f32 v125, v125
  s_waitcnt lgkmcnt(7)
  v_mfma_f32_32x32x16_bf16 a[32:47], a[168:171], v[144:147], a[32:47]
  ds_read_b128 a[136:139], v228 offset:10240
  v_fma_f32 v213, v197, s45, v230
  v_fma_f32 v214, v198, s45, v230
  v_add_f32 v226, v226, v124
  v_add_f32 v226, v226, v125
  v_cvt_pk_bf16_f32 v158, v124, v125
  v_mfma_f32_32x32x16_bf16 a[96:111], a[168:171], v[152:155], a[96:111]
  v_fma_f32 v215, v199, s45, v230
  v_fma_f32 v216, v200, s45, v230
  v_exp_f32 v126, v126
  v_exp_f32 v127, v127
  s_waitcnt lgkmcnt(7)
  v_mfma_f32_32x32x16_bf16 a[48:63], a[172:175], v[144:147], a[48:63]
  ds_read_b128 a[140:143], v228 offset:11264
  v_fma_f32 v217, v201, s45, v230
  v_fma_f32 v218, v202, s45, v230
  v_add_f32 v226, v226, v126
  v_add_f32 v226, v226, v127
  v_cvt_pk_bf16_f32 v159, v126, v127
  v_mfma_f32_32x32x16_bf16 a[112:127], a[172:175], v[152:155], a[112:127]
  v_fma_f32 v219, v203, s45, v230
  v_fma_f32 v220, v204, s45, v230
  v_fma_f32 v221, v205, s45, v230
  v_fma_f32 v222, v206, s45, v230
  v_fma_f32 v223, v207, s45, v230
  s_waitcnt lgkmcnt(7)
  v_mfma_f32_32x32x16_bf16 a[0:15], a[176:179], v[148:151], a[0:15]
  ds_read_b128 a[144:147], v228 offset:12288
  v_exp_f32 v80, v80
  v_exp_f32 v81, v81
  v_mfma_f32_32x32x16_bf16 a[64:79], a[176:179], v[156:159], a[64:79]
  v_add_f32 v226, v226, v80
  v_add_f32 v226, v226, v81
  v_cvt_pk_bf16_f32 v136, v80, v81
  s_waitcnt lgkmcnt(7)
  v_mfma_f32_32x32x16_bf16 a[16:31], a[180:183], v[148:151], a[16:31]
  ds_read_b128 a[148:151], v228 offset:13312
  v_exp_f32 v82, v82
  v_exp_f32 v83, v83
  v_mfma_f32_32x32x16_bf16 a[80:95], a[180:183], v[156:159], a[80:95]
  v_add_f32 v226, v226, v82
  v_add_f32 v226, v226, v83
  v_cvt_pk_bf16_f32 v137, v82, v83
  s_waitcnt lgkmcnt(7)
  v_mfma_f32_32x32x16_bf16 a[32:47], a[184:187], v[148:151], a[32:47]
  ds_read_b128 a[152:155], v228 offset:14336
  v_exp_f32 v84, v84
  v_exp_f32 v85, v85
  v_mfma_f32_32x32x16_bf16 a[96:111], a[184:187], v[156:159], a[96:111]
  v_add_f32 v226, v226, v84
  v_add_f32 v226, v226, v85
  v_cvt_pk_bf16_f32 v138, v84, v85
  s_waitcnt lgkmcnt(7)
  v_mfma_f32_32x32x16_bf16 a[48:63], a[188:191], v[148:151], a[48:63]
  ds_read_b128 a[156:159], v228 offset:15360
  v_exp_f32 v86, v86
  v_exp_f32 v87, v87
  v_mfma_f32_32x32x16_bf16 a[112:127], a[188:191], v[156:159], a[112:127]
  v_add_f32 v226, v226, v86
  v_add_f32 v226, v226, v87
  v_cvt_pk_bf16_f32 v139, v86, v87
  s_waitcnt lgkmcnt(7)
  v_mfma_f32_32x32x16_bf16 v[112:127], a[128:131], v[32:35], v[208:223]
  ds_read_b128 a[160:163], v228 offset:16384
  v_exp_f32 v88, v88
  v_exp_f32 v89, v89
  s_waitcnt lgkmcnt(7)
  v_mfma_f32_32x32x16_bf16 v[112:127], a[132:135], v[36:39], v[112:127]
  ds_read_b128 a[164:167], v228 offset:20480
  v_add_f32 v226, v226, v88
  v_add_f32 v226, v226, v89
  v_cvt_pk_bf16_f32 v140, v88, v89
  s_waitcnt vmcnt(8)
  s_barrier
  s_waitcnt lgkmcnt(7)
  v_mfma_f32_32x32x16_bf16 v[112:127], a[136:139], v[40:43], v[112:127]
  ds_read_b128 a[168:171], v228 offset:24576
  s_mov_b32 m0, s41
  s_nop 0
  buffer_load_dwordx4 v229, s[24:27], 0 offen offset:0 lds
  v_exp_f32 v90, v90
  v_exp_f32 v91, v91
  s_waitcnt lgkmcnt(7)
  v_mfma_f32_32x32x16_bf16 v[112:127], a[140:143], v[44:47], v[112:127]
  ds_read_b128 a[172:175], v228 offset:28672
  buffer_load_dwordx4 v229, s[24:27], 0 offen offset:1024 lds
  v_add_f32 v226, v226, v90
  v_add_f32 v226, v226, v91
  v_cvt_pk_bf16_f32 v141, v90, v91
  s_waitcnt lgkmcnt(7)
  v_mfma_f32_32x32x16_bf16 v[112:127], a[144:147], v[48:51], v[112:127]
  ds_read_b128 a[176:179], v228 offset:17408
  buffer_load_dwordx4 v229, s[24:27], 0 offen offset:2048 lds
  v_exp_f32 v92, v92
  v_exp_f32 v93, v93
  s_waitcnt lgkmcnt(7)
  v_mfma_f32_32x32x16_bf16 v[112:127], a[148:151], v[52:55], v[112:127]
  ds_read_b128 a[180:183], v228 offset:21504
  buffer_load_dwordx4 v229, s[24:27], 0 offen offset:3072 lds
  v_add_f32 v226, v226, v92
  v_add_f32 v226, v226, v93
  v_cvt_pk_bf16_f32 v142, v92, v93
  s_waitcnt lgkmcnt(7)
  v_mfma_f32_32x32x16_bf16 v[112:127], a[152:155], v[56:59], v[112:127]
  ds_read_b128 a[184:187], v228 offset:25600
  s_add_u32 m0, s41, 4096
  s_nop 0
  buffer_load_dwordx4 v229, s[24:27], s42 offen offset:0 lds
  v_exp_f32 v94, v94
  v_exp_f32 v95, v95
  s_waitcnt lgkmcnt(7)
  v_mfma_f32_32x32x16_bf16 v[112:127], a[156:159], v[60:63], v[112:127]
  ds_read_b128 a[188:191], v228 offset:29696
  buffer_load_dwordx4 v229, s[24:27], s42 offen offset:1024 lds
  v_add_f32 v226, v226, v94
  v_add_f32 v226, v226, v95
  v_cvt_pk_bf16_f32 v143, v94, v95
  s_waitcnt lgkmcnt(7)
  v_mfma_f32_32x32x16_bf16 a[64:79], a[160:163], v[136:139], a[64:79]
  ds_read_b128 a[128:131], v227 offset:0
  buffer_load_dwordx4 v229, s[24:27], s42 offen offset:2048 lds
  s_waitcnt lgkmcnt(7)
  v_mfma_f32_32x32x16_bf16 a[80:95], a[164:167], v[136:139], a[80:95]
  ds_read_b128 a[132:135], v227 offset:1024
  buffer_load_dwordx4 v229, s[24:27], s42 offen offset:3072 lds
  s_waitcnt lgkmcnt(7)
  v_mfma_f32_32x32x16_bf16 a[96:111], a[168:171], v[136:139], a[96:111]
  ds_read_b128 a[136:139], v227 offset:2048
  v_add_u32 v229, s43, v229
  s_add_u32 s41, s41, s43
  s_and_b32 s41, s41, 0x1ffff
  v_exp_f32 v112, v112
  v_exp_f32 v113, v113
  s_waitcnt lgkmcnt(7)
  v_mfma_f32_32x32x16_bf16 a[112:127], a[172:175], v[136:139], a[112:127]
  ds_read_b128 a[140:143], v227 offset:3072
  v_add_f32 v226, v226, v112
  v_add_f32 v226, v226, v113
  v_cvt_pk_bf16_f32 v152, v112, v113
  s_waitcnt lgkmcnt(7)
  v_mfma_f32_32x32x16_bf16 a[64:79], a[176:179], v[140:143], a[64:79]
  ds_read_b128 a[144:147], v227 offset:4096
  v_exp_f32 v114, v114
  v_exp_f32 v115, v115
  s_waitcnt lgkmcnt(7)
  v_mfma_f32_32x32x16_bf16 a[80:95], a[180:183], v[140:143], a[80:95]
  ds_read_b128 a[148:151], v227 offset:5120
  v_add_f32 v226, v226, v114
  v_add_f32 v226, v226, v115
  v_cvt_pk_bf16_f32 v153, v114, v115
  s_waitcnt lgkmcnt(7)
  v_mfma_f32_32x32x16_bf16 a[96:111], a[184:187], v[140:143], a[96:111]
  ds_read_b128 a[152:155], v227 offset:6144
  v_exp_f32 v116, v116
  v_exp_f32 v117, v117
  s_waitcnt lgkmcnt(7)
  v_mfma_f32_32x32x16_bf16 a[112:127], a[188:191], v[140:143], a[112:127]
  ds_read_b128 a[156:159], v227 offset:7168
  v_add_f32 v226, v226, v116
  v_add_f32 v226, v226, v117
  v_cvt_pk_bf16_f32 v154, v116, v117
  buffer_store_dwordx4 a[192:195], v251, s[92:95], 0 offen
  buffer_store_dwordx4 a[196:199], v251, s[92:95], 0 offen offset:1024
  v_swap_b32 v227, v228
  s_add_i32 s44, s44, 2
  v_mov_b32 v230, v225
  s_nop 1
  v_permlane32_swap_b32 v230, v225
  v_add_f32 v225, v225, v230
  v_rcp_f32 v230, v225
  s_lshl_b32 s48, s38, 2
  s_add_u32 s48, s48, s36
  s_lshl_b32 s48, s48, 18
  s_lshl_b32 s49, s37, 13
  s_add_u32 s48, s48, s49
  v_lshl_add_u32 v231, v224, 4, s48
  v_mov_b32 v233, v230
  v_accvgpr_read_b32 v208, a0
  v_accvgpr_read_b32 v209, a1
  v_accvgpr_read_b32 v210, a2
  v_accvgpr_read_b32 v211, a3
  v_accvgpr_read_b32 v212, a4
  v_accvgpr_read_b32 v213, a5
  v_accvgpr_read_b32 v214, a6
  v_accvgpr_read_b32 v215, a7
  v_mul_f32 v208, v208, v230
  v_mul_f32 v209, v209, v230
  v_mul_f32 v210, v210, v230
  v_mul_f32 v211, v211, v230
  v_mul_f32 v212, v212, v230
  v_mul_f32 v213, v213, v230
  v_mul_f32 v214, v214, v230
  v_mul_f32 v215, v215, v230
  v_cvt_pk_bf16_f32 v240, v208, v209
  v_or_b32_sdwa v240, v208, 1 dst_sel:WORD_0 dst_unused:UNUSED_PRESERVE src0_sel:WORD_1 src1_sel:DWORD
  v_cvt_pk_bf16_f32 v241, v210, v211
  v_cvt_pk_bf16_f32 v242, v212, v213
  v_cvt_pk_bf16_f32 v243, v214, v215
  buffer_store_dwordx4 v[240:243], v231, s[28:31], 0 offen offset:0 sc1
  v_accvgpr_read_b32 v216, a8
  v_accvgpr_read_b32 v217, a9
  v_accvgpr_read_b32 v218, a10
  v_accvgpr_read_b32 v219, a11
  v_accvgpr_read_b32 v220, a12
  v_accvgpr_read_b32 v221, a13
  v_accvgpr_read_b32 v222, a14
  v_accvgpr_read_b32 v223, a15
  v_mul_f32 v216, v216, v230
  v_mul_f32 v217, v217, v230
  v_mul_f32 v218, v218, v230
  v_mul_f32 v219, v219, v230
  v_mul_f32 v220, v220, v230
  v_mul_f32 v221, v221, v230
  v_mul_f32 v222, v222, v230
  v_mul_f32 v223, v223, v230
  v_cvt_pk_bf16_f32 v244, v216, v217
  v_or_b32_sdwa v244, v216, 1 dst_sel:WORD_0 dst_unused:UNUSED_PRESERVE src0_sel:WORD_1 src1_sel:DWORD
  v_cvt_pk_bf16_f32 v245, v218, v219
  v_cvt_pk_bf16_f32 v246, v220, v221
  v_cvt_pk_bf16_f32 v247, v222, v223
  buffer_store_dwordx4 v[244:247], v231, s[28:31], 0 offen offset:1024 sc1
  v_accvgpr_read_b32 v208, a16
  v_accvgpr_read_b32 v209, a17
  v_accvgpr_read_b32 v210, a18
  v_accvgpr_read_b32 v211, a19
  v_accvgpr_read_b32 v212, a20
  v_accvgpr_read_b32 v213, a21
  v_accvgpr_read_b32 v214, a22
  v_accvgpr_read_b32 v215, a23
  v_mul_f32 v208, v208, v230
  v_mul_f32 v209, v209, v230
  v_mul_f32 v210, v210, v230
  v_mul_f32 v211, v211, v230
  v_mul_f32 v212, v212, v230
  v_mul_f32 v213, v213, v230
  v_mul_f32 v214, v214, v230
  v_mul_f32 v215, v215, v230
  v_cvt_pk_bf16_f32 v240, v208, v209
  v_or_b32_sdwa v240, v208, 1 dst_sel:WORD_0 dst_unused:UNUSED_PRESERVE src0_sel:WORD_1 src1_sel:DWORD
  v_cvt_pk_bf16_f32 v241, v210, v211
  v_cvt_pk_bf16_f32 v242, v212, v213
  v_cvt_pk_bf16_f32 v243, v214, v215
  buffer_store_dwordx4 v[240:243], v231, s[28:31], 0 offen offset:2048 sc1
  v_accvgpr_read_b32 v216, a24
  v_accvgpr_read_b32 v217, a25
  v_accvgpr_read_b32 v218, a26
  v_accvgpr_read_b32 v219, a27
  v_accvgpr_read_b32 v220, a28
  v_accvgpr_read_b32 v221, a29
  v_accvgpr_read_b32 v222, a30
  v_accvgpr_read_b32 v223, a31
  v_mul_f32 v216, v216, v230
  v_mul_f32 v217, v217, v230
  v_mul_f32 v218, v218, v230
  v_mul_f32 v219, v219, v230
  v_mul_f32 v220, v220, v230
  v_mul_f32 v221, v221, v230
  v_mul_f32 v222, v222, v230
  v_mul_f32 v223, v223, v230
  v_cvt_pk_bf16_f32 v244, v216, v217
  v_or_b32_sdwa v244, v216, 1 dst_sel:WORD_0 dst_unused:UNUSED_PRESERVE src0_sel:WORD_1 src1_sel:DWORD
  v_cvt_pk_bf16_f32 v245, v218, v219
  v_cvt_pk_bf16_f32 v246, v220, v221
  v_cvt_pk_bf16_f32 v247, v222, v223
  buffer_store_dwordx4 v[244:247], v231, s[28:31], 0 offen offset:3072 sc1
  v_accvgpr_read_b32 v208, a32
  v_accvgpr_read_b32 v209, a33
  v_accvgpr_read_b32 v210, a34
  v_accvgpr_read_b32 v211, a35
  v_accvgpr_read_b32 v212, a36
  v_accvgpr_read_b32 v213, a37
  v_accvgpr_read_b32 v214, a38
  v_accvgpr_read_b32 v215, a39
  v_mul_f32 v208, v208, v230
  v_mul_f32 v209, v209, v230
  v_mul_f32 v210, v210, v230
  v_mul_f32 v211, v211, v230
  v_mul_f32 v212, v212, v230
  v_mul_f32 v213, v213, v230
  v_mul_f32 v214, v214, v230
  v_mul_f32 v215, v215, v230
  v_cvt_pk_bf16_f32 v240, v208, v209
  v_or_b32_sdwa v240, v208, 1 dst_sel:WORD_0 dst_unused:UNUSED_PRESERVE src0_sel:WORD_1 src1_sel:DWORD
  v_cvt_pk_bf16_f32 v241, v210, v211
  v_cvt_pk_bf16_f32 v242, v212, v213
  v_cvt_pk_bf16_f32 v243, v214, v215
  buffer_store_dwordx4 v[240:243], v231, s[28:31], s42 offen offset:0 sc1
  v_accvgpr_read_b32 v216, a40
  v_accvgpr_read_b32 v217, a41
  v_accvgpr_read_b32 v218, a42
  v_accvgpr_read_b32 v219, a43
  v_accvgpr_read_b32 v220, a44
  v_accvgpr_read_b32 v221, a45
  v_accvgpr_read_b32 v222, a46
  v_accvgpr_read_b32 v223, a47
  v_mul_f32 v216, v216, v230
  v_mul_f32 v217, v217, v230
  v_mul_f32 v218, v218, v230
  v_mul_f32 v219, v219, v230
  v_mul_f32 v220, v220, v230
  v_mul_f32 v221, v221, v230
  v_mul_f32 v222, v222, v230
  v_mul_f32 v223, v223, v230
  v_cvt_pk_bf16_f32 v244, v216, v217
  v_or_b32_sdwa v244, v216, 1 dst_sel:WORD_0 dst_unused:UNUSED_PRESERVE src0_sel:WORD_1 src1_sel:DWORD
  v_cvt_pk_bf16_f32 v245, v218, v219
  v_cvt_pk_bf16_f32 v246, v220, v221
  v_cvt_pk_bf16_f32 v247, v222, v223
  buffer_store_dwordx4 v[244:247], v231, s[28:31], s42 offen offset:1024 sc1
  v_accvgpr_read_b32 v208, a48
  v_accvgpr_read_b32 v209, a49
  v_accvgpr_read_b32 v210, a50
  v_accvgpr_read_b32 v211, a51
  v_accvgpr_read_b32 v212, a52
  v_accvgpr_read_b32 v213, a53
  v_accvgpr_read_b32 v214, a54
  v_accvgpr_read_b32 v215, a55
  v_mul_f32 v208, v208, v230
  v_mul_f32 v209, v209, v230
  v_mul_f32 v210, v210, v230
  v_mul_f32 v211, v211, v230
  v_mul_f32 v212, v212, v230
  v_mul_f32 v213, v213, v230
  v_mul_f32 v214, v214, v230
  v_mul_f32 v215, v215, v230
  v_cvt_pk_bf16_f32 v240, v208, v209
  v_or_b32_sdwa v240, v208, 1 dst_sel:WORD_0 dst_unused:UNUSED_PRESERVE src0_sel:WORD_1 src1_sel:DWORD
  v_cvt_pk_bf16_f32 v241, v210, v211
  v_cvt_pk_bf16_f32 v242, v212, v213
  v_cvt_pk_bf16_f32 v243, v214, v215
  buffer_store_dwordx4 v[240:243], v231, s[28:31], s42 offen offset:2048 sc1
  v_accvgpr_read_b32 v216, a56
  v_accvgpr_read_b32 v217, a57
  v_accvgpr_read_b32 v218, a58
  v_accvgpr_read_b32 v219, a59
  v_accvgpr_read_b32 v220, a60
  v_accvgpr_read_b32 v221, a61
  v_accvgpr_read_b32 v222, a62
  v_accvgpr_read_b32 v223, a63
  v_mul_f32 v216, v216, v230
  v_mul_f32 v217, v217, v230
  v_mul_f32 v218, v218, v230
  v_mul_f32 v219, v219, v230
  v_mul_f32 v220, v220, v230
  v_mul_f32 v221, v221, v230
  v_mul_f32 v222, v222, v230
  v_mul_f32 v223, v223, v230
  v_cvt_pk_bf16_f32 v244, v216, v217
  v_or_b32_sdwa v244, v216, 1 dst_sel:WORD_0 dst_unused:UNUSED_PRESERVE src0_sel:WORD_1 src1_sel:DWORD
  v_cvt_pk_bf16_f32 v245, v218, v219
  v_cvt_pk_bf16_f32 v246, v220, v221
  v_cvt_pk_bf16_f32 v247, v222, v223
  buffer_store_dwordx4 v[244:247], v231, s[28:31], s42 offen offset:3072 sc1
  s_cmp_eq_u32 s38, 7
  s_cbranch_scc1 K2_SM
  s_lshl_b32 s47, s38, 2
  s_sub_u32 s47, 27, s47
K2_S:
  s_waitcnt lgkmcnt(7)
  v_mfma_f32_32x32x16_bf16 v[80:95], a[128:131], v[32:35], v[176:191]
  ds_read_b128 a[160:163], v227 offset:18432
  v_exp_f32 v118, v118
  v_exp_f32 v119, v119
  s_waitcnt lgkmcnt(7)
  v_mfma_f32_32x32x16_bf16 v[80:95], a[132:135], v[36:39], v[80:95]
  ds_read_b128 a[164:167], v227 offset:22528
  buffer_load_dword v252, v250, s[80:83], 0 offen
  v_add_f32 v226, v226, v118
  v_add_f32 v226, v226, v119
  v_cvt_pk_bf16_f32 v155, v118, v119
  s_waitcnt lgkmcnt(7)
  v_mfma_f32_32x32x16_bf16 v[80:95], a[136:139], v[40:43], v[80:95]
  ds_read_b128 a[168:171], v227 offset:26624
  v_exp_f32 v120, v120
  v_exp_f32 v121, v121
  v_add_u32 v250, 430080, v250
  s_waitcnt lgkmcnt(7)
  v_mfma_f32_32x32x16_bf16 v[80:95], a[140:143], v[44:47], v[80:95]
  ds_read_b128 a[172:175], v227 offset:30720
  v_add_f32 v226, v226, v120
  v_add_f32 v226, v226, v121
  v_cvt_pk_bf16_f32 v156, v120, v121
  s_waitcnt lgkmcnt(7)
  v_mfma_f32_32x32x16_bf16 v[80:95], a[144:147], v[48:51], v[80:95]
  ds_read_b128 a[176:179], v227 offset:19456
  v_exp_f32 v122, v122
  v_exp_f32 v123, v123
  s_waitcnt lgkmcnt(7)
  v_mfma_f32_32x32x16_bf16 v[80:95], a[148:151], v[52:55], v[80:95]
  ds_read_b128 a[180:183], v227 offset:23552
  v_add_f32 v226, v226, v122
  v_add_f32 v226, v226, v123
  v_cvt_pk_bf16_f32 v157, v122, v123
  s_waitcnt lgkmcnt(7)
  v_mfma_f32_32x32x16_bf16 v[80:95], a[152:155], v[56:59], v[80:95]
  ds_read_b128 a[184:187], v227 offset:27648
  v_exp_f32 v124, v124
  v_exp_f32 v125, v125
  s_waitcnt lgkmcnt(7)
  v_mfma_f32_32x32x16_bf16 v[80:95], a[156:159], v[60:63], v[80:95]
  ds_read_b128 a[188:191], v227 offset:31744
  v_add_f32 v226, v226, v124
  v_add_f32 v226, v226, v125
  v_cvt_pk_bf16_f32 v158, v124, v125
  s_waitcnt lgkmcnt(7)
  v_mfma_f32_32x32x16_bf16 a[64:79], a[160:163], v[152:155], a[64:79]
  ds_read_b128 a[128:131], v228 offset:8192
  v_exp_f32 v126, v126
  v_exp_f32 v127, v127
  s_waitcnt lgkmcnt(7)
  v_mfma_f32_32x32x16_bf16 a[80:95], a[164:167], v[152:155], a[80:95]
  ds_read_b128 a[132:135], v228 offset:9216
  v_add_u32 v227, s43, v228
  v_add_f32 v226, v226, v126
  v_add_f32 v226, v226, v127
  v_cvt_pk_bf16_f32 v159, v126, v127
  s_waitcnt lgkmcnt(7)
  v_mfma_f32_32x32x16_bf16 a[96:111], a[168:171], v[152:155], a[96:111]
  ds_read_b128 a[136:139], v228 offset:10240
  v_and_b32 v227, 0x1ffff, v227
  v_exp_f32 v80, v80
  v_exp_f32 v81, v81
  s_waitcnt lgkmcnt(7)
  v_mfma_f32_32x32x16_bf16 a[112:127], a[172:175], v[152:155], a[112:127]
  ds_read_b128 a[140:143], v228 offset:11264
  v_add_f32 v226, v226, v80
  v_add_f32 v226, v226, v81
  v_cvt_pk_bf16_f32 v136, v80, v81
  s_waitcnt lgkmcnt(7)
  v_mfma_f32_32x32x16_bf16 a[64:79], a[176:179], v[156:159], a[64:79]
  ds_read_b128 a[144:147], v228 offset:12288
  v_exp_f32 v82, v82
  v_exp_f32 v83, v83
  s_waitcnt lgkmcnt(7)
  v_mfma_f32_32x32x16_bf16 a[80:95], a[180:183], v[156:159], a[80:95]
  ds_read_b128 a[148:151], v228 offset:13312
  v_add_f32 v226, v226, v82
  v_add_f32 v226, v226, v83
  v_cvt_pk_bf16_f32 v137, v82, v83
  s_waitcnt lgkmcnt(7)
  v_mfma_f32_32x32x16_bf16 a[96:111], a[184:187], v[156:159], a[96:111]
  ds_read_b128 a[152:155], v228 offset:14336
  v_exp_f32 v84, v84
  v_exp_f32 v85, v85
  s_waitcnt lgkmcnt(7)
  v_mfma_f32_32x32x16_bf16 a[112:127], a[188:191], v[156:159], a[112:127]
  ds_read_b128 a[156:159], v228 offset:15360
  v_add_f32 v226, v226, v84
  v_add_f32 v226, v226, v85
  v_cvt_pk_bf16_f32 v138, v84, v85
  s_waitcnt lgkmcnt(7)
  v_mfma_f32_32x32x16_bf16 v[112:127], a[128:131], v[32:35], v[176:191]
  ds_read_b128 a[160:163], v228 offset:16384
  v_exp_f32 v86, v86
  v_exp_f32 v87, v87
  s_waitcnt lgkmcnt(7)
  v_mfma_f32_32x32x16_bf16 v[112:127], a[132:135], v[36:39], v[112:127]
  ds_read_b128 a[164:167], v228 offset:20480
  v_add_f32 v226, v226, v86
  v_add_f32 v226, v226, v87
  v_cvt_pk_bf16_f32 v139, v86, v87
  s_waitcnt vmcnt(10)
  s_barrier
  s_waitcnt lgkmcnt(7)
  v_mfma_f32_32x32x16_bf16 v[112:127], a[136:139], v[40:43], v[112:127]
  ds_read_b128 a[168:171], v228 offset:24576
  s_mov_b32 m0, s41
  s_nop 0
  buffer_load_dwordx4 v229, s[24:27], 0 offen offset:0 lds
  v_exp_f32 v88, v88
  v_exp_f32 v89, v89
  s_waitcnt lgkmcnt(7)
  v_mfma_f32_32x32x16_bf16 v[112:127], a[140:143], v[44:47], v[112:127]
  ds_read_b128 a[172:175], v228 offset:28672
  buffer_load_dwordx4 v229, s[24:27], 0 offen offset:1024 lds
  v_add_f32 v226, v226, v88
  v_add_f32 v226, v226, v89
  v_cvt_pk_bf16_f32 v140, v88, v89
  s_waitcnt lgkmcnt(7)
  v_mfma_f32_32x32x16_bf16 v[112:127], a[144:147], v[48:51], v[112:127]
  ds_read_b128 a[176:179], v228 offset:17408
  buffer_load_dwordx4 v229, s[24:27], 0 offen offset:2048 lds
  v_exp_f32 v90, v90
  v_exp_f32 v91, v91
  s_waitcnt lgkmcnt(7)
  v_mfma_f32_32x32x16_bf16 v[112:127], a[148:151], v[52:55], v[112:127]
  ds_read_b128 a[180:183], v228 offset:21504
  buffer_load_dwordx4 v229, s[24:27], 0 offen offset:3072 lds
  v_add_f32 v226, v226, v90
  v_add_f32 v226, v226, v91
  v_cvt_pk_bf16_f32 v141, v90, v91
  s_waitcnt lgkmcnt(7)
  v_mfma_f32_32x32x16_bf16 v[112:127], a[152:155], v[56:59], v[112:127]
  ds_read_b128 a[184:187], v228 offset:25600
  s_add_u32 m0, s41, 4096
  s_nop 0
  buffer_load_dwordx4 v229, s[24:27], s42 offen offset:0 lds
  v_exp_f32 v92, v92
  v_exp_f32 v93, v93
  s_waitcnt lgkmcnt(7)
  v_mfma_f32_32x32x16_bf16 v[112:127], a[156:159], v[60:63], v[112:127]
  ds_read_b128 a[188:191], v228 offset:29696
  buffer_load_dwordx4 v229, s[24:27], s42 offen offset:1024 lds
  v_add_f32 v226, v226, v92
  v_add_f32 v226, v226, v93
  v_cvt_pk_bf16_f32 v142, v92, v93
  s_waitcnt lgkmcnt(7)
  v_mfma_f32_32x32x16_bf16 a[64:79], a[160:163], v[136:139], a[64:79]
  ds_read_b128 a[128:131], v227 offset:0
  buffer_load_dwordx4 v229, s[24:27], s42 offen offset:2048 lds
  v_exp_f32 v94, v94
  v_exp_f32 v95, v95
  s_waitcnt lgkmcnt(7)
  v_mfma_f32_32x32x16_bf16 a[80:95], a[164:167], v[136:139], a[80:95]
  ds_read_b128 a[132:135], v227 offset:1024
  buffer_load_dwordx4 v229, s[24:27], s42 offen offset:3072 lds
  v_add_f32 v226, v226, v94
  v_add_f32 v226, v226, v95
  v_cvt_pk_bf16_f32 v143, v94, v95
  s_waitcnt lgkmcnt(7)
  v_mfma_f32_32x32x16_bf16 a[96:111], a[168:171], v[136:139], a[96:111]
  ds_read_b128 a[136:139], v227 offset:2048
  v_add_u32 v229, s43, v229
  s_add_u32 s41, s41, s43
  s_and_b32 s41, s41, 0x1ffff
  v_exp_f32 v112, v112
  v_exp_f32 v113, v113
  s_waitcnt lgkmcnt(7)
  v_mfma_f32_32x32x16_bf16 a[112:127], a[172:175], v[136:139], a[112:127]
  ds_read_b128 a[140:143], v227 offset:3072
  v_add_f32 v226, v226, v112
  v_add_f32 v226, v226, v113
  v_cvt_pk_bf16_f32 v152, v112, v113
  s_waitcnt lgkmcnt(7)
  v_mfma_f32_32x32x16_bf16 a[64:79], a[176:179], v[140:143], a[64:79]
  ds_read_b128 a[144:147], v227 offset:4096
  v_exp_f32 v114, v114
  v_exp_f32 v115, v115
  s_waitcnt lgkmcnt(7)
  v_mfma_f32_32x32x16_bf16 a[80:95], a[180:183], v[140:143], a[80:95]
  ds_read_b128 a[148:151], v227 offset:5120
  v_add_f32 v226, v226, v114
  v_add_f32 v226, v226, v115
  v_cvt_pk_bf16_f32 v153, v114, v115
  s_waitcnt lgkmcnt(7)
  v_mfma_f32_32x32x16_bf16 a[96:111], a[184:187], v[140:143], a[96:111]
  ds_read_b128 a[152:155], v227 offset:6144
  v_exp_f32 v116, v116
  v_exp_f32 v117, v117
  s_waitcnt lgkmcnt(7)
  v_mfma_f32_32x32x16_bf16 a[112:127], a[188:191], v[140:143], a[112:127]
  ds_read_b128 a[156:159], v227 offset:7168
  v_add_f32 v226, v226, v116
  v_add_f32 v226, v226, v117
  v_cvt_pk_bf16_f32 v154, v116, v117
  v_swap_b32 v227, v228
  s_sub_u32 s47, s47, 1
  s_cmp_lg_u32 s47, 0
  s_cbranch_scc1 K2_S
  s_mov_b32 s44, 0
K2_SM:
  s_add_i32 s48, s44, 0
  s_cmp_eq_i32 s48, s36
  s_cselect_b32 s45, 1.0, 0
  s_cmp_gt_i32 s48, s36
  s_cselect_b32 s46, -1e+30, 0
  v_add_f32 v230, s46, v176
  v_fma_f32 v208, v192, s45, v230
  v_fma_f32 v209, v193, s45, v230
  v_fma_f32 v210, v194, s45, v230
  v_fma_f32 v211, v195, s45, v230
  v_fma_f32 v212, v196, s45, v230
  v_fma_f32 v213, v197, s45, v230
  v_fma_f32 v214, v198, s45, v230
  v_fma_f32 v215, v199, s45, v230
  v_fma_f32 v216, v200, s45, v230
  v_fma_f32 v217, v201, s45, v230
  v_fma_f32 v218, v202, s45, v230
  v_fma_f32 v219, v203, s45, v230
  v_fma_f32 v220, v204, s45, v230
  v_fma_f32 v221, v205, s45, v230
  v_fma_f32 v222, v206, s45, v230
  v_fma_f32 v223, v207, s45, v230
  s_waitcnt lgkmcnt(7)
  s_nop 0
  v_mfma_f32_32x32x16_bf16 v[80:95], a[128:131], v[32:35], v[208:223]
  ds_read_b128 a[160:163], v227 offset:18432
  v_exp_f32 v118, v118
  v_exp_f32 v119, v119
  s_waitcnt lgkmcnt(7)
  v_mfma_f32_32x32x16_bf16 v[80:95], a[132:135], v[36:39], v[80:95]
  ds_read_b128 a[164:167], v227 offset:22528
  v_add_f32 v226, v226, v118
  v_add_f32 v226, v226, v119
  v_cvt_pk_bf16_f32 v155, v118, v119
  s_waitcnt lgkmcnt(7)
  v_mfma_f32_32x32x16_bf16 v[80:95], a[136:139], v[40:43], v[80:95]
  ds_read_b128 a[168:171], v227 offset:26624
  v_exp_f32 v120, v120
  v_exp_f32 v121, v121
  s_waitcnt lgkmcnt(7)
  v_mfma_f32_32x32x16_bf16 v[80:95], a[140:143], v[44:47], v[80:95]
  ds_read_b128 a[172:175], v227 offset:30720
  s_add_i32 s48, s44, 1
  s_cmp_eq_i32 s48, s36
  v_add_f32 v226, v226, v120
  v_add_f32 v226, v226, v121
  v_cvt_pk_bf16_f32 v156, v120, v121
  s_waitcnt lgkmcnt(7)
  v_mfma_f32_32x32x16_bf16 v[80:95], a[144:147], v[48:51], v[80:95]
  ds_read_b128 a[176:179], v227 offset:19456
  s_cselect_b32 s45, 1.0, 0
  v_exp_f32 v122, v122
  v_exp_f32 v123, v123
  s_waitcnt lgkmcnt(7)
  v_mfma_f32_32x32x16_bf16 v[80:95], a[148:151], v[52:55], v[80:95]
  ds_read_b128 a[180:183], v227 offset:23552
  s_cmp_gt_i32 s48, s36
  s_cselect_b32 s46, -1e+30, 0
  v_add_f32 v226, v226, v122
  v_add_f32 v226, v226, v123
  v_cvt_pk_bf16_f32 v157, v122, v123
  s_waitcnt lgkmcnt(7)
  v_mfma_f32_32x32x16_bf16 v[80:95], a[152:155], v[56:59], v[80:95]
  ds_read_b128 a[184:187], v227 offset:27648
  v_add_f32 v230, s46, v176
  v_exp_f32 v124, v124
  v_exp_f32 v125, v125
  s_waitcnt lgkmcnt(7)
  v_mfma_f32_32x32x16_bf16 v[80:95], a[156:159], v[60:63], v[80:95]
  ds_read_b128 a[188:191], v227 offset:31744
  v_fma_f32 v208, v192, s45, v230
  v_fma_f32 v209, v193, s45, v230
  v_add_f32 v226, v226, v124
  v_add_f32 v226, v226, v125
  v_cvt_pk_bf16_f32 v158, v124, v125
  s_waitcnt lgkmcnt(7)
  v_mfma_f32_32x32x16_bf16 a[64:79], a[160:163], v[152:155], a[64:79]
  ds_read_b128 a[128:131], v228 offset:8192
  v_fma_f32 v210, v194, s45, v230
  v_exp_f32 v126, v126
  v_exp_f32 v127, v127
  s_waitcnt lgkmcnt(7)
  v_mfma_f32_32x32x16_bf16 a[80:95], a[164:167], v[152:155], a[80:95]
  ds_read_b128 a[132:135], v228 offset:9216
  v_fma_f32 v211, v195, s45, v230
  v_add_u32 v227, s43, v228
  v_add_f32 v226, v226, v126
  v_add_f32 v226, v226, v127
  v_cvt_pk_bf16_f32 v159, v126, v127
  s_waitcnt lgkmcnt(7)
  v_mfma_f32_32x32x16_bf16 a[96:111], a[168:171], v[152:155], a[96:111]
  ds_read_b128 a[136:139], v228 offset:10240
  v_and_b32 v227, 0x1ffff, v227
  v_exp_f32 v80, v80
  v_exp_f32 v81, v81
  s_waitcnt lgkmcnt(7)
  v_mfma_f32_32x32x16_bf16 a[112:127], a[172:175], v[152:155], a[112:127]
  ds_read_b128 a[140:143], v228 offset:11264
  v_fma_f32 v212, v196, s45, v230
  v_fma_f32 v213, v197, s45, v230
  v_add_f32 v226, v226, v80
  v_add_f32 v226, v226, v81
  v_cvt_pk_bf16_f32 v136, v80, v81
  s_waitcnt lgkmcnt(7)
  v_mfma_f32_32x32x16_bf16 a[64:79], a[176:179], v[156:159], a[64:79]
  ds_read_b128 a[144:147], v228 offset:12288
  v_fma_f32 v214, v198, s45, v230
  v_exp_f32 v82, v82
  v_exp_f32 v83, v83
  s_waitcnt lgkmcnt(7)
  v_mfma_f32_32x32x16_bf16 a[80:95], a[180:183], v[156:159], a[80:95]
  ds_read_b128 a[148:151], v228 offset:13312
  v_fma_f32 v215, v199, s45, v230
  v_fma_f32 v216, v200, s45, v230
  v_add_f32 v226, v226, v82
  v_add_f32 v226, v226, v83
  v_cvt_pk_bf16_f32 v137, v82, v83
  s_waitcnt lgkmcnt(7)
  v_mfma_f32_32x32x16_bf16 a[96:111], a[184:187], v[156:159], a[96:111]
  ds_read_b128 a[152:155], v228 offset:14336
  v_fma_f32 v217, v201, s45, v230
  v_exp_f32 v84, v84
  v_exp_f32 v85, v85
  s_waitcnt lgkmcnt(7)
  v_mfma_f32_32x32x16_bf16 a[112:127], a[188:191], v[156:159], a[112:127]
  ds_read_b128 a[156:159], v228 offset:15360
  v_fma_f32 v218, v202, s45, v230
  v_fma_f32 v219, v203, s45, v230
  v_fma_f32 v220, v204, s45, v230
  v_fma_f32 v221, v205, s45, v230
  v_fma_f32 v222, v206, s45, v230
  v_fma_f32 v223, v207, s45, v230
  v_add_f32 v226, v226, v84
  v_add_f32 v226, v226, v85
  v_cvt_pk_bf16_f32 v138, v84, v85
  s_waitcnt lgkmcnt(7)
  v_mfma_f32_32x32x16_bf16 v[112:127], a[128:131], v[32:35], v[208:223]
  ds_read_b128 a[160:163], v228 offset:16384
  v_exp_f32 v86, v86
  v_exp_f32 v87, v87
  s_waitcnt lgkmcnt(7)
  v_mfma_f32_32x32x16_bf16 v[112:127], a[132:135], v[36:39], v[112:127]
  ds_read_b128 a[164:167], v228 offset:20480
  v_add_f32 v226, v226, v86
  v_add_f32 v226, v226, v87
  v_cvt_pk_bf16_f32 v139, v86, v87
  s_waitcnt vmcnt(8)
  s_barrier
  s_waitcnt lgkmcnt(7)
  v_mfma_f32_32x32x16_bf16 v[112:127], a[136:139], v[40:43], v[112:127]
  ds_read_b128 a[168:171], v228 offset:24576
  s_mov_b32 m0, s41
  s_nop 0
  buffer_load_dwordx4 v229, s[24:27], 0 offen offset:0 lds
  v_exp_f32 v88, v88
  v_exp_f32 v89, v89
  s_waitcnt lgkmcnt(7)
  v_mfma_f32_32x32x16_bf16 v[112:127], a[140:143], v[44:47], v[112:127]
  ds_read_b128 a[172:175], v228 offset:28672
  buffer_load_dwordx4 v229, s[24:27], 0 offen offset:1024 lds
  v_add_f32 v226, v226, v88
  v_add_f32 v226, v226, v89
  v_cvt_pk_bf16_f32 v140, v88, v89
  s_waitcnt lgkmcnt(7)
  v_mfma_f32_32x32x16_bf16 v[112:127], a[144:147], v[48:51], v[112:127]
  ds_read_b128 a[176:179], v228 offset:17408
  buffer_load_dwordx4 v229, s[24:27], 0 offen offset:2048 lds
  v_exp_f32 v90, v90
  v_exp_f32 v91, v91
  s_waitcnt lgkmcnt(7)
  v_mfma_f32_32x32x16_bf16 v[112:127], a[148:151], v[52:55], v[112:127]
  ds_read_b128 a[180:183], v228 offset:21504
  buffer_load_dwordx4 v229, s[24:27], 0 offen offset:3072 lds
  v_add_f32 v226, v226, v90
  v_add_f32 v226, v226, v91
  v_cvt_pk_bf16_f32 v141, v90, v91
  s_waitcnt lgkmcnt(7)
  v_mfma_f32_32x32x16_bf16 v[112:127], a[152:155], v[56:59], v[112:127]
  ds_read_b128 a[184:187], v228 offset:25600
  s_add_u32 m0, s41, 4096
  s_nop 0
  buffer_load_dwordx4 v229, s[24:27], s42 offen offset:0 lds
  v_exp_f32 v92, v92
  v_exp_f32 v93, v93
  s_waitcnt lgkmcnt(7)
  v_mfma_f32_32x32x16_bf16 v[112:127], a[156:159], v[60:63], v[112:127]
  ds_read_b128 a[188:191], v228 offset:29696
  buffer_load_dwordx4 v229, s[24:27], s42 offen offset:1024 lds
  v_add_f32 v226, v226, v92
  v_add_f32 v226, v226, v93
  v_cvt_pk_bf16_f32 v142, v92, v93
  s_waitcnt lgkmcnt(7)
  v_mfma_f32_32x32x16_bf16 a[64:79], a[160:163], v[136:139], a[64:79]
  ds_read_b128 a[128:131], v227 offset:0
  buffer_load_dwordx4 v229, s[24:27], s42 offen offset:2048 lds
  v_exp_f32 v94, v94
  v_exp_f32 v95, v95
  s_waitcnt lgkmcnt(7)
  v_mfma_f32_32x32x16_bf16 a[80:95], a[164:167], v[136:139], a[80:95]
  ds_read_b128 a[132:135], v227 offset:1024
  buffer_load_dwordx4 v229, s[24:27], s42 offen offset:3072 lds
  v_add_f32 v226, v226, v94
  v_add_f32 v226, v226, v95
  v_cvt_pk_bf16_f32 v143, v94, v95
  s_waitcnt lgkmcnt(7)
  v_mfma_f32_32x32x16_bf16 a[96:111], a[168:171], v[136:139], a[96:111]
  ds_read_b128 a[136:139], v227 offset:2048
  v_add_u32 v229, s43, v229
  s_add_u32 s41, s41, s43
  s_and_b32 s41, s41, 0x1ffff
  v_exp_f32 v112, v112
  v_exp_f32 v113, v113
  s_waitcnt lgkmcnt(7)
  v_mfma_f32_32x32x16_bf16 a[112:127], a[172:175], v[136:139], a[112:127]
  ds_read_b128 a[140:143], v227 offset:3072
  v_add_f32 v226, v226, v112
  v_add_f32 v226, v226, v113
  v_cvt_pk_bf16_f32 v152, v112, v113
  s_waitcnt lgkmcnt(7)
  v_mfma_f32_32x32x16_bf16 a[64:79], a[176:179], v[140:143], a[64:79]
  ds_read_b128 a[144:147], v227 offset:4096
  v_exp_f32 v114, v114
  v_exp_f32 v115, v115
  s_waitcnt lgkmcnt(7)
  v_mfma_f32_32x32x16_bf16 a[80:95], a[180:183], v[140:143], a[80:95]
  ds_read_b128 a[148:151], v227 offset:5120
  v_add_f32 v226, v226, v114
  v_add_f32 v226, v226, v115
  v_cvt_pk_bf16_f32 v153, v114, v115
  s_waitcnt lgkmcnt(7)
  v_mfma_f32_32x32x16_bf16 a[96:111], a[184:187], v[140:143], a[96:111]
  ds_read_b128 a[152:155], v227 offset:6144
  v_exp_f32 v116, v116
  v_exp_f32 v117, v117
  s_waitcnt lgkmcnt(7)
  v_mfma_f32_32x32x16_bf16 a[112:127], a[188:191], v[140:143], a[112:127]
  ds_read_b128 a[156:159], v227 offset:7168
  v_add_f32 v226, v226, v116
  v_add_f32 v226, v226, v117
  v_cvt_pk_bf16_f32 v154, v116, v117
  v_swap_b32 v227, v228
  s_add_i32 s44, s44, 2
  s_cmp_lt_i32 s44, 4
  s_cbranch_scc1 K2_SM
  ds_read_b128 a[160:163], v227 offset:18432
  ds_read_b128 a[164:167], v227 offset:22528
  ds_read_b128 a[168:171], v227 offset:26624
  ds_read_b128 a[172:175], v227 offset:30720
  ds_read_b128 a[176:179], v227 offset:19456
  ds_read_b128 a[180:183], v227 offset:23552
  ds_read_b128 a[184:187], v227 offset:27648
  ds_read_b128 a[188:191], v227 offset:31744
  v_exp_f32 v118, v118
  v_exp_f32 v119, v119
  v_add_f32 v226, v226, v118
  v_add_f32 v226, v226, v119
  v_cvt_pk_bf16_f32 v155, v118, v119
  s_waitcnt lgkmcnt(7)
  s_nop 0
  v_mfma_f32_32x32x16_bf16 a[64:79], a[160:163], v[152:155], a[64:79]
  v_exp_f32 v120, v120
  v_exp_f32 v121, v121
  v_add_f32 v226, v226, v120
  v_add_f32 v226, v226, v121
  v_cvt_pk_bf16_f32 v156, v120, v121
  s_waitcnt lgkmcnt(6)
  v_mfma_f32_32x32x16_bf16 a[80:95], a[164:167], v[152:155], a[80:95]
  v_exp_f32 v122, v122
  v_exp_f32 v123, v123
  v_add_f32 v226, v226, v122
  v_add_f32 v226, v226, v123
  v_cvt_pk_bf16_f32 v157, v122, v123
  s_waitcnt lgkmcnt(5)
  v_mfma_f32_32x32x16_bf16 a[96:111], a[168:171], v[152:155], a[96:111]
  v_exp_f32 v124, v124
  v_exp_f32 v125, v125
  v_add_f32 v226, v226, v124
  v_add_f32 v226, v226, v125
  v_cvt_pk_bf16_f32 v158, v124, v125
  s_waitcnt lgkmcnt(4)
  v_mfma_f32_32x32x16_bf16 a[112:127], a[172:175], v[152:155], a[112:127]
  v_exp_f32 v126, v126
  v_exp_f32 v127, v127
  v_add_f32 v226, v226, v126
  v_add_f32 v226, v226, v127
  v_cvt_pk_bf16_f32 v159, v126, v127
  s_waitcnt lgkmcnt(3)
  s_nop 0
  v_mfma_f32_32x32x16_bf16 a[64:79], a[176:179], v[156:159], a[64:79]
  s_waitcnt lgkmcnt(2)
  v_mfma_f32_32x32x16_bf16 a[80:95], a[180:183], v[156:159], a[80:95]
  s_waitcnt lgkmcnt(1)
  v_mfma_f32_32x32x16_bf16 a[96:111], a[184:187], v[156:159], a[96:111]
  s_waitcnt lgkmcnt(0)
  v_mfma_f32_32x32x16_bf16 a[112:127], a[188:191], v[156:159], a[112:127]
  v_mov_b32 v230, v226
  s_nop 1
  v_permlane32_swap_b32 v230, v226
  v_add_f32 v226, v226, v230
  v_rcp_f32 v230, v226
  s_lshl_b32 s48, s38, 2
  s_sub_u32 s48, 60, s48
  s_add_u32 s48, s48, s36
  s_lshl_b32 s48, s48, 18
  s_lshl_b32 s49, s37, 13
  s_add_u32 s48, s48, s49
  v_lshl_add_u32 v231, v224, 4, s48
  v_mov_b32 v233, v230
  v_accvgpr_read_b32 v208, a64
  v_accvgpr_read_b32 v209, a65
  v_accvgpr_read_b32 v210, a66
  v_accvgpr_read_b32 v211, a67
  v_accvgpr_read_b32 v212, a68
  v_accvgpr_read_b32 v213, a69
  v_accvgpr_read_b32 v214, a70
  v_accvgpr_read_b32 v215, a71
  v_mul_f32 v208, v208, v230
  v_mul_f32 v209, v209, v230
  v_mul_f32 v210, v210, v230
  v_mul_f32 v211, v211, v230
  v_mul_f32 v212, v212, v230
  v_mul_f32 v213, v213, v230
  v_mul_f32 v214, v214, v230
  v_mul_f32 v215, v215, v230
  v_cvt_pk_bf16_f32 v240, v208, v209
  v_or_b32_sdwa v240, v208, 1 dst_sel:WORD_0 dst_unused:UNUSED_PRESERVE src0_sel:WORD_1 src1_sel:DWORD
  v_cvt_pk_bf16_f32 v241, v210, v211
  v_cvt_pk_bf16_f32 v242, v212, v213
  v_cvt_pk_bf16_f32 v243, v214, v215
  buffer_store_dwordx4 v[240:243], v231, s[28:31], 0 offen offset:0 sc1
  v_accvgpr_read_b32 v216, a72
  v_accvgpr_read_b32 v217, a73
  v_accvgpr_read_b32 v218, a74
  v_accvgpr_read_b32 v219, a75
  v_accvgpr_read_b32 v220, a76
  v_accvgpr_read_b32 v221, a77
  v_accvgpr_read_b32 v222, a78
  v_accvgpr_read_b32 v223, a79
  v_mul_f32 v216, v216, v230
  v_mul_f32 v217, v217, v230
  v_mul_f32 v218, v218, v230
  v_mul_f32 v219, v219, v230
  v_mul_f32 v220, v220, v230
  v_mul_f32 v221, v221, v230
  v_mul_f32 v222, v222, v230
  v_mul_f32 v223, v223, v230
  v_cvt_pk_bf16_f32 v244, v216, v217
  v_or_b32_sdwa v244, v216, 1 dst_sel:WORD_0 dst_unused:UNUSED_PRESERVE src0_sel:WORD_1 src1_sel:DWORD
  v_cvt_pk_bf16_f32 v245, v218, v219
  v_cvt_pk_bf16_f32 v246, v220, v221
  v_cvt_pk_bf16_f32 v247, v222, v223
  buffer_store_dwordx4 v[244:247], v231, s[28:31], 0 offen offset:1024 sc1
  v_accvgpr_read_b32 v208, a80
  v_accvgpr_read_b32 v209, a81
  v_accvgpr_read_b32 v210, a82
  v_accvgpr_read_b32 v211, a83
  v_accvgpr_read_b32 v212, a84
  v_accvgpr_read_b32 v213, a85
  v_accvgpr_read_b32 v214, a86
  v_accvgpr_read_b32 v215, a87
  v_mul_f32 v208, v208, v230
  v_mul_f32 v209, v209, v230
  v_mul_f32 v210, v210, v230
  v_mul_f32 v211, v211, v230
  v_mul_f32 v212, v212, v230
  v_mul_f32 v213, v213, v230
  v_mul_f32 v214, v214, v230
  v_mul_f32 v215, v215, v230
  v_cvt_pk_bf16_f32 v240, v208, v209
  v_or_b32_sdwa v240, v208, 1 dst_sel:WORD_0 dst_unused:UNUSED_PRESERVE src0_sel:WORD_1 src1_sel:DWORD
  v_cvt_pk_bf16_f32 v241, v210, v211
  v_cvt_pk_bf16_f32 v242, v212, v213
  v_cvt_pk_bf16_f32 v243, v214, v215
  buffer_store_dwordx4 v[240:243], v231, s[28:31], 0 offen offset:2048 sc1
  v_accvgpr_read_b32 v216, a88
  v_accvgpr_read_b32 v217, a89
  v_accvgpr_read_b32 v218, a90
  v_accvgpr_read_b32 v219, a91
  v_accvgpr_read_b32 v220, a92
  v_accvgpr_read_b32 v221, a93
  v_accvgpr_read_b32 v222, a94
  v_accvgpr_read_b32 v223, a95
  v_mul_f32 v216, v216, v230
  v_mul_f32 v217, v217, v230
  v_mul_f32 v218, v218, v230
  v_mul_f32 v219, v219, v230
  v_mul_f32 v220, v220, v230
  v_mul_f32 v221, v221, v230
  v_mul_f32 v222, v222, v230
  v_mul_f32 v223, v223, v230
  v_cvt_pk_bf16_f32 v244, v216, v217
  v_or_b32_sdwa v244, v216, 1 dst_sel:WORD_0 dst_unused:UNUSED_PRESERVE src0_sel:WORD_1 src1_sel:DWORD
  v_cvt_pk_bf16_f32 v245, v218, v219
  v_cvt_pk_bf16_f32 v246, v220, v221
  v_cvt_pk_bf16_f32 v247, v222, v223
  buffer_store_dwordx4 v[244:247], v231, s[28:31], 0 offen offset:3072 sc1
  v_accvgpr_read_b32 v208, a96
  v_accvgpr_read_b32 v209, a97
  v_accvgpr_read_b32 v210, a98
  v_accvgpr_read_b32 v211, a99
  v_accvgpr_read_b32 v212, a100
  v_accvgpr_read_b32 v213, a101
  v_accvgpr_read_b32 v214, a102
  v_accvgpr_read_b32 v215, a103
  v_mul_f32 v208, v208, v230
  v_mul_f32 v209, v209, v230
  v_mul_f32 v210, v210, v230
  v_mul_f32 v211, v211, v230
  v_mul_f32 v212, v212, v230
  v_mul_f32 v213, v213, v230
  v_mul_f32 v214, v214, v230
  v_mul_f32 v215, v215, v230
  v_cvt_pk_bf16_f32 v240, v208, v209
  v_or_b32_sdwa v240, v208, 1 dst_sel:WORD_0 dst_unused:UNUSED_PRESERVE src0_sel:WORD_1 src1_sel:DWORD
  v_cvt_pk_bf16_f32 v241, v210, v211
  v_cvt_pk_bf16_f32 v242, v212, v213
  v_cvt_pk_bf16_f32 v243, v214, v215
  buffer_store_dwordx4 v[240:243], v231, s[28:31], s42 offen offset:0 sc1
  v_accvgpr_read_b32 v216, a104
  v_accvgpr_read_b32 v217, a105
  v_accvgpr_read_b32 v218, a106
  v_accvgpr_read_b32 v219, a107
  v_accvgpr_read_b32 v220, a108
  v_accvgpr_read_b32 v221, a109
  v_accvgpr_read_b32 v222, a110
  v_accvgpr_read_b32 v223, a111
  v_mul_f32 v216, v216, v230
  v_mul_f32 v217, v217, v230
  v_mul_f32 v218, v218, v230
  v_mul_f32 v219, v219, v230
  v_mul_f32 v220, v220, v230
  v_mul_f32 v221, v221, v230
  v_mul_f32 v222, v222, v230
  v_mul_f32 v223, v223, v230
  v_cvt_pk_bf16_f32 v244, v216, v217
  v_or_b32_sdwa v244, v216, 1 dst_sel:WORD_0 dst_unused:UNUSED_PRESERVE src0_sel:WORD_1 src1_sel:DWORD
  v_cvt_pk_bf16_f32 v245, v218, v219
  v_cvt_pk_bf16_f32 v246, v220, v221
  v_cvt_pk_bf16_f32 v247, v222, v223
  buffer_store_dwordx4 v[244:247], v231, s[28:31], s42 offen offset:1024 sc1
  v_accvgpr_read_b32 v208, a112
  v_accvgpr_read_b32 v209, a113
  v_accvgpr_read_b32 v210, a114
  v_accvgpr_read_b32 v211, a115
  v_accvgpr_read_b32 v212, a116
  v_accvgpr_read_b32 v213, a117
  v_accvgpr_read_b32 v214, a118
  v_accvgpr_read_b32 v215, a119
  v_mul_f32 v208, v208, v230
  v_mul_f32 v209, v209, v230
  v_mul_f32 v210, v210, v230
  v_mul_f32 v211, v211, v230
  v_mul_f32 v212, v212, v230
  v_mul_f32 v213, v213, v230
  v_mul_f32 v214, v214, v230
  v_mul_f32 v215, v215, v230
  v_cvt_pk_bf16_f32 v240, v208, v209
  v_or_b32_sdwa v240, v208, 1 dst_sel:WORD_0 dst_unused:UNUSED_PRESERVE src0_sel:WORD_1 src1_sel:DWORD
  v_cvt_pk_bf16_f32 v241, v210, v211
  v_cvt_pk_bf16_f32 v242, v212, v213
  v_cvt_pk_bf16_f32 v243, v214, v215
  buffer_store_dwordx4 v[240:243], v231, s[28:31], s42 offen offset:2048 sc1
  v_accvgpr_read_b32 v216, a120
  v_accvgpr_read_b32 v217, a121
  v_accvgpr_read_b32 v218, a122
  v_accvgpr_read_b32 v219, a123
  v_accvgpr_read_b32 v220, a124
  v_accvgpr_read_b32 v221, a125
  v_accvgpr_read_b32 v222, a126
  v_accvgpr_read_b32 v223, a127
  v_mul_f32 v216, v216, v230
  v_mul_f32 v217, v217, v230
  v_mul_f32 v218, v218, v230
  v_mul_f32 v219, v219, v230
  v_mul_f32 v220, v220, v230
  v_mul_f32 v221, v221, v230
  v_mul_f32 v222, v222, v230
  v_mul_f32 v223, v223, v230
  v_cvt_pk_bf16_f32 v244, v216, v217
  v_or_b32_sdwa v244, v216, 1 dst_sel:WORD_0 dst_unused:UNUSED_PRESERVE src0_sel:WORD_1 src1_sel:DWORD
  v_cvt_pk_bf16_f32 v245, v218, v219
  v_cvt_pk_bf16_f32 v246, v220, v221
  v_cvt_pk_bf16_f32 v247, v222, v223
  buffer_store_dwordx4 v[244:247], v231, s[28:31], s42 offen offset:3072 sc1
  v_cmp_nge_f32 vcc, 0x53800000, v225
  s_nop 4
  s_cbranch_vccnz K2_FBA
K2_BACKA:
  v_cmp_nge_f32 vcc, 0x53800000, v226
  s_nop 4
  s_cbranch_vccnz K2_FBB
K2_BACKB:
K2_END:
  s_endpgm
K2_FBA:
  s_waitcnt vmcnt(0) lgkmcnt(0)
  s_lshl_b32 s50, s38, 2
  s_add_u32 s50, s50, s36
  v_mov_b32 v168, -1e+30
  s_mov_b32 s51, 0
K2_FBA1:
  s_lshr_b32 s53, s51, 1
  s_lshl_b32 s53, s53, 15
  s_and_b32 s52, s51, 1
  s_lshl_b32 s48, s52, 13
  s_add_u32 s48, s48, s53
  v_lshlrev_b32 v175, 4, v224
  v_add_u32 v170, s48, v175
  s_lshl_b32 s48, s52, 11
  s_add_u32 s48, s48, s53
  s_add_u32 s48, s48, 16384
  v_add_u32 v171, s48, v175
  v_add_u32 v172, 4096, v171
  v_add_u32 v173, 8192, v171
  v_add_u32 v174, 12288, v171
  v_add_u32 v175, 4096, v170
  s_cmp_eq_u32 s51, s50
  s_cselect_b32 s52, 1.0, 0
  buffer_load_dwordx4 v[64:67], v170, s[24:27], 0 offen offset:0
  buffer_load_dwordx4 v[68:71], v170, s[24:27], 0 offen offset:1024
  buffer_load_dwordx4 v[72:75], v170, s[24:27], 0 offen offset:2048
  buffer_load_dwordx4 v[76:79], v170, s[24:27], 0 offen offset:3072
  buffer_load_dwordx4 v[80:83], v175, s[24:27], 0 offen offset:0
  buffer_load_dwordx4 v[84:87], v175, s[24:27], 0 offen offset:1024
  buffer_load_dwordx4 v[88:91], v175, s[24:27], 0 offen offset:2048
  buffer_load_dwordx4 v[92:95], v175, s[24:27], 0 offen offset:3072
  v_mul_f32 v144, s52, v192
  v_mul_f32 v145, s52, v193
  v_mul_f32 v146, s52, v194
  v_mul_f32 v147, s52, v195
  v_mul_f32 v148, s52, v196
  v_mul_f32 v149, s52, v197
  v_mul_f32 v150, s52, v198
  v_mul_f32 v151, s52, v199
  v_mul_f32 v152, s52, v200
  v_mul_f32 v153, s52, v201
  v_mul_f32 v154, s52, v202
  v_mul_f32 v155, s52, v203
  v_mul_f32 v156, s52, v204
  v_mul_f32 v157, s52, v205
  v_mul_f32 v158, s52, v206
  v_mul_f32 v159, s52, v207
  s_waitcnt vmcnt(7)
  s_nop 0
  v_mfma_f32_32x32x16_bf16 v[128:143], v[64:67], v[0:3], v[144:159]
  s_waitcnt vmcnt(6)
  v_mfma_f32_32x32x16_bf16 v[128:143], v[68:71], v[4:7], v[128:143]
  s_waitcnt vmcnt(5)
  v_mfma_f32_32x32x16_bf16 v[128:143], v[72:75], v[8:11], v[128:143]
  s_waitcnt vmcnt(4)
  v_mfma_f32_32x32x16_bf16 v[128:143], v[76:79], v[12:15], v[128:143]
  s_waitcnt vmcnt(3)
  v_mfma_f32_32x32x16_bf16 v[128:143], v[80:83], v[16:19], v[128:143]
  s_waitcnt vmcnt(2)
  v_mfma_f32_32x32x16_bf16 v[128:143], v[84:87], v[20:23], v[128:143]
  s_waitcnt vmcnt(1)
  v_mfma_f32_32x32x16_bf16 v[128:143], v[88:91], v[24:27], v[128:143]
  s_waitcnt vmcnt(0)
  v_mfma_f32_32x32x16_bf16 v[128:143], v[92:95], v[28:31], v[128:143]
  s_nop 11
  v_max3_f32 v168, v168, v128, v129
  v_max3_f32 v168, v168, v130, v131
  v_max3_f32 v168, v168, v132, v133
  v_max3_f32 v168, v168, v134, v135
  v_max3_f32 v168, v168, v136, v137
  v_max3_f32 v168, v168, v138, v139
  v_max3_f32 v168, v168, v140, v141
  v_max3_f32 v168, v168, v142, v143
  s_add_u32 s51, s51, 1
  s_cmp_le_u32 s51, s50
  s_cbranch_scc1 K2_FBA1
  v_mov_b32 v170, v168
  s_nop 1
  v_permlane32_swap_b32 v170, v168
  v_max_f32 v168, v168, v170
  v_mov_b32 v225, 0
  v_accvgpr_write_b32 a0, 0
  v_accvgpr_write_b32 a1, 0
  v_accvgpr_write_b32 a2, 0
  v_accvgpr_write_b32 a3, 0
  v_accvgpr_write_b32 a4, 0
  v_accvgpr_write_b32 a5, 0
  v_accvgpr_write_b32 a6, 0
  v_accvgpr_write_b32 a7, 0
  v_accvgpr_write_b32 a8, 0
  v_accvgpr_write_b32 a9, 0
  v_accvgpr_write_b32 a10, 0
  v_accvgpr_write_b32 a11, 0
  v_accvgpr_write_b32 a12, 0
  v_accvgpr_write_b32 a13, 0
  v_accvgpr_write_b32 a14, 0
  v_accvgpr_write_b32 a15, 0
  v_accvgpr_write_b32 a16, 0
  v_accvgpr_write_b32 a17, 0
  v_accvgpr_write_b32 a18, 0
  v_accvgpr_write_b32 a19, 0
  v_accvgpr_write_b32 a20, 0
  v_accvgpr_write_b32 a21, 0
  v_accvgpr_write_b32 a22, 0
  v_accvgpr_write_b32 a23, 0
  v_accvgpr_write_b32 a24, 0
  v_accvgpr_write_b32 a25, 0
  v_accvgpr_write_b32 a26, 0
  v_accvgpr_write_b32 a27, 0
  v_accvgpr_write_b32 a28, 0
  v_accvgpr_write_b32 a29, 0
  v_accvgpr_write_b32 a30, 0
  v_accvgpr_write_b32 a31, 0
  v_accvgpr_write_b32 a32, 0
  v_accvgpr_write_b32 a33, 0
  v_accvgpr_write_b32 a34, 0
  v_accvgpr_write_b32 a35, 0
  v_accvgpr_write_b32 a36, 0
  v_accvgpr_write_b32 a37, 0
  v_accvgpr_write_b32 a38, 0
  v_accvgpr_write_b32 a39, 0
  v_accvgpr_write_b32 a40, 0
  v_accvgpr_write_b32 a41, 0
  v_accvgpr_write_b32 a42, 0
  v_accvgpr_write_b32 a43, 0
  v_accvgpr_write_b32 a44, 0
  v_accvgpr_write_b32 a45, 0
  v_accvgpr_write_b32 a46, 0
  v_accvgpr_write_b32 a47, 0
  v_accvgpr_write_b32 a48, 0
  v_accvgpr_write_b32 a49, 0
  v_accvgpr_write_b32 a50, 0
  v_accvgpr_write_b32 a51, 0
  v_accvgpr_write_b32 a52, 0
  v_accvgpr_write_b32 a53, 0
  v_accvgpr_write_b32 a54, 0
  v_accvgpr_write_b32 a55, 0
  v_accvgpr_write_b32 a56, 0
  v_accvgpr_write_b32 a57, 0
  v_accvgpr_write_b32 a58, 0
  v_accvgpr_write_b32 a59, 0
  v_accvgpr_write_b32 a60, 0
  v_accvgpr_write_b32 a61, 0
  v_accvgpr_write_b32 a62, 0
  v_accvgpr_write_b32 a63, 0
  s_mov_b32 s51, 0
K2_FBA2:
  s_lshr_b32 s53, s51, 1
  s_lshl_b32 s53, s53, 15
  s_and_b32 s52, s51, 1
  s_lshl_b32 s48, s52, 13
  s_add_u32 s48, s48, s53
  v_lshlrev_b32 v175, 4, v224
  v_add_u32 v170, s48, v175
  s_lshl_b32 s48, s52, 11
  s_add_u32 s48, s48, s53
  s_add_u32 s48, s48, 16384
  v_add_u32 v171, s48, v175
  v_add_u32 v172, 4096, v171
  v_add_u32 v173, 8192, v171
  v_add_u32 v174, 12288, v171
  v_add_u32 v175, 4096, v170
  s_cmp_eq_u32 s51, s50
  s_cselect_b32 s52, 1.0, 0
  buffer_load_dwordx4 v[64:67], v170, s[24:27], 0 offen offset:0
  buffer_load_dwordx4 v[68:71], v170, s[24:27], 0 offen offset:1024
  buffer_load_dwordx4 v[72:75], v170, s[24:27], 0 offen offset:2048
  buffer_load_dwordx4 v[76:79], v170, s[24:27], 0 offen offset:3072
  buffer_load_dwordx4 v[80:83], v175, s[24:27], 0 offen offset:0
  buffer_load_dwordx4 v[84:87], v175, s[24:27], 0 offen offset:1024
  buffer_load_dwordx4 v[88:91], v175, s[24:27], 0 offen offset:2048
  buffer_load_dwordx4 v[92:95], v175, s[24:27], 0 offen offset:3072
  buffer_load_dwordx4 v[96:99], v171, s[24:27], 0 offen offset:0
  buffer_load_dwordx4 v[112:115], v171, s[24:27], 0 offen offset:1024
  buffer_load_dwordx4 v[100:103], v172, s[24:27], 0 offen offset:0
  buffer_load_dwordx4 v[116:119], v172, s[24:27], 0 offen offset:1024
  buffer_load_dwordx4 v[104:107], v173, s[24:27], 0 offen offset:0
  buffer_load_dwordx4 v[120:123], v173, s[24:27], 0 offen offset:1024
  buffer_load_dwordx4 v[108:111], v174, s[24:27], 0 offen offset:0
  buffer_load_dwordx4 v[124:127], v174, s[24:27], 0 offen offset:1024
  v_fma_f32 v144, v192, s52, -v168
  v_fma_f32 v145, v193, s52, -v168
  v_fma_f32 v146, v194, s52, -v168
  v_fma_f32 v147, v195, s52, -v168
  v_fma_f32 v148, v196, s52, -v168
  v_fma_f32 v149, v197, s52, -v168
  v_fma_f32 v150, v198, s52, -v168
  v_fma_f32 v151, v199, s52, -v168
  v_fma_f32 v152, v200, s52, -v168
  v_fma_f32 v153, v201, s52, -v168
  v_fma_f32 v154, v202, s52, -v168
  v_fma_f32 v155, v203, s52, -v168
  v_fma_f32 v156, v204, s52, -v168
  v_fma_f32 v157, v205, s52, -v168
  v_fma_f32 v158, v206, s52, -v168
  v_fma_f32 v159, v207, s52, -v168
  s_waitcnt vmcnt(15)
  s_nop 0
  v_mfma_f32_32x32x16_bf16 v[128:143], v[64:67], v[0:3], v[144:159]
  s_waitcnt vmcnt(14)
  v_mfma_f32_32x32x16_bf16 v[128:143], v[68:71], v[4:7], v[128:143]
  s_waitcnt vmcnt(13)
  v_mfma_f32_32x32x16_bf16 v[128:143], v[72:75], v[8:11], v[128:143]
  s_waitcnt vmcnt(12)
  v_mfma_f32_32x32x16_bf16 v[128:143], v[76:79], v[12:15], v[128:143]
  s_waitcnt vmcnt(11)
  v_mfma_f32_32x32x16_bf16 v[128:143], v[80:83], v[16:19], v[128:143]
  s_waitcnt vmcnt(10)
  v_mfma_f32_32x32x16_bf16 v[128:143], v[84:87], v[20:23], v[128:143]
  s_waitcnt vmcnt(9)
  v_mfma_f32_32x32x16_bf16 v[128:143], v[88:91], v[24:27], v[128:143]
  s_waitcnt vmcnt(8)
  v_mfma_f32_32x32x16_bf16 v[128:143], v[92:95], v[28:31], v[128:143]
  s_nop 11
  v_exp_f32 v128, v128
  v_exp_f32 v129, v129
  v_add_f32 v225, v225, v128
  v_add_f32 v225, v225, v129
  v_cvt_pk_bf16_f32 v160, v128, v129
  v_exp_f32 v130, v130
  v_exp_f32 v131, v131
  v_add_f32 v225, v225, v130
  v_add_f32 v225, v225, v131
  v_cvt_pk_bf16_f32 v161, v130, v131
  v_exp_f32 v132, v132
  v_exp_f32 v133, v133
  v_add_f32 v225, v225, v132
  v_add_f32 v225, v225, v133
  v_cvt_pk_bf16_f32 v162, v132, v133
  v_exp_f32 v134, v134
  v_exp_f32 v135, v135
  v_add_f32 v225, v225, v134
  v_add_f32 v225, v225, v135
  v_cvt_pk_bf16_f32 v163, v134, v135
  v_exp_f32 v136, v136
  v_exp_f32 v137, v137
  v_add_f32 v225, v225, v136
  v_add_f32 v225, v225, v137
  v_cvt_pk_bf16_f32 v164, v136, v137
  v_exp_f32 v138, v138
  v_exp_f32 v139, v139
  v_add_f32 v225, v225, v138
  v_add_f32 v225, v225, v139
  v_cvt_pk_bf16_f32 v165, v138, v139
  v_exp_f32 v140, v140
  v_exp_f32 v141, v141
  v_add_f32 v225, v225, v140
  v_add_f32 v225, v225, v141
  v_cvt_pk_bf16_f32 v166, v140, v141
  v_exp_f32 v142, v142
  v_exp_f32 v143, v143
  v_add_f32 v225, v225, v142
  v_add_f32 v225, v225, v143
  v_cvt_pk_bf16_f32 v167, v142, v143
  s_waitcnt vmcnt(7)
  v_mfma_f32_32x32x16_bf16 a[0:15], v[96:99], v[160:163], a[0:15]
  s_waitcnt vmcnt(5)
  v_mfma_f32_32x32x16_bf16 a[16:31], v[100:103], v[160:163], a[16:31]
  s_waitcnt vmcnt(3)
  v_mfma_f32_32x32x16_bf16 a[32:47], v[104:107], v[160:163], a[32:47]
  s_waitcnt vmcnt(1)
  v_mfma_f32_32x32x16_bf16 a[48:63], v[108:111], v[160:163], a[48:63]
  v_mfma_f32_32x32x16_bf16 a[0:15], v[112:115], v[164:167], a[0:15]
  v_mfma_f32_32x32x16_bf16 a[16:31], v[116:119], v[164:167], a[16:31]
  v_mfma_f32_32x32x16_bf16 a[32:47], v[120:123], v[164:167], a[32:47]
  s_waitcnt vmcnt(0)
  v_mfma_f32_32x32x16_bf16 a[48:63], v[124:127], v[164:167], a[48:63]
  s_add_u32 s51, s51, 1
  s_cmp_le_u32 s51, s50
  s_cbranch_scc1 K2_FBA2
  v_mov_b32 v230, v225
  s_nop 1
  v_permlane32_swap_b32 v230, v225
  v_add_f32 v225, v225, v230
  v_rcp_f32 v230, v225
  s_lshl_b32 s48, s38, 2
  s_add_u32 s48, s48, s36
  s_lshl_b32 s48, s48, 18
  s_lshl_b32 s49, s37, 13
  s_add_u32 s48, s48, s49
  v_lshl_add_u32 v231, v224, 4, s48
  v_mov_b32 v233, v230
  v_accvgpr_read_b32 v208, a0
  v_accvgpr_read_b32 v209, a1
  v_accvgpr_read_b32 v210, a2
  v_accvgpr_read_b32 v211, a3
  v_accvgpr_read_b32 v212, a4
  v_accvgpr_read_b32 v213, a5
  v_accvgpr_read_b32 v214, a6
  v_accvgpr_read_b32 v215, a7
  v_mul_f32 v208, v208, v230
  v_mul_f32 v209, v209, v230
  v_mul_f32 v210, v210, v230
  v_mul_f32 v211, v211, v230
  v_mul_f32 v212, v212, v230
  v_mul_f32 v213, v213, v230
  v_mul_f32 v214, v214, v230
  v_mul_f32 v215, v215, v230
  v_cvt_pk_bf16_f32 v240, v208, v209
  v_or_b32_sdwa v240, v208, 1 dst_sel:WORD_0 dst_unused:UNUSED_PRESERVE src0_sel:WORD_1 src1_sel:DWORD
  v_cvt_pk_bf16_f32 v241, v210, v211
  v_cvt_pk_bf16_f32 v242, v212, v213
  v_cvt_pk_bf16_f32 v243, v214, v215
  buffer_store_dwordx4 v[240:243], v231, s[28:31], 0 offen offset:0 sc1
  v_accvgpr_read_b32 v216, a8
  v_accvgpr_read_b32 v217, a9
  v_accvgpr_read_b32 v218, a10
  v_accvgpr_read_b32 v219, a11
  v_accvgpr_read_b32 v220, a12
  v_accvgpr_read_b32 v221, a13
  v_accvgpr_read_b32 v222, a14
  v_accvgpr_read_b32 v223, a15
  v_mul_f32 v216, v216, v230
  v_mul_f32 v217, v217, v230
  v_mul_f32 v218, v218, v230
  v_mul_f32 v219, v219, v230
  v_mul_f32 v220, v220, v230
  v_mul_f32 v221, v221, v230
  v_mul_f32 v222, v222, v230
  v_mul_f32 v223, v223, v230
  v_cvt_pk_bf16_f32 v244, v216, v217
  v_or_b32_sdwa v244, v216, 1 dst_sel:WORD_0 dst_unused:UNUSED_PRESERVE src0_sel:WORD_1 src1_sel:DWORD
  v_cvt_pk_bf16_f32 v245, v218, v219
  v_cvt_pk_bf16_f32 v246, v220, v221
  v_cvt_pk_bf16_f32 v247, v222, v223
  buffer_store_dwordx4 v[244:247], v231, s[28:31], 0 offen offset:1024 sc1
  v_accvgpr_read_b32 v208, a16
  v_accvgpr_read_b32 v209, a17
  v_accvgpr_read_b32 v210, a18
  v_accvgpr_read_b32 v211, a19
  v_accvgpr_read_b32 v212, a20
  v_accvgpr_read_b32 v213, a21
  v_accvgpr_read_b32 v214, a22
  v_accvgpr_read_b32 v215, a23
  v_mul_f32 v208, v208, v230
  v_mul_f32 v209, v209, v230
  v_mul_f32 v210, v210, v230
  v_mul_f32 v211, v211, v230
  v_mul_f32 v212, v212, v230
  v_mul_f32 v213, v213, v230
  v_mul_f32 v214, v214, v230
  v_mul_f32 v215, v215, v230
  v_cvt_pk_bf16_f32 v240, v208, v209
  v_or_b32_sdwa v240, v208, 1 dst_sel:WORD_0 dst_unused:UNUSED_PRESERVE src0_sel:WORD_1 src1_sel:DWORD
  v_cvt_pk_bf16_f32 v241, v210, v211
  v_cvt_pk_bf16_f32 v242, v212, v213
  v_cvt_pk_bf16_f32 v243, v214, v215
  buffer_store_dwordx4 v[240:243], v231, s[28:31], 0 offen offset:2048 sc1
  v_accvgpr_read_b32 v216, a24
  v_accvgpr_read_b32 v217, a25
  v_accvgpr_read_b32 v218, a26
  v_accvgpr_read_b32 v219, a27
  v_accvgpr_read_b32 v220, a28
  v_accvgpr_read_b32 v221, a29
  v_accvgpr_read_b32 v222, a30
  v_accvgpr_read_b32 v223, a31
  v_mul_f32 v216, v216, v230
  v_mul_f32 v217, v217, v230
  v_mul_f32 v218, v218, v230
  v_mul_f32 v219, v219, v230
  v_mul_f32 v220, v220, v230
  v_mul_f32 v221, v221, v230
  v_mul_f32 v222, v222, v230
  v_mul_f32 v223, v223, v230
  v_cvt_pk_bf16_f32 v244, v216, v217
  v_or_b32_sdwa v244, v216, 1 dst_sel:WORD_0 dst_unused:UNUSED_PRESERVE src0_sel:WORD_1 src1_sel:DWORD
  v_cvt_pk_bf16_f32 v245, v218, v219
  v_cvt_pk_bf16_f32 v246, v220, v221
  v_cvt_pk_bf16_f32 v247, v222, v223
  buffer_store_dwordx4 v[244:247], v231, s[28:31], 0 offen offset:3072 sc1
  v_accvgpr_read_b32 v208, a32
  v_accvgpr_read_b32 v209, a33
  v_accvgpr_read_b32 v210, a34
  v_accvgpr_read_b32 v211, a35
  v_accvgpr_read_b32 v212, a36
  v_accvgpr_read_b32 v213, a37
  v_accvgpr_read_b32 v214, a38
  v_accvgpr_read_b32 v215, a39
  v_mul_f32 v208, v208, v230
  v_mul_f32 v209, v209, v230
  v_mul_f32 v210, v210, v230
  v_mul_f32 v211, v211, v230
  v_mul_f32 v212, v212, v230
  v_mul_f32 v213, v213, v230
  v_mul_f32 v214, v214, v230
  v_mul_f32 v215, v215, v230
  v_cvt_pk_bf16_f32 v240, v208, v209
  v_or_b32_sdwa v240, v208, 1 dst_sel:WORD_0 dst_unused:UNUSED_PRESERVE src0_sel:WORD_1 src1_sel:DWORD
  v_cvt_pk_bf16_f32 v241, v210, v211
  v_cvt_pk_bf16_f32 v242, v212, v213
  v_cvt_pk_bf16_f32 v243, v214, v215
  buffer_store_dwordx4 v[240:243], v231, s[28:31], s42 offen offset:0 sc1
  v_accvgpr_read_b32 v216, a40
  v_accvgpr_read_b32 v217, a41
  v_accvgpr_read_b32 v218, a42
  v_accvgpr_read_b32 v219, a43
  v_accvgpr_read_b32 v220, a44
  v_accvgpr_read_b32 v221, a45
  v_accvgpr_read_b32 v222, a46
  v_accvgpr_read_b32 v223, a47
  v_mul_f32 v216, v216, v230
  v_mul_f32 v217, v217, v230
  v_mul_f32 v218, v218, v230
  v_mul_f32 v219, v219, v230
  v_mul_f32 v220, v220, v230
  v_mul_f32 v221, v221, v230
  v_mul_f32 v222, v222, v230
  v_mul_f32 v223, v223, v230
  v_cvt_pk_bf16_f32 v244, v216, v217
  v_or_b32_sdwa v244, v216, 1 dst_sel:WORD_0 dst_unused:UNUSED_PRESERVE src0_sel:WORD_1 src1_sel:DWORD
  v_cvt_pk_bf16_f32 v245, v218, v219
  v_cvt_pk_bf16_f32 v246, v220, v221
  v_cvt_pk_bf16_f32 v247, v222, v223
  buffer_store_dwordx4 v[244:247], v231, s[28:31], s42 offen offset:1024 sc1
  v_accvgpr_read_b32 v208, a48
  v_accvgpr_read_b32 v209, a49
  v_accvgpr_read_b32 v210, a50
  v_accvgpr_read_b32 v211, a51
  v_accvgpr_read_b32 v212, a52
  v_accvgpr_read_b32 v213, a53
  v_accvgpr_read_b32 v214, a54
  v_accvgpr_read_b32 v215, a55
  v_mul_f32 v208, v208, v230
  v_mul_f32 v209, v209, v230
  v_mul_f32 v210, v210, v230
  v_mul_f32 v211, v211, v230
  v_mul_f32 v212, v212, v230
  v_mul_f32 v213, v213, v230
  v_mul_f32 v214, v214, v230
  v_mul_f32 v215, v215, v230
  v_cvt_pk_bf16_f32 v240, v208, v209
  v_or_b32_sdwa v240, v208, 1 dst_sel:WORD_0 dst_unused:UNUSED_PRESERVE src0_sel:WORD_1 src1_sel:DWORD
  v_cvt_pk_bf16_f32 v241, v210, v211
  v_cvt_pk_bf16_f32 v242, v212, v213
  v_cvt_pk_bf16_f32 v243, v214, v215
  buffer_store_dwordx4 v[240:243], v231, s[28:31], s42 offen offset:2048 sc1
  v_accvgpr_read_b32 v216, a56
  v_accvgpr_read_b32 v217, a57
  v_accvgpr_read_b32 v218, a58
  v_accvgpr_read_b32 v219, a59
  v_accvgpr_read_b32 v220, a60
  v_accvgpr_read_b32 v221, a61
  v_accvgpr_read_b32 v222, a62
  v_accvgpr_read_b32 v223, a63
  v_mul_f32 v216, v216, v230
  v_mul_f32 v217, v217, v230
  v_mul_f32 v218, v218, v230
  v_mul_f32 v219, v219, v230
  v_mul_f32 v220, v220, v230
  v_mul_f32 v221, v221, v230
  v_mul_f32 v222, v222, v230
  v_mul_f32 v223, v223, v230
  v_cvt_pk_bf16_f32 v244, v216, v217
  v_or_b32_sdwa v244, v216, 1 dst_sel:WORD_0 dst_unused:UNUSED_PRESERVE src0_sel:WORD_1 src1_sel:DWORD
  v_cvt_pk_bf16_f32 v245, v218, v219
  v_cvt_pk_bf16_f32 v246, v220, v221
  v_cvt_pk_bf16_f32 v247, v222, v223
  buffer_store_dwordx4 v[244:247], v231, s[28:31], s42 offen offset:3072 sc1
  s_branch K2_BACKA
K2_FBB:
  s_waitcnt vmcnt(0) lgkmcnt(0)
  s_lshl_b32 s50, s38, 2
  s_sub_u32 s50, 60, s50
  s_add_u32 s50, s50, s36
  v_mov_b32 v168, -1e+30
  s_mov_b32 s51, 0
K2_FBB1:
  s_lshr_b32 s53, s51, 1
  s_lshl_b32 s53, s53, 15
  s_and_b32 s52, s51, 1
  s_lshl_b32 s48, s52, 13
  s_add_u32 s48, s48, s53
  v_lshlrev_b32 v175, 4, v224
  v_add_u32 v170, s48, v175
  s_lshl_b32 s48, s52, 11
  s_add_u32 s48, s48, s53
  s_add_u32 s48, s48, 16384
  v_add_u32 v171, s48, v175
  v_add_u32 v172, 4096, v171
  v_add_u32 v173, 8192, v171
  v_add_u32 v174, 12288, v171
  v_add_u32 v175, 4096, v170
  s_cmp_eq_u32 s51, s50
  s_cselect_b32 s52, 1.0, 0
  buffer_load_dwordx4 v[64:67], v170, s[24:27], 0 offen offset:0
  buffer_load_dwordx4 v[68:71], v170, s[24:27], 0 offen offset:1024
  buffer_load_dwordx4 v[72:75], v170, s[24:27], 0 offen offset:2048
  buffer_load_dwordx4 v[76:79], v170, s[24:27], 0 offen offset:3072
  buffer_load_dwordx4 v[80:83], v175, s[24:27], 0 offen offset:0
  buffer_load_dwordx4 v[84:87], v175, s[24:27], 0 offen offset:1024
  buffer_load_dwordx4 v[88:91], v175, s[24:27], 0 offen offset:2048
  buffer_load_dwordx4 v[92:95], v175, s[24:27], 0 offen offset:3072
  v_mul_f32 v144, s52, v192
  v_mul_f32 v145, s52, v193
  v_mul_f32 v146, s52, v194
  v_mul_f32 v147, s52, v195
  v_mul_f32 v148, s52, v196
  v_mul_f32 v149, s52, v197
  v_mul_f32 v150, s52, v198
  v_mul_f32 v151, s52, v199
  v_mul_f32 v152, s52, v200
  v_mul_f32 v153, s52, v201
  v_mul_f32 v154, s52, v202
  v_mul_f32 v155, s52, v203
  v_mul_f32 v156, s52, v204
  v_mul_f32 v157, s52, v205
  v_mul_f32 v158, s52, v206
  v_mul_f32 v159, s52, v207
  s_waitcnt vmcnt(7)
  s_nop 0
  v_mfma_f32_32x32x16_bf16 v[128:143], v[64:67], v[32:35], v[144:159]
  s_waitcnt vmcnt(6)
  v_mfma_f32_32x32x16_bf16 v[128:143], v[68:71], v[36:39], v[128:143]
  s_waitcnt vmcnt(5)
  v_mfma_f32_32x32x16_bf16 v[128:143], v[72:75], v[40:43], v[128:143]
  s_waitcnt vmcnt(4)
  v_mfma_f32_32x32x16_bf16 v[128:143], v[76:79], v[44:47], v[128:143]
  s_waitcnt vmcnt(3)
  v_mfma_f32_32x32x16_bf16 v[128:143], v[80:83], v[48:51], v[128:143]
  s_waitcnt vmcnt(2)
  v_mfma_f32_32x32x16_bf16 v[128:143], v[84:87], v[52:55], v[128:143]
  s_waitcnt vmcnt(1)
  v_mfma_f32_32x32x16_bf16 v[128:143], v[88:91], v[56:59], v[128:143]
  s_waitcnt vmcnt(0)
  v_mfma_f32_32x32x16_bf16 v[128:143], v[92:95], v[60:63], v[128:143]
  s_nop 11
  v_max3_f32 v168, v168, v128, v129
  v_max3_f32 v168, v168, v130, v131
  v_max3_f32 v168, v168, v132, v133
  v_max3_f32 v168, v168, v134, v135
  v_max3_f32 v168, v168, v136, v137
  v_max3_f32 v168, v168, v138, v139
  v_max3_f32 v168, v168, v140, v141
  v_max3_f32 v168, v168, v142, v143
  s_add_u32 s51, s51, 1
  s_cmp_le_u32 s51, s50
  s_cbranch_scc1 K2_FBB1
  v_mov_b32 v170, v168
  s_nop 1
  v_permlane32_swap_b32 v170, v168
  v_max_f32 v168, v168, v170
  v_mov_b32 v226, 0
  v_accvgpr_write_b32 a64, 0
  v_accvgpr_write_b32 a65, 0
  v_accvgpr_write_b32 a66, 0
  v_accvgpr_write_b32 a67, 0
  v_accvgpr_write_b32 a68, 0
  v_accvgpr_write_b32 a69, 0
  v_accvgpr_write_b32 a70, 0
  v_accvgpr_write_b32 a71, 0
  v_accvgpr_write_b32 a72, 0
  v_accvgpr_write_b32 a73, 0
  v_accvgpr_write_b32 a74, 0
  v_accvgpr_write_b32 a75, 0
  v_accvgpr_write_b32 a76, 0
  v_accvgpr_write_b32 a77, 0
  v_accvgpr_write_b32 a78, 0
  v_accvgpr_write_b32 a79, 0
  v_accvgpr_write_b32 a80, 0
  v_accvgpr_write_b32 a81, 0
  v_accvgpr_write_b32 a82, 0
  v_accvgpr_write_b32 a83, 0
  v_accvgpr_write_b32 a84, 0
  v_accvgpr_write_b32 a85, 0
  v_accvgpr_write_b32 a86, 0
  v_accvgpr_write_b32 a87, 0
  v_accvgpr_write_b32 a88, 0
  v_accvgpr_write_b32 a89, 0
  v_accvgpr_write_b32 a90, 0
  v_accvgpr_write_b32 a91, 0
  v_accvgpr_write_b32 a92, 0
  v_accvgpr_write_b32 a93, 0
  v_accvgpr_write_b32 a94, 0
  v_accvgpr_write_b32 a95, 0
  v_accvgpr_write_b32 a96, 0
  v_accvgpr_write_b32 a97, 0
  v_accvgpr_write_b32 a98, 0
  v_accvgpr_write_b32 a99, 0
  v_accvgpr_write_b32 a100, 0
  v_accvgpr_write_b32 a101, 0
  v_accvgpr_write_b32 a102, 0
  v_accvgpr_write_b32 a103, 0
  v_accvgpr_write_b32 a104, 0
  v_accvgpr_write_b32 a105, 0
  v_accvgpr_write_b32 a106, 0
  v_accvgpr_write_b32 a107, 0
  v_accvgpr_write_b32 a108, 0
  v_accvgpr_write_b32 a109, 0
  v_accvgpr_write_b32 a110, 0
  v_accvgpr_write_b32 a111, 0
  v_accvgpr_write_b32 a112, 0
  v_accvgpr_write_b32 a113, 0
  v_accvgpr_write_b32 a114, 0
  v_accvgpr_write_b32 a115, 0
  v_accvgpr_write_b32 a116, 0
  v_accvgpr_write_b32 a117, 0
  v_accvgpr_write_b32 a118, 0
  v_accvgpr_write_b32 a119, 0
  v_accvgpr_write_b32 a120, 0
  v_accvgpr_write_b32 a121, 0
  v_accvgpr_write_b32 a122, 0
  v_accvgpr_write_b32 a123, 0
  v_accvgpr_write_b32 a124, 0
  v_accvgpr_write_b32 a125, 0
  v_accvgpr_write_b32 a126, 0
  v_accvgpr_write_b32 a127, 0
  s_mov_b32 s51, 0
K2_FBB2:
  s_lshr_b32 s53, s51, 1
  s_lshl_b32 s53, s53, 15
  s_and_b32 s52, s51, 1
  s_lshl_b32 s48, s52, 13
  s_add_u32 s48, s48, s53
  v_lshlrev_b32 v175, 4, v224
  v_add_u32 v170, s48, v175
  s_lshl_b32 s48, s52, 11
  s_add_u32 s48, s48, s53
  s_add_u32 s48, s48, 16384
  v_add_u32 v171, s48, v175
  v_add_u32 v172, 4096, v171
  v_add_u32 v173, 8192, v171
  v_add_u32 v174, 12288, v171
  v_add_u32 v175, 4096, v170
  s_cmp_eq_u32 s51, s50
  s_cselect_b32 s52, 1.0, 0
  buffer_load_dwordx4 v[64:67], v170, s[24:27], 0 offen offset:0
  buffer_load_dwordx4 v[68:71], v170, s[24:27], 0 offen offset:1024
  buffer_load_dwordx4 v[72:75], v170, s[24:27], 0 offen offset:2048
  buffer_load_dwordx4 v[76:79], v170, s[24:27], 0 offen offset:3072
  buffer_load_dwordx4 v[80:83], v175, s[24:27], 0 offen offset:0
  buffer_load_dwordx4 v[84:87], v175, s[24:27], 0 offen offset:1024
  buffer_load_dwordx4 v[88:91], v175, s[24:27], 0 offen offset:2048
  buffer_load_dwordx4 v[92:95], v175, s[24:27], 0 offen offset:3072
  buffer_load_dwordx4 v[96:99], v171, s[24:27], 0 offen offset:0
  buffer_load_dwordx4 v[112:115], v171, s[24:27], 0 offen offset:1024
  buffer_load_dwordx4 v[100:103], v172, s[24:27], 0 offen offset:0
  buffer_load_dwordx4 v[116:119], v172, s[24:27], 0 offen offset:1024
  buffer_load_dwordx4 v[104:107], v173, s[24:27], 0 offen offset:0
  buffer_load_dwordx4 v[120:123], v173, s[24:27], 0 offen offset:1024
  buffer_load_dwordx4 v[108:111], v174, s[24:27], 0 offen offset:0
  buffer_load_dwordx4 v[124:127], v174, s[24:27], 0 offen offset:1024
  v_fma_f32 v144, v192, s52, -v168
  v_fma_f32 v145, v193, s52, -v168
  v_fma_f32 v146, v194, s52, -v168
  v_fma_f32 v147, v195, s52, -v168
  v_fma_f32 v148, v196, s52, -v168
  v_fma_f32 v149, v197, s52, -v168
  v_fma_f32 v150, v198, s52, -v168
  v_fma_f32 v151, v199, s52, -v168
  v_fma_f32 v152, v200, s52, -v168
  v_fma_f32 v153, v201, s52, -v168
  v_fma_f32 v154, v202, s52, -v168
  v_fma_f32 v155, v203, s52, -v168
  v_fma_f32 v156, v204, s52, -v168
  v_fma_f32 v157, v205, s52, -v168
  v_fma_f32 v158, v206, s52, -v168
  v_fma_f32 v159, v207, s52, -v168
  s_waitcnt vmcnt(15)
  s_nop 0
  v_mfma_f32_32x32x16_bf16 v[128:143], v[64:67], v[32:35], v[144:159]
  s_waitcnt vmcnt(14)
  v_mfma_f32_32x32x16_bf16 v[128:143], v[68:71], v[36:39], v[128:143]
  s_waitcnt vmcnt(13)
  v_mfma_f32_32x32x16_bf16 v[128:143], v[72:75], v[40:43], v[128:143]
  s_waitcnt vmcnt(12)
  v_mfma_f32_32x32x16_bf16 v[128:143], v[76:79], v[44:47], v[128:143]
  s_waitcnt vmcnt(11)
  v_mfma_f32_32x32x16_bf16 v[128:143], v[80:83], v[48:51], v[128:143]
  s_waitcnt vmcnt(10)
  v_mfma_f32_32x32x16_bf16 v[128:143], v[84:87], v[52:55], v[128:143]
  s_waitcnt vmcnt(9)
  v_mfma_f32_32x32x16_bf16 v[128:143], v[88:91], v[56:59], v[128:143]
  s_waitcnt vmcnt(8)
  v_mfma_f32_32x32x16_bf16 v[128:143], v[92:95], v[60:63], v[128:143]
  s_nop 11
  v_exp_f32 v128, v128
  v_exp_f32 v129, v129
  v_add_f32 v226, v226, v128
  v_add_f32 v226, v226, v129
  v_cvt_pk_bf16_f32 v160, v128, v129
  v_exp_f32 v130, v130
  v_exp_f32 v131, v131
  v_add_f32 v226, v226, v130
  v_add_f32 v226, v226, v131
  v_cvt_pk_bf16_f32 v161, v130, v131
  v_exp_f32 v132, v132
  v_exp_f32 v133, v133
  v_add_f32 v226, v226, v132
  v_add_f32 v226, v226, v133
  v_cvt_pk_bf16_f32 v162, v132, v133
  v_exp_f32 v134, v134
  v_exp_f32 v135, v135
  v_add_f32 v226, v226, v134
  v_add_f32 v226, v226, v135
  v_cvt_pk_bf16_f32 v163, v134, v135
  v_exp_f32 v136, v136
  v_exp_f32 v137, v137
  v_add_f32 v226, v226, v136
  v_add_f32 v226, v226, v137
  v_cvt_pk_bf16_f32 v164, v136, v137
  v_exp_f32 v138, v138
  v_exp_f32 v139, v139
  v_add_f32 v226, v226, v138
  v_add_f32 v226, v226, v139
  v_cvt_pk_bf16_f32 v165, v138, v139
  v_exp_f32 v140, v140
  v_exp_f32 v141, v141
  v_add_f32 v226, v226, v140
  v_add_f32 v226, v226, v141
  v_cvt_pk_bf16_f32 v166, v140, v141
  v_exp_f32 v142, v142
  v_exp_f32 v143, v143
  v_add_f32 v226, v226, v142
  v_add_f32 v226, v226, v143
  v_cvt_pk_bf16_f32 v167, v142, v143
  s_waitcnt vmcnt(7)
  v_mfma_f32_32x32x16_bf16 a[64:79], v[96:99], v[160:163], a[64:79]
  s_waitcnt vmcnt(5)
  v_mfma_f32_32x32x16_bf16 a[80:95], v[100:103], v[160:163], a[80:95]
  s_waitcnt vmcnt(3)
  v_mfma_f32_32x32x16_bf16 a[96:111], v[104:107], v[160:163], a[96:111]
  s_waitcnt vmcnt(1)
  v_mfma_f32_32x32x16_bf16 a[112:127], v[108:111], v[160:163], a[112:127]
  v_mfma_f32_32x32x16_bf16 a[64:79], v[112:115], v[164:167], a[64:79]
  v_mfma_f32_32x32x16_bf16 a[80:95], v[116:119], v[164:167], a[80:95]
  v_mfma_f32_32x32x16_bf16 a[96:111], v[120:123], v[164:167], a[96:111]
  s_waitcnt vmcnt(0)
  v_mfma_f32_32x32x16_bf16 a[112:127], v[124:127], v[164:167], a[112:127]
  s_add_u32 s51, s51, 1
  s_cmp_le_u32 s51, s50
  s_cbranch_scc1 K2_FBB2
  v_mov_b32 v230, v226
  s_nop 1
  v_permlane32_swap_b32 v230, v226
  v_add_f32 v226, v226, v230
  v_rcp_f32 v230, v226
  s_lshl_b32 s48, s38, 2
  s_sub_u32 s48, 60, s48
  s_add_u32 s48, s48, s36
  s_lshl_b32 s48, s48, 18
  s_lshl_b32 s49, s37, 13
  s_add_u32 s48, s48, s49
  v_lshl_add_u32 v231, v224, 4, s48
  v_mov_b32 v233, v230
  v_accvgpr_read_b32 v208, a64
  v_accvgpr_read_b32 v209, a65
  v_accvgpr_read_b32 v210, a66
  v_accvgpr_read_b32 v211, a67
  v_accvgpr_read_b32 v212, a68
  v_accvgpr_read_b32 v213, a69
  v_accvgpr_read_b32 v214, a70
  v_accvgpr_read_b32 v215, a71
  v_mul_f32 v208, v208, v230
  v_mul_f32 v209, v209, v230
  v_mul_f32 v210, v210, v230
  v_mul_f32 v211, v211, v230
  v_mul_f32 v212, v212, v230
  v_mul_f32 v213, v213, v230
  v_mul_f32 v214, v214, v230
  v_mul_f32 v215, v215, v230
  v_cvt_pk_bf16_f32 v240, v208, v209
  v_or_b32_sdwa v240, v208, 1 dst_sel:WORD_0 dst_unused:UNUSED_PRESERVE src0_sel:WORD_1 src1_sel:DWORD
  v_cvt_pk_bf16_f32 v241, v210, v211
  v_cvt_pk_bf16_f32 v242, v212, v213
  v_cvt_pk_bf16_f32 v243, v214, v215
  buffer_store_dwordx4 v[240:243], v231, s[28:31], 0 offen offset:0 sc1
  v_accvgpr_read_b32 v216, a72
  v_accvgpr_read_b32 v217, a73
  v_accvgpr_read_b32 v218, a74
  v_accvgpr_read_b32 v219, a75
  v_accvgpr_read_b32 v220, a76
  v_accvgpr_read_b32 v221, a77
  v_accvgpr_read_b32 v222, a78
  v_accvgpr_read_b32 v223, a79
  v_mul_f32 v216, v216, v230
  v_mul_f32 v217, v217, v230
  v_mul_f32 v218, v218, v230
  v_mul_f32 v219, v219, v230
  v_mul_f32 v220, v220, v230
  v_mul_f32 v221, v221, v230
  v_mul_f32 v222, v222, v230
  v_mul_f32 v223, v223, v230
  v_cvt_pk_bf16_f32 v244, v216, v217
  v_or_b32_sdwa v244, v216, 1 dst_sel:WORD_0 dst_unused:UNUSED_PRESERVE src0_sel:WORD_1 src1_sel:DWORD
  v_cvt_pk_bf16_f32 v245, v218, v219
  v_cvt_pk_bf16_f32 v246, v220, v221
  v_cvt_pk_bf16_f32 v247, v222, v223
  buffer_store_dwordx4 v[244:247], v231, s[28:31], 0 offen offset:1024 sc1
  v_accvgpr_read_b32 v208, a80
  v_accvgpr_read_b32 v209, a81
  v_accvgpr_read_b32 v210, a82
  v_accvgpr_read_b32 v211, a83
  v_accvgpr_read_b32 v212, a84
  v_accvgpr_read_b32 v213, a85
  v_accvgpr_read_b32 v214, a86
  v_accvgpr_read_b32 v215, a87
  v_mul_f32 v208, v208, v230
  v_mul_f32 v209, v209, v230
  v_mul_f32 v210, v210, v230
  v_mul_f32 v211, v211, v230
  v_mul_f32 v212, v212, v230
  v_mul_f32 v213, v213, v230
  v_mul_f32 v214, v214, v230
  v_mul_f32 v215, v215, v230
  v_cvt_pk_bf16_f32 v240, v208, v209
  v_or_b32_sdwa v240, v208, 1 dst_sel:WORD_0 dst_unused:UNUSED_PRESERVE src0_sel:WORD_1 src1_sel:DWORD
  v_cvt_pk_bf16_f32 v241, v210, v211
  v_cvt_pk_bf16_f32 v242, v212, v213
  v_cvt_pk_bf16_f32 v243, v214, v215
  buffer_store_dwordx4 v[240:243], v231, s[28:31], 0 offen offset:2048 sc1
  v_accvgpr_read_b32 v216, a88
  v_accvgpr_read_b32 v217, a89
  v_accvgpr_read_b32 v218, a90
  v_accvgpr_read_b32 v219, a91
  v_accvgpr_read_b32 v220, a92
  v_accvgpr_read_b32 v221, a93
  v_accvgpr_read_b32 v222, a94
  v_accvgpr_read_b32 v223, a95
  v_mul_f32 v216, v216, v230
  v_mul_f32 v217, v217, v230
  v_mul_f32 v218, v218, v230
  v_mul_f32 v219, v219, v230
  v_mul_f32 v220, v220, v230
  v_mul_f32 v221, v221, v230
  v_mul_f32 v222, v222, v230
  v_mul_f32 v223, v223, v230
  v_cvt_pk_bf16_f32 v244, v216, v217
  v_or_b32_sdwa v244, v216, 1 dst_sel:WORD_0 dst_unused:UNUSED_PRESERVE src0_sel:WORD_1 src1_sel:DWORD
  v_cvt_pk_bf16_f32 v245, v218, v219
  v_cvt_pk_bf16_f32 v246, v220, v221
  v_cvt_pk_bf16_f32 v247, v222, v223
  buffer_store_dwordx4 v[244:247], v231, s[28:31], 0 offen offset:3072 sc1
  v_accvgpr_read_b32 v208, a96
  v_accvgpr_read_b32 v209, a97
  v_accvgpr_read_b32 v210, a98
  v_accvgpr_read_b32 v211, a99
  v_accvgpr_read_b32 v212, a100
  v_accvgpr_read_b32 v213, a101
  v_accvgpr_read_b32 v214, a102
  v_accvgpr_read_b32 v215, a103
  v_mul_f32 v208, v208, v230
  v_mul_f32 v209, v209, v230
  v_mul_f32 v210, v210, v230
  v_mul_f32 v211, v211, v230
  v_mul_f32 v212, v212, v230
  v_mul_f32 v213, v213, v230
  v_mul_f32 v214, v214, v230
  v_mul_f32 v215, v215, v230
  v_cvt_pk_bf16_f32 v240, v208, v209
  v_or_b32_sdwa v240, v208, 1 dst_sel:WORD_0 dst_unused:UNUSED_PRESERVE src0_sel:WORD_1 src1_sel:DWORD
  v_cvt_pk_bf16_f32 v241, v210, v211
  v_cvt_pk_bf16_f32 v242, v212, v213
  v_cvt_pk_bf16_f32 v243, v214, v215
  buffer_store_dwordx4 v[240:243], v231, s[28:31], s42 offen offset:0 sc1
  v_accvgpr_read_b32 v216, a104
  v_accvgpr_read_b32 v217, a105
  v_accvgpr_read_b32 v218, a106
  v_accvgpr_read_b32 v219, a107
  v_accvgpr_read_b32 v220, a108
  v_accvgpr_read_b32 v221, a109
  v_accvgpr_read_b32 v222, a110
  v_accvgpr_read_b32 v223, a111
  v_mul_f32 v216, v216, v230
  v_mul_f32 v217, v217, v230
  v_mul_f32 v218, v218, v230
  v_mul_f32 v219, v219, v230
  v_mul_f32 v220, v220, v230
  v_mul_f32 v221, v221, v230
  v_mul_f32 v222, v222, v230
  v_mul_f32 v223, v223, v230
  v_cvt_pk_bf16_f32 v244, v216, v217
  v_or_b32_sdwa v244, v216, 1 dst_sel:WORD_0 dst_unused:UNUSED_PRESERVE src0_sel:WORD_1 src1_sel:DWORD
  v_cvt_pk_bf16_f32 v245, v218, v219
  v_cvt_pk_bf16_f32 v246, v220, v221
  v_cvt_pk_bf16_f32 v247, v222, v223
  buffer_store_dwordx4 v[244:247], v231, s[28:31], s42 offen offset:1024 sc1
  v_accvgpr_read_b32 v208, a112
  v_accvgpr_read_b32 v209, a113
  v_accvgpr_read_b32 v210, a114
  v_accvgpr_read_b32 v211, a115
  v_accvgpr_read_b32 v212, a116
  v_accvgpr_read_b32 v213, a117
  v_accvgpr_read_b32 v214, a118
  v_accvgpr_read_b32 v215, a119
  v_mul_f32 v208, v208, v230
  v_mul_f32 v209, v209, v230
  v_mul_f32 v210, v210, v230
  v_mul_f32 v211, v211, v230
  v_mul_f32 v212, v212, v230
  v_mul_f32 v213, v213, v230
  v_mul_f32 v214, v214, v230
  v_mul_f32 v215, v215, v230
  v_cvt_pk_bf16_f32 v240, v208, v209
  v_or_b32_sdwa v240, v208, 1 dst_sel:WORD_0 dst_unused:UNUSED_PRESERVE src0_sel:WORD_1 src1_sel:DWORD
  v_cvt_pk_bf16_f32 v241, v210, v211
  v_cvt_pk_bf16_f32 v242, v212, v213
  v_cvt_pk_bf16_f32 v243, v214, v215
  buffer_store_dwordx4 v[240:243], v231, s[28:31], s42 offen offset:2048 sc1
  v_accvgpr_read_b32 v216, a120
  v_accvgpr_read_b32 v217, a121
  v_accvgpr_read_b32 v218, a122
  v_accvgpr_read_b32 v219, a123
  v_accvgpr_read_b32 v220, a124
  v_accvgpr_read_b32 v221, a125
  v_accvgpr_read_b32 v222, a126
  v_accvgpr_read_b32 v223, a127
  v_mul_f32 v216, v216, v230
  v_mul_f32 v217, v217, v230
  v_mul_f32 v218, v218, v230
  v_mul_f32 v219, v219, v230
  v_mul_f32 v220, v220, v230
  v_mul_f32 v221, v221, v230
  v_mul_f32 v222, v222, v230
  v_mul_f32 v223, v223, v230
  v_cvt_pk_bf16_f32 v244, v216, v217
  v_or_b32_sdwa v244, v216, 1 dst_sel:WORD_0 dst_unused:UNUSED_PRESERVE src0_sel:WORD_1 src1_sel:DWORD
  v_cvt_pk_bf16_f32 v245, v218, v219
  v_cvt_pk_bf16_f32 v246, v220, v221
  v_cvt_pk_bf16_f32 v247, v222, v223
  buffer_store_dwordx4 v[244:247], v231, s[28:31], s42 offen offset:3072 sc1
  s_branch K2_BACKB
K12_XS:
  s_mov_b32 s57, 0
K12_XL:
  buffer_load_dword v67, v66, s[8:11], 0 offen sc1
  s_add_u32 s57, s57, 1
  s_waitcnt vmcnt(0)
  v_and_b32 v67, 0x01010101, v67
  v_cmp_ne_u32 vcc, 0x01010101, v67
  s_cmp_ge_u32 s57, 65536
  s_cbranch_scc1 K12_XB
  s_nop 2
  s_cbranch_vccnz K12_XL
  s_branch K12_XB
K12_KS:
  s_mov_b32 s57, 0
K12_KL:
  buffer_load_ubyte v239, v238, s[8:11], 0 offen sc1
  s_add_u32 s57, s57, 1
  s_waitcnt vmcnt(0)
  v_and_b32 v239, 2, v239
  v_cmp_eq_u32 vcc, 0, v239
  s_cmp_ge_u32 s57, 65536
  s_cbranch_scc1 K12_KB
  s_nop 2
  s_cbranch_vccnz K12_KL
  s_branch K12_KB
.section .rodata,"a"
.p2align 6
.amdhsa_kernel kvattn_kernel
  .amdhsa_next_free_vgpr 512
  .amdhsa_next_free_sgpr 102
  .amdhsa_accum_offset 256
  .amdhsa_group_segment_fixed_size 0
  .amdhsa_kernarg_size 104
  .amdhsa_user_sgpr_count 2
  .amdhsa_user_sgpr_kernarg_segment_ptr 1
  .amdhsa_system_sgpr_workgroup_id_x 1
.end_amdhsa_kernel
.text
.globl oproj_kernel
.p2align 8
.type oproj_kernel,@function
oproj_kernel:
  s_cmp_ge_u32 s2, 256
  s_cbranch_scc1 K3_END
  s_load_dwordx2 s[8:9], s[0:1], 40
  s_load_dwordx2 s[10:11], s[0:1], 0
  s_load_dwordx2 s[12:13], s[0:1], 96
  v_and_b32 v200, 63, v0
  v_lshrrev_b32 v219, 6, v0
  s_nop 0
  v_readfirstlane_b32 s48, v219
  s_and_b32 s50, s2, 7
  s_lshr_b32 s49, s2, 3
  s_mul_i32 s51, s48, 24576
  s_add_u32 s51, s51, 65536
  v_lshlrev_b32 v212, 4, v200
  v_add_u32 v213, 65536, v212
  v_add_u32 v222, 261120, v212
  s_lshl_b32 s79, s48, 11
  s_mul_i32 s92, s49, 524288
  s_lshl_b32 s93, s48, 10
  s_add_u32 s92, s92, s93
  s_lshl_b32 s93, s50, 15
  s_add_u32 s89, s92, s93
  s_waitcnt lgkmcnt(0)
  s_add_u32 s28, s12, 37748736
  s_addc_u32 s29, s13, 0
  s_mov_b32 s30, 16777216
  s_mov_b32 s31, 0x00020000
  s_add_u32 m0, s79, 0
  s_add_u32 s53, s89, 0
  buffer_load_dwordx4 v212, s[28:31], s53 offen lds
  buffer_load_dwordx4 v222, s[28:31], s53 offen offset:1024 lds
  s_mov_b32 s24, s8
  s_mov_b32 s25, s9
  s_mov_b32 s26, 4718592
  s_mov_b32 s27, 0x00020000
  v_lshrrev_b32 v219, 3, v200
  v_bfe_u32 v220, v200, 4, 1
  v_and_b32 v221, 7, v200
  v_lshlrev_b32 v223, 2, v220
  v_xor_b32 v223, v223, v221
  v_lshlrev_b32 v223, 4, v223
  v_mul_u32_u24 v217, 1152, v219
  v_add_u32 v217, v217, v223
  v_add_u32 v218, 8192, v217
  s_mul_i32 s92, s50, 589824
  s_lshl_b32 s93, s48, 8
  s_add_u32 s3, s92, s93
  s_mul_i32 s93, s48, 147456
  s_add_u32 s100, s92, s93
  s_add_u32 s100, s100, 1024
  s_add_u32 m0, s51, 0
  s_add_u32 s52, s3, 0
  buffer_load_dwordx4 v217, s[24:27], s52 offen offset:0 lds
  buffer_load_dwordx4 v218, s[24:27], s52 offen offset:1024 lds
  s_add_u32 m0, s51, 2048
  s_add_u32 s52, s3, 18432
  buffer_load_dwordx4 v217, s[24:27], s52 offen offset:0 lds
  buffer_load_dwordx4 v218, s[24:27], s52 offen offset:1024 lds
  s_add_u32 m0, s51, 4096
  s_add_u32 s52, s3, 36864
  buffer_load_dwordx4 v217, s[24:27], s52 offen offset:0 lds
  buffer_load_dwordx4 v218, s[24:27], s52 offen offset:1024 lds
  s_add_u32 m0, s51, 6144
  s_add_u32 s52, s3, 55296
  buffer_load_dwordx4 v217, s[24:27], s52 offen offset:0 lds
  buffer_load_dwordx4 v218, s[24:27], s52 offen offset:1024 lds
  s_add_u32 m0, s79, 8192
  s_add_u32 s53, s89, 4096
  buffer_load_dwordx4 v212, s[28:31], s53 offen lds
  buffer_load_dwordx4 v222, s[28:31], s53 offen offset:1024 lds
  s_add_u32 m0, s51, 8192
  s_add_u32 s52, s3, 73728
  buffer_load_dwordx4 v217, s[24:27], s52 offen offset:0 lds
  buffer_load_dwordx4 v218, s[24:27], s52 offen offset:1024 lds
  s_add_u32 m0, s51, 10240
  s_add_u32 s52, s3, 92160
  buffer_load_dwordx4 v217, s[24:27], s52 offen offset:0 lds
  buffer_load_dwordx4 v218, s[24:27], s52 offen offset:1024 lds
  s_add_u32 m0, s51, 12288
  s_add_u32 s52, s3, 110592
  buffer_load_dwordx4 v217, s[24:27], s52 offen offset:0 lds
  buffer_load_dwordx4 v218, s[24:27], s52 offen offset:1024 lds
  s_add_u32 m0, s51, 14336
  s_add_u32 s52, s3, 129024
  buffer_load_dwordx4 v217, s[24:27], s52 offen offset:0 lds
  buffer_load_dwordx4 v218, s[24:27], s52 offen offset:1024 lds
  s_add_u32 m0, s79, 16384
  s_add_u32 s53, s89, 8192
  buffer_load_dwordx4 v212, s[28:31], s53 offen lds
  buffer_load_dwordx4 v222, s[28:31], s53 offen offset:1024 lds
  s_add_u32 m0, s51, 16384
  s_add_u32 s52, s3, 147456
  buffer_load_dwordx4 v217, s[24:27], s52 offen offset:0 lds
  buffer_load_dwordx4 v218, s[24:27], s52 offen offset:1024 lds
  s_add_u32 m0, s51, 18432
  s_add_u32 s52, s3, 165888
  buffer_load_dwordx4 v217, s[24:27], s52 offen offset:0 lds
  buffer_load_dwordx4 v218, s[24:27], s52 offen offset:1024 lds
  s_add_u32 m0, s51, 20480
  s_add_u32 s52, s3, 184320
  buffer_load_dwordx4 v217, s[24:27], s52 offen offset:0 lds
  buffer_load_dwordx4 v218, s[24:27], s52 offen offset:1024 lds
  s_add_u32 m0, s51, 22528
  s_add_u32 s52, s3, 202752
  buffer_load_dwordx4 v217, s[24:27], s52 offen offset:0 lds
  buffer_load_dwordx4 v218, s[24:27], s52 offen offset:1024 lds
  s_add_u32 m0, s79, 24576
  s_add_u32 s53, s89, 12288
  buffer_load_dwordx4 v212, s[28:31], s53 offen lds
  buffer_load_dwordx4 v222, s[28:31], s53 offen offset:1024 lds
  v_lshrrev_b32 v219, 5, v200
  v_bfe_u32 v220, v200, 2, 2
  v_lshl_add_u32 v219, v219, 2, v220
  v_bfe_u32 v221, v200, 4, 1
  v_and_b32 v223, 3, v200
  v_lshlrev_b32 v223, 3, v223
  v_add_u32 v223, s51, v223
  v_lshrrev_b32 v220, 1, v220
  v_lshl_add_u32 v216, v219, 7, v223
  v_lshl_add_u32 v216, v221, 5, v216
  v_lshl_add_u32 v215, v220, 6, v216
  v_xor_b32 v214, 1, v220
  v_lshl_add_u32 v216, v214, 6, v216
  s_lshl_b32 s92, s48, 14
  v_add_u32 v214, s92, v212
  s_mov_b32 s32, s12
  s_mov_b32 s33, s13
  s_mov_b32 s34, 18874368
  s_mov_b32 s35, 0x00020000
  v_bfe_u32 v219, v200, 3, 2
  v_mul_u32_u24 v201, 73728, v219
  v_and_b32 v219, 7, v200
  v_lshl_add_u32 v201, v219, 4, v201
  v_lshrrev_b32 v219, 5, v200
  v_lshl_add_u32 v201, v219, 7, v201
  s_lshl_b32 s92, s48, 12
  v_add_u32 v202, s92, v212
  s_lshl_b32 s92, s48, 14
  v_add_u32 v203, s92, v212
  s_mul_i32 s92, s49, 589824
  s_mul_i32 s95, s50, 73728
  s_add_u32 s95, s95, s92
  s_mul_i32 s93, s50, 9216
  s_add_u32 s92, s92, s93
  s_lshl_b32 s93, s48, 10
  s_add_u32 s54, s92, s93
  s_add_u32 s55, s54, 294912
  s_and_b32 s93, s48, 1
  s_mul_i32 s93, s93, 294912
  s_add_u32 s92, s92, s93
  s_lshr_b32 s93, s48, 1
  s_lshl_b32 s93, s93, 9
  s_add_u32 s92, s92, s93
  s_add_u32 s56, s92, 8192
  s_lshl_b32 s92, s48, 10
  v_add_u32 v204, s92, v212
  v_mul_u32_u24 v206, 9216, v200
  s_add_u32 s92, s92, 1008
  v_add_u32 v206, s92, v206
  v_mov_b32 v219, 2130706432
  v_cmp_gt_u32 vcc, 8, v200
  s_nop 1
  v_cndmask_b32 v206, v219, v206, vcc
  s_lshl_b32 s92, s48, 8
  s_add_u32 s92, s92, 8192
  v_add_u32 v205, s92, v212
  v_cmp_gt_u32 vcc, 16, v200
  s_nop 1
  v_cndmask_b32 v205, v219, v205, vcc
  s_movk_i32 s94, 4096
  s_mov_b32 s57, 0
  s_waitcnt vmcnt(30)
  s_barrier
  ds_read_b128 a[0:3], v212 offset:0
  ds_read_b128 a[4:7], v212 offset:1024
  ds_read_b128 a[8:11], v212 offset:2048
  ds_read_b128 a[12:15], v212 offset:3072
  s_waitcnt vmcnt(28)
  ds_read_b64_tr_b16 v[128:129], v215 offset:0
  ds_read_b64_tr_b16 v[130:131], v215 offset:1024
  ds_read_b64_tr_b16 v[132:133], v216 offset:0
  ds_read_b64_tr_b16 v[134:135], v216 offset:1024
  s_waitcnt vmcnt(26)
  ds_read_b64_tr_b16 v[136:137], v215 offset:2048
  ds_read_b64_tr_b16 v[138:139], v215 offset:3072
  ds_read_b64_tr_b16 v[140:141], v216 offset:2048
  ds_read_b64_tr_b16 v[142:143], v216 offset:3072
  s_add_u32 m0, s79, 32768
  s_waitcnt lgkmcnt(6)
  v_mfma_f32_32x32x16_bf16 v[0:15], v[128:131], a[0:3], 0
  s_waitcnt vmcnt(24)
  ds_read_b128 a[16:19], v212 offset:4096
  ds_read_b64_tr_b16 v[144:145], v215 offset:4096
  s_add_u32 s53, s89, 16384
  buffer_load_dwordx4 v212, s[28:31], s53 offen lds
  v_mfma_f32_32x32x16_bf16 v[16:31], v[128:131], a[4:7], 0
  ds_read_b64_tr_b16 v[146:147], v215 offset:5120
  buffer_load_dwordx4 v222, s[28:31], s53 offen offset:1024 lds
  s_add_u32 m0, s51, 0
  s_waitcnt lgkmcnt(7)
  v_mfma_f32_32x32x16_bf16 v[32:47], v[132:135], a[0:3], 0
  ds_read_b128 a[20:23], v212 offset:5120
  ds_read_b64_tr_b16 v[148:149], v216 offset:4096
  s_add_u32 s52, s3, 221184
  buffer_load_dwordx4 v217, s[24:27], s52 offen offset:0 lds
  v_mfma_f32_32x32x16_bf16 v[48:63], v[132:135], a[4:7], 0
  ds_read_b64_tr_b16 v[150:151], v216 offset:5120
  buffer_load_dwordx4 v218, s[24:27], s52 offen offset:1024 lds
  s_add_u32 m0, s51, 2048
  s_waitcnt lgkmcnt(8)
  v_mfma_f32_32x32x16_bf16 v[0:15], v[136:139], a[8:11], v[0:15]
  s_waitcnt vmcnt(26)
  ds_read_b128 a[24:27], v212 offset:6144
  ds_read_b64_tr_b16 v[152:153], v215 offset:6144
  v_mfma_f32_32x32x16_bf16 v[16:31], v[136:139], a[12:15], v[16:31]
  ds_read_b64_tr_b16 v[154:155], v215 offset:7168
  s_waitcnt lgkmcnt(9)
  v_mfma_f32_32x32x16_bf16 v[32:47], v[140:143], a[8:11], v[32:47]
  ds_read_b128 a[28:31], v212 offset:7168
  ds_read_b64_tr_b16 v[156:157], v216 offset:6144
  s_add_u32 s52, s3, 239616
  buffer_load_dwordx4 v217, s[24:27], s52 offen offset:0 lds
  v_mfma_f32_32x32x16_bf16 v[48:63], v[140:143], a[12:15], v[48:63]
  ds_read_b64_tr_b16 v[158:159], v216 offset:7168
  buffer_load_dwordx4 v218, s[24:27], s52 offen offset:1024 lds
  s_add_u32 m0, s51, 4096
  s_waitcnt vmcnt(26)
  s_barrier
  s_waitcnt lgkmcnt(9)
  v_mfma_f32_32x32x16_bf16 v[0:15], v[144:147], a[16:19], v[0:15]
  s_waitcnt vmcnt(24)
  ds_read_b128 a[32:35], v212 offset:8192
  ds_read_b64_tr_b16 v[128:129], v215 offset:8192
  s_waitcnt lgkmcnt(10)
  v_mfma_f32_32x32x16_bf16 v[16:31], v[144:147], a[20:23], v[16:31]
  ds_read_b64_tr_b16 v[130:131], v215 offset:9216
  s_waitcnt lgkmcnt(9)
  v_mfma_f32_32x32x16_bf16 v[32:47], v[148:151], a[16:19], v[32:47]
  ds_read_b128 a[36:39], v212 offset:9216
  ds_read_b64_tr_b16 v[132:133], v216 offset:8192
  s_add_u32 s52, s3, 258048
  buffer_load_dwordx4 v217, s[24:27], s52 offen offset:0 lds
  v_mfma_f32_32x32x16_bf16 v[48:63], v[148:151], a[20:23], v[48:63]
  ds_read_b64_tr_b16 v[134:135], v216 offset:9216
  buffer_load_dwordx4 v218, s[24:27], s52 offen offset:1024 lds
  s_add_u32 m0, s51, 6144
  s_waitcnt lgkmcnt(9)
  v_mfma_f32_32x32x16_bf16 v[0:15], v[152:155], a[24:27], v[0:15]
  s_waitcnt vmcnt(24)
  ds_read_b128 a[40:43], v212 offset:10240
  ds_read_b64_tr_b16 v[136:137], v215 offset:10240
  s_waitcnt lgkmcnt(10)
  v_mfma_f32_32x32x16_bf16 v[16:31], v[152:155], a[28:31], v[16:31]
  ds_read_b64_tr_b16 v[138:139], v215 offset:11264
  s_waitcnt lgkmcnt(9)
  v_mfma_f32_32x32x16_bf16 v[32:47], v[156:159], a[24:27], v[32:47]
  ds_read_b128 a[44:47], v212 offset:11264
  ds_read_b64_tr_b16 v[140:141], v216 offset:10240
  s_add_u32 s52, s3, 276480
  buffer_load_dwordx4 v217, s[24:27], s52 offen offset:0 lds
  v_mfma_f32_32x32x16_bf16 v[48:63], v[156:159], a[28:31], v[48:63]
  ds_read_b64_tr_b16 v[142:143], v216 offset:11264
  buffer_load_dwordx4 v218, s[24:27], s52 offen offset:1024 lds
  s_add_u32 m0, s79, 40960
  s_waitcnt lgkmcnt(9)
  v_mfma_f32_32x32x16_bf16 v[0:15], v[128:131], a[32:35], v[0:15]
  s_waitcnt vmcnt(24)
  ds_read_b128 a[48:51], v212 offset:12288
  ds_read_b64_tr_b16 v[144:145], v215 offset:12288
  s_add_u32 s53, s89, 20480
  buffer_load_dwordx4 v212, s[28:31], s53 offen lds
  s_waitcnt lgkmcnt(10)
  v_mfma_f32_32x32x16_bf16 v[16:31], v[128:131], a[36:39], v[16:31]
  ds_read_b64_tr_b16 v[146:147], v215 offset:13312
  buffer_load_dwordx4 v222, s[28:31], s53 offen offset:1024 lds
  s_add_u32 m0, s51, 8192
  s_waitcnt lgkmcnt(9)
  v_mfma_f32_32x32x16_bf16 v[32:47], v[132:135], a[32:35], v[32:47]
  ds_read_b128 a[52:55], v212 offset:13312
  ds_read_b64_tr_b16 v[148:149], v216 offset:12288
  s_add_u32 s52, s3, 294912
  buffer_load_dwordx4 v217, s[24:27], s52 offen offset:0 lds
  v_mfma_f32_32x32x16_bf16 v[48:63], v[132:135], a[36:39], v[48:63]
  ds_read_b64_tr_b16 v[150:151], v216 offset:13312
  buffer_load_dwordx4 v218, s[24:27], s52 offen offset:1024 lds
  s_add_u32 m0, s51, 10240
  s_waitcnt lgkmcnt(9)
  v_mfma_f32_32x32x16_bf16 v[0:15], v[136:139], a[40:43], v[0:15]
  s_waitcnt vmcnt(26)
  ds_read_b128 a[56:59], v212 offset:14336
  ds_read_b64_tr_b16 v[152:153], v215 offset:14336
  s_waitcnt lgkmcnt(10)
  v_mfma_f32_32x32x16_bf16 v[16:31], v[136:139], a[44:47], v[16:31]
  ds_read_b64_tr_b16 v[154:155], v215 offset:15360
  s_waitcnt lgkmcnt(9)
  v_mfma_f32_32x32x16_bf16 v[32:47], v[140:143], a[40:43], v[32:47]
  ds_read_b128 a[60:63], v212 offset:15360
  ds_read_b64_tr_b16 v[156:157], v216 offset:14336
  s_add_u32 s52, s3, 313344
  buffer_load_dwordx4 v217, s[24:27], s52 offen offset:0 lds
  v_mfma_f32_32x32x16_bf16 v[48:63], v[140:143], a[44:47], v[48:63]
  ds_read_b64_tr_b16 v[158:159], v216 offset:15360
  buffer_load_dwordx4 v218, s[24:27], s52 offen offset:1024 lds
  s_add_u32 m0, s51, 12288
  s_waitcnt vmcnt(26)
  s_barrier
  s_waitcnt lgkmcnt(9)
  v_mfma_f32_32x32x16_bf16 v[0:15], v[144:147], a[48:51], v[0:15]
  s_waitcnt vmcnt(24)
  ds_read_b128 a[64:67], v212 offset:16384
  ds_read_b64_tr_b16 v[128:129], v215 offset:16384
  s_waitcnt lgkmcnt(10)
  v_mfma_f32_32x32x16_bf16 v[16:31], v[144:147], a[52:55], v[16:31]
  ds_read_b64_tr_b16 v[130:131], v215 offset:17408
  s_waitcnt lgkmcnt(9)
  v_mfma_f32_32x32x16_bf16 v[32:47], v[148:151], a[48:51], v[32:47]
  ds_read_b128 a[68:71], v212 offset:17408
  ds_read_b64_tr_b16 v[132:133], v216 offset:16384
  s_add_u32 s52, s3, 331776
  buffer_load_dwordx4 v217, s[24:27], s52 offen offset:0 lds
  v_mfma_f32_32x32x16_bf16 v[48:63], v[148:151], a[52:55], v[48:63]
  ds_read_b64_tr_b16 v[134:135], v216 offset:17408
  buffer_load_dwordx4 v218, s[24:27], s52 offen offset:1024 lds
  s_add_u32 m0, s51, 14336
  s_waitcnt lgkmcnt(9)
  v_mfma_f32_32x32x16_bf16 v[0:15], v[152:155], a[56:59], v[0:15]
  s_waitcnt vmcnt(24)
  ds_read_b128 a[72:75], v212 offset:18432
  ds_read_b64_tr_b16 v[136:137], v215 offset:18432
  s_waitcnt lgkmcnt(10)
  v_mfma_f32_32x32x16_bf16 v[16:31], v[152:155], a[60:63], v[16:31]
  ds_read_b64_tr_b16 v[138:139], v215 offset:19456
  s_waitcnt lgkmcnt(9)
  v_mfma_f32_32x32x16_bf16 v[32:47], v[156:159], a[56:59], v[32:47]
  ds_read_b128 a[76:79], v212 offset:19456
  ds_read_b64_tr_b16 v[140:141], v216 offset:18432
  s_add_u32 s52, s3, 350208
  buffer_load_dwordx4 v217, s[24:27], s52 offen offset:0 lds
  v_mfma_f32_32x32x16_bf16 v[48:63], v[156:159], a[60:63], v[48:63]
  ds_read_b64_tr_b16 v[142:143], v216 offset:19456
  buffer_load_dwordx4 v218, s[24:27], s52 offen offset:1024 lds
  s_add_u32 m0, s79, 49152
  s_waitcnt lgkmcnt(9)
  v_mfma_f32_32x32x16_bf16 v[0:15], v[128:131], a[64:67], v[0:15]
  s_waitcnt vmcnt(24)
  ds_read_b128 a[80:83], v212 offset:20480
  ds_read_b64_tr_b16 v[144:145], v215 offset:20480
  s_add_u32 s53, s89, 24576
  buffer_load_dwordx4 v212, s[28:31], s53 offen lds
  s_waitcnt lgkmcnt(10)
  v_mfma_f32_32x32x16_bf16 v[16:31], v[128:131], a[68:71], v[16:31]
  ds_read_b64_tr_b16 v[146:147], v215 offset:21504
  buffer_load_dwordx4 v222, s[28:31], s53 offen offset:1024 lds
  s_add_u32 m0, s51, 16384
  s_waitcnt lgkmcnt(9)
  v_mfma_f32_32x32x16_bf16 v[32:47], v[132:135], a[64:67], v[32:47]
  ds_read_b128 a[84:87], v212 offset:21504
  ds_read_b64_tr_b16 v[148:149], v216 offset:20480
  s_add_u32 s52, s3, 368640
  buffer_load_dwordx4 v217, s[24:27], s52 offen offset:0 lds
  v_mfma_f32_32x32x16_bf16 v[48:63], v[132:135], a[68:71], v[48:63]
  ds_read_b64_tr_b16 v[150:151], v216 offset:21504
  buffer_load_dwordx4 v218, s[24:27], s52 offen offset:1024 lds
  s_add_u32 m0, s51, 18432
  s_waitcnt lgkmcnt(9)
  v_mfma_f32_32x32x16_bf16 v[0:15], v[136:139], a[72:75], v[0:15]
  s_waitcnt vmcnt(26)
  ds_read_b128 a[88:91], v212 offset:22528
  ds_read_b64_tr_b16 v[152:153], v215 offset:22528
  s_waitcnt lgkmcnt(10)
  v_mfma_f32_32x32x16_bf16 v[16:31], v[136:139], a[76:79], v[16:31]
  ds_read_b64_tr_b16 v[154:155], v215 offset:23552
  s_waitcnt lgkmcnt(9)
  v_mfma_f32_32x32x16_bf16 v[32:47], v[140:143], a[72:75], v[32:47]
  ds_read_b128 a[92:95], v212 offset:23552
  ds_read_b64_tr_b16 v[156:157], v216 offset:22528
  s_add_u32 s52, s3, 387072
  buffer_load_dwordx4 v217, s[24:27], s52 offen offset:0 lds
  v_mfma_f32_32x32x16_bf16 v[48:63], v[140:143], a[76:79], v[48:63]
  ds_read_b64_tr_b16 v[158:159], v216 offset:23552
  buffer_load_dwordx4 v218, s[24:27], s52 offen offset:1024 lds
  s_add_u32 m0, s51, 20480
  s_waitcnt vmcnt(26)
  s_barrier
  s_waitcnt lgkmcnt(9)
  v_mfma_f32_32x32x16_bf16 v[0:15], v[144:147], a[80:83], v[0:15]
  s_waitcnt vmcnt(22)
  ds_read_b128 a[96:99], v212 offset:24576
  ds_read_b64_tr_b16 v[128:129], v215 offset:0
  s_waitcnt lgkmcnt(10)
  v_mfma_f32_32x32x16_bf16 v[16:31], v[144:147], a[84:87], v[16:31]
  ds_read_b64_tr_b16 v[130:131], v215 offset:1024
  s_waitcnt lgkmcnt(9)
  v_mfma_f32_32x32x16_bf16 v[32:47], v[148:151], a[80:83], v[32:47]
  ds_read_b128 a[100:103], v212 offset:25600
  ds_read_b64_tr_b16 v[132:133], v216 offset:0
  s_add_u32 s52, s3, 405504
  buffer_load_dwordx4 v217, s[24:27], s52 offen offset:0 lds
  v_mfma_f32_32x32x16_bf16 v[48:63], v[148:151], a[84:87], v[48:63]
  ds_read_b64_tr_b16 v[134:135], v216 offset:1024
  buffer_load_dwordx4 v218, s[24:27], s52 offen offset:1024 lds
  s_add_u32 m0, s51, 22528
  s_waitcnt lgkmcnt(9)
  v_mfma_f32_32x32x16_bf16 v[0:15], v[152:155], a[88:91], v[0:15]
  s_waitcnt vmcnt(22)
  ds_read_b128 a[104:107], v212 offset:26624
  ds_read_b64_tr_b16 v[136:137], v215 offset:2048
  s_waitcnt lgkmcnt(10)
  v_mfma_f32_32x32x16_bf16 v[16:31], v[152:155], a[92:95], v[16:31]
  ds_read_b64_tr_b16 v[138:139], v215 offset:3072
  s_waitcnt lgkmcnt(9)
  v_mfma_f32_32x32x16_bf16 v[32:47], v[156:159], a[88:91], v[32:47]
  ds_read_b128 a[108:111], v212 offset:27648
  ds_read_b64_tr_b16 v[140:141], v216 offset:2048
  s_add_u32 s52, s3, 423936
  buffer_load_dwordx4 v217, s[24:27], s52 offen offset:0 lds
  v_mfma_f32_32x32x16_bf16 v[48:63], v[156:159], a[92:95], v[48:63]
  ds_read_b64_tr_b16 v[142:143], v216 offset:3072
  buffer_load_dwordx4 v218, s[24:27], s52 offen offset:1024 lds
  s_add_u32 m0, s79, 57344
  s_waitcnt lgkmcnt(9)
  v_mfma_f32_32x32x16_bf16 v[0:15], v[128:131], a[96:99], v[0:15]
  s_waitcnt vmcnt(22)
  ds_read_b128 a[112:115], v212 offset:28672
  ds_read_b64_tr_b16 v[144:145], v215 offset:4096
  s_add_u32 s53, s89, 28672
  buffer_load_dwordx4 v212, s[28:31], s53 offen lds
  s_waitcnt lgkmcnt(10)
  v_mfma_f32_32x32x16_bf16 v[16:31], v[128:131], a[100:103], v[16:31]
  ds_read_b64_tr_b16 v[146:147], v215 offset:5120
  buffer_load_dwordx4 v222, s[28:31], s53 offen offset:1024 lds
  s_add_u32 m0, s51, 0
  s_waitcnt lgkmcnt(9)
  v_mfma_f32_32x32x16_bf16 v[32:47], v[132:135], a[96:99], v[32:47]
  ds_read_b128 a[116:119], v212 offset:29696
  ds_read_b64_tr_b16 v[148:149], v216 offset:4096
  s_add_u32 s52, s3, 442368
  buffer_load_dwordx4 v217, s[24:27], s52 offen offset:0 lds
  v_mfma_f32_32x32x16_bf16 v[48:63], v[132:135], a[100:103], v[48:63]
  ds_read_b64_tr_b16 v[150:151], v216 offset:5120
  buffer_load_dwordx4 v218, s[24:27], s52 offen offset:1024 lds
  s_add_u32 m0, s51, 2048
  s_waitcnt lgkmcnt(9)
  v_mfma_f32_32x32x16_bf16 v[0:15], v[136:139], a[104:107], v[0:15]
  s_waitcnt vmcnt(24)
  ds_read_b128 a[120:123], v212 offset:30720
  ds_read_b64_tr_b16 v[152:153], v215 offset:6144
  s_waitcnt lgkmcnt(10)
  v_mfma_f32_32x32x16_bf16 v[16:31], v[136:139], a[108:111], v[16:31]
  ds_read_b64_tr_b16 v[154:155], v215 offset:7168
  s_waitcnt lgkmcnt(9)
  v_mfma_f32_32x32x16_bf16 v[32:47], v[140:143], a[104:107], v[32:47]
  ds_read_b128 a[124:127], v212 offset:31744
  ds_read_b64_tr_b16 v[156:157], v216 offset:6144
  s_add_u32 s52, s3, 460800
  buffer_load_dwordx4 v217, s[24:27], s52 offen offset:0 lds
  v_mfma_f32_32x32x16_bf16 v[48:63], v[140:143], a[108:111], v[48:63]
  ds_read_b64_tr_b16 v[158:159], v216 offset:7168
  buffer_load_dwordx4 v218, s[24:27], s52 offen offset:1024 lds
  s_add_u32 m0, s51, 4096
  s_barrier
  s_waitcnt lgkmcnt(9)
  v_mfma_f32_32x32x16_bf16 v[0:15], v[144:147], a[112:115], v[0:15]
  s_waitcnt vmcnt(22)
  ds_read_b128 a[128:131], v212 offset:32768
  ds_read_b64_tr_b16 v[128:129], v215 offset:8192
  s_waitcnt lgkmcnt(10)
  v_mfma_f32_32x32x16_bf16 v[16:31], v[144:147], a[116:119], v[16:31]
  ds_read_b64_tr_b16 v[130:131], v215 offset:9216
  s_waitcnt lgkmcnt(9)
  v_mfma_f32_32x32x16_bf16 v[32:47], v[148:151], a[112:115], v[32:47]
  ds_read_b128 a[132:135], v212 offset:33792
  ds_read_b64_tr_b16 v[132:133], v216 offset:8192
  s_add_u32 s52, s3, 479232
  buffer_load_dwordx4 v217, s[24:27], s52 offen offset:0 lds
  v_mfma_f32_32x32x16_bf16 v[48:63], v[148:151], a[116:119], v[48:63]
  ds_read_b64_tr_b16 v[134:135], v216 offset:9216
  buffer_load_dwordx4 v218, s[24:27], s52 offen offset:1024 lds
  s_add_u32 m0, s51, 6144
  s_waitcnt lgkmcnt(9)
  v_mfma_f32_32x32x16_bf16 v[0:15], v[152:155], a[120:123], v[0:15]
  s_waitcnt vmcnt(22)
  ds_read_b128 a[136:139], v212 offset:34816
  ds_read_b64_tr_b16 v[136:137], v215 offset:10240
  s_waitcnt lgkmcnt(10)
  v_mfma_f32_32x32x16_bf16 v[16:31], v[152:155], a[124:127], v[16:31]
  ds_read_b64_tr_b16 v[138:139], v215 offset:11264
  s_waitcnt lgkmcnt(9)
  v_mfma_f32_32x32x16_bf16 v[32:47], v[156:159], a[120:123], v[32:47]
  ds_read_b128 a[140:143], v212 offset:35840
  ds_read_b64_tr_b16 v[140:141], v216 offset:10240
  s_add_u32 s52, s3, 497664
  buffer_load_dwordx4 v217, s[24:27], s52 offen offset:0 lds
  v_mfma_f32_32x32x16_bf16 v[48:63], v[156:159], a[124:127], v[48:63]
  ds_read_b64_tr_b16 v[142:143], v216 offset:11264
  buffer_load_dwordx4 v218, s[24:27], s52 offen offset:1024 lds
  s_add_u32 m0, s51, 8192
  s_waitcnt lgkmcnt(9)
  v_mfma_f32_32x32x16_bf16 v[0:15], v[128:131], a[128:131], v[0:15]
  s_waitcnt vmcnt(22)
  ds_read_b128 a[144:147], v212 offset:36864
  ds_read_b64_tr_b16 v[144:145], v215 offset:12288
  s_waitcnt lgkmcnt(10)
  v_mfma_f32_32x32x16_bf16 v[16:31], v[128:131], a[132:135], v[16:31]
  ds_read_b64_tr_b16 v[146:147], v215 offset:13312
  s_waitcnt lgkmcnt(9)
  v_mfma_f32_32x32x16_bf16 v[32:47], v[132:135], a[128:131], v[32:47]
  ds_read_b128 a[148:151], v212 offset:37888
  ds_read_b64_tr_b16 v[148:149], v216 offset:12288
  s_add_u32 s52, s3, 516096
  buffer_load_dwordx4 v217, s[24:27], s52 offen offset:0 lds
  v_mfma_f32_32x32x16_bf16 v[48:63], v[132:135], a[132:135], v[48:63]
  ds_read_b64_tr_b16 v[150:151], v216 offset:13312
  buffer_load_dwordx4 v218, s[24:27], s52 offen offset:1024 lds
  s_add_u32 m0, s51, 10240
  s_waitcnt lgkmcnt(9)
  v_mfma_f32_32x32x16_bf16 v[0:15], v[136:139], a[136:139], v[0:15]
  s_waitcnt vmcnt(22)
  ds_read_b128 a[152:155], v212 offset:38912
  ds_read_b64_tr_b16 v[152:153], v215 offset:14336
  s_waitcnt lgkmcnt(10)
  v_mfma_f32_32x32x16_bf16 v[16:31], v[136:139], a[140:143], v[16:31]
  ds_read_b64_tr_b16 v[154:155], v215 offset:15360
  s_waitcnt lgkmcnt(9)
  v_mfma_f32_32x32x16_bf16 v[32:47], v[140:143], a[136:139], v[32:47]
  ds_read_b128 a[156:159], v212 offset:39936
  ds_read_b64_tr_b16 v[156:157], v216 offset:14336
  s_add_u32 s52, s3, 534528
  buffer_load_dwordx4 v217, s[24:27], s52 offen offset:0 lds
  v_mfma_f32_32x32x16_bf16 v[48:63], v[140:143], a[140:143], v[48:63]
  ds_read_b64_tr_b16 v[158:159], v216 offset:15360
  buffer_load_dwordx4 v218, s[24:27], s52 offen offset:1024 lds
  s_add_u32 m0, s51, 12288
  s_barrier
  s_waitcnt lgkmcnt(9)
  v_mfma_f32_32x32x16_bf16 v[0:15], v[144:147], a[144:147], v[0:15]
  s_waitcnt vmcnt(20)
  ds_read_b128 a[160:163], v212 offset:40960
  ds_read_b64_tr_b16 v[128:129], v215 offset:16384
  s_waitcnt lgkmcnt(10)
  v_mfma_f32_32x32x16_bf16 v[16:31], v[144:147], a[148:151], v[16:31]
  ds_read_b64_tr_b16 v[130:131], v215 offset:17408
  s_waitcnt lgkmcnt(9)
  v_mfma_f32_32x32x16_bf16 v[32:47], v[148:151], a[144:147], v[32:47]
  ds_read_b128 a[164:167], v212 offset:41984
  ds_read_b64_tr_b16 v[132:133], v216 offset:16384
  s_add_u32 s52, s3, 552960
  buffer_load_dwordx4 v217, s[24:27], s52 offen offset:0 lds
  v_mfma_f32_32x32x16_bf16 v[48:63], v[148:151], a[148:151], v[48:63]
  ds_read_b64_tr_b16 v[134:135], v216 offset:17408
  buffer_load_dwordx4 v218, s[24:27], s52 offen offset:1024 lds
  s_add_u32 m0, s51, 14336
  s_waitcnt lgkmcnt(9)
  v_mfma_f32_32x32x16_bf16 v[0:15], v[152:155], a[152:155], v[0:15]
  s_waitcnt vmcnt(20)
  ds_read_b128 a[168:171], v212 offset:43008
  ds_read_b64_tr_b16 v[136:137], v215 offset:18432
  s_waitcnt lgkmcnt(10)
  v_mfma_f32_32x32x16_bf16 v[16:31], v[152:155], a[156:159], v[16:31]
  ds_read_b64_tr_b16 v[138:139], v215 offset:19456
  s_waitcnt lgkmcnt(9)
  v_mfma_f32_32x32x16_bf16 v[32:47], v[156:159], a[152:155], v[32:47]
  ds_read_b128 a[172:175], v212 offset:44032
  ds_read_b64_tr_b16 v[140:141], v216 offset:18432
  s_add_u32 s52, s3, 571392
  buffer_load_dwordx4 v217, s[24:27], s52 offen offset:0 lds
  v_mfma_f32_32x32x16_bf16 v[48:63], v[156:159], a[156:159], v[48:63]
  ds_read_b64_tr_b16 v[142:143], v216 offset:19456
  buffer_load_dwordx4 v218, s[24:27], s52 offen offset:1024 lds
  s_add_u32 m0, s51, 16384
  s_waitcnt lgkmcnt(9)
  v_mfma_f32_32x32x16_bf16 v[0:15], v[128:131], a[160:163], v[0:15]
  s_waitcnt vmcnt(20)
  ds_read_b128 a[176:179], v212 offset:45056
  ds_read_b64_tr_b16 v[144:145], v215 offset:20480
  s_waitcnt lgkmcnt(10)
  v_mfma_f32_32x32x16_bf16 v[16:31], v[128:131], a[164:167], v[16:31]
  ds_read_b64_tr_b16 v[146:147], v215 offset:21504
  s_waitcnt lgkmcnt(9)
  v_mfma_f32_32x32x16_bf16 v[32:47], v[132:135], a[160:163], v[32:47]
  ds_read_b128 a[180:183], v212 offset:46080
  ds_read_b64_tr_b16 v[148:149], v216 offset:20480
  s_add_u32 s52, s3, 128
  buffer_load_dwordx4 v217, s[24:27], s52 offen offset:0 lds
  v_mfma_f32_32x32x16_bf16 v[48:63], v[132:135], a[164:167], v[48:63]
  ds_read_b64_tr_b16 v[150:151], v216 offset:21504
  buffer_load_dwordx4 v218, s[24:27], s52 offen offset:1024 lds
  s_add_u32 m0, s51, 18432
  s_waitcnt lgkmcnt(9)
  v_mfma_f32_32x32x16_bf16 v[0:15], v[136:139], a[168:171], v[0:15]
  s_waitcnt vmcnt(20)
  ds_read_b128 a[184:187], v212 offset:47104
  ds_read_b64_tr_b16 v[152:153], v215 offset:22528
  s_waitcnt lgkmcnt(10)
  v_mfma_f32_32x32x16_bf16 v[16:31], v[136:139], a[172:175], v[16:31]
  ds_read_b64_tr_b16 v[154:155], v215 offset:23552
  s_waitcnt lgkmcnt(9)
  v_mfma_f32_32x32x16_bf16 v[32:47], v[140:143], a[168:171], v[32:47]
  ds_read_b128 a[188:191], v212 offset:48128
  ds_read_b64_tr_b16 v[156:157], v216 offset:22528
  s_add_u32 s52, s3, 18560
  buffer_load_dwordx4 v217, s[24:27], s52 offen offset:0 lds
  v_mfma_f32_32x32x16_bf16 v[48:63], v[140:143], a[172:175], v[48:63]
  ds_read_b64_tr_b16 v[158:159], v216 offset:23552
  buffer_load_dwordx4 v218, s[24:27], s52 offen offset:1024 lds
  s_add_u32 m0, s51, 20480
  s_barrier
  s_waitcnt lgkmcnt(9)
  v_mfma_f32_32x32x16_bf16 v[0:15], v[144:147], a[176:179], v[0:15]
  s_waitcnt vmcnt(18)
  ds_read_b128 a[192:195], v212 offset:49152
  ds_read_b64_tr_b16 v[128:129], v215 offset:0
  s_waitcnt lgkmcnt(10)
  v_mfma_f32_32x32x16_bf16 v[16:31], v[144:147], a[180:183], v[16:31]
  ds_read_b64_tr_b16 v[130:131], v215 offset:1024
  s_waitcnt lgkmcnt(9)
  v_mfma_f32_32x32x16_bf16 v[32:47], v[148:151], a[176:179], v[32:47]
  ds_read_b128 a[196:199], v212 offset:50176
  ds_read_b64_tr_b16 v[132:133], v216 offset:0
  s_add_u32 s52, s3, 36992
  buffer_load_dwordx4 v217, s[24:27], s52 offen offset:0 lds
  v_mfma_f32_32x32x16_bf16 v[48:63], v[148:151], a[180:183], v[48:63]
  ds_read_b64_tr_b16 v[134:135], v216 offset:1024
  buffer_load_dwordx4 v218, s[24:27], s52 offen offset:1024 lds
  s_add_u32 m0, s51, 22528
  s_waitcnt lgkmcnt(9)
  v_mfma_f32_32x32x16_bf16 v[0:15], v[152:155], a[184:187], v[0:15]
  s_waitcnt vmcnt(18)
  ds_read_b128 a[200:203], v212 offset:51200
  ds_read_b64_tr_b16 v[136:137], v215 offset:2048
  s_waitcnt lgkmcnt(10)
  v_mfma_f32_32x32x16_bf16 v[16:31], v[152:155], a[188:191], v[16:31]
  ds_read_b64_tr_b16 v[138:139], v215 offset:3072
  s_waitcnt lgkmcnt(9)
  v_mfma_f32_32x32x16_bf16 v[32:47], v[156:159], a[184:187], v[32:47]
  ds_read_b128 a[204:207], v212 offset:52224
  ds_read_b64_tr_b16 v[140:141], v216 offset:2048
  s_add_u32 s52, s3, 55424
  buffer_load_dwordx4 v217, s[24:27], s52 offen offset:0 lds
  v_mfma_f32_32x32x16_bf16 v[48:63], v[156:159], a[188:191], v[48:63]
  ds_read_b64_tr_b16 v[142:143], v216 offset:3072
  buffer_load_dwordx4 v218, s[24:27], s52 offen offset:1024 lds
  s_add_u32 m0, s51, 0
  s_waitcnt lgkmcnt(9)
  v_mfma_f32_32x32x16_bf16 v[0:15], v[128:131], a[192:195], v[0:15]
  s_waitcnt vmcnt(18)
  ds_read_b128 a[208:211], v212 offset:53248
  ds_read_b64_tr_b16 v[144:145], v215 offset:4096
  s_waitcnt lgkmcnt(10)
  v_mfma_f32_32x32x16_bf16 v[16:31], v[128:131], a[196:199], v[16:31]
  ds_read_b64_tr_b16 v[146:147], v215 offset:5120
  s_waitcnt lgkmcnt(9)
  v_mfma_f32_32x32x16_bf16 v[32:47], v[132:135], a[192:195], v[32:47]
  ds_read_b128 a[212:215], v212 offset:54272
  ds_read_b64_tr_b16 v[148:149], v216 offset:4096
  s_add_u32 s52, s3, 73856
  buffer_load_dwordx4 v217, s[24:27], s52 offen offset:0 lds
  v_mfma_f32_32x32x16_bf16 v[48:63], v[132:135], a[196:199], v[48:63]
  ds_read_b64_tr_b16 v[150:151], v216 offset:5120
  buffer_load_dwordx4 v218, s[24:27], s52 offen offset:1024 lds
  s_add_u32 m0, s51, 2048
  s_waitcnt lgkmcnt(9)
  v_mfma_f32_32x32x16_bf16 v[0:15], v[136:139], a[200:203], v[0:15]
  s_waitcnt vmcnt(18)
  ds_read_b128 a[216:219], v212 offset:55296
  ds_read_b64_tr_b16 v[152:153], v215 offset:6144
  s_waitcnt lgkmcnt(10)
  v_mfma_f32_32x32x16_bf16 v[16:31], v[136:139], a[204:207], v[16:31]
  ds_read_b64_tr_b16 v[154:155], v215 offset:7168
  s_waitcnt lgkmcnt(9)
  v_mfma_f32_32x32x16_bf16 v[32:47], v[140:143], a[200:203], v[32:47]
  ds_read_b128 a[220:223], v212 offset:56320
  ds_read_b64_tr_b16 v[156:157], v216 offset:6144
  s_add_u32 s52, s3, 92288
  buffer_load_dwordx4 v217, s[24:27], s52 offen offset:0 lds
  v_mfma_f32_32x32x16_bf16 v[48:63], v[140:143], a[204:207], v[48:63]
  ds_read_b64_tr_b16 v[158:159], v216 offset:7168
  buffer_load_dwordx4 v218, s[24:27], s52 offen offset:1024 lds
  s_add_u32 m0, s51, 4096
  s_barrier
  s_waitcnt lgkmcnt(9)
  v_mfma_f32_32x32x16_bf16 v[0:15], v[144:147], a[208:211], v[0:15]
  s_waitcnt vmcnt(18)
  ds_read_b128 a[224:227], v212 offset:57344
  ds_read_b64_tr_b16 v[128:129], v215 offset:8192
  s_waitcnt lgkmcnt(10)
  v_mfma_f32_32x32x16_bf16 v[16:31], v[144:147], a[212:215], v[16:31]
  ds_read_b64_tr_b16 v[130:131], v215 offset:9216
  s_waitcnt lgkmcnt(9)
  v_mfma_f32_32x32x16_bf16 v[32:47], v[148:151], a[208:211], v[32:47]
  ds_read_b128 a[228:231], v212 offset:58368
  ds_read_b64_tr_b16 v[132:133], v216 offset:8192
  s_add_u32 s52, s3, 110720
  buffer_load_dwordx4 v217, s[24:27], s52 offen offset:0 lds
  v_mfma_f32_32x32x16_bf16 v[48:63], v[148:151], a[212:215], v[48:63]
  ds_read_b64_tr_b16 v[134:135], v216 offset:9216
  buffer_load_dwordx4 v218, s[24:27], s52 offen offset:1024 lds
  s_add_u32 m0, s51, 6144
  s_waitcnt lgkmcnt(9)
  v_mfma_f32_32x32x16_bf16 v[0:15], v[152:155], a[216:219], v[0:15]
  s_waitcnt vmcnt(18)
  ds_read_b128 a[232:235], v212 offset:59392
  ds_read_b64_tr_b16 v[136:137], v215 offset:10240
  s_waitcnt lgkmcnt(10)
  v_mfma_f32_32x32x16_bf16 v[16:31], v[152:155], a[220:223], v[16:31]
  ds_read_b64_tr_b16 v[138:139], v215 offset:11264
  s_waitcnt lgkmcnt(9)
  v_mfma_f32_32x32x16_bf16 v[32:47], v[156:159], a[216:219], v[32:47]
  ds_read_b128 a[236:239], v212 offset:60416
  ds_read_b64_tr_b16 v[140:141], v216 offset:10240
  s_add_u32 s52, s3, 129152
  buffer_load_dwordx4 v217, s[24:27], s52 offen offset:0 lds
  v_mfma_f32_32x32x16_bf16 v[48:63], v[156:159], a[220:223], v[48:63]
  ds_read_b64_tr_b16 v[142:143], v216 offset:11264
  buffer_load_dwordx4 v218, s[24:27], s52 offen offset:1024 lds
  s_add_u32 m0, s51, 8192
  s_waitcnt lgkmcnt(9)
  v_mfma_f32_32x32x16_bf16 v[0:15], v[128:131], a[224:227], v[0:15]
  s_waitcnt vmcnt(18)
  ds_read_b128 a[240:243], v212 offset:61440
  ds_read_b64_tr_b16 v[144:145], v215 offset:12288
  s_waitcnt lgkmcnt(10)
  v_mfma_f32_32x32x16_bf16 v[16:31], v[128:131], a[228:231], v[16:31]
  ds_read_b64_tr_b16 v[146:147], v215 offset:13312
  s_waitcnt lgkmcnt(9)
  v_mfma_f32_32x32x16_bf16 v[32:47], v[132:135], a[224:227], v[32:47]
  ds_read_b128 a[244:247], v212 offset:62464
  ds_read_b64_tr_b16 v[148:149], v216 offset:12288
  s_add_u32 s52, s3, 147584
  buffer_load_dwordx4 v217, s[24:27], s52 offen offset:0 lds
  v_mfma_f32_32x32x16_bf16 v[48:63], v[132:135], a[228:231], v[48:63]
  ds_read_b64_tr_b16 v[150:151], v216 offset:13312
  buffer_load_dwordx4 v218, s[24:27], s52 offen offset:1024 lds
  s_add_u32 m0, s51, 10240
  s_waitcnt lgkmcnt(9)
  v_mfma_f32_32x32x16_bf16 v[0:15], v[136:139], a[232:235], v[0:15]
  s_waitcnt vmcnt(18)
  ds_read_b128 a[248:251], v212 offset:63488
  ds_read_b64_tr_b16 v[152:153], v215 offset:14336
  s_waitcnt lgkmcnt(10)
  v_mfma_f32_32x32x16_bf16 v[16:31], v[136:139], a[236:239], v[16:31]
  ds_read_b64_tr_b16 v[154:155], v215 offset:15360
  s_waitcnt lgkmcnt(9)
  v_mfma_f32_32x32x16_bf16 v[32:47], v[140:143], a[232:235], v[32:47]
  ds_read_b128 a[252:255], v212 offset:64512
  ds_read_b64_tr_b16 v[156:157], v216 offset:14336
  s_add_u32 s52, s3, 166016
  buffer_load_dwordx4 v217, s[24:27], s52 offen offset:0 lds
  v_mfma_f32_32x32x16_bf16 v[48:63], v[140:143], a[236:239], v[48:63]
  ds_read_b64_tr_b16 v[158:159], v216 offset:15360
  buffer_load_dwordx4 v218, s[24:27], s52 offen offset:1024 lds
  s_add_u32 m0, s51, 12288
  s_waitcnt lgkmcnt(9)
  v_mfma_f32_32x32x16_bf16 v[0:15], v[144:147], a[240:243], v[0:15]
  s_waitcnt vmcnt(18)
  ds_read_b64_tr_b16 v[128:129], v215 offset:16384
  s_waitcnt lgkmcnt(9)
  v_mfma_f32_32x32x16_bf16 v[16:31], v[144:147], a[244:247], v[16:31]
  ds_read_b64_tr_b16 v[130:131], v215 offset:17408
  s_waitcnt lgkmcnt(8)
  v_mfma_f32_32x32x16_bf16 v[32:47], v[148:151], a[240:243], v[32:47]
  ds_read_b64_tr_b16 v[132:133], v216 offset:16384
  s_add_u32 s52, s3, 184448
  buffer_load_dwordx4 v217, s[24:27], s52 offen offset:0 lds
  v_mfma_f32_32x32x16_bf16 v[48:63], v[148:151], a[244:247], v[48:63]
  ds_read_b64_tr_b16 v[134:135], v216 offset:17408
  buffer_load_dwordx4 v218, s[24:27], s52 offen offset:1024 lds
  s_add_u32 m0, s51, 14336
  s_waitcnt lgkmcnt(7)
  v_mfma_f32_32x32x16_bf16 v[0:15], v[152:155], a[248:251], v[0:15]
  s_waitcnt vmcnt(18)
  ds_read_b64_tr_b16 v[136:137], v215 offset:18432
  s_waitcnt lgkmcnt(7)
  v_mfma_f32_32x32x16_bf16 v[16:31], v[152:155], a[252:255], v[16:31]
  ds_read_b64_tr_b16 v[138:139], v215 offset:19456
  s_waitcnt lgkmcnt(6)
  v_mfma_f32_32x32x16_bf16 v[32:47], v[156:159], a[248:251], v[32:47]
  ds_read_b64_tr_b16 v[140:141], v216 offset:18432
  s_add_u32 s52, s3, 202880
  buffer_load_dwordx4 v217, s[24:27], s52 offen offset:0 lds
  v_mfma_f32_32x32x16_bf16 v[48:63], v[156:159], a[252:255], v[48:63]
  ds_read_b64_tr_b16 v[142:143], v216 offset:19456
  buffer_load_dwordx4 v218, s[24:27], s52 offen offset:1024 lds
  s_add_u32 m0, s51, 16384
  s_waitcnt lgkmcnt(6)
  v_mfma_f32_32x32x16_bf16 v[64:79], v[128:131], a[0:3], 0
  s_waitcnt vmcnt(18)
  ds_read_b64_tr_b16 v[144:145], v215 offset:20480
  v_mfma_f32_32x32x16_bf16 v[80:95], v[128:131], a[4:7], 0
  ds_read_b64_tr_b16 v[146:147], v215 offset:21504
  s_waitcnt lgkmcnt(6)
  v_mfma_f32_32x32x16_bf16 v[96:111], v[132:135], a[0:3], 0
  ds_read_b64_tr_b16 v[148:149], v216 offset:20480
  s_add_u32 s52, s3, 221312
  buffer_load_dwordx4 v217, s[24:27], s52 offen offset:0 lds
  v_mfma_f32_32x32x16_bf16 v[112:127], v[132:135], a[4:7], 0
  ds_read_b64_tr_b16 v[150:151], v216 offset:21504
  buffer_load_dwordx4 v218, s[24:27], s52 offen offset:1024 lds
  s_add_u32 m0, s51, 18432
  v_cvt_pk_bf16_f32 v160, v0, v1
  v_cvt_pk_bf16_f32 v161, v2, v3
  s_waitcnt lgkmcnt(6)
  v_mfma_f32_32x32x16_bf16 v[64:79], v[136:139], a[8:11], v[64:79]
  s_waitcnt vmcnt(18)
  ds_read_b64_tr_b16 v[152:153], v215 offset:22528
  v_and_b32 v160, 0xfffffffe, v160
  v_cvt_pk_bf16_f32 v162, v4, v5
  v_mfma_f32_32x32x16_bf16 v[80:95], v[136:139], a[12:15], v[80:95]
  ds_read_b64_tr_b16 v[154:155], v215 offset:23552
  v_cvt_pk_bf16_f32 v163, v6, v7
  v_cvt_pk_bf16_f32 v164, v8, v9
  v_cvt_pk_bf16_f32 v165, v10, v11
  s_waitcnt lgkmcnt(6)
  v_mfma_f32_32x32x16_bf16 v[96:111], v[140:143], a[8:11], v[96:111]
  ds_read_b64_tr_b16 v[156:157], v216 offset:22528
  s_add_u32 s52, s3, 239744
  buffer_load_dwordx4 v217, s[24:27], s52 offen offset:0 lds
  v_mfma_f32_32x32x16_bf16 v[112:127], v[140:143], a[12:15], v[112:127]
  ds_read_b64_tr_b16 v[158:159], v216 offset:23552
  buffer_load_dwordx4 v218, s[24:27], s52 offen offset:1024 lds
  s_add_u32 m0, s51, 20480
  v_and_b32 v164, 0xfffffffe, v164
  v_cvt_pk_bf16_f32 v166, v12, v13
  s_waitcnt lgkmcnt(6)
  v_mfma_f32_32x32x16_bf16 v[64:79], v[144:147], a[16:19], v[64:79]
  s_waitcnt vmcnt(18)
  ds_read_b64_tr_b16 v[128:129], v215 offset:0
  v_cvt_pk_bf16_f32 v167, v14, v15
  v_cvt_pk_bf16_f32 v168, v16, v17
  v_mfma_f32_32x32x16_bf16 v[80:95], v[144:147], a[20:23], v[80:95]
  ds_read_b64_tr_b16 v[130:131], v215 offset:1024
  v_cvt_pk_bf16_f32 v169, v18, v19
  v_and_b32 v168, 0xfffffffe, v168
  v_cvt_pk_bf16_f32 v170, v20, v21
  s_waitcnt lgkmcnt(6)
  v_mfma_f32_32x32x16_bf16 v[96:111], v[148:151], a[16:19], v[96:111]
  ds_read_b64_tr_b16 v[132:133], v216 offset:0
  s_add_u32 s52, s3, 258176
  buffer_load_dwordx4 v217, s[24:27], s52 offen offset:0 lds
  v_mfma_f32_32x32x16_bf16 v[112:127], v[148:151], a[20:23], v[112:127]
  ds_read_b64_tr_b16 v[134:135], v216 offset:1024
  buffer_load_dwordx4 v218, s[24:27], s52 offen offset:1024 lds
  s_add_u32 m0, s51, 22528
  v_cvt_pk_bf16_f32 v171, v22, v23
  v_cvt_pk_bf16_f32 v172, v24, v25
  buffer_store_dwordx4 v[160:163], v201, s[32:35], s54 offen offset:0 sc1
  s_waitcnt lgkmcnt(6)
  v_mfma_f32_32x32x16_bf16 v[64:79], v[152:155], a[24:27], v[64:79]
  s_waitcnt vmcnt(19)
  ds_read_b64_tr_b16 v[136:137], v215 offset:2048
  v_cvt_pk_bf16_f32 v173, v26, v27
  v_and_b32 v172, 0xfffffffe, v172
  v_mfma_f32_32x32x16_bf16 v[80:95], v[152:155], a[28:31], v[80:95]
  ds_read_b64_tr_b16 v[138:139], v215 offset:3072
  v_cvt_pk_bf16_f32 v174, v28, v29
  v_cvt_pk_bf16_f32 v175, v30, v31
  v_cvt_pk_bf16_f32 v176, v32, v33
  s_waitcnt lgkmcnt(6)
  v_mfma_f32_32x32x16_bf16 v[96:111], v[156:159], a[24:27], v[96:111]
  ds_read_b64_tr_b16 v[140:141], v216 offset:2048
  s_add_u32 s52, s3, 276608
  buffer_load_dwordx4 v217, s[24:27], s52 offen offset:0 lds
  v_mfma_f32_32x32x16_bf16 v[112:127], v[156:159], a[28:31], v[112:127]
  ds_read_b64_tr_b16 v[142:143], v216 offset:3072
  buffer_load_dwordx4 v218, s[24:27], s52 offen offset:1024 lds
  s_add_u32 m0, s51, 0
  v_cvt_pk_bf16_f32 v177, v34, v35
  v_and_b32 v176, 0xfffffffe, v176
  s_waitcnt lgkmcnt(6)
  v_mfma_f32_32x32x16_bf16 v[64:79], v[128:131], a[32:35], v[64:79]
  s_waitcnt vmcnt(19)
  ds_read_b64_tr_b16 v[144:145], v215 offset:4096
  v_cvt_pk_bf16_f32 v178, v36, v37
  v_cvt_pk_bf16_f32 v179, v38, v39
  v_mfma_f32_32x32x16_bf16 v[80:95], v[128:131], a[36:39], v[80:95]
  ds_read_b64_tr_b16 v[146:147], v215 offset:5120
  v_cvt_pk_bf16_f32 v180, v40, v41
  v_cvt_pk_bf16_f32 v181, v42, v43
  v_and_b32 v180, 0xfffffffe, v180
  s_waitcnt lgkmcnt(6)
  v_mfma_f32_32x32x16_bf16 v[96:111], v[132:135], a[32:35], v[96:111]
  ds_read_b64_tr_b16 v[148:149], v216 offset:4096
  s_add_u32 s52, s3, 295040
  buffer_load_dwordx4 v217, s[24:27], s52 offen offset:0 lds
  v_mfma_f32_32x32x16_bf16 v[112:127], v[132:135], a[36:39], v[112:127]
  ds_read_b64_tr_b16 v[150:151], v216 offset:5120
  buffer_load_dwordx4 v218, s[24:27], s52 offen offset:1024 lds
  s_add_u32 m0, s51, 2048
  v_cvt_pk_bf16_f32 v182, v44, v45
  v_cvt_pk_bf16_f32 v183, v46, v47
  buffer_store_dwordx4 v[164:167], v201, s[32:35], s54 offen offset:256 sc1
  s_waitcnt lgkmcnt(6)
  v_mfma_f32_32x32x16_bf16 v[64:79], v[136:139], a[40:43], v[64:79]
  s_waitcnt vmcnt(20)
  ds_read_b64_tr_b16 v[152:153], v215 offset:6144
  v_cvt_pk_bf16_f32 v184, v48, v49
  v_cvt_pk_bf16_f32 v185, v50, v51
  v_mfma_f32_32x32x16_bf16 v[80:95], v[136:139], a[44:47], v[80:95]
  ds_read_b64_tr_b16 v[154:155], v215 offset:7168
  v_and_b32 v184, 0xfffffffe, v184
  v_cvt_pk_bf16_f32 v186, v52, v53
  v_cvt_pk_bf16_f32 v187, v54, v55
  s_waitcnt lgkmcnt(6)
  v_mfma_f32_32x32x16_bf16 v[96:111], v[140:143], a[40:43], v[96:111]
  ds_read_b64_tr_b16 v[156:157], v216 offset:6144
  s_add_u32 s52, s3, 313472
  buffer_load_dwordx4 v217, s[24:27], s52 offen offset:0 lds
  v_mfma_f32_32x32x16_bf16 v[112:127], v[140:143], a[44:47], v[112:127]
  ds_read_b64_tr_b16 v[158:159], v216 offset:7168
  buffer_load_dwordx4 v218, s[24:27], s52 offen offset:1024 lds
  s_add_u32 m0, s51, 4096
  v_cvt_pk_bf16_f32 v188, v56, v57
  v_cvt_pk_bf16_f32 v189, v58, v59
  s_waitcnt lgkmcnt(6)
  v_mfma_f32_32x32x16_bf16 v[64:79], v[144:147], a[48:51], v[64:79]
  s_waitcnt vmcnt(20)
  ds_read_b64_tr_b16 v[128:129], v215 offset:8192
  v_and_b32 v188, 0xfffffffe, v188
  v_cvt_pk_bf16_f32 v190, v60, v61
  v_mfma_f32_32x32x16_bf16 v[80:95], v[144:147], a[52:55], v[80:95]
  ds_read_b64_tr_b16 v[130:131], v215 offset:9216
  v_cvt_pk_bf16_f32 v191, v62, v63
  s_waitcnt lgkmcnt(6)
  v_mfma_f32_32x32x16_bf16 v[96:111], v[148:151], a[48:51], v[96:111]
  ds_read_b64_tr_b16 v[132:133], v216 offset:8192
  s_add_u32 s52, s3, 331904
  buffer_load_dwordx4 v217, s[24:27], s52 offen offset:0 lds
  v_mfma_f32_32x32x16_bf16 v[112:127], v[148:151], a[52:55], v[112:127]
  ds_read_b64_tr_b16 v[134:135], v216 offset:9216
  buffer_load_dwordx4 v218, s[24:27], s52 offen offset:1024 lds
  s_add_u32 m0, s51, 6144
  buffer_store_dwordx4 v[168:171], v201, s[32:35], s55 offen offset:0 sc1
  s_waitcnt lgkmcnt(6)
  v_mfma_f32_32x32x16_bf16 v[64:79], v[152:155], a[56:59], v[64:79]
  s_waitcnt vmcnt(21)
  ds_read_b64_tr_b16 v[136:137], v215 offset:10240
  v_mfma_f32_32x32x16_bf16 v[80:95], v[152:155], a[60:63], v[80:95]
  ds_read_b64_tr_b16 v[138:139], v215 offset:11264
  s_waitcnt lgkmcnt(6)
  v_mfma_f32_32x32x16_bf16 v[96:111], v[156:159], a[56:59], v[96:111]
  ds_read_b64_tr_b16 v[140:141], v216 offset:10240
  s_add_u32 s52, s3, 350336
  buffer_load_dwordx4 v217, s[24:27], s52 offen offset:0 lds
  v_mfma_f32_32x32x16_bf16 v[112:127], v[156:159], a[60:63], v[112:127]
  ds_read_b64_tr_b16 v[142:143], v216 offset:11264
  buffer_load_dwordx4 v218, s[24:27], s52 offen offset:1024 lds
  s_add_u32 m0, s51, 8192
  s_waitcnt lgkmcnt(6)
  v_mfma_f32_32x32x16_bf16 v[64:79], v[128:131], a[64:67], v[64:79]
  s_waitcnt vmcnt(21)
  ds_read_b64_tr_b16 v[144:145], v215 offset:12288
  v_mfma_f32_32x32x16_bf16 v[80:95], v[128:131], a[68:71], v[80:95]
  ds_read_b64_tr_b16 v[146:147], v215 offset:13312
  s_waitcnt lgkmcnt(6)
  v_mfma_f32_32x32x16_bf16 v[96:111], v[132:135], a[64:67], v[96:111]
  ds_read_b64_tr_b16 v[148:149], v216 offset:12288
  s_add_u32 s52, s3, 368768
  buffer_load_dwordx4 v217, s[24:27], s52 offen offset:0 lds
  v_mfma_f32_32x32x16_bf16 v[112:127], v[132:135], a[68:71], v[112:127]
  ds_read_b64_tr_b16 v[150:151], v216 offset:13312
  buffer_load_dwordx4 v218, s[24:27], s52 offen offset:1024 lds
  s_add_u32 m0, s51, 10240
  buffer_store_dwordx4 v[172:175], v201, s[32:35], s55 offen offset:256 sc1
  s_waitcnt lgkmcnt(6)
  v_mfma_f32_32x32x16_bf16 v[64:79], v[136:139], a[72:75], v[64:79]
  s_waitcnt vmcnt(22)
  ds_read_b128 a[0:3], v214 offset:0
  ds_read_b64_tr_b16 v[152:153], v215 offset:14336
  v_mfma_f32_32x32x16_bf16 v[80:95], v[136:139], a[76:79], v[80:95]
  ds_read_b64_tr_b16 v[154:155], v215 offset:15360
  s_waitcnt lgkmcnt(7)
  v_mfma_f32_32x32x16_bf16 v[96:111], v[140:143], a[72:75], v[96:111]
  ds_read_b128 a[4:7], v214 offset:1024
  ds_read_b64_tr_b16 v[156:157], v216 offset:14336
  s_add_u32 s52, s3, 387200
  buffer_load_dwordx4 v217, s[24:27], s52 offen offset:0 lds
  v_mfma_f32_32x32x16_bf16 v[112:127], v[140:143], a[76:79], v[112:127]
  ds_read_b64_tr_b16 v[158:159], v216 offset:15360
  buffer_load_dwordx4 v218, s[24:27], s52 offen offset:1024 lds
  s_add_u32 m0, s51, 12288
  s_waitcnt lgkmcnt(8)
  v_mfma_f32_32x32x16_bf16 v[64:79], v[144:147], a[80:83], v[64:79]
  s_waitcnt vmcnt(22)
  ds_read_b128 a[8:11], v214 offset:2048
  ds_read_b64_tr_b16 v[128:129], v215 offset:16384
  v_mfma_f32_32x32x16_bf16 v[80:95], v[144:147], a[84:87], v[80:95]
  ds_read_b64_tr_b16 v[130:131], v215 offset:17408
  s_waitcnt lgkmcnt(9)
  v_mfma_f32_32x32x16_bf16 v[96:111], v[148:151], a[80:83], v[96:111]
  ds_read_b128 a[12:15], v214 offset:3072
  ds_read_b64_tr_b16 v[132:133], v216 offset:16384
  s_add_u32 s52, s3, 405632
  buffer_load_dwordx4 v217, s[24:27], s52 offen offset:0 lds
  v_mfma_f32_32x32x16_bf16 v[112:127], v[148:151], a[84:87], v[112:127]
  ds_read_b64_tr_b16 v[134:135], v216 offset:17408
  buffer_load_dwordx4 v218, s[24:27], s52 offen offset:1024 lds
  s_add_u32 m0, s51, 14336
  buffer_store_dwordx4 v[176:179], v201, s[32:35], s54 offen offset:512 sc1
  s_waitcnt lgkmcnt(9)
  v_mfma_f32_32x32x16_bf16 v[64:79], v[152:155], a[88:91], v[64:79]
  s_waitcnt vmcnt(23)
  ds_read_b128 a[16:19], v214 offset:4096
  ds_read_b64_tr_b16 v[136:137], v215 offset:18432
  v_mfma_f32_32x32x16_bf16 v[80:95], v[152:155], a[92:95], v[80:95]
  ds_read_b64_tr_b16 v[138:139], v215 offset:19456
  s_waitcnt lgkmcnt(9)
  v_mfma_f32_32x32x16_bf16 v[96:111], v[156:159], a[88:91], v[96:111]
  ds_read_b128 a[20:23], v214 offset:5120
  ds_read_b64_tr_b16 v[140:141], v216 offset:18432
  s_add_u32 s52, s3, 424064
  buffer_load_dwordx4 v217, s[24:27], s52 offen offset:0 lds
  v_mfma_f32_32x32x16_bf16 v[112:127], v[156:159], a[92:95], v[112:127]
  ds_read_b64_tr_b16 v[142:143], v216 offset:19456
  buffer_load_dwordx4 v218, s[24:27], s52 offen offset:1024 lds
  s_add_u32 m0, s51, 16384
  s_waitcnt lgkmcnt(9)
  v_mfma_f32_32x32x16_bf16 v[64:79], v[128:131], a[96:99], v[64:79]
  s_waitcnt vmcnt(23)
  ds_read_b128 a[24:27], v214 offset:6144
  ds_read_b64_tr_b16 v[144:145], v215 offset:20480
  v_mfma_f32_32x32x16_bf16 v[80:95], v[128:131], a[100:103], v[80:95]
  ds_read_b64_tr_b16 v[146:147], v215 offset:21504
  s_waitcnt lgkmcnt(9)
  v_mfma_f32_32x32x16_bf16 v[96:111], v[132:135], a[96:99], v[96:111]
  ds_read_b128 a[28:31], v214 offset:7168
  ds_read_b64_tr_b16 v[148:149], v216 offset:20480
  s_add_u32 s52, s3, 442496
  buffer_load_dwordx4 v217, s[24:27], s52 offen offset:0 lds
  v_mfma_f32_32x32x16_bf16 v[112:127], v[132:135], a[100:103], v[112:127]
  ds_read_b64_tr_b16 v[150:151], v216 offset:21504
  buffer_load_dwordx4 v218, s[24:27], s52 offen offset:1024 lds
  s_add_u32 m0, s51, 18432
  buffer_store_dwordx4 v[180:183], v201, s[32:35], s54 offen offset:768 sc1
  s_waitcnt lgkmcnt(9)
  v_mfma_f32_32x32x16_bf16 v[64:79], v[136:139], a[104:107], v[64:79]
  s_waitcnt vmcnt(23)
  ds_read_b128 a[32:35], v214 offset:8192
  ds_read_b64_tr_b16 v[152:153], v215 offset:22528
  v_mfma_f32_32x32x16_bf16 v[80:95], v[136:139], a[108:111], v[80:95]
  ds_read_b64_tr_b16 v[154:155], v215 offset:23552
  s_waitcnt lgkmcnt(9)
  v_mfma_f32_32x32x16_bf16 v[96:111], v[140:143], a[104:107], v[96:111]
  ds_read_b128 a[36:39], v214 offset:9216
  ds_read_b64_tr_b16 v[156:157], v216 offset:22528
  s_add_u32 s52, s3, 460928
  buffer_load_dwordx4 v217, s[24:27], s52 offen offset:0 lds
  v_mfma_f32_32x32x16_bf16 v[112:127], v[140:143], a[108:111], v[112:127]
  ds_read_b64_tr_b16 v[158:159], v216 offset:23552
  buffer_load_dwordx4 v218, s[24:27], s52 offen offset:1024 lds
  s_add_u32 m0, s51, 20480
  s_waitcnt lgkmcnt(9)
  v_mfma_f32_32x32x16_bf16 v[64:79], v[144:147], a[112:115], v[64:79]
  s_waitcnt vmcnt(23)
  ds_read_b128 a[40:43], v214 offset:10240
  ds_read_b64_tr_b16 v[128:129], v215 offset:0
  v_mfma_f32_32x32x16_bf16 v[80:95], v[144:147], a[116:119], v[80:95]
  ds_read_b64_tr_b16 v[130:131], v215 offset:1024
  s_waitcnt lgkmcnt(9)
  v_mfma_f32_32x32x16_bf16 v[96:111], v[148:151], a[112:115], v[96:111]
  ds_read_b128 a[44:47], v214 offset:11264
  ds_read_b64_tr_b16 v[132:133], v216 offset:0
  s_add_u32 s52, s3, 479360
  buffer_load_dwordx4 v217, s[24:27], s52 offen offset:0 lds
  v_mfma_f32_32x32x16_bf16 v[112:127], v[148:151], a[116:119], v[112:127]
  ds_read_b64_tr_b16 v[134:135], v216 offset:1024
  buffer_load_dwordx4 v218, s[24:27], s52 offen offset:1024 lds
  s_add_u32 m0, s51, 22528
  buffer_store_dwordx4 v[184:187], v201, s[32:35], s55 offen offset:512 sc1
  s_waitcnt lgkmcnt(9)
  v_mfma_f32_32x32x16_bf16 v[64:79], v[152:155], a[120:123], v[64:79]
  s_waitcnt vmcnt(23)
  ds_read_b128 a[48:51], v214 offset:12288
  ds_read_b64_tr_b16 v[136:137], v215 offset:2048
  v_mfma_f32_32x32x16_bf16 v[80:95], v[152:155], a[124:127], v[80:95]
  ds_read_b64_tr_b16 v[138:139], v215 offset:3072
  s_waitcnt lgkmcnt(9)
  v_mfma_f32_32x32x16_bf16 v[96:111], v[156:159], a[120:123], v[96:111]
  ds_read_b128 a[52:55], v214 offset:13312
  ds_read_b64_tr_b16 v[140:141], v216 offset:2048
  s_add_u32 s52, s3, 497792
  buffer_load_dwordx4 v217, s[24:27], s52 offen offset:0 lds
  v_mfma_f32_32x32x16_bf16 v[112:127], v[156:159], a[124:127], v[112:127]
  ds_read_b64_tr_b16 v[142:143], v216 offset:3072
  buffer_load_dwordx4 v218, s[24:27], s52 offen offset:1024 lds
  s_add_u32 m0, s51, 0
  s_waitcnt lgkmcnt(9)
  v_mfma_f32_32x32x16_bf16 v[64:79], v[128:131], a[128:131], v[64:79]
  s_waitcnt vmcnt(23)
  ds_read_b128 a[56:59], v214 offset:14336
  ds_read_b64_tr_b16 v[144:145], v215 offset:4096
  v_mfma_f32_32x32x16_bf16 v[80:95], v[128:131], a[132:135], v[80:95]
  ds_read_b64_tr_b16 v[146:147], v215 offset:5120
  s_waitcnt lgkmcnt(9)
  v_mfma_f32_32x32x16_bf16 v[96:111], v[132:135], a[128:131], v[96:111]
  ds_read_b128 a[60:63], v214 offset:15360
  ds_read_b64_tr_b16 v[148:149], v216 offset:4096
  s_add_u32 s52, s3, 516224
  buffer_load_dwordx4 v217, s[24:27], s52 offen offset:0 lds
  v_mfma_f32_32x32x16_bf16 v[112:127], v[132:135], a[132:135], v[112:127]
  ds_read_b64_tr_b16 v[150:151], v216 offset:5120
  buffer_load_dwordx4 v218, s[24:27], s52 offen offset:1024 lds
  s_add_u32 m0, s51, 2048
  buffer_store_dwordx4 v[188:191], v201, s[32:35], s55 offen offset:768 sc1
  s_add_u32 s54, s54, 4096
  s_add_u32 s55, s55, 4096
  s_waitcnt lgkmcnt(9)
  v_mfma_f32_32x32x16_bf16 v[64:79], v[136:139], a[136:139], v[64:79]
  s_waitcnt vmcnt(23)
  ds_read_b64_tr_b16 v[152:153], v215 offset:6144
  v_mfma_f32_32x32x16_bf16 v[80:95], v[136:139], a[140:143], v[80:95]
  ds_read_b64_tr_b16 v[154:155], v215 offset:7168
  s_waitcnt lgkmcnt(8)
  v_mfma_f32_32x32x16_bf16 v[96:111], v[140:143], a[136:139], v[96:111]
  ds_read_b64_tr_b16 v[156:157], v216 offset:6144
  s_add_u32 s52, s3, 534656
  buffer_load_dwordx4 v217, s[24:27], s52 offen offset:0 lds
  v_mfma_f32_32x32x16_bf16 v[112:127], v[140:143], a[140:143], v[112:127]
  ds_read_b64_tr_b16 v[158:159], v216 offset:7168
  buffer_load_dwordx4 v218, s[24:27], s52 offen offset:1024 lds
  s_add_u32 m0, s51, 4096
  s_waitcnt lgkmcnt(7)
  v_mfma_f32_32x32x16_bf16 v[64:79], v[144:147], a[144:147], v[64:79]
  s_waitcnt vmcnt(23)
  ds_read_b64_tr_b16 v[128:129], v215 offset:8192
  v_mfma_f32_32x32x16_bf16 v[80:95], v[144:147], a[148:151], v[80:95]
  ds_read_b64_tr_b16 v[130:131], v215 offset:9216
  s_waitcnt lgkmcnt(6)
  v_mfma_f32_32x32x16_bf16 v[96:111], v[148:151], a[144:147], v[96:111]
  ds_read_b64_tr_b16 v[132:133], v216 offset:8192
  s_add_u32 s52, s3, 553088
  buffer_load_dwordx4 v217, s[24:27], s52 offen offset:0 lds
  v_mfma_f32_32x32x16_bf16 v[112:127], v[148:151], a[148:151], v[112:127]
  ds_read_b64_tr_b16 v[134:135], v216 offset:9216
  buffer_load_dwordx4 v218, s[24:27], s52 offen offset:1024 lds
  s_add_u32 m0, s51, 6144
  s_waitcnt lgkmcnt(6)
  v_mfma_f32_32x32x16_bf16 v[64:79], v[152:155], a[152:155], v[64:79]
  s_waitcnt vmcnt(22)
  ds_read_b64_tr_b16 v[136:137], v215 offset:10240
  v_mfma_f32_32x32x16_bf16 v[80:95], v[152:155], a[156:159], v[80:95]
  ds_read_b64_tr_b16 v[138:139], v215 offset:11264
  s_waitcnt lgkmcnt(6)
  v_mfma_f32_32x32x16_bf16 v[96:111], v[156:159], a[152:155], v[96:111]
  ds_read_b64_tr_b16 v[140:141], v216 offset:10240
  s_add_u32 s52, s3, 571520
  buffer_load_dwordx4 v217, s[24:27], s52 offen offset:0 lds
  v_mfma_f32_32x32x16_bf16 v[112:127], v[156:159], a[156:159], v[112:127]
  ds_read_b64_tr_b16 v[142:143], v216 offset:11264
  buffer_load_dwordx4 v218, s[24:27], s52 offen offset:1024 lds
  s_add_u32 m0, s51, 8192
  s_waitcnt lgkmcnt(6)
  v_mfma_f32_32x32x16_bf16 v[64:79], v[128:131], a[160:163], v[64:79]
  s_waitcnt vmcnt(22)
  ds_read_b64_tr_b16 v[144:145], v215 offset:12288
  v_mfma_f32_32x32x16_bf16 v[80:95], v[128:131], a[164:167], v[80:95]
  ds_read_b64_tr_b16 v[146:147], v215 offset:13312
  s_waitcnt lgkmcnt(6)
  v_mfma_f32_32x32x16_bf16 v[96:111], v[132:135], a[160:163], v[96:111]
  ds_read_b64_tr_b16 v[148:149], v216 offset:12288
  s_add_u32 s52, s100, 0
  buffer_load_dwordx4 v217, s[24:27], s52 offen offset:0 lds
  v_mfma_f32_32x32x16_bf16 v[112:127], v[132:135], a[164:167], v[112:127]
  ds_read_b64_tr_b16 v[150:151], v216 offset:13312
  buffer_load_dwordx4 v218, s[24:27], s52 offen offset:1024 lds
  s_add_u32 m0, s51, 10240
  s_waitcnt lgkmcnt(6)
  v_mfma_f32_32x32x16_bf16 v[64:79], v[136:139], a[168:171], v[64:79]
  s_waitcnt vmcnt(21)
  ds_read_b64_tr_b16 v[152:153], v215 offset:14336
  v_mfma_f32_32x32x16_bf16 v[80:95], v[136:139], a[172:175], v[80:95]
  ds_read_b64_tr_b16 v[154:155], v215 offset:15360
  s_waitcnt lgkmcnt(6)
  v_mfma_f32_32x32x16_bf16 v[96:111], v[140:143], a[168:171], v[96:111]
  ds_read_b64_tr_b16 v[156:157], v216 offset:14336
  s_add_u32 s52, s100, 18432
  buffer_load_dwordx4 v217, s[24:27], s52 offen offset:0 lds
  v_mfma_f32_32x32x16_bf16 v[112:127], v[140:143], a[172:175], v[112:127]
  ds_read_b64_tr_b16 v[158:159], v216 offset:15360
  buffer_load_dwordx4 v218, s[24:27], s52 offen offset:1024 lds
  s_add_u32 m0, s51, 12288
  s_waitcnt lgkmcnt(6)
  v_mfma_f32_32x32x16_bf16 v[64:79], v[144:147], a[176:179], v[64:79]
  s_waitcnt vmcnt(21)
  ds_read_b64_tr_b16 v[128:129], v215 offset:16384
  v_mfma_f32_32x32x16_bf16 v[80:95], v[144:147], a[180:183], v[80:95]
  ds_read_b64_tr_b16 v[130:131], v215 offset:17408
  s_waitcnt lgkmcnt(6)
  v_mfma_f32_32x32x16_bf16 v[96:111], v[148:151], a[176:179], v[96:111]
  ds_read_b64_tr_b16 v[132:133], v216 offset:16384
  s_add_u32 s52, s100, 36864
  buffer_load_dwordx4 v217, s[24:27], s52 offen offset:0 lds
  v_mfma_f32_32x32x16_bf16 v[112:127], v[148:151], a[180:183], v[112:127]
  ds_read_b64_tr_b16 v[134:135], v216 offset:17408
  buffer_load_dwordx4 v218, s[24:27], s52 offen offset:1024 lds
  s_add_u32 m0, s51, 14336
  s_waitcnt lgkmcnt(6)
  v_mfma_f32_32x32x16_bf16 v[64:79], v[152:155], a[184:187], v[64:79]
  s_waitcnt vmcnt(20)
  ds_read_b64_tr_b16 v[136:137], v215 offset:18432
  v_mfma_f32_32x32x16_bf16 v[80:95], v[152:155], a[188:191], v[80:95]
  ds_read_b64_tr_b16 v[138:139], v215 offset:19456
  s_waitcnt lgkmcnt(6)
  v_mfma_f32_32x32x16_bf16 v[96:111], v[156:159], a[184:187], v[96:111]
  ds_read_b64_tr_b16 v[140:141], v216 offset:18432
  s_add_u32 s52, s100, 55296
  buffer_load_dwordx4 v217, s[24:27], s52 offen offset:0 lds
  v_mfma_f32_32x32x16_bf16 v[112:127], v[156:159], a[188:191], v[112:127]
  ds_read_b64_tr_b16 v[142:143], v216 offset:19456
  buffer_load_dwordx4 v218, s[24:27], s52 offen offset:1024 lds
  s_add_u32 m0, s51, 16384
  s_waitcnt lgkmcnt(6)
  v_mfma_f32_32x32x16_bf16 v[64:79], v[128:131], a[192:195], v[64:79]
  s_waitcnt vmcnt(20)
  ds_read_b64_tr_b16 v[144:145], v215 offset:20480
  v_mfma_f32_32x32x16_bf16 v[80:95], v[128:131], a[196:199], v[80:95]
  ds_read_b64_tr_b16 v[146:147], v215 offset:21504
  s_waitcnt lgkmcnt(6)
  v_mfma_f32_32x32x16_bf16 v[96:111], v[132:135], a[192:195], v[96:111]
  ds_read_b64_tr_b16 v[148:149], v216 offset:20480
  s_add_u32 s52, s100, 73728
  buffer_load_dwordx4 v217, s[24:27], s52 offen offset:0 lds
  v_mfma_f32_32x32x16_bf16 v[112:127], v[132:135], a[196:199], v[112:127]
  ds_read_b64_tr_b16 v[150:151], v216 offset:21504
  buffer_load_dwordx4 v218, s[24:27], s52 offen offset:1024 lds
  s_add_u32 m0, s51, 18432
  s_waitcnt lgkmcnt(6)
  v_mfma_f32_32x32x16_bf16 v[64:79], v[136:139], a[200:203], v[64:79]
  s_waitcnt vmcnt(19)
  ds_read_b64_tr_b16 v[152:153], v215 offset:22528
  v_mfma_f32_32x32x16_bf16 v[80:95], v[136:139], a[204:207], v[80:95]
  ds_read_b64_tr_b16 v[154:155], v215 offset:23552
  s_waitcnt lgkmcnt(6)
  v_mfma_f32_32x32x16_bf16 v[96:111], v[140:143], a[200:203], v[96:111]
  ds_read_b64_tr_b16 v[156:157], v216 offset:22528
  s_add_u32 s52, s100, 92160
  buffer_load_dwordx4 v217, s[24:27], s52 offen offset:0 lds
  v_mfma_f32_32x32x16_bf16 v[112:127], v[140:143], a[204:207], v[112:127]
  ds_read_b64_tr_b16 v[158:159], v216 offset:23552
  buffer_load_dwordx4 v218, s[24:27], s52 offen offset:1024 lds
  s_add_u32 m0, s51, 20480
  s_waitcnt lgkmcnt(6)
  v_mfma_f32_32x32x16_bf16 v[64:79], v[144:147], a[208:211], v[64:79]
  s_waitcnt vmcnt(19)
  ds_read_b64_tr_b16 v[128:129], v215 offset:0
  v_mfma_f32_32x32x16_bf16 v[80:95], v[144:147], a[212:215], v[80:95]
  ds_read_b64_tr_b16 v[130:131], v215 offset:1024
  s_waitcnt lgkmcnt(6)
  v_mfma_f32_32x32x16_bf16 v[96:111], v[148:151], a[208:211], v[96:111]
  ds_read_b64_tr_b16 v[132:133], v216 offset:0
  s_add_u32 s52, s100, 110592
  buffer_load_dwordx4 v217, s[24:27], s52 offen offset:0 lds
  v_mfma_f32_32x32x16_bf16 v[112:127], v[148:151], a[212:215], v[112:127]
  ds_read_b64_tr_b16 v[134:135], v216 offset:1024
  buffer_load_dwordx4 v218, s[24:27], s52 offen offset:1024 lds
  s_add_u32 m0, s51, 22528
  s_waitcnt lgkmcnt(6)
  v_mfma_f32_32x32x16_bf16 v[64:79], v[152:155], a[216:219], v[64:79]
  s_waitcnt vmcnt(18)
  ds_read_b64_tr_b16 v[136:137], v215 offset:2048
  v_mfma_f32_32x32x16_bf16 v[80:95], v[152:155], a[220:223], v[80:95]
  ds_read_b64_tr_b16 v[138:139], v215 offset:3072
  s_waitcnt lgkmcnt(6)
  v_mfma_f32_32x32x16_bf16 v[96:111], v[156:159], a[216:219], v[96:111]
  ds_read_b64_tr_b16 v[140:141], v216 offset:2048
  s_add_u32 s52, s100, 129024
  buffer_load_dwordx4 v217, s[24:27], s52 offen offset:0 lds
  v_mfma_f32_32x32x16_bf16 v[112:127], v[156:159], a[220:223], v[112:127]
  ds_read_b64_tr_b16 v[142:143], v216 offset:3072
  buffer_load_dwordx4 v218, s[24:27], s52 offen offset:1024 lds
  s_waitcnt lgkmcnt(6)
  v_mfma_f32_32x32x16_bf16 v[64:79], v[128:131], a[224:227], v[64:79]
  s_waitcnt vmcnt(18)
  ds_read_b64_tr_b16 v[144:145], v215 offset:4096
  v_mfma_f32_32x32x16_bf16 v[80:95], v[128:131], a[228:231], v[80:95]
  ds_read_b64_tr_b16 v[146:147], v215 offset:5120
  s_waitcnt lgkmcnt(6)
  v_mfma_f32_32x32x16_bf16 v[96:111], v[132:135], a[224:227], v[96:111]
  ds_read_b64_tr_b16 v[148:149], v216 offset:4096
  v_mfma_f32_32x32x16_bf16 v[112:127], v[132:135], a[228:231], v[112:127]
  ds_read_b64_tr_b16 v[150:151], v216 offset:5120
  s_waitcnt lgkmcnt(6)
  v_mfma_f32_32x32x16_bf16 v[64:79], v[136:139], a[232:235], v[64:79]
  s_waitcnt vmcnt(16)
  ds_read_b64_tr_b16 v[152:153], v215 offset:6144
  v_mfma_f32_32x32x16_bf16 v[80:95], v[136:139], a[236:239], v[80:95]
  ds_read_b64_tr_b16 v[154:155], v215 offset:7168
  s_waitcnt lgkmcnt(6)
  v_mfma_f32_32x32x16_bf16 v[96:111], v[140:143], a[232:235], v[96:111]
  ds_read_b64_tr_b16 v[156:157], v216 offset:6144
  v_mfma_f32_32x32x16_bf16 v[112:127], v[140:143], a[236:239], v[112:127]
  ds_read_b64_tr_b16 v[158:159], v216 offset:7168
  s_waitcnt lgkmcnt(6)
  v_mfma_f32_32x32x16_bf16 v[64:79], v[144:147], a[240:243], v[64:79]
  s_waitcnt vmcnt(14)
  ds_read_b64_tr_b16 v[128:129], v215 offset:8192
  v_mfma_f32_32x32x16_bf16 v[80:95], v[144:147], a[244:247], v[80:95]
  ds_read_b64_tr_b16 v[130:131], v215 offset:9216
  s_waitcnt lgkmcnt(6)
  v_mfma_f32_32x32x16_bf16 v[96:111], v[148:151], a[240:243], v[96:111]
  s_waitcnt vmcnt(12)
  ds_read_b64_tr_b16 v[132:133], v215 offset:10240
  v_mfma_f32_32x32x16_bf16 v[112:127], v[148:151], a[244:247], v[112:127]
  ds_read_b64_tr_b16 v[134:135], v215 offset:11264
  s_waitcnt lgkmcnt(6)
  v_mfma_f32_32x32x16_bf16 v[64:79], v[152:155], a[248:251], v[64:79]
  s_waitcnt vmcnt(10)
  ds_read_b64_tr_b16 v[136:137], v215 offset:12288
  v_mfma_f32_32x32x16_bf16 v[80:95], v[152:155], a[252:255], v[80:95]
  ds_read_b64_tr_b16 v[138:139], v215 offset:13312
  s_waitcnt lgkmcnt(6)
  v_mfma_f32_32x32x16_bf16 v[96:111], v[156:159], a[248:251], v[96:111]
  s_waitcnt vmcnt(8)
  ds_read_b64_tr_b16 v[140:141], v215 offset:14336
  v_mfma_f32_32x32x16_bf16 v[112:127], v[156:159], a[252:255], v[112:127]
  ds_read_b64_tr_b16 v[142:143], v215 offset:15360
  s_add_u32 s92, s95, 0
  buffer_load_dwordx4 v[224:227], v204, s[32:35], s92 offen sc1
  s_waitcnt lgkmcnt(6)
  v_mfma_f32_32x32x16_bf16 v[0:15], v[128:131], a[0:3], 0
  s_waitcnt vmcnt(7)
  ds_read_b64_tr_b16 v[144:145], v215 offset:16384
  s_add_u32 s92, s95, 9216
  buffer_load_dwordx4 v[228:231], v204, s[32:35], s92 offen sc1
  v_mfma_f32_32x32x16_bf16 v[16:31], v[128:131], a[4:7], 0
  ds_read_b64_tr_b16 v[146:147], v215 offset:17408
  s_add_u32 s92, s95, 18432
  buffer_load_dwordx4 v[232:235], v204, s[32:35], s92 offen sc1
  s_waitcnt lgkmcnt(6)
  v_mfma_f32_32x32x16_bf16 v[0:15], v[132:135], a[8:11], v[0:15]
  s_waitcnt vmcnt(7)
  ds_read_b64_tr_b16 v[148:149], v215 offset:18432
  s_add_u32 s92, s95, 27648
  buffer_load_dwordx4 v[236:239], v204, s[32:35], s92 offen sc1
  v_mfma_f32_32x32x16_bf16 v[16:31], v[132:135], a[12:15], v[16:31]
  ds_read_b64_tr_b16 v[150:151], v215 offset:19456
  s_add_u32 s92, s95, 36864
  buffer_load_dwordx4 v[240:243], v204, s[32:35], s92 offen sc1
  s_waitcnt lgkmcnt(6)
  v_mfma_f32_32x32x16_bf16 v[0:15], v[136:139], a[16:19], v[0:15]
  s_waitcnt vmcnt(7)
  ds_read_b64_tr_b16 v[152:153], v215 offset:20480
  s_add_u32 s92, s95, 46080
  buffer_load_dwordx4 v[244:247], v204, s[32:35], s92 offen sc1
  v_mfma_f32_32x32x16_bf16 v[16:31], v[136:139], a[20:23], v[16:31]
  ds_read_b64_tr_b16 v[154:155], v215 offset:21504
  s_add_u32 s92, s95, 55296
  buffer_load_dwordx4 v[248:251], v204, s[32:35], s92 offen sc1
  s_waitcnt lgkmcnt(6)
  v_mfma_f32_32x32x16_bf16 v[0:15], v[140:143], a[24:27], v[0:15]
  s_waitcnt vmcnt(7)
  ds_read_b64_tr_b16 v[156:157], v215 offset:22528
  s_add_u32 s92, s95, 64512
  buffer_load_dwordx4 v[252:255], v204, s[32:35], s92 offen sc1
  v_mfma_f32_32x32x16_bf16 v[16:31], v[140:143], a[28:31], v[16:31]
  ds_read_b64_tr_b16 v[158:159], v215 offset:23552
  s_waitcnt lgkmcnt(6)
  v_mfma_f32_32x32x16_bf16 v[0:15], v[144:147], a[32:35], v[0:15]
  ds_read_b64_tr_b16 v[128:129], v216 offset:8192
  v_cvt_pk_bf16_f32 v160, v64, v65
  v_cvt_pk_bf16_f32 v161, v66, v67
  v_and_b32 v160, 0xfffffffe, v160
  v_cvt_pk_bf16_f32 v162, v68, v69
  v_mfma_f32_32x32x16_bf16 v[16:31], v[144:147], a[36:39], v[16:31]
  ds_read_b64_tr_b16 v[130:131], v216 offset:9216
  v_cvt_pk_bf16_f32 v163, v70, v71
  v_cvt_pk_bf16_f32 v164, v72, v73
  v_cvt_pk_bf16_f32 v165, v74, v75
  v_and_b32 v164, 0xfffffffe, v164
  s_waitcnt lgkmcnt(6)
  v_mfma_f32_32x32x16_bf16 v[0:15], v[148:151], a[40:43], v[0:15]
  ds_read_b64_tr_b16 v[132:133], v216 offset:10240
  v_cvt_pk_bf16_f32 v166, v76, v77
  v_cvt_pk_bf16_f32 v167, v78, v79
  buffer_store_dwordx4 v[160:163], v201, s[32:35], s54 offen offset:0 sc1
  buffer_store_dwordx4 v[164:167], v201, s[32:35], s54 offen offset:256 sc1
  v_mfma_f32_32x32x16_bf16 v[16:31], v[148:151], a[44:47], v[16:31]
  ds_read_b64_tr_b16 v[134:135], v216 offset:11264
  v_cvt_pk_bf16_f32 v168, v80, v81
  v_cvt_pk_bf16_f32 v169, v82, v83
  v_and_b32 v168, 0xfffffffe, v168
  v_cvt_pk_bf16_f32 v170, v84, v85
  s_waitcnt lgkmcnt(6)
  v_mfma_f32_32x32x16_bf16 v[0:15], v[152:155], a[48:51], v[0:15]
  ds_read_b64_tr_b16 v[136:137], v216 offset:12288
  v_cvt_pk_bf16_f32 v171, v86, v87
  v_cvt_pk_bf16_f32 v172, v88, v89
  v_cvt_pk_bf16_f32 v173, v90, v91
  v_and_b32 v172, 0xfffffffe, v172
  v_mfma_f32_32x32x16_bf16 v[16:31], v[152:155], a[52:55], v[16:31]
  ds_read_b64_tr_b16 v[138:139], v216 offset:13312
  v_cvt_pk_bf16_f32 v174, v92, v93
  v_cvt_pk_bf16_f32 v175, v94, v95
  buffer_store_dwordx4 v[168:171], v201, s[32:35], s55 offen offset:0 sc1
  buffer_store_dwordx4 v[172:175], v201, s[32:35], s55 offen offset:256 sc1
  s_waitcnt lgkmcnt(6)
  v_mfma_f32_32x32x16_bf16 v[0:15], v[156:159], a[56:59], v[0:15]
  ds_read_b64_tr_b16 v[140:141], v216 offset:14336
  v_cvt_pk_bf16_f32 v176, v96, v97
  v_cvt_pk_bf16_f32 v177, v98, v99
  v_and_b32 v176, 0xfffffffe, v176
  v_cvt_pk_bf16_f32 v178, v100, v101
  v_mfma_f32_32x32x16_bf16 v[16:31], v[156:159], a[60:63], v[16:31]
  ds_read_b64_tr_b16 v[142:143], v216 offset:15360
  v_cvt_pk_bf16_f32 v179, v102, v103
  v_cvt_pk_bf16_f32 v180, v104, v105
  v_cvt_pk_bf16_f32 v181, v106, v107
  v_and_b32 v180, 0xfffffffe, v180
  s_waitcnt lgkmcnt(6)
  v_mfma_f32_32x32x16_bf16 v[32:47], v[128:131], a[0:3], 0
  ds_read_b64_tr_b16 v[144:145], v216 offset:16384
  v_cvt_pk_bf16_f32 v182, v108, v109
  v_cvt_pk_bf16_f32 v183, v110, v111
  buffer_store_dwordx4 v[176:179], v201, s[32:35], s54 offen offset:512 sc1
  buffer_store_dwordx4 v[180:183], v201, s[32:35], s54 offen offset:768 sc1
  s_barrier
  v_mfma_f32_32x32x16_bf16 v[48:63], v[128:131], a[4:7], 0
  ds_read_b64_tr_b16 v[146:147], v216 offset:17408
  v_cvt_pk_bf16_f32 v184, v112, v113
  v_cvt_pk_bf16_f32 v185, v114, v115
  v_and_b32 v184, 0xfffffffe, v184
  v_cvt_pk_bf16_f32 v186, v116, v117
  s_waitcnt lgkmcnt(6)
  v_mfma_f32_32x32x16_bf16 v[32:47], v[132:135], a[8:11], v[32:47]
  ds_read_b64_tr_b16 v[148:149], v216 offset:18432
  v_cvt_pk_bf16_f32 v187, v118, v119
  v_cvt_pk_bf16_f32 v188, v120, v121
  v_cvt_pk_bf16_f32 v189, v122, v123
  v_and_b32 v188, 0xfffffffe, v188
  ds_write_b128 v203, v[0:3] offset:0
  ds_write_b128 v203, v[4:7] offset:1024
  v_mfma_f32_32x32x16_bf16 v[48:63], v[132:135], a[12:15], v[48:63]
  ds_read_b64_tr_b16 v[150:151], v216 offset:19456
  v_cvt_pk_bf16_f32 v190, v124, v125
  v_cvt_pk_bf16_f32 v191, v126, v127
  buffer_store_dwordx4 v[184:187], v201, s[32:35], s55 offen offset:512 sc1
  buffer_store_dwordx4 v[188:191], v201, s[32:35], s55 offen offset:768 sc1
  ds_write_b128 v203, v[8:11] offset:2048
  ds_write_b128 v203, v[12:15] offset:3072
  s_waitcnt lgkmcnt(10)
  v_mfma_f32_32x32x16_bf16 v[32:47], v[136:139], a[16:19], v[32:47]
  ds_read_b64_tr_b16 v[152:153], v216 offset:20480
  s_add_u32 s54, s54, 4096
  s_add_u32 s55, s55, 4096
  ds_write_b128 v203, v[16:19] offset:4096
  ds_write_b128 v203, v[20:23] offset:5120
  ds_write_b128 v203, v[24:27] offset:6144
  ds_write_b128 v203, v[28:31] offset:7168
  v_mfma_f32_32x32x16_bf16 v[48:63], v[136:139], a[20:23], v[48:63]
  ds_read_b64_tr_b16 v[154:155], v216 offset:21504
  s_waitcnt lgkmcnt(14)
  v_mfma_f32_32x32x16_bf16 v[32:47], v[140:143], a[24:27], v[32:47]
  ds_read_b64_tr_b16 v[156:157], v216 offset:22528
  v_mfma_f32_32x32x16_bf16 v[48:63], v[140:143], a[28:31], v[48:63]
  ds_read_b64_tr_b16 v[158:159], v216 offset:23552
  s_waitcnt lgkmcnt(14)
  v_mfma_f32_32x32x16_bf16 v[32:47], v[144:147], a[32:35], v[32:47]
  v_mfma_f32_32x32x16_bf16 v[48:63], v[144:147], a[36:39], v[48:63]
  s_waitcnt lgkmcnt(10)
  v_mfma_f32_32x32x16_bf16 v[32:47], v[148:151], a[40:43], v[32:47]
  v_mfma_f32_32x32x16_bf16 v[48:63], v[148:151], a[44:47], v[48:63]
  s_waitcnt lgkmcnt(2)
  v_mfma_f32_32x32x16_bf16 v[32:47], v[152:155], a[48:51], v[32:47]
  v_mfma_f32_32x32x16_bf16 v[48:63], v[152:155], a[52:55], v[48:63]
  s_waitcnt lgkmcnt(0)
  v_mfma_f32_32x32x16_bf16 v[32:47], v[156:159], a[56:59], v[32:47]
  v_mfma_f32_32x32x16_bf16 v[48:63], v[156:159], a[60:63], v[48:63]
  s_nop 10
  ds_write_b128 v203, v[32:35] offset:8192
  ds_write_b128 v203, v[36:39] offset:9216
  ds_write_b128 v203, v[40:43] offset:10240
  ds_write_b128 v203, v[44:47] offset:11264
  ds_write_b128 v203, v[48:51] offset:12288
  ds_write_b128 v203, v[52:55] offset:13312
  ds_write_b128 v203, v[56:59] offset:14336
  ds_write_b128 v203, v[60:63] offset:15360
  v_and_b32 v220, 7, v200
  v_bfe_u32 v221, v200, 3, 1
  v_lshrrev_b32 v213, 4, v200
  v_mov_b32 v219, 2130706432
  v_cmp_gt_u32 vcc, 16, v200
  s_mov_b32 s36, s10
  s_mov_b32 s37, s11
  s_mov_b32 s38, 2359296
  s_mov_b32 s39, 0x00020000
  s_add_u32 s40, s12, 59768832
  s_addc_u32 s41, s13, 0
  s_mov_b32 s42, 2359296
  s_mov_b32 s43, 0x00020000
  s_add_u32 s44, s12, 56623104
  s_addc_u32 s45, s13, 0
  s_mov_b32 s46, 2359296
  s_mov_b32 s47, 0x00020000
  s_lshl_b32 s92, s49, 3
  s_add_u32 s92, s92, s50
  s_mul_i32 s92, s92, 9216
  v_mul_u32_u24 v208, 1152, v220
  v_add_u32 v208, s92, v208
  v_mul_u32_u24 v207, 8, v221
  v_add_u32 v208, v208, v207
  v_lshl_add_u32 v207, v213, 5, v208
  s_lshl_b32 s92, s48, 8
  v_add_u32 v207, s92, v207
  s_lshl_b32 s92, s48, 5
  s_add_u32 s92, s92, 1024
  v_add_u32 v208, s92, v208
  v_cndmask_b32 v208, v219, v208, vcc
  s_lshr_b32 s92, s50, 2
  s_lshl_b32 s93, s49, 1
  s_add_u32 s92, s92, s93
  s_mul_i32 s92, s92, 36864
  s_and_b32 s93, s50, 3
  s_lshl_b32 s93, s93, 7
  s_add_u32 s92, s92, s93
  v_lshlrev_b32 v210, 9, v221
  v_lshl_add_u32 v210, v220, 4, v210
  v_add_u32 v210, s92, v210
  v_lshl_add_u32 v209, v213, 10, v210
  s_lshl_b32 s92, s48, 13
  v_add_u32 v209, s92, v209
  s_lshl_b32 s92, s48, 10
  s_add_u32 s92, s92, 32768
  v_add_u32 v210, s92, v210
  v_cndmask_b32 v210, v219, v210, vcc
  s_waitcnt lgkmcnt(0)
  s_barrier
  ds_read_b128 v[0:3], v202 offset:0
  ds_read_b128 v[4:7], v202 offset:1024
  ds_read_b128 v[8:11], v202 offset:2048
  ds_read_b128 v[12:15], v202 offset:3072
  ds_read_b128 v[16:19], v202 offset:16384
  ds_read_b128 v[20:23], v202 offset:17408
  ds_read_b128 v[24:27], v202 offset:18432
  ds_read_b128 v[28:31], v202 offset:19456
  ds_read_b128 v[32:35], v202 offset:32768
  ds_read_b128 v[36:39], v202 offset:33792
  ds_read_b128 v[40:43], v202 offset:34816
  ds_read_b128 v[44:47], v202 offset:35840
  ds_read_b128 v[48:51], v202 offset:49152
  ds_read_b128 v[52:55], v202 offset:50176
  ds_read_b128 v[56:59], v202 offset:51200
  ds_read_b128 v[60:63], v202 offset:52224
  s_lshl_b32 s92, s49, 3
  s_add_u32 s92, s92, s50
  s_mul_i32 s55, s92, 9216
  s_add_u32 s54, s55, 4096
  s_mov_b32 s58, 0x00003f80
  s_mov_b32 s59, 0x3f800000
  s_waitcnt lgkmcnt(11)
  v_add_f32 v0, v0, v16
  v_add_f32 v1, v1, v17
  v_add_f32 v2, v2, v18
  v_add_f32 v3, v3, v19
  s_waitcnt lgkmcnt(10)
  v_add_f32 v4, v4, v20
  v_add_f32 v5, v5, v21
  v_add_f32 v6, v6, v22
  v_add_f32 v7, v7, v23
  s_waitcnt lgkmcnt(9)
  v_add_f32 v8, v8, v24
  v_add_f32 v9, v9, v25
  v_add_f32 v10, v10, v26
  v_add_f32 v11, v11, v27
  s_waitcnt lgkmcnt(8)
  v_add_f32 v12, v12, v28
  v_add_f32 v13, v13, v29
  v_add_f32 v14, v14, v30
  v_add_f32 v15, v15, v31
  s_waitcnt lgkmcnt(3)
  v_add_f32 v32, v32, v48
  v_add_f32 v33, v33, v49
  v_add_f32 v34, v34, v50
  v_add_f32 v35, v35, v51
  s_waitcnt lgkmcnt(2)
  v_add_f32 v36, v36, v52
  v_add_f32 v37, v37, v53
  v_add_f32 v38, v38, v54
  v_add_f32 v39, v39, v55
  s_waitcnt lgkmcnt(1)
  v_add_f32 v40, v40, v56
  v_add_f32 v41, v41, v57
  v_add_f32 v42, v42, v58
  v_add_f32 v43, v43, v59
  s_waitcnt lgkmcnt(0)
  v_add_f32 v44, v44, v60
  v_add_f32 v45, v45, v61
  v_add_f32 v46, v46, v62
  v_add_f32 v47, v47, v63
  v_add_f32 v0, v0, v32
  v_add_f32 v1, v1, v33
  v_add_f32 v2, v2, v34
  v_add_f32 v3, v3, v35
  v_add_f32 v4, v4, v36
  v_add_f32 v5, v5, v37
  v_add_f32 v6, v6, v38
  v_add_f32 v7, v7, v39
  v_add_f32 v8, v8, v40
  v_add_f32 v9, v9, v41
  v_add_f32 v10, v10, v42
  v_add_f32 v11, v11, v43
  v_add_f32 v12, v12, v44
  v_add_f32 v13, v13, v45
  v_add_f32 v14, v14, v46
  v_add_f32 v15, v15, v47
  v_cvt_pk_bf16_f32 v192, v0, v1
  v_cvt_pk_bf16_f32 v193, v2, v3
  v_and_b32 v192, 0xfffffffe, v192
  v_cvt_pk_bf16_f32 v194, v4, v5
  v_cvt_pk_bf16_f32 v195, v6, v7
  v_cvt_pk_bf16_f32 v196, v8, v9
  v_cvt_pk_bf16_f32 v197, v10, v11
  v_and_b32 v196, 0xfffffffe, v196
  v_cvt_pk_bf16_f32 v198, v12, v13
  v_cvt_pk_bf16_f32 v199, v14, v15
  buffer_store_dwordx4 v[192:195], v201, s[32:35], s56 offen offset:0 sc1
  buffer_store_dwordx4 v[196:199], v201, s[32:35], s56 offen offset:256 sc1
  buffer_load_dwordx2 v[160:161], v207, s[36:39], 0 offen offset:0
  buffer_load_dwordx2 v[162:163], v207, s[36:39], 0 offen offset:16
  buffer_load_dwordx2 v[164:165], v207, s[36:39], 0 offen offset:128
  buffer_load_dwordx2 v[166:167], v207, s[36:39], 0 offen offset:144
  buffer_load_dwordx2 v[168:169], v208, s[36:39], 0 offen offset:0
  buffer_load_dwordx2 v[170:171], v208, s[36:39], 0 offen offset:16
  s_waitcnt vmcnt(21)
  v_or3_b32 v219, v224, v228, v232
  s_waitcnt vmcnt(19)
  v_or3_b32 v219, v219, v236, v240
  s_waitcnt vmcnt(17)
  v_or3_b32 v219, v219, v244, v248
  s_waitcnt vmcnt(16)
  v_or_b32 v219, v219, v252
  v_and_b32 v219, 1, v219
  v_cmp_eq_u32 vcc, 1, v219
  s_cmp_ge_u32 s57, 16384
  s_nop 2
  s_cbranch_scc1 K3_AOK
  s_cbranch_vccz K3_AOK
K3_AP:
  s_add_u32 s92, s95, 0
  buffer_load_dword v219, v206, s[32:35], s92 offen sc1
  s_add_u32 s57, s57, 1
  s_waitcnt vmcnt(0)
  v_and_b32 v219, 1, v219
  v_cmp_eq_u32 vcc, 1, v219
  s_cmp_ge_u32 s57, 16384
  s_cbranch_scc1 K3_AP_GO
  s_nop 2
  s_cbranch_vccnz K3_AP
K3_AP_GO:
  s_add_u32 s92, s95, 0
  buffer_load_dwordx4 v[224:227], v204, s[32:35], s92 offen sc1
  s_add_u32 s92, s95, 9216
  buffer_load_dwordx4 v[228:231], v204, s[32:35], s92 offen sc1
  s_add_u32 s92, s95, 18432
  buffer_load_dwordx4 v[232:235], v204, s[32:35], s92 offen sc1
  s_add_u32 s92, s95, 27648
  buffer_load_dwordx4 v[236:239], v204, s[32:35], s92 offen sc1
  s_add_u32 s92, s95, 36864
  buffer_load_dwordx4 v[240:243], v204, s[32:35], s92 offen sc1
  s_add_u32 s92, s95, 46080
  buffer_load_dwordx4 v[244:247], v204, s[32:35], s92 offen sc1
  s_add_u32 s92, s95, 55296
  buffer_load_dwordx4 v[248:251], v204, s[32:35], s92 offen sc1
  s_add_u32 s92, s95, 64512
  buffer_load_dwordx4 v[252:255], v204, s[32:35], s92 offen sc1
  s_waitcnt vmcnt(0)
  v_or3_b32 v219, v224, v228, v232
  v_or3_b32 v219, v219, v236, v240
  v_or3_b32 v219, v219, v244, v248
  v_or_b32 v219, v219, v252
  v_and_b32 v219, 1, v219
  v_cmp_eq_u32 vcc, 1, v219
  s_cmp_ge_u32 s57, 16384
  s_nop 2
  s_cbranch_scc1 K3_AOK
  s_cbranch_vccnz K3_AP
K3_AOK:
  v_lshlrev_b32 v128, 16, v224
  v_and_b32 v129, 0xffff0000, v224
  v_lshlrev_b32 v130, 16, v225
  v_and_b32 v131, 0xffff0000, v225
  v_lshlrev_b32 v132, 16, v226
  v_and_b32 v133, 0xffff0000, v226
  v_lshlrev_b32 v134, 16, v227
  v_and_b32 v135, 0xffff0000, v227
  v_dot2c_f32_bf16 v128, s58, v228
  v_dot2c_f32_bf16 v129, s59, v228
  v_dot2c_f32_bf16 v130, s58, v229
  v_dot2c_f32_bf16 v131, s59, v229
  v_dot2c_f32_bf16 v132, s58, v230
  v_dot2c_f32_bf16 v133, s59, v230
  v_dot2c_f32_bf16 v134, s58, v231
  v_dot2c_f32_bf16 v135, s59, v231
  v_dot2c_f32_bf16 v128, s58, v232
  v_dot2c_f32_bf16 v129, s59, v232
  v_dot2c_f32_bf16 v130, s58, v233
  v_dot2c_f32_bf16 v131, s59, v233
  v_dot2c_f32_bf16 v132, s58, v234
  v_dot2c_f32_bf16 v133, s59, v234
  v_dot2c_f32_bf16 v134, s58, v235
  v_dot2c_f32_bf16 v135, s59, v235
  v_dot2c_f32_bf16 v128, s58, v236
  v_dot2c_f32_bf16 v129, s59, v236
  v_dot2c_f32_bf16 v130, s58, v237
  v_dot2c_f32_bf16 v131, s59, v237
  v_dot2c_f32_bf16 v132, s58, v238
  v_dot2c_f32_bf16 v133, s59, v238
  v_dot2c_f32_bf16 v134, s58, v239
  v_dot2c_f32_bf16 v135, s59, v239
  v_dot2c_f32_bf16 v128, s58, v240
  v_dot2c_f32_bf16 v129, s59, v240
  v_dot2c_f32_bf16 v130, s58, v241
  v_dot2c_f32_bf16 v131, s59, v241
  v_dot2c_f32_bf16 v132, s58, v242
  v_dot2c_f32_bf16 v133, s59, v242
  v_dot2c_f32_bf16 v134, s58, v243
  v_dot2c_f32_bf16 v135, s59, v243
  v_dot2c_f32_bf16 v128, s58, v244
  v_dot2c_f32_bf16 v129, s59, v244
  v_dot2c_f32_bf16 v130, s58, v245
  v_dot2c_f32_bf16 v131, s59, v245
  v_dot2c_f32_bf16 v132, s58, v246
  v_dot2c_f32_bf16 v133, s59, v246
  v_dot2c_f32_bf16 v134, s58, v247
  v_dot2c_f32_bf16 v135, s59, v247
  v_dot2c_f32_bf16 v128, s58, v248
  v_dot2c_f32_bf16 v129, s59, v248
  v_dot2c_f32_bf16 v130, s58, v249
  v_dot2c_f32_bf16 v131, s59, v249
  v_dot2c_f32_bf16 v132, s58, v250
  v_dot2c_f32_bf16 v133, s59, v250
  v_dot2c_f32_bf16 v134, s58, v251
  v_dot2c_f32_bf16 v135, s59, v251
  v_dot2c_f32_bf16 v128, s58, v252
  v_dot2c_f32_bf16 v129, s59, v252
  v_dot2c_f32_bf16 v130, s58, v253
  v_dot2c_f32_bf16 v131, s59, v253
  v_dot2c_f32_bf16 v132, s58, v254
  v_dot2c_f32_bf16 v133, s59, v254
  v_dot2c_f32_bf16 v134, s58, v255
  v_dot2c_f32_bf16 v135, s59, v255
K3_BP:
  s_add_u32 s92, s95, 4096
  buffer_load_dword v219, v206, s[32:35], s92 offen sc1
  s_add_u32 s57, s57, 1
  s_waitcnt vmcnt(0)
  v_and_b32 v219, 1, v219
  v_cmp_eq_u32 vcc, 1, v219
  s_cmp_ge_u32 s57, 16384
  s_cbranch_scc1 K3_BP_GO
  s_nop 2
  s_cbranch_vccnz K3_BP
K3_BP_GO:
  s_add_u32 s92, s95, 4096
  buffer_load_dwordx4 v[64:67], v204, s[32:35], s92 offen sc1
  s_add_u32 s92, s95, 13312
  buffer_load_dwordx4 v[68:71], v204, s[32:35], s92 offen sc1
  s_add_u32 s92, s95, 22528
  buffer_load_dwordx4 v[72:75], v204, s[32:35], s92 offen sc1
  s_add_u32 s92, s95, 31744
  buffer_load_dwordx4 v[76:79], v204, s[32:35], s92 offen sc1
  s_add_u32 s92, s95, 40960
  buffer_load_dwordx4 v[80:83], v204, s[32:35], s92 offen sc1
  s_add_u32 s92, s95, 50176
  buffer_load_dwordx4 v[84:87], v204, s[32:35], s92 offen sc1
  s_add_u32 s92, s95, 59392
  buffer_load_dwordx4 v[88:91], v204, s[32:35], s92 offen sc1
  s_add_u32 s92, s95, 68608
  buffer_load_dwordx4 v[92:95], v204, s[32:35], s92 offen sc1
  s_add_u32 s92, s95, 0
  buffer_load_dwordx4 v[96:99], v205, s[32:35], s92 offen sc1
  s_add_u32 s92, s95, 9216
  buffer_load_dwordx4 v[100:103], v205, s[32:35], s92 offen sc1
  s_add_u32 s92, s95, 18432
  buffer_load_dwordx4 v[104:107], v205, s[32:35], s92 offen sc1
  s_add_u32 s92, s95, 27648
  buffer_load_dwordx4 v[108:111], v205, s[32:35], s92 offen sc1
  s_add_u32 s92, s95, 36864
  buffer_load_dwordx4 v[112:115], v205, s[32:35], s92 offen sc1
  s_add_u32 s92, s95, 46080
  buffer_load_dwordx4 v[116:119], v205, s[32:35], s92 offen sc1
  s_add_u32 s92, s95, 55296
  buffer_load_dwordx4 v[120:123], v205, s[32:35], s92 offen sc1
  s_add_u32 s92, s95, 64512
  buffer_load_dwordx4 v[124:127], v205, s[32:35], s92 offen sc1
  s_waitcnt vmcnt(13)
  v_or3_b32 v219, v64, v68, v72
  s_waitcnt vmcnt(11)
  v_or3_b32 v219, v219, v76, v80
  s_waitcnt vmcnt(9)
  v_or3_b32 v219, v219, v84, v88
  s_waitcnt vmcnt(8)
  v_or_b32 v219, v219, v92
  v_and_b32 v219, 1, v219
  v_cmp_eq_u32 vcc, 1, v219
  s_cmp_ge_u32 s57, 16384
  s_nop 2
  s_cbranch_scc1 K3_BOK
  s_cbranch_vccnz K3_BP
K3_BOK:
  v_lshlrev_b32 v136, 16, v64
  v_and_b32 v137, 0xffff0000, v64
  v_lshlrev_b32 v138, 16, v65
  v_and_b32 v139, 0xffff0000, v65
  v_lshlrev_b32 v140, 16, v66
  v_and_b32 v141, 0xffff0000, v66
  v_lshlrev_b32 v142, 16, v67
  v_and_b32 v143, 0xffff0000, v67
  v_dot2c_f32_bf16 v136, s58, v68
  v_dot2c_f32_bf16 v137, s59, v68
  v_dot2c_f32_bf16 v138, s58, v69
  v_dot2c_f32_bf16 v139, s59, v69
  v_dot2c_f32_bf16 v140, s58, v70
  v_dot2c_f32_bf16 v141, s59, v70
  v_dot2c_f32_bf16 v142, s58, v71
  v_dot2c_f32_bf16 v143, s59, v71
  v_dot2c_f32_bf16 v136, s58, v72
  v_dot2c_f32_bf16 v137, s59, v72
  v_dot2c_f32_bf16 v138, s58, v73
  v_dot2c_f32_bf16 v139, s59, v73
  v_dot2c_f32_bf16 v140, s58, v74
  v_dot2c_f32_bf16 v141, s59, v74
  v_dot2c_f32_bf16 v142, s58, v75
  v_dot2c_f32_bf16 v143, s59, v75
  v_dot2c_f32_bf16 v136, s58, v76
  v_dot2c_f32_bf16 v137, s59, v76
  v_dot2c_f32_bf16 v138, s58, v77
  v_dot2c_f32_bf16 v139, s59, v77
  v_dot2c_f32_bf16 v140, s58, v78
  v_dot2c_f32_bf16 v141, s59, v78
  v_dot2c_f32_bf16 v142, s58, v79
  v_dot2c_f32_bf16 v143, s59, v79
  v_dot2c_f32_bf16 v136, s58, v80
  v_dot2c_f32_bf16 v137, s59, v80
  v_dot2c_f32_bf16 v138, s58, v81
  v_dot2c_f32_bf16 v139, s59, v81
  v_dot2c_f32_bf16 v140, s58, v82
  v_dot2c_f32_bf16 v141, s59, v82
  v_dot2c_f32_bf16 v142, s58, v83
  v_dot2c_f32_bf16 v143, s59, v83
  v_dot2c_f32_bf16 v136, s58, v84
  v_dot2c_f32_bf16 v137, s59, v84
  v_dot2c_f32_bf16 v138, s58, v85
  v_dot2c_f32_bf16 v139, s59, v85
  v_dot2c_f32_bf16 v140, s58, v86
  v_dot2c_f32_bf16 v141, s59, v86
  v_dot2c_f32_bf16 v142, s58, v87
  v_dot2c_f32_bf16 v143, s59, v87
  v_dot2c_f32_bf16 v136, s58, v88
  v_dot2c_f32_bf16 v137, s59, v88
  v_dot2c_f32_bf16 v138, s58, v89
  v_dot2c_f32_bf16 v139, s59, v89
  v_dot2c_f32_bf16 v140, s58, v90
  v_dot2c_f32_bf16 v141, s59, v90
  v_dot2c_f32_bf16 v142, s58, v91
  v_dot2c_f32_bf16 v143, s59, v91
  v_dot2c_f32_bf16 v136, s58, v92
  v_dot2c_f32_bf16 v137, s59, v92
  v_dot2c_f32_bf16 v138, s58, v93
  v_dot2c_f32_bf16 v139, s59, v93
  v_dot2c_f32_bf16 v140, s58, v94
  v_dot2c_f32_bf16 v141, s59, v94
  v_dot2c_f32_bf16 v142, s58, v95
  v_dot2c_f32_bf16 v143, s59, v95
  s_waitcnt vmcnt(5)
  v_or3_b32 v219, v96, v100, v104
  s_waitcnt vmcnt(3)
  v_or3_b32 v219, v219, v108, v112
  s_waitcnt vmcnt(1)
  v_or3_b32 v219, v219, v116, v120
  s_waitcnt vmcnt(0)
  v_or_b32 v219, v219, v124
  v_and_b32 v219, 1, v219
  v_cmp_eq_u32 vcc, 1, v219
  s_cmp_ge_u32 s57, 16384
  s_nop 2
  s_cbranch_scc1 K3_OOK
  s_cbranch_vccz K3_OOK
K3_OR:
  s_add_u32 s92, s95, 0
  buffer_load_dwordx4 v[96:99], v205, s[32:35], s92 offen sc1
  s_add_u32 s92, s95, 9216
  buffer_load_dwordx4 v[100:103], v205, s[32:35], s92 offen sc1
  s_add_u32 s92, s95, 18432
  buffer_load_dwordx4 v[104:107], v205, s[32:35], s92 offen sc1
  s_add_u32 s92, s95, 27648
  buffer_load_dwordx4 v[108:111], v205, s[32:35], s92 offen sc1
  s_add_u32 s92, s95, 36864
  buffer_load_dwordx4 v[112:115], v205, s[32:35], s92 offen sc1
  s_add_u32 s92, s95, 46080
  buffer_load_dwordx4 v[116:119], v205, s[32:35], s92 offen sc1
  s_add_u32 s92, s95, 55296
  buffer_load_dwordx4 v[120:123], v205, s[32:35], s92 offen sc1
  s_add_u32 s92, s95, 64512
  buffer_load_dwordx4 v[124:127], v205, s[32:35], s92 offen sc1
  s_add_u32 s57, s57, 1
  s_waitcnt vmcnt(0)
  v_or3_b32 v219, v96, v100, v104
  v_or3_b32 v219, v219, v108, v112
  v_or3_b32 v219, v219, v116, v120
  v_or_b32 v219, v219, v124
  v_and_b32 v219, 1, v219
  v_cmp_eq_u32 vcc, 1, v219
  s_cmp_ge_u32 s57, 16384
  s_nop 2
  s_cbranch_scc1 K3_OOK
  s_cbranch_vccnz K3_OR
K3_OOK:
  v_lshlrev_b32 v144, 16, v96
  v_and_b32 v145, 0xffff0000, v96
  v_lshlrev_b32 v146, 16, v97
  v_and_b32 v147, 0xffff0000, v97
  v_lshlrev_b32 v148, 16, v98
  v_and_b32 v149, 0xffff0000, v98
  v_lshlrev_b32 v150, 16, v99
  v_and_b32 v151, 0xffff0000, v99
  v_dot2c_f32_bf16 v144, s58, v100
  v_dot2c_f32_bf16 v145, s59, v100
  v_dot2c_f32_bf16 v146, s58, v101
  v_dot2c_f32_bf16 v147, s59, v101
  v_dot2c_f32_bf16 v148, s58, v102
  v_dot2c_f32_bf16 v149, s59, v102
  v_dot2c_f32_bf16 v150, s58, v103
  v_dot2c_f32_bf16 v151, s59, v103
  v_dot2c_f32_bf16 v144, s58, v104
  v_dot2c_f32_bf16 v145, s59, v104
  v_dot2c_f32_bf16 v146, s58, v105
  v_dot2c_f32_bf16 v147, s59, v105
  v_dot2c_f32_bf16 v148, s58, v106
  v_dot2c_f32_bf16 v149, s59, v106
  v_dot2c_f32_bf16 v150, s58, v107
  v_dot2c_f32_bf16 v151, s59, v107
  v_dot2c_f32_bf16 v144, s58, v108
  v_dot2c_f32_bf16 v145, s59, v108
  v_dot2c_f32_bf16 v146, s58, v109
  v_dot2c_f32_bf16 v147, s59, v109
  v_dot2c_f32_bf16 v148, s58, v110
  v_dot2c_f32_bf16 v149, s59, v110
  v_dot2c_f32_bf16 v150, s58, v111
  v_dot2c_f32_bf16 v151, s59, v111
  v_dot2c_f32_bf16 v144, s58, v112
  v_dot2c_f32_bf16 v145, s59, v112
  v_dot2c_f32_bf16 v146, s58, v113
  v_dot2c_f32_bf16 v147, s59, v113
  v_dot2c_f32_bf16 v148, s58, v114
  v_dot2c_f32_bf16 v149, s59, v114
  v_dot2c_f32_bf16 v150, s58, v115
  v_dot2c_f32_bf16 v151, s59, v115
  v_dot2c_f32_bf16 v144, s58, v116
  v_dot2c_f32_bf16 v145, s59, v116
  v_dot2c_f32_bf16 v146, s58, v117
  v_dot2c_f32_bf16 v147, s59, v117
  v_dot2c_f32_bf16 v148, s58, v118
  v_dot2c_f32_bf16 v149, s59, v118
  v_dot2c_f32_bf16 v150, s58, v119
  v_dot2c_f32_bf16 v151, s59, v119
  v_dot2c_f32_bf16 v144, s58, v120
  v_dot2c_f32_bf16 v145, s59, v120
  v_dot2c_f32_bf16 v146, s58, v121
  v_dot2c_f32_bf16 v147, s59, v121
  v_dot2c_f32_bf16 v148, s58, v122
  v_dot2c_f32_bf16 v149, s59, v122
  v_dot2c_f32_bf16 v150, s58, v123
  v_dot2c_f32_bf16 v151, s59, v123
  v_dot2c_f32_bf16 v144, s58, v124
  v_dot2c_f32_bf16 v145, s59, v124
  v_dot2c_f32_bf16 v146, s58, v125
  v_dot2c_f32_bf16 v147, s59, v125
  v_dot2c_f32_bf16 v148, s58, v126
  v_dot2c_f32_bf16 v149, s59, v126
  v_dot2c_f32_bf16 v150, s58, v127
  v_dot2c_f32_bf16 v151, s59, v127
  v_dot2c_f32_bf16 v128, s58, v160
  v_dot2c_f32_bf16 v129, s59, v160
  v_dot2c_f32_bf16 v130, s58, v161
  v_dot2c_f32_bf16 v131, s59, v161
  v_dot2c_f32_bf16 v132, s58, v162
  v_dot2c_f32_bf16 v133, s59, v162
  v_dot2c_f32_bf16 v134, s58, v163
  v_dot2c_f32_bf16 v135, s59, v163
  v_dot2c_f32_bf16 v136, s58, v164
  v_dot2c_f32_bf16 v137, s59, v164
  v_dot2c_f32_bf16 v138, s58, v165
  v_dot2c_f32_bf16 v139, s59, v165
  v_dot2c_f32_bf16 v140, s58, v166
  v_dot2c_f32_bf16 v141, s59, v166
  v_dot2c_f32_bf16 v142, s58, v167
  v_dot2c_f32_bf16 v143, s59, v167
  v_dot2c_f32_bf16 v144, s58, v168
  v_dot2c_f32_bf16 v145, s59, v168
  v_dot2c_f32_bf16 v146, s58, v169
  v_dot2c_f32_bf16 v147, s59, v169
  v_dot2c_f32_bf16 v148, s58, v170
  v_dot2c_f32_bf16 v149, s59, v170
  v_dot2c_f32_bf16 v150, s58, v171
  v_dot2c_f32_bf16 v151, s59, v171
  v_add_f32 v120, v128, v129
  v_mul_f32 v121, v128, v128
  v_fmac_f32 v121, v129, v129
  v_add_f32 v120, v120, v130
  v_fmac_f32 v121, v130, v130
  v_add_f32 v120, v120, v131
  v_fmac_f32 v121, v131, v131
  v_add_f32 v120, v120, v132
  v_fmac_f32 v121, v132, v132
  v_add_f32 v120, v120, v133
  v_fmac_f32 v121, v133, v133
  v_add_f32 v120, v120, v134
  v_fmac_f32 v121, v134, v134
  v_add_f32 v120, v120, v135
  v_fmac_f32 v121, v135, v135
  v_add_f32 v120, v120, v136
  v_fmac_f32 v121, v136, v136
  v_add_f32 v120, v120, v137
  v_fmac_f32 v121, v137, v137
  v_add_f32 v120, v120, v138
  v_fmac_f32 v121, v138, v138
  v_add_f32 v120, v120, v139
  v_fmac_f32 v121, v139, v139
  v_add_f32 v120, v120, v140
  v_fmac_f32 v121, v140, v140
  v_add_f32 v120, v120, v141
  v_fmac_f32 v121, v141, v141
  v_add_f32 v120, v120, v142
  v_fmac_f32 v121, v142, v142
  v_add_f32 v120, v120, v143
  v_fmac_f32 v121, v143, v143
  v_add_f32 v120, v120, v144
  v_fmac_f32 v121, v144, v144
  v_add_f32 v120, v120, v145
  v_fmac_f32 v121, v145, v145
  v_add_f32 v120, v120, v146
  v_fmac_f32 v121, v146, v146
  v_add_f32 v120, v120, v147
  v_fmac_f32 v121, v147, v147
  v_add_f32 v120, v120, v148
  v_fmac_f32 v121, v148, v148
  v_add_f32 v120, v120, v149
  v_fmac_f32 v121, v149, v149
  v_add_f32 v120, v120, v150
  v_fmac_f32 v121, v150, v150
  v_add_f32 v120, v120, v151
  v_fmac_f32 v121, v151, v151
  s_nop 0
  v_add_f32_dpp v120, v120, v120 row_ror:8 row_mask:0xf bank_mask:0xf
  v_add_f32_dpp v121, v121, v121 row_ror:8 row_mask:0xf bank_mask:0xf
  v_mov_b32 v118, v120
  v_mov_b32 v119, v121
  s_nop 0
  v_permlane16_swap_b32 v118, v120
  v_permlane16_swap_b32 v119, v121
  v_add_f32 v120, v120, v118
  v_add_f32 v121, v121, v119
  v_mov_b32 v118, v120
  v_mov_b32 v119, v121
  s_nop 0
  v_permlane32_swap_b32 v118, v120
  v_permlane32_swap_b32 v119, v121
  v_add_f32 v120, v120, v118
  v_add_f32 v121, v121, v119
  s_lshl_b32 s92, s48, 6
  v_lshl_add_u32 v118, v220, 3, s92
  v_add_u32 v118, 65536, v118
  ds_write_b64 v118, v[120:121]
  v_cvt_pk_bf16_f32 v0, v128, v129
  v_cvt_pk_bf16_f32 v1, v130, v131
  v_cvt_pk_bf16_f32 v2, v132, v133
  v_cvt_pk_bf16_f32 v3, v134, v135
  buffer_store_dwordx4 v[0:3], v204, s[44:47], s55 offen sc1
  v_cvt_pk_bf16_f32 v4, v136, v137
  v_cvt_pk_bf16_f32 v5, v138, v139
  v_cvt_pk_bf16_f32 v6, v140, v141
  v_cvt_pk_bf16_f32 v7, v142, v143
  buffer_store_dwordx4 v[4:7], v204, s[44:47], s54 offen sc1
  v_cvt_pk_bf16_f32 v8, v144, v145
  v_cvt_pk_bf16_f32 v9, v146, v147
  v_cvt_pk_bf16_f32 v10, v148, v149
  v_cvt_pk_bf16_f32 v11, v150, v151
  buffer_store_dwordx4 v[8:11], v205, s[44:47], s55 offen sc1
  v_lshlrev_b32 v118, 3, v220
  v_add_u32 v118, 65536, v118
  s_waitcnt lgkmcnt(0)
  s_barrier
  ds_read_b64 v[100:101], v118 offset:0
  ds_read_b64 v[102:103], v118 offset:64
  ds_read_b64 v[104:105], v118 offset:128
  ds_read_b64 v[106:107], v118 offset:192
  s_waitcnt lgkmcnt(2)
  v_add_f32 v100, v100, v102
  s_waitcnt lgkmcnt(0)
  v_add_f32 v104, v104, v106
  v_add_f32 v101, v101, v103
  v_add_f32 v105, v105, v107
  v_add_f32 v100, v100, v104
  v_add_f32 v101, v101, v105
  v_mul_f32 v100, 0.001736111111111111, v100
  v_mul_f32 v101, 0.001736111111111111, v101
  v_fma_f32 v101, -v100, v100, v101
  v_max_f32 v101, 0, v101
  v_add_f32 v101, 1e-05, v101
  v_rsq_f32 v101, v101
  s_nop 0
  v_mul_f32 v100, v100, v101
  v_fma_f32 v128, v128, v101, -v100
  v_fma_f32 v129, v129, v101, -v100
  v_fma_f32 v130, v130, v101, -v100
  v_fma_f32 v131, v131, v101, -v100
  v_fma_f32 v132, v132, v101, -v100
  v_fma_f32 v133, v133, v101, -v100
  v_fma_f32 v134, v134, v101, -v100
  v_fma_f32 v135, v135, v101, -v100
  v_cvt_pk_bf16_f32 v12, v128, v129
  v_cvt_pk_bf16_f32 v13, v130, v131
  v_cvt_pk_bf16_f32 v14, v132, v133
  v_cvt_pk_bf16_f32 v15, v134, v135
  buffer_store_dwordx4 v[12:15], v209, s[40:43], 0 offen sc1
  v_fma_f32 v136, v136, v101, -v100
  v_fma_f32 v137, v137, v101, -v100
  v_fma_f32 v138, v138, v101, -v100
  v_fma_f32 v139, v139, v101, -v100
  v_fma_f32 v140, v140, v101, -v100
  v_fma_f32 v141, v141, v101, -v100
  v_fma_f32 v142, v142, v101, -v100
  v_fma_f32 v143, v143, v101, -v100
  v_cvt_pk_bf16_f32 v16, v136, v137
  v_cvt_pk_bf16_f32 v17, v138, v139
  v_cvt_pk_bf16_f32 v18, v140, v141
  v_cvt_pk_bf16_f32 v19, v142, v143
  buffer_store_dwordx4 v[16:19], v209, s[40:43], s94 offen sc1
  v_fma_f32 v144, v144, v101, -v100
  v_fma_f32 v145, v145, v101, -v100
  v_fma_f32 v146, v146, v101, -v100
  v_fma_f32 v147, v147, v101, -v100
  v_fma_f32 v148, v148, v101, -v100
  v_fma_f32 v149, v149, v101, -v100
  v_fma_f32 v150, v150, v101, -v100
  v_fma_f32 v151, v151, v101, -v100
  v_cvt_pk_bf16_f32 v20, v144, v145
  v_cvt_pk_bf16_f32 v21, v146, v147
  v_cvt_pk_bf16_f32 v22, v148, v149
  v_cvt_pk_bf16_f32 v23, v150, v151
  buffer_store_dwordx4 v[20:23], v210, s[40:43], 0 offen sc1
K3_END:
  s_endpgm
.section .rodata,"a"
.p2align 6
.amdhsa_kernel oproj_kernel
  .amdhsa_next_free_vgpr 512
  .amdhsa_next_free_sgpr 102
  .amdhsa_accum_offset 256
  .amdhsa_group_segment_fixed_size 0
  .amdhsa_kernarg_size 104
  .amdhsa_user_sgpr_count 2
  .amdhsa_user_sgpr_kernarg_segment_ptr 1
  .amdhsa_system_sgpr_workgroup_id_x 1
.end_amdhsa_kernel
.text
.globl ffn_kernel
.p2align 8
.type ffn_kernel,@function
ffn_kernel:
  s_cmp_ge_u32 s2, 256
  s_cbranch_scc1 K4_END
  s_load_dwordx4 s[4:7], s[0:1], 56
  s_load_dwordx2 s[8:9], s[0:1], 72
  s_load_dwordx2 s[10:11], s[0:1], 80
  s_load_dwordx2 s[12:13], s[0:1], 96
  v_and_b32 v200, 63, v0
  v_lshrrev_b32 v219, 6, v0
  s_nop 0
  v_readfirstlane_b32 s48, v219
  s_and_b32 s50, s2, 7
  s_lshr_b32 s49, s2, 3
  s_mul_i32 s51, s48, 22528
  s_add_u32 s51, s51, 73728
  v_lshlrev_b32 v212, 4, v200
  v_add_u32 v213, 65536, v212
  v_add_u32 v222, 35840, v212
  s_lshl_b32 s79, s48, 11
  s_mul_i32 s92, s49, 73728
  s_lshl_b32 s93, s48, 10
  s_add_u32 s92, s92, s93
  s_lshr_b32 s93, s49, 1
  s_mul_i32 s94, s93, 11
  s_lshr_b32 s94, s94, 5
  s_mul_i32 s94, s94, 3
  s_sub_u32 s93, s93, s94
  s_add_u32 s94, s93, 1
  s_cmp_eq_u32 s94, 3
  s_cselect_b32 s94, 0, s94
  s_add_u32 s95, s94, 1
  s_cmp_eq_u32 s95, 3
  s_cselect_b32 s95, 0, s95
  s_mul_i32 s89, s93, 12288
  s_add_u32 s89, s89, s92
  s_mul_i32 s90, s94, 12288
  s_add_u32 s90, s90, s92
  s_mul_i32 s91, s95, 12288
  s_add_u32 s91, s91, s92
  s_waitcnt lgkmcnt(0)
  s_add_u32 s28, s12, 59768832
  s_addc_u32 s29, s13, 0
  s_mov_b32 s30, 2359296
  s_mov_b32 s31, 0x00020000
  s_add_u32 m0, s79, 0
  s_add_u32 s53, s89, 0
  buffer_load_dwordx4 v212, s[28:31], s53 offen lds
  buffer_load_dwordx4 v222, s[28:31], s53 offen offset:1024 lds
  s_mov_b32 s16, s4
  s_mov_b32 s17, s5
  s_mov_b32 s18, 5308416
  s_mov_b32 s19, 0x00020000
  s_mov_b32 s20, s6
  s_mov_b32 s21, s7
  s_mov_b32 s22, 5308416
  s_mov_b32 s23, 0x00020000
  v_lshrrev_b32 v219, 3, v200
  v_bfe_u32 v220, v200, 4, 1
  v_and_b32 v221, 7, v200
  v_lshlrev_b32 v223, 1, v220
  v_xor_b32 v223, v223, v221
  v_lshlrev_b32 v223, 4, v223
  v_mul_u32_u24 v206, 9216, v219
  v_add_u32 v206, v206, v223
  v_add_u32 v207, 72704, v206
  v_xor_b32 v208, 64, v206
  v_xor_b32 v209, 64, v207
  s_add_u32 s44, s12, 62914560
  s_addc_u32 s45, s13, 0
  s_mov_b32 s46, 1179648
  s_mov_b32 s47, 0x00020000
  v_lshlrev_b32 v210, 4, v200
  s_mul_i32 s56, s50, 1152
  s_lshl_b32 s54, s48, 8
  s_add_u32 s54, s54, s56
  s_and_b32 s57, s49, 1
  s_lshl_b32 s53, s57, 7
  s_xor_b32 s52, s53, 128
  s_add_u32 s55, s54, s52
  s_add_u32 s54, s54, s53
  s_lshl_b32 s53, s48, 5
  s_add_u32 s56, s56, s53
  s_add_u32 s56, s56, 1024
  s_lshl_b32 s56, s50, 2
  s_add_u32 s56, s56, s48
  s_mul_i32 s56, s56, 36864
  s_mul_i32 s53, s93, 1769472
  s_add_u32 s80, s54, s53
  s_add_u32 s83, s55, s53
  s_mul_i32 s53, s93, 12288
  s_add_u32 s86, s56, s53
  s_mul_i32 s53, s94, 1769472
  s_add_u32 s81, s54, s53
  s_add_u32 s84, s55, s53
  s_mul_i32 s53, s94, 12288
  s_add_u32 s87, s56, s53
  s_mul_i32 s53, s95, 1769472
  s_add_u32 s82, s54, s53
  s_add_u32 s85, s55, s53
  s_mul_i32 s53, s95, 12288
  s_add_u32 s88, s56, s53
  s_mov_b32 s24, s8
  s_mov_b32 s25, s9
  s_mov_b32 s26, 5308416
  s_mov_b32 s27, 0x00020000
  v_lshrrev_b32 v219, 3, v200
  v_bfe_u32 v220, v200, 4, 1
  v_and_b32 v221, 7, v200
  v_lshlrev_b32 v223, 2, v220
  v_xor_b32 v223, v223, v221
  v_lshlrev_b32 v223, 4, v223
  v_mul_u32_u24 v217, 1152, v219
  v_add_u32 v217, v217, v223
  v_add_u32 v218, 8192, v217
  s_add_u32 m0, s51, 0
  s_add_u32 s52, s80, 0
  buffer_load_dwordx4 v206, s[16:19], s52 offen offset:0 lds
  buffer_load_dwordx4 v207, s[16:19], s52 offen offset:1024 lds
  s_add_u32 m0, s51, 2048
  s_nop 0
  buffer_load_dwordx4 v208, s[20:23], s52 offen offset:0 lds
  buffer_load_dwordx4 v209, s[20:23], s52 offen offset:1024 lds
  s_add_u32 m0, s51, 4096
  s_add_u32 s52, s80, 147456
  buffer_load_dwordx4 v206, s[16:19], s52 offen offset:0 lds
  buffer_load_dwordx4 v207, s[16:19], s52 offen offset:1024 lds
  s_add_u32 m0, s51, 6144
  s_nop 0
  buffer_load_dwordx4 v208, s[20:23], s52 offen offset:0 lds
  buffer_load_dwordx4 v209, s[20:23], s52 offen offset:1024 lds
  s_add_u32 m0, s51, 8192
  s_add_u32 s52, s80, 294912
  buffer_load_dwordx4 v206, s[16:19], s52 offen offset:0 lds
  buffer_load_dwordx4 v207, s[16:19], s52 offen offset:1024 lds
  s_add_u32 m0, s51, 10240
  s_nop 0
  buffer_load_dwordx4 v208, s[20:23], s52 offen offset:0 lds
  buffer_load_dwordx4 v209, s[20:23], s52 offen offset:1024 lds
  s_add_u32 m0, s51, 12288
  s_add_u32 s52, s80, 442368
  buffer_load_dwordx4 v206, s[16:19], s52 offen offset:0 lds
  buffer_load_dwordx4 v207, s[16:19], s52 offen offset:1024 lds
  s_add_u32 m0, s51, 14336
  s_nop 0
  buffer_load_dwordx4 v208, s[20:23], s52 offen offset:0 lds
  buffer_load_dwordx4 v209, s[20:23], s52 offen offset:1024 lds
  s_add_u32 m0, s79, 8192
  s_add_u32 s53, s89, 4096
  buffer_load_dwordx4 v212, s[28:31], s53 offen lds
  buffer_load_dwordx4 v222, s[28:31], s53 offen offset:1024 lds
  s_add_u32 m0, s51, 16384
  s_add_u32 s52, s80, 589824
  buffer_load_dwordx4 v206, s[16:19], s52 offen offset:0 lds
  buffer_load_dwordx4 v207, s[16:19], s52 offen offset:1024 lds
  s_add_u32 m0, s51, 18432
  s_nop 0
  buffer_load_dwordx4 v208, s[20:23], s52 offen offset:0 lds
  buffer_load_dwordx4 v209, s[20:23], s52 offen offset:1024 lds
  s_mul_i32 s92, s50, 663552
  s_lshl_b32 s93, s48, 8
  s_add_u32 s15, s92, s93
  s_mul_i32 s93, s57, 73728
  s_add_u32 s3, s15, s93
  s_sub_u32 s14, 73728, s93
  s_add_u32 s14, s14, s15
  s_add_u32 s15, s15, 589824
  s_add_u32 s92, s92, 1024
  s_mul_i32 s94, s48, 147456
  s_add_u32 s94, s94, s92
  s_add_u32 s100, s94, s93
  s_sub_u32 s101, 73728, s93
  s_add_u32 s101, s101, s94
  s_mul_i32 s78, s48, 18432
  s_add_u32 s78, s78, s92
  s_add_u32 s78, s78, 589824
  v_lshrrev_b32 v219, 5, v200
  v_bfe_u32 v220, v200, 2, 2
  v_lshl_add_u32 v219, v219, 2, v220
  v_bfe_u32 v221, v200, 4, 1
  v_and_b32 v223, 3, v200
  v_lshlrev_b32 v223, 3, v223
  v_add_u32 v223, s51, v223
  v_lshrrev_b32 v220, 1, v220
  v_lshl_add_u32 v216, v219, 7, v223
  v_lshl_add_u32 v216, v221, 5, v216
  v_lshl_add_u32 v215, v220, 6, v216
  v_xor_b32 v214, 1, v220
  v_lshl_add_u32 v216, v214, 6, v216
  v_lshl_add_u32 v220, v221, 1, v220
  v_lshl_add_u32 v205, v219, 7, v223
  v_lshl_add_u32 v205, v221, 11, v205
  v_xor_b32 v201, 0, v220
  v_lshl_add_u32 v201, v201, 5, v205
  v_xor_b32 v202, 1, v220
  v_lshl_add_u32 v202, v202, 5, v205
  v_xor_b32 v203, 2, v220
  v_lshl_add_u32 v203, v203, 5, v205
  v_xor_b32 v204, 3, v220
  v_lshl_add_u32 v204, v204, 5, v205
  v_lshlrev_b32 v220, 2, v221
  v_xor_b32 v219, v219, v220
  v_lshl_add_u32 v205, v219, 5, v223
  v_lshl_add_u32 v205, v221, 10, v205
  s_lshl_b32 s92, s48, 13
  v_add_u32 v214, s92, v212
  v_add_u32 v223, s79, v213
  s_mov_b32 s32, s12
  s_mov_b32 s33, s13
  s_mov_b32 s34, 42467328
  s_mov_b32 s35, 0x00020000
  s_waitcnt vmcnt(22)
  s_barrier
  ds_read_b128 a[0:3], v212 offset:0
  ds_read_b128 a[4:7], v212 offset:1024
  ds_read_b128 a[8:11], v212 offset:2048
  ds_read_b128 a[12:15], v212 offset:3072
  s_waitcnt vmcnt(18)
  ds_read_b64_tr_b16 v[128:129], v201 offset:0
  ds_read_b64_tr_b16 v[130:131], v201 offset:1024
  ds_read_b64_tr_b16 v[132:133], v202 offset:0
  ds_read_b64_tr_b16 v[134:135], v202 offset:1024
  ds_read_b64_tr_b16 v[136:137], v203 offset:0
  ds_read_b64_tr_b16 v[138:139], v203 offset:1024
  ds_read_b64_tr_b16 v[140:141], v204 offset:0
  ds_read_b64_tr_b16 v[142:143], v204 offset:1024
  s_add_u32 m0, s79, 16384
  s_waitcnt lgkmcnt(6)
  v_mfma_f32_32x32x16_bf16 v[0:15], v[128:131], a[0:3], 0
  s_waitcnt vmcnt(14)
  ds_read_b128 a[16:19], v212 offset:4096
  ds_read_b64_tr_b16 v[144:145], v201 offset:4096
  s_add_u32 s53, s89, 8192
  buffer_load_dwordx4 v212, s[28:31], s53 offen lds
  v_mfma_f32_32x32x16_bf16 v[16:31], v[128:131], a[4:7], 0
  ds_read_b64_tr_b16 v[146:147], v201 offset:5120
  buffer_load_dwordx4 v222, s[28:31], s53 offen offset:1024 lds
  s_add_u32 m0, s51, 0
  s_waitcnt lgkmcnt(7)
  v_mfma_f32_32x32x16_bf16 v[32:47], v[132:135], a[0:3], 0
  ds_read_b64_tr_b16 v[148:149], v202 offset:4096
  v_mfma_f32_32x32x16_bf16 v[48:63], v[132:135], a[4:7], 0
  ds_read_b64_tr_b16 v[150:151], v202 offset:5120
  s_waitcnt lgkmcnt(7)
  v_mfma_f32_32x32x16_bf16 v[64:79], v[136:139], a[0:3], 0
  ds_read_b128 a[20:23], v212 offset:5120
  ds_read_b64_tr_b16 v[152:153], v203 offset:4096
  v_mfma_f32_32x32x16_bf16 v[80:95], v[136:139], a[4:7], 0
  ds_read_b64_tr_b16 v[154:155], v203 offset:5120
  s_waitcnt lgkmcnt(8)
  v_mfma_f32_32x32x16_bf16 v[96:111], v[140:143], a[0:3], 0
  ds_read_b64_tr_b16 v[156:157], v204 offset:4096
  s_add_u32 s52, s80, 737280
  buffer_load_dwordx4 v206, s[16:19], s52 offen offset:0 lds
  v_mfma_f32_32x32x16_bf16 v[112:127], v[140:143], a[4:7], 0
  ds_read_b64_tr_b16 v[158:159], v204 offset:5120
  buffer_load_dwordx4 v207, s[16:19], s52 offen offset:1024 lds
  s_add_u32 m0, s51, 2048
  s_waitcnt lgkmcnt(7)
  v_mfma_f32_32x32x16_bf16 v[0:15], v[144:147], a[8:11], v[0:15]
  s_waitcnt vmcnt(14)
  ds_read_b128 a[24:27], v212 offset:6144
  ds_read_b64_tr_b16 v[128:129], v201 offset:8192
  buffer_load_dwordx4 v208, s[20:23], s52 offen offset:0 lds
  v_mfma_f32_32x32x16_bf16 v[16:31], v[144:147], a[12:15], v[16:31]
  ds_read_b64_tr_b16 v[130:131], v201 offset:9216
  buffer_load_dwordx4 v209, s[20:23], s52 offen offset:1024 lds
  s_add_u32 m0, s51, 4096
  s_waitcnt lgkmcnt(8)
  v_mfma_f32_32x32x16_bf16 v[32:47], v[148:151], a[8:11], v[32:47]
  ds_read_b64_tr_b16 v[132:133], v202 offset:8192
  v_mfma_f32_32x32x16_bf16 v[48:63], v[148:151], a[12:15], v[48:63]
  ds_read_b64_tr_b16 v[134:135], v202 offset:9216
  s_waitcnt lgkmcnt(7)
  v_mfma_f32_32x32x16_bf16 v[64:79], v[152:155], a[8:11], v[64:79]
  ds_read_b128 a[28:31], v212 offset:7168
  ds_read_b64_tr_b16 v[136:137], v203 offset:8192
  v_mfma_f32_32x32x16_bf16 v[80:95], v[152:155], a[12:15], v[80:95]
  ds_read_b64_tr_b16 v[138:139], v203 offset:9216
  s_waitcnt lgkmcnt(8)
  v_mfma_f32_32x32x16_bf16 v[96:111], v[156:159], a[8:11], v[96:111]
  ds_read_b64_tr_b16 v[140:141], v204 offset:8192
  s_add_u32 s52, s80, 884736
  buffer_load_dwordx4 v206, s[16:19], s52 offen offset:0 lds
  v_mfma_f32_32x32x16_bf16 v[112:127], v[156:159], a[12:15], v[112:127]
  ds_read_b64_tr_b16 v[142:143], v204 offset:9216
  buffer_load_dwordx4 v207, s[16:19], s52 offen offset:1024 lds
  s_add_u32 m0, s51, 6144
  s_waitcnt vmcnt(12)
  s_barrier
  s_waitcnt lgkmcnt(7)
  v_mfma_f32_32x32x16_bf16 v[0:15], v[128:131], a[16:19], v[0:15]
  ds_read_b128 a[32:35], v212 offset:8192
  ds_read_b64_tr_b16 v[144:145], v201 offset:12288
  buffer_load_dwordx4 v208, s[20:23], s52 offen offset:0 lds
  v_mfma_f32_32x32x16_bf16 v[16:31], v[128:131], a[20:23], v[16:31]
  ds_read_b64_tr_b16 v[146:147], v201 offset:13312
  buffer_load_dwordx4 v209, s[20:23], s52 offen offset:1024 lds
  s_add_u32 m0, s51, 8192
  s_waitcnt lgkmcnt(8)
  v_mfma_f32_32x32x16_bf16 v[32:47], v[132:135], a[16:19], v[32:47]
  ds_read_b64_tr_b16 v[148:149], v202 offset:12288
  v_mfma_f32_32x32x16_bf16 v[48:63], v[132:135], a[20:23], v[48:63]
  ds_read_b64_tr_b16 v[150:151], v202 offset:13312
  s_waitcnt lgkmcnt(7)
  v_mfma_f32_32x32x16_bf16 v[64:79], v[136:139], a[16:19], v[64:79]
  ds_read_b128 a[36:39], v212 offset:9216
  ds_read_b64_tr_b16 v[152:153], v203 offset:12288
  v_mfma_f32_32x32x16_bf16 v[80:95], v[136:139], a[20:23], v[80:95]
  ds_read_b64_tr_b16 v[154:155], v203 offset:13312
  s_waitcnt lgkmcnt(8)
  v_mfma_f32_32x32x16_bf16 v[96:111], v[140:143], a[16:19], v[96:111]
  ds_read_b64_tr_b16 v[156:157], v204 offset:12288
  s_add_u32 s52, s80, 1032192
  buffer_load_dwordx4 v206, s[16:19], s52 offen offset:0 lds
  v_mfma_f32_32x32x16_bf16 v[112:127], v[140:143], a[20:23], v[112:127]
  ds_read_b64_tr_b16 v[158:159], v204 offset:13312
  buffer_load_dwordx4 v207, s[16:19], s52 offen offset:1024 lds
  s_add_u32 m0, s51, 10240
  s_waitcnt lgkmcnt(7)
  v_mfma_f32_32x32x16_bf16 v[0:15], v[144:147], a[24:27], v[0:15]
  s_waitcnt vmcnt(12)
  ds_read_b128 a[40:43], v212 offset:10240
  ds_read_b64_tr_b16 v[128:129], v201 offset:16384
  buffer_load_dwordx4 v208, s[20:23], s52 offen offset:0 lds
  v_mfma_f32_32x32x16_bf16 v[16:31], v[144:147], a[28:31], v[16:31]
  ds_read_b64_tr_b16 v[130:131], v201 offset:17408
  buffer_load_dwordx4 v209, s[20:23], s52 offen offset:1024 lds
  s_add_u32 m0, s51, 12288
  s_waitcnt lgkmcnt(8)
  v_mfma_f32_32x32x16_bf16 v[32:47], v[148:151], a[24:27], v[32:47]
  ds_read_b64_tr_b16 v[132:133], v202 offset:16384
  v_mfma_f32_32x32x16_bf16 v[48:63], v[148:151], a[28:31], v[48:63]
  ds_read_b64_tr_b16 v[134:135], v202 offset:17408
  s_waitcnt lgkmcnt(7)
  v_mfma_f32_32x32x16_bf16 v[64:79], v[152:155], a[24:27], v[64:79]
  ds_read_b128 a[44:47], v212 offset:11264
  ds_read_b64_tr_b16 v[136:137], v203 offset:16384
  v_mfma_f32_32x32x16_bf16 v[80:95], v[152:155], a[28:31], v[80:95]
  ds_read_b64_tr_b16 v[138:139], v203 offset:17408
  s_waitcnt lgkmcnt(8)
  v_mfma_f32_32x32x16_bf16 v[96:111], v[156:159], a[24:27], v[96:111]
  ds_read_b64_tr_b16 v[140:141], v204 offset:16384
  s_add_u32 s52, s80, 1179648
  buffer_load_dwordx4 v206, s[16:19], s52 offen offset:0 lds
  v_mfma_f32_32x32x16_bf16 v[112:127], v[156:159], a[28:31], v[112:127]
  ds_read_b64_tr_b16 v[142:143], v204 offset:17408
  buffer_load_dwordx4 v207, s[16:19], s52 offen offset:1024 lds
  s_add_u32 m0, s79, 24576
  s_waitcnt lgkmcnt(7)
  v_mfma_f32_32x32x16_bf16 v[0:15], v[128:131], a[32:35], v[0:15]
  s_waitcnt vmcnt(10)
  ds_read_b128 a[48:51], v212 offset:12288
  ds_read_b64_tr_b16 v[144:145], v201 offset:0
  s_add_u32 s53, s90, 0
  buffer_load_dwordx4 v212, s[28:31], s53 offen lds
  s_add_u32 m0, s51, 14336
  s_nop 0
  buffer_load_dwordx4 v208, s[20:23], s52 offen offset:0 lds
  s_add_u32 m0, s79, 24576
  v_mfma_f32_32x32x16_bf16 v[16:31], v[128:131], a[36:39], v[16:31]
  ds_read_b64_tr_b16 v[146:147], v201 offset:1024
  buffer_load_dwordx4 v222, s[28:31], s53 offen offset:1024 lds
  s_add_u32 m0, s51, 14336
  s_nop 0
  buffer_load_dwordx4 v209, s[20:23], s52 offen offset:1024 lds
  s_add_u32 m0, s51, 16384
  s_waitcnt lgkmcnt(8)
  v_mfma_f32_32x32x16_bf16 v[32:47], v[132:135], a[32:35], v[32:47]
  ds_read_b64_tr_b16 v[148:149], v202 offset:0
  v_mfma_f32_32x32x16_bf16 v[48:63], v[132:135], a[36:39], v[48:63]
  ds_read_b64_tr_b16 v[150:151], v202 offset:1024
  s_waitcnt lgkmcnt(7)
  v_mfma_f32_32x32x16_bf16 v[64:79], v[136:139], a[32:35], v[64:79]
  ds_read_b128 a[52:55], v212 offset:13312
  ds_read_b64_tr_b16 v[152:153], v203 offset:0
  v_mfma_f32_32x32x16_bf16 v[80:95], v[136:139], a[36:39], v[80:95]
  ds_read_b64_tr_b16 v[154:155], v203 offset:1024
  s_waitcnt lgkmcnt(8)
  v_mfma_f32_32x32x16_bf16 v[96:111], v[140:143], a[32:35], v[96:111]
  ds_read_b64_tr_b16 v[156:157], v204 offset:0
  s_add_u32 s52, s80, 1327104
  buffer_load_dwordx4 v206, s[16:19], s52 offen offset:0 lds
  v_mfma_f32_32x32x16_bf16 v[112:127], v[140:143], a[36:39], v[112:127]
  ds_read_b64_tr_b16 v[158:159], v204 offset:1024
  buffer_load_dwordx4 v207, s[16:19], s52 offen offset:1024 lds
  s_add_u32 m0, s51, 18432
  s_waitcnt lgkmcnt(7)
  v_mfma_f32_32x32x16_bf16 v[0:15], v[144:147], a[40:43], v[0:15]
  s_waitcnt vmcnt(12)
  ds_read_b128 a[56:59], v212 offset:14336
  ds_read_b64_tr_b16 v[128:129], v201 offset:4096
  buffer_load_dwordx4 v208, s[20:23], s52 offen offset:0 lds
  v_mfma_f32_32x32x16_bf16 v[16:31], v[144:147], a[44:47], v[16:31]
  ds_read_b64_tr_b16 v[130:131], v201 offset:5120
  buffer_load_dwordx4 v209, s[20:23], s52 offen offset:1024 lds
  s_add_u32 m0, s51, 0
  s_waitcnt lgkmcnt(8)
  v_mfma_f32_32x32x16_bf16 v[32:47], v[148:151], a[40:43], v[32:47]
  ds_read_b64_tr_b16 v[132:133], v202 offset:4096
  v_mfma_f32_32x32x16_bf16 v[48:63], v[148:151], a[44:47], v[48:63]
  ds_read_b64_tr_b16 v[134:135], v202 offset:5120
  s_waitcnt lgkmcnt(7)
  v_mfma_f32_32x32x16_bf16 v[64:79], v[152:155], a[40:43], v[64:79]
  ds_read_b128 a[60:63], v212 offset:15360
  ds_read_b64_tr_b16 v[136:137], v203 offset:4096
  v_mfma_f32_32x32x16_bf16 v[80:95], v[152:155], a[44:47], v[80:95]
  ds_read_b64_tr_b16 v[138:139], v203 offset:5120
  s_waitcnt lgkmcnt(8)
  v_mfma_f32_32x32x16_bf16 v[96:111], v[156:159], a[40:43], v[96:111]
  ds_read_b64_tr_b16 v[140:141], v204 offset:4096
  s_add_u32 s52, s80, 1474560
  buffer_load_dwordx4 v206, s[16:19], s52 offen offset:0 lds
  v_mfma_f32_32x32x16_bf16 v[112:127], v[156:159], a[44:47], v[112:127]
  ds_read_b64_tr_b16 v[142:143], v204 offset:5120
  buffer_load_dwordx4 v207, s[16:19], s52 offen offset:1024 lds
  s_add_u32 m0, s51, 2048
  s_barrier
  s_waitcnt lgkmcnt(7)
  v_mfma_f32_32x32x16_bf16 v[0:15], v[128:131], a[48:51], v[0:15]
  s_waitcnt vmcnt(12)
  ds_read_b128 a[64:67], v212 offset:16384
  ds_read_b64_tr_b16 v[144:145], v201 offset:8192
  buffer_load_dwordx4 v208, s[20:23], s52 offen offset:0 lds
  v_mfma_f32_32x32x16_bf16 v[16:31], v[128:131], a[52:55], v[16:31]
  ds_read_b64_tr_b16 v[146:147], v201 offset:9216
  buffer_load_dwordx4 v209, s[20:23], s52 offen offset:1024 lds
  s_add_u32 m0, s51, 4096
  s_waitcnt lgkmcnt(8)
  v_mfma_f32_32x32x16_bf16 v[32:47], v[132:135], a[48:51], v[32:47]
  ds_read_b64_tr_b16 v[148:149], v202 offset:8192
  v_mfma_f32_32x32x16_bf16 v[48:63], v[132:135], a[52:55], v[48:63]
  ds_read_b64_tr_b16 v[150:151], v202 offset:9216
  s_waitcnt lgkmcnt(7)
  v_mfma_f32_32x32x16_bf16 v[64:79], v[136:139], a[48:51], v[64:79]
  ds_read_b128 a[68:71], v212 offset:17408
  ds_read_b64_tr_b16 v[152:153], v203 offset:8192
  v_mfma_f32_32x32x16_bf16 v[80:95], v[136:139], a[52:55], v[80:95]
  ds_read_b64_tr_b16 v[154:155], v203 offset:9216
  s_waitcnt lgkmcnt(8)
  v_mfma_f32_32x32x16_bf16 v[96:111], v[140:143], a[48:51], v[96:111]
  ds_read_b64_tr_b16 v[156:157], v204 offset:8192
  s_add_u32 s52, s80, 1622016
  buffer_load_dwordx4 v206, s[16:19], s52 offen offset:0 lds
  v_mfma_f32_32x32x16_bf16 v[112:127], v[140:143], a[52:55], v[112:127]
  ds_read_b64_tr_b16 v[158:159], v204 offset:9216
  buffer_load_dwordx4 v207, s[16:19], s52 offen offset:1024 lds
  s_add_u32 m0, s51, 6144
  s_waitcnt lgkmcnt(7)
  v_mfma_f32_32x32x16_bf16 v[0:15], v[144:147], a[56:59], v[0:15]
  s_waitcnt vmcnt(10)
  ds_read_b128 a[72:75], v212 offset:18432
  ds_read_b64_tr_b16 v[128:129], v201 offset:12288
  buffer_load_dwordx4 v208, s[20:23], s52 offen offset:0 lds
  v_mfma_f32_32x32x16_bf16 v[16:31], v[144:147], a[60:63], v[16:31]
  ds_read_b64_tr_b16 v[130:131], v201 offset:13312
  buffer_load_dwordx4 v209, s[20:23], s52 offen offset:1024 lds
  s_add_u32 m0, s51, 8192
  s_waitcnt lgkmcnt(8)
  v_mfma_f32_32x32x16_bf16 v[32:47], v[148:151], a[56:59], v[32:47]
  ds_read_b64_tr_b16 v[132:133], v202 offset:12288
  v_mfma_f32_32x32x16_bf16 v[48:63], v[148:151], a[60:63], v[48:63]
  ds_read_b64_tr_b16 v[134:135], v202 offset:13312
  s_waitcnt lgkmcnt(7)
  v_mfma_f32_32x32x16_bf16 v[64:79], v[152:155], a[56:59], v[64:79]
  ds_read_b128 a[76:79], v212 offset:19456
  ds_read_b64_tr_b16 v[136:137], v203 offset:12288
  v_mfma_f32_32x32x16_bf16 v[80:95], v[152:155], a[60:63], v[80:95]
  ds_read_b64_tr_b16 v[138:139], v203 offset:13312
  s_waitcnt lgkmcnt(8)
  v_mfma_f32_32x32x16_bf16 v[96:111], v[156:159], a[56:59], v[96:111]
  ds_read_b64_tr_b16 v[140:141], v204 offset:12288
  s_add_u32 s52, s81, 0
  buffer_load_dwordx4 v206, s[16:19], s52 offen offset:0 lds
  v_mfma_f32_32x32x16_bf16 v[112:127], v[156:159], a[60:63], v[112:127]
  ds_read_b64_tr_b16 v[142:143], v204 offset:13312
  buffer_load_dwordx4 v207, s[16:19], s52 offen offset:1024 lds
  s_add_u32 m0, s79, 32768
  s_waitcnt lgkmcnt(7)
  v_mfma_f32_32x32x16_bf16 v[0:15], v[128:131], a[64:67], v[0:15]
  s_waitcnt vmcnt(10)
  ds_read_b128 a[80:83], v212 offset:20480
  ds_read_b64_tr_b16 v[144:145], v201 offset:16384
  s_add_u32 s53, s90, 4096
  buffer_load_dwordx4 v212, s[28:31], s53 offen lds
  s_add_u32 m0, s51, 10240
  s_nop 0
  buffer_load_dwordx4 v208, s[20:23], s52 offen offset:0 lds
  s_add_u32 m0, s79, 32768
  v_mfma_f32_32x32x16_bf16 v[16:31], v[128:131], a[68:71], v[16:31]
  ds_read_b64_tr_b16 v[146:147], v201 offset:17408
  buffer_load_dwordx4 v222, s[28:31], s53 offen offset:1024 lds
  s_add_u32 m0, s51, 10240
  s_nop 0
  buffer_load_dwordx4 v209, s[20:23], s52 offen offset:1024 lds
  s_add_u32 m0, s51, 12288
  s_waitcnt lgkmcnt(8)
  v_mfma_f32_32x32x16_bf16 v[32:47], v[132:135], a[64:67], v[32:47]
  ds_read_b64_tr_b16 v[148:149], v202 offset:16384
  v_mfma_f32_32x32x16_bf16 v[48:63], v[132:135], a[68:71], v[48:63]
  ds_read_b64_tr_b16 v[150:151], v202 offset:17408
  s_waitcnt lgkmcnt(7)
  v_mfma_f32_32x32x16_bf16 v[64:79], v[136:139], a[64:67], v[64:79]
  ds_read_b128 a[84:87], v212 offset:21504
  ds_read_b64_tr_b16 v[152:153], v203 offset:16384
  v_mfma_f32_32x32x16_bf16 v[80:95], v[136:139], a[68:71], v[80:95]
  ds_read_b64_tr_b16 v[154:155], v203 offset:17408
  s_waitcnt lgkmcnt(8)
  v_mfma_f32_32x32x16_bf16 v[96:111], v[140:143], a[64:67], v[96:111]
  ds_read_b64_tr_b16 v[156:157], v204 offset:16384
  s_add_u32 s52, s81, 147456
  buffer_load_dwordx4 v206, s[16:19], s52 offen offset:0 lds
  v_mfma_f32_32x32x16_bf16 v[112:127], v[140:143], a[68:71], v[112:127]
  ds_read_b64_tr_b16 v[158:159], v204 offset:17408
  buffer_load_dwordx4 v207, s[16:19], s52 offen offset:1024 lds
  s_add_u32 m0, s51, 14336
  s_waitcnt lgkmcnt(7)
  v_mfma_f32_32x32x16_bf16 v[0:15], v[144:147], a[72:75], v[0:15]
  s_waitcnt vmcnt(12)
  ds_read_b128 a[88:91], v212 offset:22528
  ds_read_b64_tr_b16 v[128:129], v201 offset:0
  buffer_load_dwordx4 v208, s[20:23], s52 offen offset:0 lds
  v_mfma_f32_32x32x16_bf16 v[16:31], v[144:147], a[76:79], v[16:31]
  ds_read_b64_tr_b16 v[130:131], v201 offset:1024
  buffer_load_dwordx4 v209, s[20:23], s52 offen offset:1024 lds
  s_add_u32 m0, s51, 16384
  s_waitcnt lgkmcnt(8)
  v_mfma_f32_32x32x16_bf16 v[32:47], v[148:151], a[72:75], v[32:47]
  ds_read_b64_tr_b16 v[132:133], v202 offset:0
  v_mfma_f32_32x32x16_bf16 v[48:63], v[148:151], a[76:79], v[48:63]
  ds_read_b64_tr_b16 v[134:135], v202 offset:1024
  s_waitcnt lgkmcnt(7)
  v_mfma_f32_32x32x16_bf16 v[64:79], v[152:155], a[72:75], v[64:79]
  ds_read_b128 a[92:95], v212 offset:23552
  ds_read_b64_tr_b16 v[136:137], v203 offset:0
  v_mfma_f32_32x32x16_bf16 v[80:95], v[152:155], a[76:79], v[80:95]
  ds_read_b64_tr_b16 v[138:139], v203 offset:1024
  s_waitcnt lgkmcnt(8)
  v_mfma_f32_32x32x16_bf16 v[96:111], v[156:159], a[72:75], v[96:111]
  ds_read_b64_tr_b16 v[140:141], v204 offset:0
  s_add_u32 s52, s81, 294912
  buffer_load_dwordx4 v206, s[16:19], s52 offen offset:0 lds
  v_mfma_f32_32x32x16_bf16 v[112:127], v[156:159], a[76:79], v[112:127]
  ds_read_b64_tr_b16 v[142:143], v204 offset:1024
  buffer_load_dwordx4 v207, s[16:19], s52 offen offset:1024 lds
  s_add_u32 m0, s51, 18432
  s_barrier
  s_waitcnt lgkmcnt(7)
  v_mfma_f32_32x32x16_bf16 v[0:15], v[128:131], a[80:83], v[0:15]
  s_waitcnt vmcnt(12)
  ds_read_b128 a[96:99], v212 offset:24576
  ds_read_b64_tr_b16 v[144:145], v201 offset:4096
  buffer_load_dwordx4 v208, s[20:23], s52 offen offset:0 lds
  v_mfma_f32_32x32x16_bf16 v[16:31], v[128:131], a[84:87], v[16:31]
  ds_read_b64_tr_b16 v[146:147], v201 offset:5120
  buffer_load_dwordx4 v209, s[20:23], s52 offen offset:1024 lds
  s_add_u32 m0, s51, 0
  s_waitcnt lgkmcnt(8)
  v_mfma_f32_32x32x16_bf16 v[32:47], v[132:135], a[80:83], v[32:47]
  ds_read_b64_tr_b16 v[148:149], v202 offset:4096
  v_mfma_f32_32x32x16_bf16 v[48:63], v[132:135], a[84:87], v[48:63]
  ds_read_b64_tr_b16 v[150:151], v202 offset:5120
  s_waitcnt lgkmcnt(7)
  v_mfma_f32_32x32x16_bf16 v[64:79], v[136:139], a[80:83], v[64:79]
  ds_read_b128 a[100:103], v212 offset:25600
  ds_read_b64_tr_b16 v[152:153], v203 offset:4096
  v_mfma_f32_32x32x16_bf16 v[80:95], v[136:139], a[84:87], v[80:95]
  ds_read_b64_tr_b16 v[154:155], v203 offset:5120
  s_waitcnt lgkmcnt(8)
  v_mfma_f32_32x32x16_bf16 v[96:111], v[140:143], a[80:83], v[96:111]
  ds_read_b64_tr_b16 v[156:157], v204 offset:4096
  s_add_u32 s52, s81, 442368
  buffer_load_dwordx4 v206, s[16:19], s52 offen offset:0 lds
  v_mfma_f32_32x32x16_bf16 v[112:127], v[140:143], a[84:87], v[112:127]
  ds_read_b64_tr_b16 v[158:159], v204 offset:5120
  buffer_load_dwordx4 v207, s[16:19], s52 offen offset:1024 lds
  s_add_u32 m0, s51, 2048
  s_waitcnt lgkmcnt(7)
  v_mfma_f32_32x32x16_bf16 v[0:15], v[144:147], a[88:91], v[0:15]
  s_waitcnt vmcnt(10)
  ds_read_b128 a[104:107], v212 offset:26624
  ds_read_b64_tr_b16 v[128:129], v201 offset:8192
  buffer_load_dwordx4 v208, s[20:23], s52 offen offset:0 lds
  v_mfma_f32_32x32x16_bf16 v[16:31], v[144:147], a[92:95], v[16:31]
  ds_read_b64_tr_b16 v[130:131], v201 offset:9216
  buffer_load_dwordx4 v209, s[20:23], s52 offen offset:1024 lds
  s_add_u32 m0, s51, 4096
  s_waitcnt lgkmcnt(8)
  v_mfma_f32_32x32x16_bf16 v[32:47], v[148:151], a[88:91], v[32:47]
  ds_read_b64_tr_b16 v[132:133], v202 offset:8192
  v_mfma_f32_32x32x16_bf16 v[48:63], v[148:151], a[92:95], v[48:63]
  ds_read_b64_tr_b16 v[134:135], v202 offset:9216
  s_waitcnt lgkmcnt(7)
  v_mfma_f32_32x32x16_bf16 v[64:79], v[152:155], a[88:91], v[64:79]
  ds_read_b128 a[108:111], v212 offset:27648
  ds_read_b64_tr_b16 v[136:137], v203 offset:8192
  v_mfma_f32_32x32x16_bf16 v[80:95], v[152:155], a[92:95], v[80:95]
  ds_read_b64_tr_b16 v[138:139], v203 offset:9216
  s_waitcnt lgkmcnt(8)
  v_mfma_f32_32x32x16_bf16 v[96:111], v[156:159], a[88:91], v[96:111]
  ds_read_b64_tr_b16 v[140:141], v204 offset:8192
  s_add_u32 s52, s81, 589824
  buffer_load_dwordx4 v206, s[16:19], s52 offen offset:0 lds
  v_mfma_f32_32x32x16_bf16 v[112:127], v[156:159], a[92:95], v[112:127]
  ds_read_b64_tr_b16 v[142:143], v204 offset:9216
  buffer_load_dwordx4 v207, s[16:19], s52 offen offset:1024 lds
  s_add_u32 m0, s79, 40960
  s_waitcnt lgkmcnt(7)
  v_mfma_f32_32x32x16_bf16 v[0:15], v[128:131], a[96:99], v[0:15]
  s_waitcnt vmcnt(10)
  ds_read_b128 a[112:115], v212 offset:28672
  ds_read_b64_tr_b16 v[144:145], v201 offset:12288
  s_add_u32 s53, s90, 8192
  buffer_load_dwordx4 v212, s[28:31], s53 offen lds
  s_add_u32 m0, s51, 6144
  s_nop 0
  buffer_load_dwordx4 v208, s[20:23], s52 offen offset:0 lds
  s_add_u32 m0, s79, 40960
  v_mfma_f32_32x32x16_bf16 v[16:31], v[128:131], a[100:103], v[16:31]
  ds_read_b64_tr_b16 v[146:147], v201 offset:13312
  buffer_load_dwordx4 v222, s[28:31], s53 offen offset:1024 lds
  s_add_u32 m0, s51, 6144
  s_nop 0
  buffer_load_dwordx4 v209, s[20:23], s52 offen offset:1024 lds
  s_add_u32 m0, s51, 8192
  s_waitcnt lgkmcnt(8)
  v_mfma_f32_32x32x16_bf16 v[32:47], v[132:135], a[96:99], v[32:47]
  ds_read_b64_tr_b16 v[148:149], v202 offset:12288
  v_mfma_f32_32x32x16_bf16 v[48:63], v[132:135], a[100:103], v[48:63]
  ds_read_b64_tr_b16 v[150:151], v202 offset:13312
  s_waitcnt lgkmcnt(7)
  v_mfma_f32_32x32x16_bf16 v[64:79], v[136:139], a[96:99], v[64:79]
  ds_read_b128 a[116:119], v212 offset:29696
  ds_read_b64_tr_b16 v[152:153], v203 offset:12288
  v_mfma_f32_32x32x16_bf16 v[80:95], v[136:139], a[100:103], v[80:95]
  ds_read_b64_tr_b16 v[154:155], v203 offset:13312
  s_waitcnt lgkmcnt(8)
  v_mfma_f32_32x32x16_bf16 v[96:111], v[140:143], a[96:99], v[96:111]
  ds_read_b64_tr_b16 v[156:157], v204 offset:12288
  s_add_u32 s52, s81, 737280
  buffer_load_dwordx4 v206, s[16:19], s52 offen offset:0 lds
  v_mfma_f32_32x32x16_bf16 v[112:127], v[140:143], a[100:103], v[112:127]
  ds_read_b64_tr_b16 v[158:159], v204 offset:13312
  buffer_load_dwordx4 v207, s[16:19], s52 offen offset:1024 lds
  s_add_u32 m0, s51, 10240
  s_waitcnt lgkmcnt(7)
  v_mfma_f32_32x32x16_bf16 v[0:15], v[144:147], a[104:107], v[0:15]
  s_waitcnt vmcnt(12)
  ds_read_b128 a[120:123], v212 offset:30720
  ds_read_b64_tr_b16 v[128:129], v201 offset:16384
  buffer_load_dwordx4 v208, s[20:23], s52 offen offset:0 lds
  v_mfma_f32_32x32x16_bf16 v[16:31], v[144:147], a[108:111], v[16:31]
  ds_read_b64_tr_b16 v[130:131], v201 offset:17408
  buffer_load_dwordx4 v209, s[20:23], s52 offen offset:1024 lds
  s_add_u32 m0, s51, 12288
  s_waitcnt lgkmcnt(8)
  v_mfma_f32_32x32x16_bf16 v[32:47], v[148:151], a[104:107], v[32:47]
  ds_read_b64_tr_b16 v[132:133], v202 offset:16384
  v_mfma_f32_32x32x16_bf16 v[48:63], v[148:151], a[108:111], v[48:63]
  ds_read_b64_tr_b16 v[134:135], v202 offset:17408
  s_waitcnt lgkmcnt(7)
  v_mfma_f32_32x32x16_bf16 v[64:79], v[152:155], a[104:107], v[64:79]
  ds_read_b128 a[124:127], v212 offset:31744
  ds_read_b64_tr_b16 v[136:137], v203 offset:16384
  v_mfma_f32_32x32x16_bf16 v[80:95], v[152:155], a[108:111], v[80:95]
  ds_read_b64_tr_b16 v[138:139], v203 offset:17408
  s_waitcnt lgkmcnt(8)
  v_mfma_f32_32x32x16_bf16 v[96:111], v[156:159], a[104:107], v[96:111]
  ds_read_b64_tr_b16 v[140:141], v204 offset:16384
  s_add_u32 s52, s81, 884736
  buffer_load_dwordx4 v206, s[16:19], s52 offen offset:0 lds
  v_mfma_f32_32x32x16_bf16 v[112:127], v[156:159], a[108:111], v[112:127]
  ds_read_b64_tr_b16 v[142:143], v204 offset:17408
  buffer_load_dwordx4 v207, s[16:19], s52 offen offset:1024 lds
  s_add_u32 m0, s51, 14336
  s_barrier
  s_waitcnt lgkmcnt(7)
  v_mfma_f32_32x32x16_bf16 v[0:15], v[128:131], a[112:115], v[0:15]
  s_waitcnt vmcnt(12)
  ds_read_b128 a[128:131], v212 offset:32768
  ds_read_b64_tr_b16 v[144:145], v201 offset:0
  buffer_load_dwordx4 v208, s[20:23], s52 offen offset:0 lds
  v_mfma_f32_32x32x16_bf16 v[16:31], v[128:131], a[116:119], v[16:31]
  ds_read_b64_tr_b16 v[146:147], v201 offset:1024
  buffer_load_dwordx4 v209, s[20:23], s52 offen offset:1024 lds
  s_add_u32 m0, s51, 16384
  s_waitcnt lgkmcnt(8)
  v_mfma_f32_32x32x16_bf16 v[32:47], v[132:135], a[112:115], v[32:47]
  ds_read_b64_tr_b16 v[148:149], v202 offset:0
  v_mfma_f32_32x32x16_bf16 v[48:63], v[132:135], a[116:119], v[48:63]
  ds_read_b64_tr_b16 v[150:151], v202 offset:1024
  s_waitcnt lgkmcnt(7)
  v_mfma_f32_32x32x16_bf16 v[64:79], v[136:139], a[112:115], v[64:79]
  ds_read_b128 a[132:135], v212 offset:33792
  ds_read_b64_tr_b16 v[152:153], v203 offset:0
  v_mfma_f32_32x32x16_bf16 v[80:95], v[136:139], a[116:119], v[80:95]
  ds_read_b64_tr_b16 v[154:155], v203 offset:1024
  s_waitcnt lgkmcnt(8)
  v_mfma_f32_32x32x16_bf16 v[96:111], v[140:143], a[112:115], v[96:111]
  ds_read_b64_tr_b16 v[156:157], v204 offset:0
  s_add_u32 s52, s81, 1032192
  buffer_load_dwordx4 v206, s[16:19], s52 offen offset:0 lds
  v_mfma_f32_32x32x16_bf16 v[112:127], v[140:143], a[116:119], v[112:127]
  ds_read_b64_tr_b16 v[158:159], v204 offset:1024
  buffer_load_dwordx4 v207, s[16:19], s52 offen offset:1024 lds
  s_add_u32 m0, s51, 18432
  s_waitcnt lgkmcnt(7)
  v_mfma_f32_32x32x16_bf16 v[0:15], v[144:147], a[120:123], v[0:15]
  s_waitcnt vmcnt(10)
  ds_read_b128 a[136:139], v212 offset:34816
  ds_read_b64_tr_b16 v[128:129], v201 offset:4096
  buffer_load_dwordx4 v208, s[20:23], s52 offen offset:0 lds
  v_mfma_f32_32x32x16_bf16 v[16:31], v[144:147], a[124:127], v[16:31]
  ds_read_b64_tr_b16 v[130:131], v201 offset:5120
  buffer_load_dwordx4 v209, s[20:23], s52 offen offset:1024 lds
  s_add_u32 m0, s51, 0
  s_waitcnt lgkmcnt(8)
  v_mfma_f32_32x32x16_bf16 v[32:47], v[148:151], a[120:123], v[32:47]
  ds_read_b64_tr_b16 v[132:133], v202 offset:4096
  v_mfma_f32_32x32x16_bf16 v[48:63], v[148:151], a[124:127], v[48:63]
  ds_read_b64_tr_b16 v[134:135], v202 offset:5120
  s_waitcnt lgkmcnt(7)
  v_mfma_f32_32x32x16_bf16 v[64:79], v[152:155], a[120:123], v[64:79]
  ds_read_b128 a[140:143], v212 offset:35840
  ds_read_b64_tr_b16 v[136:137], v203 offset:4096
  v_mfma_f32_32x32x16_bf16 v[80:95], v[152:155], a[124:127], v[80:95]
  ds_read_b64_tr_b16 v[138:139], v203 offset:5120
  s_waitcnt lgkmcnt(8)
  v_mfma_f32_32x32x16_bf16 v[96:111], v[156:159], a[120:123], v[96:111]
  ds_read_b64_tr_b16 v[140:141], v204 offset:4096
  s_add_u32 s52, s81, 1179648
  buffer_load_dwordx4 v206, s[16:19], s52 offen offset:0 lds
  v_mfma_f32_32x32x16_bf16 v[112:127], v[156:159], a[124:127], v[112:127]
  ds_read_b64_tr_b16 v[142:143], v204 offset:5120
  buffer_load_dwordx4 v207, s[16:19], s52 offen offset:1024 lds
  s_add_u32 m0, s79, 49152
  s_waitcnt lgkmcnt(7)
  v_mfma_f32_32x32x16_bf16 v[0:15], v[128:131], a[128:131], v[0:15]
  s_waitcnt vmcnt(10)
  ds_read_b128 a[144:147], v212 offset:36864
  ds_read_b64_tr_b16 v[144:145], v201 offset:8192
  s_add_u32 s53, s91, 0
  buffer_load_dwordx4 v212, s[28:31], s53 offen lds
  s_add_u32 m0, s51, 2048
  s_nop 0
  buffer_load_dwordx4 v208, s[20:23], s52 offen offset:0 lds
  s_add_u32 m0, s79, 49152
  v_mfma_f32_32x32x16_bf16 v[16:31], v[128:131], a[132:135], v[16:31]
  ds_read_b64_tr_b16 v[146:147], v201 offset:9216
  buffer_load_dwordx4 v222, s[28:31], s53 offen offset:1024 lds
  s_add_u32 m0, s51, 2048
  s_nop 0
  buffer_load_dwordx4 v209, s[20:23], s52 offen offset:1024 lds
  s_add_u32 m0, s51, 4096
  s_waitcnt lgkmcnt(8)
  v_mfma_f32_32x32x16_bf16 v[32:47], v[132:135], a[128:131], v[32:47]
  ds_read_b64_tr_b16 v[148:149], v202 offset:8192
  v_mfma_f32_32x32x16_bf16 v[48:63], v[132:135], a[132:135], v[48:63]
  ds_read_b64_tr_b16 v[150:151], v202 offset:9216
  s_waitcnt lgkmcnt(7)
  v_mfma_f32_32x32x16_bf16 v[64:79], v[136:139], a[128:131], v[64:79]
  ds_read_b128 a[148:151], v212 offset:37888
  ds_read_b64_tr_b16 v[152:153], v203 offset:8192
  v_mfma_f32_32x32x16_bf16 v[80:95], v[136:139], a[132:135], v[80:95]
  ds_read_b64_tr_b16 v[154:155], v203 offset:9216
  s_waitcnt lgkmcnt(8)
  v_mfma_f32_32x32x16_bf16 v[96:111], v[140:143], a[128:131], v[96:111]
  ds_read_b64_tr_b16 v[156:157], v204 offset:8192
  s_add_u32 s52, s81, 1327104
  buffer_load_dwordx4 v206, s[16:19], s52 offen offset:0 lds
  v_mfma_f32_32x32x16_bf16 v[112:127], v[140:143], a[132:135], v[112:127]
  ds_read_b64_tr_b16 v[158:159], v204 offset:9216
  buffer_load_dwordx4 v207, s[16:19], s52 offen offset:1024 lds
  s_add_u32 m0, s51, 6144
  s_waitcnt lgkmcnt(7)
  v_mfma_f32_32x32x16_bf16 v[0:15], v[144:147], a[136:139], v[0:15]
  s_waitcnt vmcnt(12)
  ds_read_b128 a[152:155], v212 offset:38912
  ds_read_b64_tr_b16 v[128:129], v201 offset:12288
  buffer_load_dwordx4 v208, s[20:23], s52 offen offset:0 lds
  v_mfma_f32_32x32x16_bf16 v[16:31], v[144:147], a[140:143], v[16:31]
  ds_read_b64_tr_b16 v[130:131], v201 offset:13312
  buffer_load_dwordx4 v209, s[20:23], s52 offen offset:1024 lds
  s_add_u32 m0, s51, 8192
  s_waitcnt lgkmcnt(8)
  v_mfma_f32_32x32x16_bf16 v[32:47], v[148:151], a[136:139], v[32:47]
  ds_read_b64_tr_b16 v[132:133], v202 offset:12288
  v_mfma_f32_32x32x16_bf16 v[48:63], v[148:151], a[140:143], v[48:63]
  ds_read_b64_tr_b16 v[134:135], v202 offset:13312
  s_waitcnt lgkmcnt(7)
  v_mfma_f32_32x32x16_bf16 v[64:79], v[152:155], a[136:139], v[64:79]
  ds_read_b128 a[156:159], v212 offset:39936
  ds_read_b64_tr_b16 v[136:137], v203 offset:12288
  v_mfma_f32_32x32x16_bf16 v[80:95], v[152:155], a[140:143], v[80:95]
  ds_read_b64_tr_b16 v[138:139], v203 offset:13312
  s_waitcnt lgkmcnt(8)
  v_mfma_f32_32x32x16_bf16 v[96:111], v[156:159], a[136:139], v[96:111]
  ds_read_b64_tr_b16 v[140:141], v204 offset:12288
  s_add_u32 s52, s81, 1474560
  buffer_load_dwordx4 v206, s[16:19], s52 offen offset:0 lds
  v_mfma_f32_32x32x16_bf16 v[112:127], v[156:159], a[140:143], v[112:127]
  ds_read_b64_tr_b16 v[142:143], v204 offset:13312
  buffer_load_dwordx4 v207, s[16:19], s52 offen offset:1024 lds
  s_add_u32 m0, s51, 10240
  s_barrier
  s_waitcnt lgkmcnt(7)
  v_mfma_f32_32x32x16_bf16 v[0:15], v[128:131], a[144:147], v[0:15]
  s_waitcnt vmcnt(12)
  ds_read_b128 a[160:163], v212 offset:40960
  ds_read_b64_tr_b16 v[144:145], v201 offset:16384
  buffer_load_dwordx4 v208, s[20:23], s52 offen offset:0 lds
  v_mfma_f32_32x32x16_bf16 v[16:31], v[128:131], a[148:151], v[16:31]
  ds_read_b64_tr_b16 v[146:147], v201 offset:17408
  buffer_load_dwordx4 v209, s[20:23], s52 offen offset:1024 lds
  s_add_u32 m0, s51, 12288
  s_waitcnt lgkmcnt(8)
  v_mfma_f32_32x32x16_bf16 v[32:47], v[132:135], a[144:147], v[32:47]
  ds_read_b64_tr_b16 v[148:149], v202 offset:16384
  v_mfma_f32_32x32x16_bf16 v[48:63], v[132:135], a[148:151], v[48:63]
  ds_read_b64_tr_b16 v[150:151], v202 offset:17408
  s_waitcnt lgkmcnt(7)
  v_mfma_f32_32x32x16_bf16 v[64:79], v[136:139], a[144:147], v[64:79]
  ds_read_b128 a[164:167], v212 offset:41984
  ds_read_b64_tr_b16 v[152:153], v203 offset:16384
  v_mfma_f32_32x32x16_bf16 v[80:95], v[136:139], a[148:151], v[80:95]
  ds_read_b64_tr_b16 v[154:155], v203 offset:17408
  s_waitcnt lgkmcnt(8)
  v_mfma_f32_32x32x16_bf16 v[96:111], v[140:143], a[144:147], v[96:111]
  ds_read_b64_tr_b16 v[156:157], v204 offset:16384
  s_add_u32 s52, s81, 1622016
  buffer_load_dwordx4 v206, s[16:19], s52 offen offset:0 lds
  v_mfma_f32_32x32x16_bf16 v[112:127], v[140:143], a[148:151], v[112:127]
  ds_read_b64_tr_b16 v[158:159], v204 offset:17408
  buffer_load_dwordx4 v207, s[16:19], s52 offen offset:1024 lds
  s_add_u32 m0, s51, 14336
  s_waitcnt lgkmcnt(7)
  v_mfma_f32_32x32x16_bf16 v[0:15], v[144:147], a[152:155], v[0:15]
  s_waitcnt vmcnt(10)
  ds_read_b128 a[168:171], v212 offset:43008
  ds_read_b64_tr_b16 v[128:129], v201 offset:0
  buffer_load_dwordx4 v208, s[20:23], s52 offen offset:0 lds
  v_mfma_f32_32x32x16_bf16 v[16:31], v[144:147], a[156:159], v[16:31]
  ds_read_b64_tr_b16 v[130:131], v201 offset:1024
  buffer_load_dwordx4 v209, s[20:23], s52 offen offset:1024 lds
  s_add_u32 m0, s51, 16384
  s_waitcnt lgkmcnt(8)
  v_mfma_f32_32x32x16_bf16 v[32:47], v[148:151], a[152:155], v[32:47]
  ds_read_b64_tr_b16 v[132:133], v202 offset:0
  v_mfma_f32_32x32x16_bf16 v[48:63], v[148:151], a[156:159], v[48:63]
  ds_read_b64_tr_b16 v[134:135], v202 offset:1024
  s_waitcnt lgkmcnt(7)
  v_mfma_f32_32x32x16_bf16 v[64:79], v[152:155], a[152:155], v[64:79]
  ds_read_b128 a[172:175], v212 offset:44032
  ds_read_b64_tr_b16 v[136:137], v203 offset:0
  v_mfma_f32_32x32x16_bf16 v[80:95], v[152:155], a[156:159], v[80:95]
  ds_read_b64_tr_b16 v[138:139], v203 offset:1024
  s_waitcnt lgkmcnt(8)
  v_mfma_f32_32x32x16_bf16 v[96:111], v[156:159], a[152:155], v[96:111]
  ds_read_b64_tr_b16 v[140:141], v204 offset:0
  s_add_u32 s52, s82, 0
  buffer_load_dwordx4 v206, s[16:19], s52 offen offset:0 lds
  v_mfma_f32_32x32x16_bf16 v[112:127], v[156:159], a[156:159], v[112:127]
  ds_read_b64_tr_b16 v[142:143], v204 offset:1024
  buffer_load_dwordx4 v207, s[16:19], s52 offen offset:1024 lds
  s_add_u32 m0, s79, 57344
  s_waitcnt lgkmcnt(7)
  v_mfma_f32_32x32x16_bf16 v[0:15], v[128:131], a[160:163], v[0:15]
  s_waitcnt vmcnt(10)
  ds_read_b128 a[176:179], v212 offset:45056
  ds_read_b64_tr_b16 v[144:145], v201 offset:4096
  s_add_u32 s53, s91, 4096
  buffer_load_dwordx4 v212, s[28:31], s53 offen lds
  s_add_u32 m0, s51, 18432
  s_nop 0
  buffer_load_dwordx4 v208, s[20:23], s52 offen offset:0 lds
  s_add_u32 m0, s79, 57344
  v_mfma_f32_32x32x16_bf16 v[16:31], v[128:131], a[164:167], v[16:31]
  ds_read_b64_tr_b16 v[146:147], v201 offset:5120
  buffer_load_dwordx4 v222, s[28:31], s53 offen offset:1024 lds
  s_add_u32 m0, s51, 18432
  s_nop 0
  buffer_load_dwordx4 v209, s[20:23], s52 offen offset:1024 lds
  s_add_u32 m0, s51, 0
  s_waitcnt lgkmcnt(8)
  v_mfma_f32_32x32x16_bf16 v[32:47], v[132:135], a[160:163], v[32:47]
  ds_read_b64_tr_b16 v[148:149], v202 offset:4096
  v_mfma_f32_32x32x16_bf16 v[48:63], v[132:135], a[164:167], v[48:63]
  ds_read_b64_tr_b16 v[150:151], v202 offset:5120
  s_waitcnt lgkmcnt(7)
  v_mfma_f32_32x32x16_bf16 v[64:79], v[136:139], a[160:163], v[64:79]
  ds_read_b128 a[180:183], v212 offset:46080
  ds_read_b64_tr_b16 v[152:153], v203 offset:4096
  v_mfma_f32_32x32x16_bf16 v[80:95], v[136:139], a[164:167], v[80:95]
  ds_read_b64_tr_b16 v[154:155], v203 offset:5120
  s_waitcnt lgkmcnt(8)
  v_mfma_f32_32x32x16_bf16 v[96:111], v[140:143], a[160:163], v[96:111]
  ds_read_b64_tr_b16 v[156:157], v204 offset:4096
  s_add_u32 s52, s82, 147456
  buffer_load_dwordx4 v206, s[16:19], s52 offen offset:0 lds
  v_mfma_f32_32x32x16_bf16 v[112:127], v[140:143], a[164:167], v[112:127]
  ds_read_b64_tr_b16 v[158:159], v204 offset:5120
  buffer_load_dwordx4 v207, s[16:19], s52 offen offset:1024 lds
  s_add_u32 m0, s51, 2048
  s_waitcnt lgkmcnt(7)
  v_mfma_f32_32x32x16_bf16 v[0:15], v[144:147], a[168:171], v[0:15]
  s_waitcnt vmcnt(12)
  ds_read_b128 a[184:187], v212 offset:47104
  ds_read_b64_tr_b16 v[128:129], v201 offset:8192
  buffer_load_dwordx4 v208, s[20:23], s52 offen offset:0 lds
  v_mfma_f32_32x32x16_bf16 v[16:31], v[144:147], a[172:175], v[16:31]
  ds_read_b64_tr_b16 v[130:131], v201 offset:9216
  buffer_load_dwordx4 v209, s[20:23], s52 offen offset:1024 lds
  s_add_u32 m0, s51, 4096
  s_waitcnt lgkmcnt(8)
  v_mfma_f32_32x32x16_bf16 v[32:47], v[148:151], a[168:171], v[32:47]
  ds_read_b64_tr_b16 v[132:133], v202 offset:8192
  v_mfma_f32_32x32x16_bf16 v[48:63], v[148:151], a[172:175], v[48:63]
  ds_read_b64_tr_b16 v[134:135], v202 offset:9216
  s_waitcnt lgkmcnt(7)
  v_mfma_f32_32x32x16_bf16 v[64:79], v[152:155], a[168:171], v[64:79]
  ds_read_b128 a[188:191], v212 offset:48128
  ds_read_b64_tr_b16 v[136:137], v203 offset:8192
  v_mfma_f32_32x32x16_bf16 v[80:95], v[152:155], a[172:175], v[80:95]
  ds_read_b64_tr_b16 v[138:139], v203 offset:9216
  s_waitcnt lgkmcnt(8)
  v_mfma_f32_32x32x16_bf16 v[96:111], v[156:159], a[168:171], v[96:111]
  ds_read_b64_tr_b16 v[140:141], v204 offset:8192
  s_add_u32 s52, s82, 294912
  buffer_load_dwordx4 v206, s[16:19], s52 offen offset:0 lds
  v_mfma_f32_32x32x16_bf16 v[112:127], v[156:159], a[172:175], v[112:127]
  ds_read_b64_tr_b16 v[142:143], v204 offset:9216
  buffer_load_dwordx4 v207, s[16:19], s52 offen offset:1024 lds
  s_add_u32 m0, s51, 6144
  s_barrier
  s_waitcnt lgkmcnt(7)
  v_mfma_f32_32x32x16_bf16 v[0:15], v[128:131], a[176:179], v[0:15]
  s_waitcnt vmcnt(12)
  ds_read_b128 a[192:195], v212 offset:49152
  ds_read_b64_tr_b16 v[144:145], v201 offset:12288
  buffer_load_dwordx4 v208, s[20:23], s52 offen offset:0 lds
  v_mfma_f32_32x32x16_bf16 v[16:31], v[128:131], a[180:183], v[16:31]
  ds_read_b64_tr_b16 v[146:147], v201 offset:13312
  buffer_load_dwordx4 v209, s[20:23], s52 offen offset:1024 lds
  s_add_u32 m0, s51, 8192
  s_waitcnt lgkmcnt(8)
  v_mfma_f32_32x32x16_bf16 v[32:47], v[132:135], a[176:179], v[32:47]
  ds_read_b64_tr_b16 v[148:149], v202 offset:12288
  v_mfma_f32_32x32x16_bf16 v[48:63], v[132:135], a[180:183], v[48:63]
  ds_read_b64_tr_b16 v[150:151], v202 offset:13312
  s_waitcnt lgkmcnt(7)
  v_mfma_f32_32x32x16_bf16 v[64:79], v[136:139], a[176:179], v[64:79]
  ds_read_b128 a[196:199], v212 offset:50176
  ds_read_b64_tr_b16 v[152:153], v203 offset:12288
  v_mfma_f32_32x32x16_bf16 v[80:95], v[136:139], a[180:183], v[80:95]
  ds_read_b64_tr_b16 v[154:155], v203 offset:13312
  s_waitcnt lgkmcnt(8)
  v_mfma_f32_32x32x16_bf16 v[96:111], v[140:143], a[176:179], v[96:111]
  ds_read_b64_tr_b16 v[156:157], v204 offset:12288
  s_add_u32 s52, s82, 442368
  buffer_load_dwordx4 v206, s[16:19], s52 offen offset:0 lds
  v_mfma_f32_32x32x16_bf16 v[112:127], v[140:143], a[180:183], v[112:127]
  ds_read_b64_tr_b16 v[158:159], v204 offset:13312
  buffer_load_dwordx4 v207, s[16:19], s52 offen offset:1024 lds
  s_add_u32 m0, s51, 10240
  s_waitcnt lgkmcnt(7)
  v_mfma_f32_32x32x16_bf16 v[0:15], v[144:147], a[184:187], v[0:15]
  s_waitcnt vmcnt(10)
  ds_read_b128 a[200:203], v212 offset:51200
  ds_read_b64_tr_b16 v[128:129], v201 offset:16384
  buffer_load_dwordx4 v208, s[20:23], s52 offen offset:0 lds
  v_mfma_f32_32x32x16_bf16 v[16:31], v[144:147], a[188:191], v[16:31]
  ds_read_b64_tr_b16 v[130:131], v201 offset:17408
  buffer_load_dwordx4 v209, s[20:23], s52 offen offset:1024 lds
  s_add_u32 m0, s51, 12288
  s_waitcnt lgkmcnt(8)
  v_mfma_f32_32x32x16_bf16 v[32:47], v[148:151], a[184:187], v[32:47]
  ds_read_b64_tr_b16 v[132:133], v202 offset:16384
  v_mfma_f32_32x32x16_bf16 v[48:63], v[148:151], a[188:191], v[48:63]
  ds_read_b64_tr_b16 v[134:135], v202 offset:17408
  s_waitcnt lgkmcnt(7)
  v_mfma_f32_32x32x16_bf16 v[64:79], v[152:155], a[184:187], v[64:79]
  ds_read_b128 a[204:207], v212 offset:52224
  ds_read_b64_tr_b16 v[136:137], v203 offset:16384
  v_mfma_f32_32x32x16_bf16 v[80:95], v[152:155], a[188:191], v[80:95]
  ds_read_b64_tr_b16 v[138:139], v203 offset:17408
  s_waitcnt lgkmcnt(8)
  v_mfma_f32_32x32x16_bf16 v[96:111], v[156:159], a[184:187], v[96:111]
  ds_read_b64_tr_b16 v[140:141], v204 offset:16384
  s_add_u32 s52, s82, 589824
  buffer_load_dwordx4 v206, s[16:19], s52 offen offset:0 lds
  v_mfma_f32_32x32x16_bf16 v[112:127], v[156:159], a[188:191], v[112:127]
  ds_read_b64_tr_b16 v[142:143], v204 offset:17408
  buffer_load_dwordx4 v207, s[16:19], s52 offen offset:1024 lds
  s_add_u32 m0, s79, 65536
  s_waitcnt lgkmcnt(7)
  v_mfma_f32_32x32x16_bf16 v[0:15], v[128:131], a[192:195], v[0:15]
  s_waitcnt vmcnt(10)
  ds_read_b128 a[208:211], v212 offset:53248
  ds_read_b64_tr_b16 v[144:145], v201 offset:0
  s_add_u32 s53, s91, 8192
  buffer_load_dwordx4 v212, s[28:31], s53 offen lds
  s_add_u32 m0, s51, 14336
  s_nop 0
  buffer_load_dwordx4 v208, s[20:23], s52 offen offset:0 lds
  s_add_u32 m0, s79, 65536
  v_mfma_f32_32x32x16_bf16 v[16:31], v[128:131], a[196:199], v[16:31]
  ds_read_b64_tr_b16 v[146:147], v201 offset:1024
  buffer_load_dwordx4 v222, s[28:31], s53 offen offset:1024 lds
  s_add_u32 m0, s51, 14336
  s_nop 0
  buffer_load_dwordx4 v209, s[20:23], s52 offen offset:1024 lds
  s_add_u32 m0, s51, 16384
  s_waitcnt lgkmcnt(8)
  v_mfma_f32_32x32x16_bf16 v[32:47], v[132:135], a[192:195], v[32:47]
  ds_read_b64_tr_b16 v[148:149], v202 offset:0
  v_mfma_f32_32x32x16_bf16 v[48:63], v[132:135], a[196:199], v[48:63]
  ds_read_b64_tr_b16 v[150:151], v202 offset:1024
  s_waitcnt lgkmcnt(7)
  v_mfma_f32_32x32x16_bf16 v[64:79], v[136:139], a[192:195], v[64:79]
  ds_read_b128 a[212:215], v212 offset:54272
  ds_read_b64_tr_b16 v[152:153], v203 offset:0
  v_mfma_f32_32x32x16_bf16 v[80:95], v[136:139], a[196:199], v[80:95]
  ds_read_b64_tr_b16 v[154:155], v203 offset:1024
  s_waitcnt lgkmcnt(8)
  v_mfma_f32_32x32x16_bf16 v[96:111], v[140:143], a[192:195], v[96:111]
  ds_read_b64_tr_b16 v[156:157], v204 offset:0
  s_add_u32 s52, s82, 737280
  buffer_load_dwordx4 v206, s[16:19], s52 offen offset:0 lds
  v_mfma_f32_32x32x16_bf16 v[112:127], v[140:143], a[196:199], v[112:127]
  ds_read_b64_tr_b16 v[158:159], v204 offset:1024
  buffer_load_dwordx4 v207, s[16:19], s52 offen offset:1024 lds
  s_add_u32 m0, s51, 18432
  s_waitcnt lgkmcnt(7)
  v_mfma_f32_32x32x16_bf16 v[0:15], v[144:147], a[200:203], v[0:15]
  s_waitcnt vmcnt(12)
  ds_read_b128 a[216:219], v212 offset:55296
  ds_read_b64_tr_b16 v[128:129], v201 offset:4096
  buffer_load_dwordx4 v208, s[20:23], s52 offen offset:0 lds
  v_mfma_f32_32x32x16_bf16 v[16:31], v[144:147], a[204:207], v[16:31]
  ds_read_b64_tr_b16 v[130:131], v201 offset:5120
  buffer_load_dwordx4 v209, s[20:23], s52 offen offset:1024 lds
  s_add_u32 m0, s51, 0
  s_waitcnt lgkmcnt(8)
  v_mfma_f32_32x32x16_bf16 v[32:47], v[148:151], a[200:203], v[32:47]
  ds_read_b64_tr_b16 v[132:133], v202 offset:4096
  v_mfma_f32_32x32x16_bf16 v[48:63], v[148:151], a[204:207], v[48:63]
  ds_read_b64_tr_b16 v[134:135], v202 offset:5120
  s_waitcnt lgkmcnt(7)
  v_mfma_f32_32x32x16_bf16 v[64:79], v[152:155], a[200:203], v[64:79]
  ds_read_b128 a[220:223], v212 offset:56320
  ds_read_b64_tr_b16 v[136:137], v203 offset:4096
  v_mfma_f32_32x32x16_bf16 v[80:95], v[152:155], a[204:207], v[80:95]
  ds_read_b64_tr_b16 v[138:139], v203 offset:5120
  s_waitcnt lgkmcnt(8)
  v_mfma_f32_32x32x16_bf16 v[96:111], v[156:159], a[200:203], v[96:111]
  ds_read_b64_tr_b16 v[140:141], v204 offset:4096
  s_add_u32 s52, s82, 884736
  buffer_load_dwordx4 v206, s[16:19], s52 offen offset:0 lds
  v_mfma_f32_32x32x16_bf16 v[112:127], v[156:159], a[204:207], v[112:127]
  ds_read_b64_tr_b16 v[142:143], v204 offset:5120
  buffer_load_dwordx4 v207, s[16:19], s52 offen offset:1024 lds
  s_add_u32 m0, s51, 2048
  s_barrier
  s_waitcnt lgkmcnt(7)
  v_mfma_f32_32x32x16_bf16 v[0:15], v[128:131], a[208:211], v[0:15]
  s_waitcnt vmcnt(12)
  ds_read_b128 a[224:227], v212 offset:57344
  ds_read_b64_tr_b16 v[144:145], v201 offset:8192
  buffer_load_dwordx4 v208, s[20:23], s52 offen offset:0 lds
  v_mfma_f32_32x32x16_bf16 v[16:31], v[128:131], a[212:215], v[16:31]
  ds_read_b64_tr_b16 v[146:147], v201 offset:9216
  buffer_load_dwordx4 v209, s[20:23], s52 offen offset:1024 lds
  s_add_u32 m0, s51, 4096
  s_waitcnt lgkmcnt(8)
  v_mfma_f32_32x32x16_bf16 v[32:47], v[132:135], a[208:211], v[32:47]
  ds_read_b64_tr_b16 v[148:149], v202 offset:8192
  v_mfma_f32_32x32x16_bf16 v[48:63], v[132:135], a[212:215], v[48:63]
  ds_read_b64_tr_b16 v[150:151], v202 offset:9216
  s_waitcnt lgkmcnt(7)
  v_mfma_f32_32x32x16_bf16 v[64:79], v[136:139], a[208:211], v[64:79]
  ds_read_b128 a[228:231], v212 offset:58368
  ds_read_b64_tr_b16 v[152:153], v203 offset:8192
  v_mfma_f32_32x32x16_bf16 v[80:95], v[136:139], a[212:215], v[80:95]
  ds_read_b64_tr_b16 v[154:155], v203 offset:9216
  s_waitcnt lgkmcnt(8)
  v_mfma_f32_32x32x16_bf16 v[96:111], v[140:143], a[208:211], v[96:111]
  ds_read_b64_tr_b16 v[156:157], v204 offset:8192
  s_add_u32 s52, s82, 1032192
  buffer_load_dwordx4 v206, s[16:19], s52 offen offset:0 lds
  v_mfma_f32_32x32x16_bf16 v[112:127], v[140:143], a[212:215], v[112:127]
  ds_read_b64_tr_b16 v[158:159], v204 offset:9216
  buffer_load_dwordx4 v207, s[16:19], s52 offen offset:1024 lds
  s_add_u32 m0, s51, 6144
  s_waitcnt lgkmcnt(7)
  v_mfma_f32_32x32x16_bf16 v[0:15], v[144:147], a[216:219], v[0:15]
  s_waitcnt vmcnt(10)
  ds_read_b128 a[232:235], v212 offset:59392
  ds_read_b64_tr_b16 v[128:129], v201 offset:12288
  buffer_load_dwordx4 v208, s[20:23], s52 offen offset:0 lds
  v_mfma_f32_32x32x16_bf16 v[16:31], v[144:147], a[220:223], v[16:31]
  ds_read_b64_tr_b16 v[130:131], v201 offset:13312
  buffer_load_dwordx4 v209, s[20:23], s52 offen offset:1024 lds
  s_add_u32 m0, s51, 8192
  s_waitcnt lgkmcnt(8)
  v_mfma_f32_32x32x16_bf16 v[32:47], v[148:151], a[216:219], v[32:47]
  ds_read_b64_tr_b16 v[132:133], v202 offset:12288
  v_mfma_f32_32x32x16_bf16 v[48:63], v[148:151], a[220:223], v[48:63]
  ds_read_b64_tr_b16 v[134:135], v202 offset:13312
  s_waitcnt lgkmcnt(7)
  v_mfma_f32_32x32x16_bf16 v[64:79], v[152:155], a[216:219], v[64:79]
  ds_read_b128 a[236:239], v212 offset:60416
  ds_read_b64_tr_b16 v[136:137], v203 offset:12288
  v_mfma_f32_32x32x16_bf16 v[80:95], v[152:155], a[220:223], v[80:95]
  ds_read_b64_tr_b16 v[138:139], v203 offset:13312
  s_waitcnt lgkmcnt(8)
  v_mfma_f32_32x32x16_bf16 v[96:111], v[156:159], a[216:219], v[96:111]
  ds_read_b64_tr_b16 v[140:141], v204 offset:12288
  s_add_u32 s52, s82, 1179648
  buffer_load_dwordx4 v206, s[16:19], s52 offen offset:0 lds
  v_mfma_f32_32x32x16_bf16 v[112:127], v[156:159], a[220:223], v[112:127]
  ds_read_b64_tr_b16 v[142:143], v204 offset:13312
  buffer_load_dwordx4 v207, s[16:19], s52 offen offset:1024 lds
  s_add_u32 m0, s51, 10240
  s_waitcnt lgkmcnt(7)
  v_mfma_f32_32x32x16_bf16 v[0:15], v[128:131], a[224:227], v[0:15]
  s_waitcnt vmcnt(10)
  ds_read_b128 a[240:243], v212 offset:61440
  ds_read_b64_tr_b16 v[144:145], v201 offset:16384
  buffer_load_dwordx4 v208, s[20:23], s52 offen offset:0 lds
  v_mfma_f32_32x32x16_bf16 v[16:31], v[128:131], a[228:231], v[16:31]
  ds_read_b64_tr_b16 v[146:147], v201 offset:17408
  buffer_load_dwordx4 v209, s[20:23], s52 offen offset:1024 lds
  s_add_u32 m0, s51, 12288
  s_waitcnt lgkmcnt(8)
  v_mfma_f32_32x32x16_bf16 v[32:47], v[132:135], a[224:227], v[32:47]
  ds_read_b64_tr_b16 v[148:149], v202 offset:16384
  v_mfma_f32_32x32x16_bf16 v[48:63], v[132:135], a[228:231], v[48:63]
  ds_read_b64_tr_b16 v[150:151], v202 offset:17408
  s_waitcnt lgkmcnt(7)
  v_mfma_f32_32x32x16_bf16 v[64:79], v[136:139], a[224:227], v[64:79]
  ds_read_b128 a[244:247], v212 offset:62464
  ds_read_b64_tr_b16 v[152:153], v203 offset:16384
  v_mfma_f32_32x32x16_bf16 v[80:95], v[136:139], a[228:231], v[80:95]
  ds_read_b64_tr_b16 v[154:155], v203 offset:17408
  s_waitcnt lgkmcnt(8)
  v_mfma_f32_32x32x16_bf16 v[96:111], v[140:143], a[224:227], v[96:111]
  ds_read_b64_tr_b16 v[156:157], v204 offset:16384
  s_add_u32 s52, s82, 1327104
  buffer_load_dwordx4 v206, s[16:19], s52 offen offset:0 lds
  v_mfma_f32_32x32x16_bf16 v[112:127], v[140:143], a[228:231], v[112:127]
  ds_read_b64_tr_b16 v[158:159], v204 offset:17408
  buffer_load_dwordx4 v207, s[16:19], s52 offen offset:1024 lds
  s_add_u32 m0, s51, 14336
  s_waitcnt lgkmcnt(7)
  v_mfma_f32_32x32x16_bf16 v[0:15], v[144:147], a[232:235], v[0:15]
  s_waitcnt vmcnt(10)
  ds_read_b128 a[248:251], v212 offset:63488
  ds_read_b64_tr_b16 v[128:129], v201 offset:0
  buffer_load_dwordx4 v208, s[20:23], s52 offen offset:0 lds
  v_mfma_f32_32x32x16_bf16 v[16:31], v[144:147], a[236:239], v[16:31]
  ds_read_b64_tr_b16 v[130:131], v201 offset:1024
  buffer_load_dwordx4 v209, s[20:23], s52 offen offset:1024 lds
  s_add_u32 m0, s51, 16384
  s_waitcnt lgkmcnt(8)
  v_mfma_f32_32x32x16_bf16 v[32:47], v[148:151], a[232:235], v[32:47]
  ds_read_b64_tr_b16 v[132:133], v202 offset:0
  v_mfma_f32_32x32x16_bf16 v[48:63], v[148:151], a[236:239], v[48:63]
  ds_read_b64_tr_b16 v[134:135], v202 offset:1024
  s_waitcnt lgkmcnt(7)
  v_mfma_f32_32x32x16_bf16 v[64:79], v[152:155], a[232:235], v[64:79]
  ds_read_b128 a[252:255], v212 offset:64512
  ds_read_b64_tr_b16 v[136:137], v203 offset:0
  v_mfma_f32_32x32x16_bf16 v[80:95], v[152:155], a[236:239], v[80:95]
  ds_read_b64_tr_b16 v[138:139], v203 offset:1024
  s_waitcnt lgkmcnt(8)
  v_mfma_f32_32x32x16_bf16 v[96:111], v[156:159], a[232:235], v[96:111]
  ds_read_b64_tr_b16 v[140:141], v204 offset:0
  s_add_u32 s52, s82, 1474560
  buffer_load_dwordx4 v206, s[16:19], s52 offen offset:0 lds
  v_mfma_f32_32x32x16_bf16 v[112:127], v[156:159], a[236:239], v[112:127]
  ds_read_b64_tr_b16 v[142:143], v204 offset:1024
  buffer_load_dwordx4 v207, s[16:19], s52 offen offset:1024 lds
  s_add_u32 m0, s51, 18432
  s_barrier
  s_waitcnt lgkmcnt(7)
  v_mfma_f32_32x32x16_bf16 v[0:15], v[128:131], a[240:243], v[0:15]
  s_waitcnt vmcnt(10)
  ds_read_b128 v[224:227], v213 offset:0
  ds_read_b64_tr_b16 v[144:145], v201 offset:4096
  buffer_load_dwordx4 v208, s[20:23], s52 offen offset:0 lds
  v_mfma_f32_32x32x16_bf16 v[16:31], v[128:131], a[244:247], v[16:31]
  ds_read_b64_tr_b16 v[146:147], v201 offset:5120
  buffer_load_dwordx4 v209, s[20:23], s52 offen offset:1024 lds
  s_add_u32 m0, s51, 0
  s_waitcnt lgkmcnt(8)
  v_mfma_f32_32x32x16_bf16 v[32:47], v[132:135], a[240:243], v[32:47]
  ds_read_b64_tr_b16 v[148:149], v202 offset:4096
  v_mfma_f32_32x32x16_bf16 v[48:63], v[132:135], a[244:247], v[48:63]
  ds_read_b64_tr_b16 v[150:151], v202 offset:5120
  s_waitcnt lgkmcnt(7)
  v_mfma_f32_32x32x16_bf16 v[64:79], v[136:139], a[240:243], v[64:79]
  ds_read_b128 v[228:231], v213 offset:1024
  ds_read_b64_tr_b16 v[152:153], v203 offset:4096
  v_mfma_f32_32x32x16_bf16 v[80:95], v[136:139], a[244:247], v[80:95]
  ds_read_b64_tr_b16 v[154:155], v203 offset:5120
  s_waitcnt lgkmcnt(8)
  v_mfma_f32_32x32x16_bf16 v[96:111], v[140:143], a[240:243], v[96:111]
  ds_read_b64_tr_b16 v[156:157], v204 offset:4096
  s_add_u32 s52, s82, 1622016
  buffer_load_dwordx4 v206, s[16:19], s52 offen offset:0 lds
  v_mfma_f32_32x32x16_bf16 v[112:127], v[140:143], a[244:247], v[112:127]
  ds_read_b64_tr_b16 v[158:159], v204 offset:5120
  buffer_load_dwordx4 v207, s[16:19], s52 offen offset:1024 lds
  s_add_u32 m0, s51, 2048
  s_waitcnt lgkmcnt(7)
  v_mfma_f32_32x32x16_bf16 v[0:15], v[144:147], a[248:251], v[0:15]
  s_waitcnt vmcnt(10)
  ds_read_b128 v[232:235], v213 offset:2048
  ds_read_b64_tr_b16 v[128:129], v201 offset:8192
  buffer_load_dwordx4 v208, s[20:23], s52 offen offset:0 lds
  v_mfma_f32_32x32x16_bf16 v[16:31], v[144:147], a[252:255], v[16:31]
  ds_read_b64_tr_b16 v[130:131], v201 offset:9216
  buffer_load_dwordx4 v209, s[20:23], s52 offen offset:1024 lds
  s_add_u32 m0, s51, 4096
  s_waitcnt lgkmcnt(8)
  v_mfma_f32_32x32x16_bf16 v[32:47], v[148:151], a[248:251], v[32:47]
  ds_read_b64_tr_b16 v[132:133], v202 offset:8192
  v_mfma_f32_32x32x16_bf16 v[48:63], v[148:151], a[252:255], v[48:63]
  ds_read_b64_tr_b16 v[134:135], v202 offset:9216
  s_waitcnt lgkmcnt(7)
  v_mfma_f32_32x32x16_bf16 v[64:79], v[152:155], a[248:251], v[64:79]
  ds_read_b128 v[236:239], v213 offset:3072
  ds_read_b64_tr_b16 v[136:137], v203 offset:8192
  v_mfma_f32_32x32x16_bf16 v[80:95], v[152:155], a[252:255], v[80:95]
  ds_read_b64_tr_b16 v[138:139], v203 offset:9216
  s_waitcnt lgkmcnt(8)
  v_mfma_f32_32x32x16_bf16 v[96:111], v[156:159], a[248:251], v[96:111]
  ds_read_b64_tr_b16 v[140:141], v204 offset:8192
  s_add_u32 s52, s86, 0
  buffer_load_dwordx4 v210, s[44:47], s52 offen offset:0 lds
  v_mfma_f32_32x32x16_bf16 v[112:127], v[156:159], a[252:255], v[112:127]
  ds_read_b64_tr_b16 v[142:143], v204 offset:9216
  buffer_load_dwordx4 v210, s[44:47], s52 offen offset:1024 lds
  s_add_u32 m0, s51, 6144
  s_waitcnt lgkmcnt(7)
  v_mfma_f32_32x32x16_bf16 v[0:15], v[128:131], v[224:227], v[0:15]
  s_waitcnt vmcnt(10)
  ds_read_b128 v[240:243], v213 offset:4096
  ds_read_b64_tr_b16 v[144:145], v201 offset:12288
  s_add_u32 s52, s86, 2048
  buffer_load_dwordx4 v210, s[44:47], s52 offen offset:0 lds
  v_mfma_f32_32x32x16_bf16 v[16:31], v[128:131], v[228:231], v[16:31]
  ds_read_b64_tr_b16 v[146:147], v201 offset:13312
  buffer_load_dwordx4 v210, s[44:47], s52 offen offset:1024 lds
  s_add_u32 m0, s51, 8192
  s_waitcnt lgkmcnt(8)
  v_mfma_f32_32x32x16_bf16 v[32:47], v[132:135], v[224:227], v[32:47]
  ds_read_b64_tr_b16 v[148:149], v202 offset:12288
  v_mfma_f32_32x32x16_bf16 v[48:63], v[132:135], v[228:231], v[48:63]
  ds_read_b64_tr_b16 v[150:151], v202 offset:13312
  s_waitcnt lgkmcnt(7)
  v_mfma_f32_32x32x16_bf16 v[64:79], v[136:139], v[224:227], v[64:79]
  ds_read_b128 v[244:247], v213 offset:5120
  ds_read_b64_tr_b16 v[152:153], v203 offset:12288
  v_mfma_f32_32x32x16_bf16 v[80:95], v[136:139], v[228:231], v[80:95]
  ds_read_b64_tr_b16 v[154:155], v203 offset:13312
  s_waitcnt lgkmcnt(8)
  v_mfma_f32_32x32x16_bf16 v[96:111], v[140:143], v[224:227], v[96:111]
  ds_read_b64_tr_b16 v[156:157], v204 offset:12288
  s_add_u32 s52, s86, 4096
  buffer_load_dwordx4 v210, s[44:47], s52 offen offset:0 lds
  v_mfma_f32_32x32x16_bf16 v[112:127], v[140:143], v[228:231], v[112:127]
  ds_read_b64_tr_b16 v[158:159], v204 offset:13312
  buffer_load_dwordx4 v210, s[44:47], s52 offen offset:1024 lds
  s_add_u32 m0, s51, 10240
  s_waitcnt lgkmcnt(7)
  v_mfma_f32_32x32x16_bf16 v[0:15], v[144:147], v[232:235], v[0:15]
  s_waitcnt vmcnt(10)
  ds_read_b128 v[248:251], v213 offset:6144
  ds_read_b64_tr_b16 v[128:129], v201 offset:16384
  s_add_u32 s52, s86, 6144
  buffer_load_dwordx4 v210, s[44:47], s52 offen offset:0 lds
  v_mfma_f32_32x32x16_bf16 v[16:31], v[144:147], v[236:239], v[16:31]
  ds_read_b64_tr_b16 v[130:131], v201 offset:17408
  buffer_load_dwordx4 v210, s[44:47], s52 offen offset:1024 lds
  s_add_u32 m0, s51, 12288
  s_waitcnt lgkmcnt(8)
  v_mfma_f32_32x32x16_bf16 v[32:47], v[148:151], v[232:235], v[32:47]
  ds_read_b64_tr_b16 v[132:133], v202 offset:16384
  v_mfma_f32_32x32x16_bf16 v[48:63], v[148:151], v[236:239], v[48:63]
  ds_read_b64_tr_b16 v[134:135], v202 offset:17408
  s_waitcnt lgkmcnt(7)
  v_mfma_f32_32x32x16_bf16 v[64:79], v[152:155], v[232:235], v[64:79]
  ds_read_b128 v[252:255], v213 offset:7168
  ds_read_b64_tr_b16 v[136:137], v203 offset:16384
  v_mfma_f32_32x32x16_bf16 v[80:95], v[152:155], v[236:239], v[80:95]
  ds_read_b64_tr_b16 v[138:139], v203 offset:17408
  s_waitcnt lgkmcnt(8)
  v_mfma_f32_32x32x16_bf16 v[96:111], v[156:159], v[232:235], v[96:111]
  ds_read_b64_tr_b16 v[140:141], v204 offset:16384
  s_add_u32 s52, s86, 8192
  buffer_load_dwordx4 v210, s[44:47], s52 offen offset:0 lds
  v_mfma_f32_32x32x16_bf16 v[112:127], v[156:159], v[236:239], v[112:127]
  ds_read_b64_tr_b16 v[142:143], v204 offset:17408
  buffer_load_dwordx4 v210, s[44:47], s52 offen offset:1024 lds
  s_add_u32 m0, s51, 14336
  s_waitcnt lgkmcnt(7)
  v_mfma_f32_32x32x16_bf16 v[0:15], v[128:131], v[240:243], v[0:15]
  s_waitcnt vmcnt(10)
  ds_read_b64_tr_b16 v[144:145], v201 offset:0
  s_add_u32 s52, s86, 10240
  buffer_load_dwordx4 v210, s[44:47], s52 offen offset:0 lds
  v_mfma_f32_32x32x16_bf16 v[16:31], v[128:131], v[244:247], v[16:31]
  ds_read_b64_tr_b16 v[146:147], v201 offset:1024
  buffer_load_dwordx4 v210, s[44:47], s52 offen offset:1024 lds
  s_add_u32 m0, s51, 16384
  s_waitcnt lgkmcnt(7)
  v_mfma_f32_32x32x16_bf16 v[32:47], v[132:135], v[240:243], v[32:47]
  ds_read_b64_tr_b16 v[148:149], v202 offset:0
  v_mfma_f32_32x32x16_bf16 v[48:63], v[132:135], v[244:247], v[48:63]
  ds_read_b64_tr_b16 v[150:151], v202 offset:1024
  s_waitcnt lgkmcnt(6)
  v_mfma_f32_32x32x16_bf16 v[64:79], v[136:139], v[240:243], v[64:79]
  ds_read_b64_tr_b16 v[152:153], v203 offset:0
  v_mfma_f32_32x32x16_bf16 v[80:95], v[136:139], v[244:247], v[80:95]
  ds_read_b64_tr_b16 v[154:155], v203 offset:1024
  s_waitcnt lgkmcnt(6)
  v_mfma_f32_32x32x16_bf16 v[96:111], v[140:143], v[240:243], v[96:111]
  ds_read_b64_tr_b16 v[156:157], v204 offset:0
  s_add_u32 s52, s87, 0
  buffer_load_dwordx4 v210, s[44:47], s52 offen offset:0 lds
  v_mfma_f32_32x32x16_bf16 v[112:127], v[140:143], v[244:247], v[112:127]
  ds_read_b64_tr_b16 v[158:159], v204 offset:1024
  buffer_load_dwordx4 v210, s[44:47], s52 offen offset:1024 lds
  s_add_u32 m0, s51, 18432
  s_waitcnt lgkmcnt(6)
  v_mfma_f32_32x32x16_bf16 v[0:15], v[144:147], v[248:251], v[0:15]
  s_waitcnt vmcnt(12)
  ds_read_b64_tr_b16 v[128:129], v205 offset:4096
  s_add_u32 s52, s87, 2048
  buffer_load_dwordx4 v210, s[44:47], s52 offen offset:0 lds
  v_mfma_f32_32x32x16_bf16 v[16:31], v[144:147], v[252:255], v[16:31]
  ds_read_b64_tr_b16 v[130:131], v205 offset:4352
  buffer_load_dwordx4 v210, s[44:47], s52 offen offset:1024 lds
  s_add_u32 m0, s51, 20480
  s_waitcnt lgkmcnt(6)
  v_mfma_f32_32x32x16_bf16 v[32:47], v[148:151], v[248:251], v[32:47]
  ds_read_b64_tr_b16 v[132:133], v205 offset:4608
  s_add_u32 s52, s87, 4096
  buffer_load_dwordx4 v210, s[44:47], s52 offen offset:0 lds
  v_mfma_f32_32x32x16_bf16 v[48:63], v[148:151], v[252:255], v[48:63]
  ds_read_b64_tr_b16 v[134:135], v205 offset:4864
  buffer_load_dwordx4 v210, s[44:47], s52 offen offset:1024 lds
  s_add_u32 m0, s51, 0
  s_waitcnt lgkmcnt(6)
  v_mfma_f32_32x32x16_bf16 v[64:79], v[152:155], v[248:251], v[64:79]
  s_waitcnt vmcnt(14)
  ds_read_b64_tr_b16 v[136:137], v205 offset:6144
  v_mfma_f32_32x32x16_bf16 v[80:95], v[152:155], v[252:255], v[80:95]
  ds_read_b64_tr_b16 v[138:139], v205 offset:6400
  s_waitcnt lgkmcnt(6)
  v_mfma_f32_32x32x16_bf16 v[96:111], v[156:159], v[248:251], v[96:111]
  ds_read_b64_tr_b16 v[140:141], v205 offset:6656
  s_add_u32 s52, s87, 6144
  buffer_load_dwordx4 v210, s[44:47], s52 offen offset:0 lds
  v_mfma_f32_32x32x16_bf16 v[112:127], v[156:159], v[252:255], v[112:127]
  ds_read_b64_tr_b16 v[142:143], v205 offset:6912
  buffer_load_dwordx4 v210, s[44:47], s52 offen offset:1024 lds
  s_add_u32 m0, s51, 2048
  s_barrier
  s_waitcnt lgkmcnt(6)
  v_mfma_f32_32x32x16_bf16 v[160:175], v[128:131], a[0:3], 0
  s_waitcnt vmcnt(14)
  ds_read_b64_tr_b16 v[144:145], v205 offset:8192
  s_add_u32 s52, s87, 8192
  buffer_load_dwordx4 v210, s[44:47], s52 offen offset:0 lds
  v_mfma_f32_32x32x16_bf16 v[176:191], v[128:131], a[4:7], 0
  ds_read_b64_tr_b16 v[146:147], v205 offset:8448
  buffer_load_dwordx4 v210, s[44:47], s52 offen offset:1024 lds
  s_add_u32 m0, s51, 4096
  v_max_f32 v0, 0, v0
  v_max_f32 v1, 0, v1
  v_mul_f32 v0, v0, v8
  s_waitcnt lgkmcnt(6)
  v_mfma_f32_32x32x16_bf16 v[160:175], v[132:135], a[8:11], v[160:175]
  ds_read_b64_tr_b16 v[148:149], v205 offset:8704
  s_add_u32 s52, s87, 10240
  buffer_load_dwordx4 v210, s[44:47], s52 offen offset:0 lds
  v_mul_f32 v1, v1, v9
  v_mfma_f32_32x32x16_bf16 v[176:191], v[132:135], a[12:15], v[176:191]
  ds_read_b64_tr_b16 v[150:151], v205 offset:8960
  buffer_load_dwordx4 v210, s[44:47], s52 offen offset:1024 lds
  s_add_u32 m0, s51, 6144
  v_cvt_pk_bf16_f32 v0, v0, v1
  v_max_f32 v2, 0, v2
  v_max_f32 v3, 0, v3
  s_waitcnt lgkmcnt(6)
  v_mfma_f32_32x32x16_bf16 v[160:175], v[136:139], a[16:19], v[160:175]
  s_waitcnt vmcnt(16)
  ds_read_b64_tr_b16 v[152:153], v205 offset:10240
  v_mul_f32 v2, v2, v10
  v_mul_f32 v3, v3, v11
  v_cvt_pk_bf16_f32 v1, v2, v3
  v_mfma_f32_32x32x16_bf16 v[176:191], v[136:139], a[20:23], v[176:191]
  ds_read_b64_tr_b16 v[154:155], v205 offset:10496
  v_max_f32 v4, 0, v4
  v_max_f32 v5, 0, v5
  v_mul_f32 v4, v4, v12
  v_mul_f32 v5, v5, v13
  s_waitcnt lgkmcnt(6)
  v_mfma_f32_32x32x16_bf16 v[160:175], v[140:143], a[24:27], v[160:175]
  ds_read_b64_tr_b16 v[156:157], v205 offset:10752
  v_cvt_pk_bf16_f32 v2, v4, v5
  v_max_f32 v6, 0, v6
  v_max_f32 v7, 0, v7
  v_mul_f32 v6, v6, v14
  v_mfma_f32_32x32x16_bf16 v[176:191], v[140:143], a[28:31], v[176:191]
  ds_read_b64_tr_b16 v[158:159], v205 offset:11008
  v_mul_f32 v7, v7, v15
  v_cvt_pk_bf16_f32 v3, v6, v7
  ds_write_b128 v214, v[0:3] offset:0
  v_max_f32 v16, 0, v16
  s_waitcnt lgkmcnt(7)
  v_mfma_f32_32x32x16_bf16 v[160:175], v[144:147], a[32:35], v[160:175]
  s_waitcnt vmcnt(14)
  ds_read_b64_tr_b16 v[128:129], v205 offset:12288
  v_max_f32 v17, 0, v17
  v_mul_f32 v16, v16, v24
  v_mul_f32 v17, v17, v25
  v_mfma_f32_32x32x16_bf16 v[176:191], v[144:147], a[36:39], v[176:191]
  ds_read_b64_tr_b16 v[130:131], v205 offset:12544
  v_cvt_pk_bf16_f32 v16, v16, v17
  v_max_f32 v18, 0, v18
  v_max_f32 v19, 0, v19
  v_mul_f32 v18, v18, v26
  s_waitcnt lgkmcnt(7)
  v_mfma_f32_32x32x16_bf16 v[160:175], v[148:151], a[40:43], v[160:175]
  ds_read_b64_tr_b16 v[132:133], v205 offset:12800
  s_add_u32 s52, s83, 0
  buffer_load_dwordx4 v206, s[16:19], s52 offen offset:0 lds
  v_mul_f32 v19, v19, v27
  v_mfma_f32_32x32x16_bf16 v[176:191], v[148:151], a[44:47], v[176:191]
  ds_read_b64_tr_b16 v[134:135], v205 offset:13056
  buffer_load_dwordx4 v207, s[16:19], s52 offen offset:1024 lds
  s_add_u32 m0, s51, 8192
  v_cvt_pk_bf16_f32 v17, v18, v19
  v_max_f32 v20, 0, v20
  s_waitcnt lgkmcnt(7)
  v_mfma_f32_32x32x16_bf16 v[160:175], v[152:155], a[48:51], v[160:175]
  s_waitcnt vmcnt(14)
  ds_read_b64_tr_b16 v[136:137], v205 offset:14336
  buffer_load_dwordx4 v208, s[20:23], s52 offen offset:0 lds
  v_max_f32 v21, 0, v21
  v_mul_f32 v20, v20, v28
  v_mfma_f32_32x32x16_bf16 v[176:191], v[152:155], a[52:55], v[176:191]
  ds_read_b64_tr_b16 v[138:139], v205 offset:14592
  buffer_load_dwordx4 v209, s[20:23], s52 offen offset:1024 lds
  s_add_u32 m0, s51, 10240
  v_mul_f32 v21, v21, v29
  v_cvt_pk_bf16_f32 v18, v20, v21
  v_max_f32 v22, 0, v22
  s_waitcnt lgkmcnt(7)
  v_mfma_f32_32x32x16_bf16 v[160:175], v[156:159], a[56:59], v[160:175]
  ds_read_b64_tr_b16 v[140:141], v205 offset:14848
  v_max_f32 v23, 0, v23
  v_mul_f32 v22, v22, v30
  v_mul_f32 v23, v23, v31
  v_cvt_pk_bf16_f32 v19, v22, v23
  v_mfma_f32_32x32x16_bf16 v[176:191], v[156:159], a[60:63], v[176:191]
  ds_read_b64_tr_b16 v[142:143], v205 offset:15104
  ds_write_b128 v214, v[16:19] offset:1024
  v_max_f32 v32, 0, v32
  v_max_f32 v33, 0, v33
  v_mul_f32 v32, v32, v40
  s_waitcnt lgkmcnt(7)
  v_mfma_f32_32x32x16_bf16 v[160:175], v[128:131], a[64:67], v[160:175]
  s_waitcnt vmcnt(14)
  ds_read_b64_tr_b16 v[144:145], v205 offset:16384
  v_mul_f32 v33, v33, v41
  v_cvt_pk_bf16_f32 v32, v32, v33
  v_max_f32 v34, 0, v34
  v_mfma_f32_32x32x16_bf16 v[176:191], v[128:131], a[68:71], v[176:191]
  ds_read_b64_tr_b16 v[146:147], v205 offset:16640
  v_max_f32 v35, 0, v35
  v_mul_f32 v34, v34, v42
  v_mul_f32 v35, v35, v43
  v_cvt_pk_bf16_f32 v33, v34, v35
  s_waitcnt lgkmcnt(7)
  v_mfma_f32_32x32x16_bf16 v[160:175], v[132:135], a[72:75], v[160:175]
  ds_read_b64_tr_b16 v[148:149], v205 offset:16896
  s_add_u32 s52, s83, 147456
  buffer_load_dwordx4 v206, s[16:19], s52 offen offset:0 lds
  v_max_f32 v36, 0, v36
  v_mfma_f32_32x32x16_bf16 v[176:191], v[132:135], a[76:79], v[176:191]
  ds_read_b64_tr_b16 v[150:151], v205 offset:17152
  buffer_load_dwordx4 v207, s[16:19], s52 offen offset:1024 lds
  s_add_u32 m0, s51, 12288
  v_max_f32 v37, 0, v37
  v_mul_f32 v36, v36, v44
  s_waitcnt lgkmcnt(7)
  v_mfma_f32_32x32x16_bf16 v[160:175], v[136:139], a[80:83], v[160:175]
  s_waitcnt vmcnt(14)
  ds_read_b64_tr_b16 v[152:153], v205 offset:18432
  buffer_load_dwordx4 v208, s[20:23], s52 offen offset:0 lds
  v_mul_f32 v37, v37, v45
  v_cvt_pk_bf16_f32 v34, v36, v37
  v_mfma_f32_32x32x16_bf16 v[176:191], v[136:139], a[84:87], v[176:191]
  ds_read_b64_tr_b16 v[154:155], v205 offset:18688
  buffer_load_dwordx4 v209, s[20:23], s52 offen offset:1024 lds
  s_add_u32 m0, s51, 14336
  v_max_f32 v38, 0, v38
  v_max_f32 v39, 0, v39
  v_mul_f32 v38, v38, v46
  s_waitcnt lgkmcnt(7)
  v_mfma_f32_32x32x16_bf16 v[160:175], v[140:143], a[88:91], v[160:175]
  ds_read_b64_tr_b16 v[156:157], v205 offset:18944
  v_mul_f32 v39, v39, v47
  v_cvt_pk_bf16_f32 v35, v38, v39
  ds_write_b128 v214, v[32:35] offset:2048
  v_max_f32 v48, 0, v48
  v_mfma_f32_32x32x16_bf16 v[176:191], v[140:143], a[92:95], v[176:191]
  ds_read_b64_tr_b16 v[158:159], v205 offset:19200
  v_max_f32 v49, 0, v49
  v_mul_f32 v48, v48, v56
  v_mul_f32 v49, v49, v57
  v_cvt_pk_bf16_f32 v48, v48, v49
  s_waitcnt lgkmcnt(7)
  v_mfma_f32_32x32x16_bf16 v[160:175], v[144:147], a[96:99], v[160:175]
  s_waitcnt vmcnt(14)
  ds_read_b64_tr_b16 v[128:129], v205 offset:20480
  v_max_f32 v50, 0, v50
  v_max_f32 v51, 0, v51
  v_mul_f32 v50, v50, v58
  v_mfma_f32_32x32x16_bf16 v[176:191], v[144:147], a[100:103], v[176:191]
  ds_read_b64_tr_b16 v[130:131], v205 offset:20736
  v_mul_f32 v51, v51, v59
  v_cvt_pk_bf16_f32 v49, v50, v51
  v_max_f32 v52, 0, v52
  v_max_f32 v53, 0, v53
  s_waitcnt lgkmcnt(7)
  v_mfma_f32_32x32x16_bf16 v[160:175], v[148:151], a[104:107], v[160:175]
  ds_read_b64_tr_b16 v[132:133], v205 offset:20992
  s_add_u32 s52, s83, 294912
  buffer_load_dwordx4 v206, s[16:19], s52 offen offset:0 lds
  v_mul_f32 v52, v52, v60
  v_mfma_f32_32x32x16_bf16 v[176:191], v[148:151], a[108:111], v[176:191]
  ds_read_b64_tr_b16 v[134:135], v205 offset:21248
  buffer_load_dwordx4 v207, s[16:19], s52 offen offset:1024 lds
  s_add_u32 m0, s51, 16384
  v_mul_f32 v53, v53, v61
  v_cvt_pk_bf16_f32 v50, v52, v53
  s_waitcnt lgkmcnt(7)
  v_mfma_f32_32x32x16_bf16 v[160:175], v[152:155], a[112:115], v[160:175]
  s_waitcnt vmcnt(14)
  ds_read_b64_tr_b16 v[136:137], v205 offset:0
  buffer_load_dwordx4 v208, s[20:23], s52 offen offset:0 lds
  v_max_f32 v54, 0, v54
  v_max_f32 v55, 0, v55
  v_mfma_f32_32x32x16_bf16 v[176:191], v[152:155], a[116:119], v[176:191]
  ds_read_b64_tr_b16 v[138:139], v205 offset:256
  buffer_load_dwordx4 v209, s[20:23], s52 offen offset:1024 lds
  s_add_u32 m0, s51, 18432
  v_mul_f32 v54, v54, v62
  v_mul_f32 v55, v55, v63
  v_cvt_pk_bf16_f32 v51, v54, v55
  s_waitcnt lgkmcnt(6)
  v_mfma_f32_32x32x16_bf16 v[160:175], v[156:159], a[120:123], v[160:175]
  ds_read_b64_tr_b16 v[140:141], v205 offset:512
  ds_write_b128 v214, v[48:51] offset:3072
  v_max_f32 v64, 0, v64
  v_max_f32 v65, 0, v65
  v_mul_f32 v64, v64, v72
  v_mfma_f32_32x32x16_bf16 v[176:191], v[156:159], a[124:127], v[176:191]
  ds_read_b64_tr_b16 v[142:143], v205 offset:768
  v_mul_f32 v65, v65, v73
  v_cvt_pk_bf16_f32 v64, v64, v65
  v_max_f32 v66, 0, v66
  v_max_f32 v67, 0, v67
  s_waitcnt lgkmcnt(7)
  v_mfma_f32_32x32x16_bf16 v[160:175], v[128:131], a[128:131], v[160:175]
  s_waitcnt vmcnt(14)
  ds_read_b64_tr_b16 v[144:145], v205 offset:2048
  v_mul_f32 v66, v66, v74
  v_mul_f32 v67, v67, v75
  v_cvt_pk_bf16_f32 v65, v66, v67
  v_mfma_f32_32x32x16_bf16 v[176:191], v[128:131], a[132:135], v[176:191]
  ds_read_b64_tr_b16 v[146:147], v205 offset:2304
  v_max_f32 v68, 0, v68
  v_max_f32 v69, 0, v69
  v_mul_f32 v68, v68, v76
  v_mul_f32 v69, v69, v77
  s_waitcnt lgkmcnt(7)
  v_mfma_f32_32x32x16_bf16 v[160:175], v[132:135], a[136:139], v[160:175]
  ds_read_b64_tr_b16 v[148:149], v205 offset:2560
  s_add_u32 s52, s83, 442368
  buffer_load_dwordx4 v206, s[16:19], s52 offen offset:0 lds
  v_cvt_pk_bf16_f32 v66, v68, v69
  v_mfma_f32_32x32x16_bf16 v[176:191], v[132:135], a[140:143], v[176:191]
  ds_read_b64_tr_b16 v[150:151], v205 offset:2816
  buffer_load_dwordx4 v207, s[16:19], s52 offen offset:1024 lds
  s_add_u32 m0, s51, 20480
  v_max_f32 v70, 0, v70
  v_max_f32 v71, 0, v71
  s_waitcnt lgkmcnt(7)
  v_mfma_f32_32x32x16_bf16 v[160:175], v[136:139], a[144:147], v[160:175]
  s_waitcnt vmcnt(14)
  ds_read_b64_tr_b16 v[152:153], v205 offset:4096
  buffer_load_dwordx4 v208, s[20:23], s52 offen offset:0 lds
  v_mul_f32 v70, v70, v78
  v_mul_f32 v71, v71, v79
  v_mfma_f32_32x32x16_bf16 v[176:191], v[136:139], a[148:151], v[176:191]
  ds_read_b64_tr_b16 v[154:155], v205 offset:4352
  buffer_load_dwordx4 v209, s[20:23], s52 offen offset:1024 lds
  s_add_u32 m0, s51, 0
  v_cvt_pk_bf16_f32 v67, v70, v71
  ds_write_b128 v214, v[64:67] offset:4096
  v_max_f32 v80, 0, v80
  s_waitcnt lgkmcnt(7)
  v_mfma_f32_32x32x16_bf16 v[160:175], v[140:143], a[152:155], v[160:175]
  ds_read_b64_tr_b16 v[156:157], v205 offset:4608
  v_max_f32 v81, 0, v81
  v_mul_f32 v80, v80, v88
  v_mul_f32 v81, v81, v89
  v_cvt_pk_bf16_f32 v80, v80, v81
  v_mfma_f32_32x32x16_bf16 v[176:191], v[140:143], a[156:159], v[176:191]
  ds_read_b64_tr_b16 v[158:159], v205 offset:4864
  v_max_f32 v82, 0, v82
  v_max_f32 v83, 0, v83
  v_mul_f32 v82, v82, v90
  v_mul_f32 v83, v83, v91
  s_waitcnt lgkmcnt(7)
  v_mfma_f32_32x32x16_bf16 v[160:175], v[144:147], a[160:163], v[160:175]
  s_waitcnt vmcnt(12)
  ds_read_b64_tr_b16 v[128:129], v201 offset:6144
  v_cvt_pk_bf16_f32 v81, v82, v83
  v_max_f32 v84, 0, v84
  v_max_f32 v85, 0, v85
  v_mfma_f32_32x32x16_bf16 v[176:191], v[144:147], a[164:167], v[176:191]
  ds_read_b64_tr_b16 v[130:131], v201 offset:7168
  v_mul_f32 v84, v84, v92
  v_mul_f32 v85, v85, v93
  v_cvt_pk_bf16_f32 v82, v84, v85
  v_max_f32 v86, 0, v86
  s_waitcnt lgkmcnt(7)
  v_mfma_f32_32x32x16_bf16 v[160:175], v[148:151], a[168:171], v[160:175]
  ds_read_b64_tr_b16 v[132:133], v202 offset:6144
  s_add_u32 s52, s83, 589824
  buffer_load_dwordx4 v206, s[16:19], s52 offen offset:0 lds
  v_max_f32 v87, 0, v87
  v_mfma_f32_32x32x16_bf16 v[176:191], v[148:151], a[172:175], v[176:191]
  ds_read_b64_tr_b16 v[134:135], v202 offset:7168
  buffer_load_dwordx4 v207, s[16:19], s52 offen offset:1024 lds
  s_add_u32 m0, s51, 2048
  v_mul_f32 v86, v86, v94
  v_mul_f32 v87, v87, v95
  s_waitcnt lgkmcnt(7)
  v_mfma_f32_32x32x16_bf16 v[160:175], v[152:155], a[176:179], v[160:175]
  ds_read_b64_tr_b16 v[136:137], v203 offset:6144
  buffer_load_dwordx4 v208, s[20:23], s52 offen offset:0 lds
  v_cvt_pk_bf16_f32 v83, v86, v87
  ds_write_b128 v214, v[80:83] offset:5120
  v_max_f32 v96, 0, v96
  v_mfma_f32_32x32x16_bf16 v[176:191], v[152:155], a[180:183], v[176:191]
  ds_read_b64_tr_b16 v[138:139], v203 offset:7168
  buffer_load_dwordx4 v209, s[20:23], s52 offen offset:1024 lds
  s_add_u32 m0, s51, 4096
  v_max_f32 v97, 0, v97
  v_mul_f32 v96, v96, v104
  v_mul_f32 v97, v97, v105
  s_waitcnt lgkmcnt(7)
  v_mfma_f32_32x32x16_bf16 v[160:175], v[156:159], a[184:187], v[160:175]
  ds_read_b64_tr_b16 v[140:141], v204 offset:6144
  v_cvt_pk_bf16_f32 v96, v96, v97
  v_max_f32 v98, 0, v98
  v_max_f32 v99, 0, v99
  v_mul_f32 v98, v98, v106
  v_mfma_f32_32x32x16_bf16 v[176:191], v[156:159], a[188:191], v[176:191]
  ds_read_b64_tr_b16 v[142:143], v204 offset:7168
  v_mul_f32 v99, v99, v107
  v_cvt_pk_bf16_f32 v97, v98, v99
  v_max_f32 v100, 0, v100
  v_max_f32 v101, 0, v101
  v_mul_f32 v100, v100, v108
  v_mul_f32 v101, v101, v109
  v_cvt_pk_bf16_f32 v98, v100, v101
  v_max_f32 v102, 0, v102
  v_max_f32 v103, 0, v103
  v_mul_f32 v102, v102, v110
  v_mul_f32 v103, v103, v111
  v_cvt_pk_bf16_f32 v99, v102, v103
  ds_write_b128 v214, v[96:99] offset:6144
  v_max_f32 v112, 0, v112
  v_max_f32 v113, 0, v113
  v_mul_f32 v112, v112, v120
  v_mul_f32 v113, v113, v121
  v_cvt_pk_bf16_f32 v112, v112, v113
  v_max_f32 v114, 0, v114
  v_max_f32 v115, 0, v115
  v_mul_f32 v114, v114, v122
  v_mul_f32 v115, v115, v123
  v_cvt_pk_bf16_f32 v113, v114, v115
  v_max_f32 v116, 0, v116
  v_max_f32 v117, 0, v117
  v_mul_f32 v116, v116, v124
  v_mul_f32 v117, v117, v125
  v_cvt_pk_bf16_f32 v114, v116, v117
  v_max_f32 v118, 0, v118
  v_max_f32 v119, 0, v119
  v_mul_f32 v118, v118, v126
  v_mul_f32 v119, v119, v127
  v_cvt_pk_bf16_f32 v115, v118, v119
  ds_write_b128 v214, v[112:115] offset:7168
  s_waitcnt lgkmcnt(9)
  v_mfma_f32_32x32x16_bf16 v[0:15], v[128:131], a[0:3], 0
  s_waitcnt vmcnt(12)
  ds_read_b64_tr_b16 v[144:145], v201 offset:10240
  v_mfma_f32_32x32x16_bf16 v[16:31], v[128:131], a[4:7], 0
  ds_read_b64_tr_b16 v[146:147], v201 offset:11264
  s_waitcnt lgkmcnt(9)
  v_mfma_f32_32x32x16_bf16 v[32:47], v[132:135], a[0:3], 0
  ds_read_b64_tr_b16 v[148:149], v202 offset:10240
  v_mfma_f32_32x32x16_bf16 v[48:63], v[132:135], a[4:7], 0
  ds_read_b64_tr_b16 v[150:151], v202 offset:11264
  s_waitcnt lgkmcnt(8)
  v_mfma_f32_32x32x16_bf16 v[64:79], v[136:139], a[0:3], 0
  ds_read_b64_tr_b16 v[152:153], v203 offset:10240
  v_mfma_f32_32x32x16_bf16 v[80:95], v[136:139], a[4:7], 0
  ds_read_b64_tr_b16 v[154:155], v203 offset:11264
  s_waitcnt lgkmcnt(8)
  v_mfma_f32_32x32x16_bf16 v[96:111], v[140:143], a[0:3], 0
  ds_read_b64_tr_b16 v[156:157], v204 offset:10240
  s_add_u32 s52, s83, 737280
  buffer_load_dwordx4 v206, s[16:19], s52 offen offset:0 lds
  v_mfma_f32_32x32x16_bf16 v[112:127], v[140:143], a[4:7], 0
  ds_read_b64_tr_b16 v[158:159], v204 offset:11264
  buffer_load_dwordx4 v207, s[16:19], s52 offen offset:1024 lds
  s_add_u32 m0, s51, 6144
  s_waitcnt lgkmcnt(6)
  v_mfma_f32_32x32x16_bf16 v[0:15], v[144:147], a[8:11], v[0:15]
  s_waitcnt vmcnt(10)
  ds_read_b64_tr_b16 v[128:129], v201 offset:14336
  buffer_load_dwordx4 v208, s[20:23], s52 offen offset:0 lds
  v_mfma_f32_32x32x16_bf16 v[16:31], v[144:147], a[12:15], v[16:31]
  ds_read_b64_tr_b16 v[130:131], v201 offset:15360
  buffer_load_dwordx4 v209, s[20:23], s52 offen offset:1024 lds
  s_add_u32 m0, s51, 8192
  s_waitcnt lgkmcnt(6)
  v_mfma_f32_32x32x16_bf16 v[32:47], v[148:151], a[8:11], v[32:47]
  ds_read_b64_tr_b16 v[132:133], v202 offset:14336
  v_mfma_f32_32x32x16_bf16 v[48:63], v[148:151], a[12:15], v[48:63]
  ds_read_b64_tr_b16 v[134:135], v202 offset:15360
  s_waitcnt lgkmcnt(6)
  v_mfma_f32_32x32x16_bf16 v[64:79], v[152:155], a[8:11], v[64:79]
  ds_read_b64_tr_b16 v[136:137], v203 offset:14336
  v_mfma_f32_32x32x16_bf16 v[80:95], v[152:155], a[12:15], v[80:95]
  ds_read_b64_tr_b16 v[138:139], v203 offset:15360
  s_waitcnt lgkmcnt(6)
  v_mfma_f32_32x32x16_bf16 v[96:111], v[156:159], a[8:11], v[96:111]
  ds_read_b64_tr_b16 v[140:141], v204 offset:14336
  s_add_u32 s52, s83, 884736
  buffer_load_dwordx4 v206, s[16:19], s52 offen offset:0 lds
  v_mfma_f32_32x32x16_bf16 v[112:127], v[156:159], a[12:15], v[112:127]
  ds_read_b64_tr_b16 v[142:143], v204 offset:15360
  buffer_load_dwordx4 v207, s[16:19], s52 offen offset:1024 lds
  s_add_u32 m0, s51, 10240
  s_waitcnt lgkmcnt(6)
  v_mfma_f32_32x32x16_bf16 v[0:15], v[128:131], a[16:19], v[0:15]
  s_waitcnt vmcnt(10)
  ds_read_b64_tr_b16 v[144:145], v201 offset:18432
  buffer_load_dwordx4 v208, s[20:23], s52 offen offset:0 lds
  v_mfma_f32_32x32x16_bf16 v[16:31], v[128:131], a[20:23], v[16:31]
  ds_read_b64_tr_b16 v[146:147], v201 offset:19456
  buffer_load_dwordx4 v209, s[20:23], s52 offen offset:1024 lds
  s_add_u32 m0, s51, 12288
  s_waitcnt lgkmcnt(6)
  v_mfma_f32_32x32x16_bf16 v[32:47], v[132:135], a[16:19], v[32:47]
  ds_read_b64_tr_b16 v[148:149], v202 offset:18432
  v_mfma_f32_32x32x16_bf16 v[48:63], v[132:135], a[20:23], v[48:63]
  ds_read_b64_tr_b16 v[150:151], v202 offset:19456
  s_waitcnt lgkmcnt(6)
  v_mfma_f32_32x32x16_bf16 v[64:79], v[136:139], a[16:19], v[64:79]
  ds_read_b64_tr_b16 v[152:153], v203 offset:18432
  v_mfma_f32_32x32x16_bf16 v[80:95], v[136:139], a[20:23], v[80:95]
  ds_read_b64_tr_b16 v[154:155], v203 offset:19456
  s_waitcnt lgkmcnt(6)
  v_mfma_f32_32x32x16_bf16 v[96:111], v[140:143], a[16:19], v[96:111]
  ds_read_b64_tr_b16 v[156:157], v204 offset:18432
  s_add_u32 s52, s83, 1032192
  buffer_load_dwordx4 v206, s[16:19], s52 offen offset:0 lds
  v_mfma_f32_32x32x16_bf16 v[112:127], v[140:143], a[20:23], v[112:127]
  ds_read_b64_tr_b16 v[158:159], v204 offset:19456
  buffer_load_dwordx4 v207, s[16:19], s52 offen offset:1024 lds
  s_add_u32 m0, s51, 14336
  s_waitcnt lgkmcnt(6)
  v_mfma_f32_32x32x16_bf16 v[0:15], v[144:147], a[24:27], v[0:15]
  s_waitcnt vmcnt(10)
  ds_read_b64_tr_b16 v[128:129], v201 offset:0
  buffer_load_dwordx4 v208, s[20:23], s52 offen offset:0 lds
  v_mfma_f32_32x32x16_bf16 v[16:31], v[144:147], a[28:31], v[16:31]
  ds_read_b64_tr_b16 v[130:131], v201 offset:1024
  buffer_load_dwordx4 v209, s[20:23], s52 offen offset:1024 lds
  s_add_u32 m0, s51, 16384
  s_waitcnt lgkmcnt(6)
  v_mfma_f32_32x32x16_bf16 v[32:47], v[148:151], a[24:27], v[32:47]
  ds_read_b64_tr_b16 v[132:133], v202 offset:0
  v_mfma_f32_32x32x16_bf16 v[48:63], v[148:151], a[28:31], v[48:63]
  ds_read_b64_tr_b16 v[134:135], v202 offset:1024
  s_waitcnt lgkmcnt(6)
  v_mfma_f32_32x32x16_bf16 v[64:79], v[152:155], a[24:27], v[64:79]
  ds_read_b64_tr_b16 v[136:137], v203 offset:0
  v_mfma_f32_32x32x16_bf16 v[80:95], v[152:155], a[28:31], v[80:95]
  ds_read_b64_tr_b16 v[138:139], v203 offset:1024
  s_waitcnt lgkmcnt(6)
  v_mfma_f32_32x32x16_bf16 v[96:111], v[156:159], a[24:27], v[96:111]
  ds_read_b64_tr_b16 v[140:141], v204 offset:0
  s_add_u32 s52, s83, 1179648
  buffer_load_dwordx4 v206, s[16:19], s52 offen offset:0 lds
  v_mfma_f32_32x32x16_bf16 v[112:127], v[156:159], a[28:31], v[112:127]
  ds_read_b64_tr_b16 v[142:143], v204 offset:1024
  buffer_load_dwordx4 v207, s[16:19], s52 offen offset:1024 lds
  s_add_u32 m0, s51, 18432
  s_waitcnt lgkmcnt(6)
  v_mfma_f32_32x32x16_bf16 v[0:15], v[128:131], a[32:35], v[0:15]
  s_waitcnt vmcnt(10)
  ds_read_b64_tr_b16 v[144:145], v201 offset:4096
  buffer_load_dwordx4 v208, s[20:23], s52 offen offset:0 lds
  v_mfma_f32_32x32x16_bf16 v[16:31], v[128:131], a[36:39], v[16:31]
  ds_read_b64_tr_b16 v[146:147], v201 offset:5120
  buffer_load_dwordx4 v209, s[20:23], s52 offen offset:1024 lds
  s_add_u32 m0, s51, 0
  s_waitcnt lgkmcnt(6)
  v_mfma_f32_32x32x16_bf16 v[32:47], v[132:135], a[32:35], v[32:47]
  ds_read_b64_tr_b16 v[148:149], v202 offset:4096
  v_mfma_f32_32x32x16_bf16 v[48:63], v[132:135], a[36:39], v[48:63]
  ds_read_b64_tr_b16 v[150:151], v202 offset:5120
  s_waitcnt lgkmcnt(6)
  v_mfma_f32_32x32x16_bf16 v[64:79], v[136:139], a[32:35], v[64:79]
  ds_read_b64_tr_b16 v[152:153], v203 offset:4096
  v_mfma_f32_32x32x16_bf16 v[80:95], v[136:139], a[36:39], v[80:95]
  ds_read_b64_tr_b16 v[154:155], v203 offset:5120
  s_waitcnt lgkmcnt(6)
  v_mfma_f32_32x32x16_bf16 v[96:111], v[140:143], a[32:35], v[96:111]
  ds_read_b64_tr_b16 v[156:157], v204 offset:4096
  s_add_u32 s52, s83, 1327104
  buffer_load_dwordx4 v206, s[16:19], s52 offen offset:0 lds
  v_mfma_f32_32x32x16_bf16 v[112:127], v[140:143], a[36:39], v[112:127]
  ds_read_b64_tr_b16 v[158:159], v204 offset:5120
  buffer_load_dwordx4 v207, s[16:19], s52 offen offset:1024 lds
  s_add_u32 m0, s51, 2048
  s_waitcnt lgkmcnt(6)
  v_mfma_f32_32x32x16_bf16 v[0:15], v[144:147], a[40:43], v[0:15]
  s_waitcnt vmcnt(10)
  ds_read_b64_tr_b16 v[128:129], v201 offset:8192
  buffer_load_dwordx4 v208, s[20:23], s52 offen offset:0 lds
  v_mfma_f32_32x32x16_bf16 v[16:31], v[144:147], a[44:47], v[16:31]
  ds_read_b64_tr_b16 v[130:131], v201 offset:9216
  buffer_load_dwordx4 v209, s[20:23], s52 offen offset:1024 lds
  s_add_u32 m0, s51, 4096
  s_waitcnt lgkmcnt(6)
  v_mfma_f32_32x32x16_bf16 v[32:47], v[148:151], a[40:43], v[32:47]
  ds_read_b64_tr_b16 v[132:133], v202 offset:8192
  v_mfma_f32_32x32x16_bf16 v[48:63], v[148:151], a[44:47], v[48:63]
  ds_read_b64_tr_b16 v[134:135], v202 offset:9216
  s_waitcnt lgkmcnt(6)
  v_mfma_f32_32x32x16_bf16 v[64:79], v[152:155], a[40:43], v[64:79]
  ds_read_b64_tr_b16 v[136:137], v203 offset:8192
  v_mfma_f32_32x32x16_bf16 v[80:95], v[152:155], a[44:47], v[80:95]
  ds_read_b64_tr_b16 v[138:139], v203 offset:9216
  s_waitcnt lgkmcnt(6)
  v_mfma_f32_32x32x16_bf16 v[96:111], v[156:159], a[40:43], v[96:111]
  ds_read_b64_tr_b16 v[140:141], v204 offset:8192
  s_add_u32 s52, s83, 1474560
  buffer_load_dwordx4 v206, s[16:19], s52 offen offset:0 lds
  v_mfma_f32_32x32x16_bf16 v[112:127], v[156:159], a[44:47], v[112:127]
  ds_read_b64_tr_b16 v[142:143], v204 offset:9216
  buffer_load_dwordx4 v207, s[16:19], s52 offen offset:1024 lds
  s_add_u32 m0, s51, 6144
  s_waitcnt lgkmcnt(6)
  v_mfma_f32_32x32x16_bf16 v[0:15], v[128:131], a[48:51], v[0:15]
  s_waitcnt vmcnt(10)
  ds_read_b64_tr_b16 v[144:145], v201 offset:12288
  buffer_load_dwordx4 v208, s[20:23], s52 offen offset:0 lds
  v_mfma_f32_32x32x16_bf16 v[16:31], v[128:131], a[52:55], v[16:31]
  ds_read_b64_tr_b16 v[146:147], v201 offset:13312
  buffer_load_dwordx4 v209, s[20:23], s52 offen offset:1024 lds
  s_add_u32 m0, s51, 8192
  s_waitcnt lgkmcnt(6)
  v_mfma_f32_32x32x16_bf16 v[32:47], v[132:135], a[48:51], v[32:47]
  ds_read_b64_tr_b16 v[148:149], v202 offset:12288
  v_mfma_f32_32x32x16_bf16 v[48:63], v[132:135], a[52:55], v[48:63]
  ds_read_b64_tr_b16 v[150:151], v202 offset:13312
  s_waitcnt lgkmcnt(6)
  v_mfma_f32_32x32x16_bf16 v[64:79], v[136:139], a[48:51], v[64:79]
  ds_read_b64_tr_b16 v[152:153], v203 offset:12288
  v_mfma_f32_32x32x16_bf16 v[80:95], v[136:139], a[52:55], v[80:95]
  ds_read_b64_tr_b16 v[154:155], v203 offset:13312
  s_waitcnt lgkmcnt(6)
  v_mfma_f32_32x32x16_bf16 v[96:111], v[140:143], a[48:51], v[96:111]
  ds_read_b64_tr_b16 v[156:157], v204 offset:12288
  s_add_u32 s52, s83, 1622016
  buffer_load_dwordx4 v206, s[16:19], s52 offen offset:0 lds
  v_mfma_f32_32x32x16_bf16 v[112:127], v[140:143], a[52:55], v[112:127]
  ds_read_b64_tr_b16 v[158:159], v204 offset:13312
  buffer_load_dwordx4 v207, s[16:19], s52 offen offset:1024 lds
  s_add_u32 m0, s51, 10240
  s_waitcnt lgkmcnt(6)
  v_mfma_f32_32x32x16_bf16 v[0:15], v[144:147], a[56:59], v[0:15]
  s_waitcnt vmcnt(10)
  ds_read_b64_tr_b16 v[128:129], v201 offset:16384
  buffer_load_dwordx4 v208, s[20:23], s52 offen offset:0 lds
  v_mfma_f32_32x32x16_bf16 v[16:31], v[144:147], a[60:63], v[16:31]
  ds_read_b64_tr_b16 v[130:131], v201 offset:17408
  buffer_load_dwordx4 v209, s[20:23], s52 offen offset:1024 lds
  s_add_u32 m0, s51, 12288
  s_waitcnt lgkmcnt(6)
  v_mfma_f32_32x32x16_bf16 v[32:47], v[148:151], a[56:59], v[32:47]
  ds_read_b64_tr_b16 v[132:133], v202 offset:16384
  v_mfma_f32_32x32x16_bf16 v[48:63], v[148:151], a[60:63], v[48:63]
  ds_read_b64_tr_b16 v[134:135], v202 offset:17408
  s_waitcnt lgkmcnt(6)
  v_mfma_f32_32x32x16_bf16 v[64:79], v[152:155], a[56:59], v[64:79]
  ds_read_b64_tr_b16 v[136:137], v203 offset:16384
  v_mfma_f32_32x32x16_bf16 v[80:95], v[152:155], a[60:63], v[80:95]
  ds_read_b64_tr_b16 v[138:139], v203 offset:17408
  s_waitcnt lgkmcnt(6)
  v_mfma_f32_32x32x16_bf16 v[96:111], v[156:159], a[56:59], v[96:111]
  ds_read_b64_tr_b16 v[140:141], v204 offset:16384
  s_add_u32 s52, s84, 0
  buffer_load_dwordx4 v206, s[16:19], s52 offen offset:0 lds
  v_mfma_f32_32x32x16_bf16 v[112:127], v[156:159], a[60:63], v[112:127]
  ds_read_b64_tr_b16 v[142:143], v204 offset:17408
  buffer_load_dwordx4 v207, s[16:19], s52 offen offset:1024 lds
  s_add_u32 m0, s51, 14336
  s_waitcnt lgkmcnt(0)
  s_barrier
  v_mfma_f32_32x32x16_bf16 v[0:15], v[128:131], a[64:67], v[0:15]
  s_waitcnt vmcnt(10)
  ds_read_b64_tr_b16 v[144:145], v201 offset:0
  buffer_load_dwordx4 v208, s[20:23], s52 offen offset:0 lds
  v_mfma_f32_32x32x16_bf16 v[16:31], v[128:131], a[68:71], v[16:31]
  ds_read_b64_tr_b16 v[146:147], v201 offset:1024
  buffer_load_dwordx4 v209, s[20:23], s52 offen offset:1024 lds
  s_add_u32 m0, s51, 16384
  v_mfma_f32_32x32x16_bf16 v[32:47], v[132:135], a[64:67], v[32:47]
  ds_read_b64_tr_b16 v[148:149], v202 offset:0
  v_mfma_f32_32x32x16_bf16 v[48:63], v[132:135], a[68:71], v[48:63]
  ds_read_b64_tr_b16 v[150:151], v202 offset:1024
  v_mfma_f32_32x32x16_bf16 v[64:79], v[136:139], a[64:67], v[64:79]
  ds_read_b64_tr_b16 v[152:153], v203 offset:0
  v_mfma_f32_32x32x16_bf16 v[80:95], v[136:139], a[68:71], v[80:95]
  ds_read_b64_tr_b16 v[154:155], v203 offset:1024
  v_mfma_f32_32x32x16_bf16 v[96:111], v[140:143], a[64:67], v[96:111]
  ds_read_b64_tr_b16 v[156:157], v204 offset:0
  s_add_u32 s52, s84, 147456
  buffer_load_dwordx4 v206, s[16:19], s52 offen offset:0 lds
  v_mfma_f32_32x32x16_bf16 v[112:127], v[140:143], a[68:71], v[112:127]
  ds_read_b64_tr_b16 v[158:159], v204 offset:1024
  buffer_load_dwordx4 v207, s[16:19], s52 offen offset:1024 lds
  s_add_u32 m0, s51, 18432
  s_waitcnt lgkmcnt(6)
  v_mfma_f32_32x32x16_bf16 v[0:15], v[144:147], a[72:75], v[0:15]
  s_waitcnt vmcnt(10)
  ds_read_b64_tr_b16 v[128:129], v201 offset:4096
  buffer_load_dwordx4 v208, s[20:23], s52 offen offset:0 lds
  v_mfma_f32_32x32x16_bf16 v[16:31], v[144:147], a[76:79], v[16:31]
  ds_read_b64_tr_b16 v[130:131], v201 offset:5120
  buffer_load_dwordx4 v209, s[20:23], s52 offen offset:1024 lds
  s_add_u32 m0, s51, 0
  s_waitcnt lgkmcnt(6)
  v_mfma_f32_32x32x16_bf16 v[32:47], v[148:151], a[72:75], v[32:47]
  ds_read_b64_tr_b16 v[132:133], v202 offset:4096
  v_mfma_f32_32x32x16_bf16 v[48:63], v[148:151], a[76:79], v[48:63]
  ds_read_b64_tr_b16 v[134:135], v202 offset:5120
  s_waitcnt lgkmcnt(6)
  v_mfma_f32_32x32x16_bf16 v[64:79], v[152:155], a[72:75], v[64:79]
  ds_read_b64_tr_b16 v[136:137], v203 offset:4096
  v_mfma_f32_32x32x16_bf16 v[80:95], v[152:155], a[76:79], v[80:95]
  ds_read_b64_tr_b16 v[138:139], v203 offset:5120
  s_waitcnt lgkmcnt(6)
  v_mfma_f32_32x32x16_bf16 v[96:111], v[156:159], a[72:75], v[96:111]
  ds_read_b64_tr_b16 v[140:141], v204 offset:4096
  s_add_u32 s52, s84, 294912
  buffer_load_dwordx4 v206, s[16:19], s52 offen offset:0 lds
  v_mfma_f32_32x32x16_bf16 v[112:127], v[156:159], a[76:79], v[112:127]
  ds_read_b64_tr_b16 v[142:143], v204 offset:5120
  buffer_load_dwordx4 v207, s[16:19], s52 offen offset:1024 lds
  s_add_u32 m0, s51, 2048
  s_waitcnt lgkmcnt(6)
  v_mfma_f32_32x32x16_bf16 v[0:15], v[128:131], a[80:83], v[0:15]
  s_waitcnt vmcnt(10)
  ds_read_b64_tr_b16 v[144:145], v201 offset:8192
  buffer_load_dwordx4 v208, s[20:23], s52 offen offset:0 lds
  v_mfma_f32_32x32x16_bf16 v[16:31], v[128:131], a[84:87], v[16:31]
  ds_read_b64_tr_b16 v[146:147], v201 offset:9216
  buffer_load_dwordx4 v209, s[20:23], s52 offen offset:1024 lds
  s_add_u32 m0, s51, 4096
  s_waitcnt lgkmcnt(6)
  v_mfma_f32_32x32x16_bf16 v[32:47], v[132:135], a[80:83], v[32:47]
  ds_read_b64_tr_b16 v[148:149], v202 offset:8192
  v_mfma_f32_32x32x16_bf16 v[48:63], v[132:135], a[84:87], v[48:63]
  ds_read_b64_tr_b16 v[150:151], v202 offset:9216
  s_waitcnt lgkmcnt(6)
  v_mfma_f32_32x32x16_bf16 v[64:79], v[136:139], a[80:83], v[64:79]
  ds_read_b64_tr_b16 v[152:153], v203 offset:8192
  v_mfma_f32_32x32x16_bf16 v[80:95], v[136:139], a[84:87], v[80:95]
  ds_read_b64_tr_b16 v[154:155], v203 offset:9216
  s_waitcnt lgkmcnt(6)
  v_mfma_f32_32x32x16_bf16 v[96:111], v[140:143], a[80:83], v[96:111]
  ds_read_b64_tr_b16 v[156:157], v204 offset:8192
  s_add_u32 s52, s84, 442368
  buffer_load_dwordx4 v206, s[16:19], s52 offen offset:0 lds
  v_mfma_f32_32x32x16_bf16 v[112:127], v[140:143], a[84:87], v[112:127]
  ds_read_b64_tr_b16 v[158:159], v204 offset:9216
  buffer_load_dwordx4 v207, s[16:19], s52 offen offset:1024 lds
  s_add_u32 m0, s51, 6144
  s_waitcnt lgkmcnt(6)
  v_mfma_f32_32x32x16_bf16 v[0:15], v[144:147], a[88:91], v[0:15]
  s_waitcnt vmcnt(10)
  ds_read_b64_tr_b16 v[128:129], v201 offset:12288
  buffer_load_dwordx4 v208, s[20:23], s52 offen offset:0 lds
  v_mfma_f32_32x32x16_bf16 v[16:31], v[144:147], a[92:95], v[16:31]
  ds_read_b64_tr_b16 v[130:131], v201 offset:13312
  buffer_load_dwordx4 v209, s[20:23], s52 offen offset:1024 lds
  s_add_u32 m0, s51, 8192
  s_waitcnt lgkmcnt(6)
  v_mfma_f32_32x32x16_bf16 v[32:47], v[148:151], a[88:91], v[32:47]
  ds_read_b64_tr_b16 v[132:133], v202 offset:12288
  v_mfma_f32_32x32x16_bf16 v[48:63], v[148:151], a[92:95], v[48:63]
  ds_read_b64_tr_b16 v[134:135], v202 offset:13312
  s_waitcnt lgkmcnt(6)
  v_mfma_f32_32x32x16_bf16 v[64:79], v[152:155], a[88:91], v[64:79]
  ds_read_b64_tr_b16 v[136:137], v203 offset:12288
  v_mfma_f32_32x32x16_bf16 v[80:95], v[152:155], a[92:95], v[80:95]
  ds_read_b64_tr_b16 v[138:139], v203 offset:13312
  s_waitcnt lgkmcnt(6)
  v_mfma_f32_32x32x16_bf16 v[96:111], v[156:159], a[88:91], v[96:111]
  ds_read_b64_tr_b16 v[140:141], v204 offset:12288
  s_add_u32 s52, s84, 589824
  buffer_load_dwordx4 v206, s[16:19], s52 offen offset:0 lds
  v_mfma_f32_32x32x16_bf16 v[112:127], v[156:159], a[92:95], v[112:127]
  ds_read_b64_tr_b16 v[142:143], v204 offset:13312
  buffer_load_dwordx4 v207, s[16:19], s52 offen offset:1024 lds
  s_add_u32 m0, s51, 10240
  s_waitcnt lgkmcnt(6)
  v_mfma_f32_32x32x16_bf16 v[0:15], v[128:131], a[96:99], v[0:15]
  s_waitcnt vmcnt(10)
  ds_read_b64_tr_b16 v[144:145], v201 offset:16384
  buffer_load_dwordx4 v208, s[20:23], s52 offen offset:0 lds
  v_mfma_f32_32x32x16_bf16 v[16:31], v[128:131], a[100:103], v[16:31]
  ds_read_b64_tr_b16 v[146:147], v201 offset:17408
  buffer_load_dwordx4 v209, s[20:23], s52 offen offset:1024 lds
  s_add_u32 m0, s51, 12288
  s_waitcnt lgkmcnt(6)
  v_mfma_f32_32x32x16_bf16 v[32:47], v[132:135], a[96:99], v[32:47]
  ds_read_b64_tr_b16 v[148:149], v202 offset:16384
  v_mfma_f32_32x32x16_bf16 v[48:63], v[132:135], a[100:103], v[48:63]
  ds_read_b64_tr_b16 v[150:151], v202 offset:17408
  s_waitcnt lgkmcnt(6)
  v_mfma_f32_32x32x16_bf16 v[64:79], v[136:139], a[96:99], v[64:79]
  ds_read_b64_tr_b16 v[152:153], v203 offset:16384
  v_mfma_f32_32x32x16_bf16 v[80:95], v[136:139], a[100:103], v[80:95]
  ds_read_b64_tr_b16 v[154:155], v203 offset:17408
  s_waitcnt lgkmcnt(6)
  v_mfma_f32_32x32x16_bf16 v[96:111], v[140:143], a[96:99], v[96:111]
  ds_read_b64_tr_b16 v[156:157], v204 offset:16384
  s_add_u32 s52, s84, 737280
  buffer_load_dwordx4 v206, s[16:19], s52 offen offset:0 lds
  v_mfma_f32_32x32x16_bf16 v[112:127], v[140:143], a[100:103], v[112:127]
  ds_read_b64_tr_b16 v[158:159], v204 offset:17408
  buffer_load_dwordx4 v207, s[16:19], s52 offen offset:1024 lds
  s_add_u32 m0, s51, 14336
  s_waitcnt lgkmcnt(6)
  v_mfma_f32_32x32x16_bf16 v[0:15], v[144:147], a[104:107], v[0:15]
  s_waitcnt vmcnt(10)
  ds_read_b64_tr_b16 v[128:129], v201 offset:0
  buffer_load_dwordx4 v208, s[20:23], s52 offen offset:0 lds
  v_mfma_f32_32x32x16_bf16 v[16:31], v[144:147], a[108:111], v[16:31]
  ds_read_b64_tr_b16 v[130:131], v201 offset:1024
  buffer_load_dwordx4 v209, s[20:23], s52 offen offset:1024 lds
  s_add_u32 m0, s51, 16384
  s_waitcnt lgkmcnt(6)
  v_mfma_f32_32x32x16_bf16 v[32:47], v[148:151], a[104:107], v[32:47]
  ds_read_b64_tr_b16 v[132:133], v202 offset:0
  v_mfma_f32_32x32x16_bf16 v[48:63], v[148:151], a[108:111], v[48:63]
  ds_read_b64_tr_b16 v[134:135], v202 offset:1024
  s_waitcnt lgkmcnt(6)
  v_mfma_f32_32x32x16_bf16 v[64:79], v[152:155], a[104:107], v[64:79]
  ds_read_b64_tr_b16 v[136:137], v203 offset:0
  v_mfma_f32_32x32x16_bf16 v[80:95], v[152:155], a[108:111], v[80:95]
  ds_read_b64_tr_b16 v[138:139], v203 offset:1024
  s_waitcnt lgkmcnt(6)
  v_mfma_f32_32x32x16_bf16 v[96:111], v[156:159], a[104:107], v[96:111]
  ds_read_b64_tr_b16 v[140:141], v204 offset:0
  s_add_u32 s52, s84, 884736
  buffer_load_dwordx4 v206, s[16:19], s52 offen offset:0 lds
  v_mfma_f32_32x32x16_bf16 v[112:127], v[156:159], a[108:111], v[112:127]
  ds_read_b64_tr_b16 v[142:143], v204 offset:1024
  buffer_load_dwordx4 v207, s[16:19], s52 offen offset:1024 lds
  s_add_u32 m0, s51, 18432
  s_waitcnt lgkmcnt(6)
  v_mfma_f32_32x32x16_bf16 v[0:15], v[128:131], a[112:115], v[0:15]
  s_waitcnt vmcnt(10)
  ds_read_b64_tr_b16 v[144:145], v201 offset:4096
  buffer_load_dwordx4 v208, s[20:23], s52 offen offset:0 lds
  v_mfma_f32_32x32x16_bf16 v[16:31], v[128:131], a[116:119], v[16:31]
  ds_read_b64_tr_b16 v[146:147], v201 offset:5120
  buffer_load_dwordx4 v209, s[20:23], s52 offen offset:1024 lds
  s_add_u32 m0, s51, 0
  s_waitcnt lgkmcnt(6)
  v_mfma_f32_32x32x16_bf16 v[32:47], v[132:135], a[112:115], v[32:47]
  ds_read_b64_tr_b16 v[148:149], v202 offset:4096
  v_mfma_f32_32x32x16_bf16 v[48:63], v[132:135], a[116:119], v[48:63]
  ds_read_b64_tr_b16 v[150:151], v202 offset:5120
  s_waitcnt lgkmcnt(6)
  v_mfma_f32_32x32x16_bf16 v[64:79], v[136:139], a[112:115], v[64:79]
  ds_read_b64_tr_b16 v[152:153], v203 offset:4096
  v_mfma_f32_32x32x16_bf16 v[80:95], v[136:139], a[116:119], v[80:95]
  ds_read_b64_tr_b16 v[154:155], v203 offset:5120
  s_waitcnt lgkmcnt(6)
  v_mfma_f32_32x32x16_bf16 v[96:111], v[140:143], a[112:115], v[96:111]
  ds_read_b64_tr_b16 v[156:157], v204 offset:4096
  s_add_u32 s52, s84, 1032192
  buffer_load_dwordx4 v206, s[16:19], s52 offen offset:0 lds
  v_mfma_f32_32x32x16_bf16 v[112:127], v[140:143], a[116:119], v[112:127]
  ds_read_b64_tr_b16 v[158:159], v204 offset:5120
  buffer_load_dwordx4 v207, s[16:19], s52 offen offset:1024 lds
  s_add_u32 m0, s51, 2048
  s_waitcnt lgkmcnt(6)
  v_mfma_f32_32x32x16_bf16 v[0:15], v[144:147], a[120:123], v[0:15]
  s_waitcnt vmcnt(10)
  ds_read_b64_tr_b16 v[128:129], v201 offset:8192
  buffer_load_dwordx4 v208, s[20:23], s52 offen offset:0 lds
  v_mfma_f32_32x32x16_bf16 v[16:31], v[144:147], a[124:127], v[16:31]
  ds_read_b64_tr_b16 v[130:131], v201 offset:9216
  buffer_load_dwordx4 v209, s[20:23], s52 offen offset:1024 lds
  s_add_u32 m0, s51, 4096
  s_waitcnt lgkmcnt(6)
  v_mfma_f32_32x32x16_bf16 v[32:47], v[148:151], a[120:123], v[32:47]
  ds_read_b64_tr_b16 v[132:133], v202 offset:8192
  v_mfma_f32_32x32x16_bf16 v[48:63], v[148:151], a[124:127], v[48:63]
  ds_read_b64_tr_b16 v[134:135], v202 offset:9216
  s_waitcnt lgkmcnt(6)
  v_mfma_f32_32x32x16_bf16 v[64:79], v[152:155], a[120:123], v[64:79]
  ds_read_b64_tr_b16 v[136:137], v203 offset:8192
  v_mfma_f32_32x32x16_bf16 v[80:95], v[152:155], a[124:127], v[80:95]
  ds_read_b64_tr_b16 v[138:139], v203 offset:9216
  s_waitcnt lgkmcnt(6)
  v_mfma_f32_32x32x16_bf16 v[96:111], v[156:159], a[120:123], v[96:111]
  ds_read_b64_tr_b16 v[140:141], v204 offset:8192
  s_add_u32 s52, s84, 1179648
  buffer_load_dwordx4 v206, s[16:19], s52 offen offset:0 lds
  v_mfma_f32_32x32x16_bf16 v[112:127], v[156:159], a[124:127], v[112:127]
  ds_read_b64_tr_b16 v[142:143], v204 offset:9216
  buffer_load_dwordx4 v207, s[16:19], s52 offen offset:1024 lds
  s_add_u32 m0, s51, 6144
  s_waitcnt lgkmcnt(6)
  v_mfma_f32_32x32x16_bf16 v[0:15], v[128:131], a[128:131], v[0:15]
  s_waitcnt vmcnt(10)
  ds_read_b64_tr_b16 v[144:145], v201 offset:12288
  buffer_load_dwordx4 v208, s[20:23], s52 offen offset:0 lds
  v_mfma_f32_32x32x16_bf16 v[16:31], v[128:131], a[132:135], v[16:31]
  ds_read_b64_tr_b16 v[146:147], v201 offset:13312
  buffer_load_dwordx4 v209, s[20:23], s52 offen offset:1024 lds
  s_add_u32 m0, s51, 8192
  s_waitcnt lgkmcnt(6)
  v_mfma_f32_32x32x16_bf16 v[32:47], v[132:135], a[128:131], v[32:47]
  ds_read_b64_tr_b16 v[148:149], v202 offset:12288
  v_mfma_f32_32x32x16_bf16 v[48:63], v[132:135], a[132:135], v[48:63]
  ds_read_b64_tr_b16 v[150:151], v202 offset:13312
  s_waitcnt lgkmcnt(6)
  v_mfma_f32_32x32x16_bf16 v[64:79], v[136:139], a[128:131], v[64:79]
  ds_read_b64_tr_b16 v[152:153], v203 offset:12288
  v_mfma_f32_32x32x16_bf16 v[80:95], v[136:139], a[132:135], v[80:95]
  ds_read_b64_tr_b16 v[154:155], v203 offset:13312
  s_waitcnt lgkmcnt(6)
  v_mfma_f32_32x32x16_bf16 v[96:111], v[140:143], a[128:131], v[96:111]
  ds_read_b64_tr_b16 v[156:157], v204 offset:12288
  s_add_u32 s52, s84, 1327104
  buffer_load_dwordx4 v206, s[16:19], s52 offen offset:0 lds
  v_mfma_f32_32x32x16_bf16 v[112:127], v[140:143], a[132:135], v[112:127]
  ds_read_b64_tr_b16 v[158:159], v204 offset:13312
  buffer_load_dwordx4 v207, s[16:19], s52 offen offset:1024 lds
  s_add_u32 m0, s51, 10240
  s_waitcnt lgkmcnt(6)
  v_mfma_f32_32x32x16_bf16 v[0:15], v[144:147], a[136:139], v[0:15]
  s_waitcnt vmcnt(10)
  ds_read_b64_tr_b16 v[128:129], v201 offset:16384
  buffer_load_dwordx4 v208, s[20:23], s52 offen offset:0 lds
  v_mfma_f32_32x32x16_bf16 v[16:31], v[144:147], a[140:143], v[16:31]
  ds_read_b64_tr_b16 v[130:131], v201 offset:17408
  buffer_load_dwordx4 v209, s[20:23], s52 offen offset:1024 lds
  s_add_u32 m0, s51, 12288
  s_waitcnt lgkmcnt(6)
  v_mfma_f32_32x32x16_bf16 v[32:47], v[148:151], a[136:139], v[32:47]
  ds_read_b64_tr_b16 v[132:133], v202 offset:16384
  v_mfma_f32_32x32x16_bf16 v[48:63], v[148:151], a[140:143], v[48:63]
  ds_read_b64_tr_b16 v[134:135], v202 offset:17408
  s_waitcnt lgkmcnt(6)
  v_mfma_f32_32x32x16_bf16 v[64:79], v[152:155], a[136:139], v[64:79]
  ds_read_b64_tr_b16 v[136:137], v203 offset:16384
  v_mfma_f32_32x32x16_bf16 v[80:95], v[152:155], a[140:143], v[80:95]
  ds_read_b64_tr_b16 v[138:139], v203 offset:17408
  s_waitcnt lgkmcnt(6)
  v_mfma_f32_32x32x16_bf16 v[96:111], v[156:159], a[136:139], v[96:111]
  ds_read_b64_tr_b16 v[140:141], v204 offset:16384
  s_add_u32 s52, s84, 1474560
  buffer_load_dwordx4 v206, s[16:19], s52 offen offset:0 lds
  v_mfma_f32_32x32x16_bf16 v[112:127], v[156:159], a[140:143], v[112:127]
  ds_read_b64_tr_b16 v[142:143], v204 offset:17408
  buffer_load_dwordx4 v207, s[16:19], s52 offen offset:1024 lds
  s_add_u32 m0, s51, 14336
  s_waitcnt lgkmcnt(6)
  v_mfma_f32_32x32x16_bf16 v[0:15], v[128:131], a[144:147], v[0:15]
  s_waitcnt vmcnt(10)
  ds_read_b64_tr_b16 v[144:145], v201 offset:0
  buffer_load_dwordx4 v208, s[20:23], s52 offen offset:0 lds
  v_mfma_f32_32x32x16_bf16 v[16:31], v[128:131], a[148:151], v[16:31]
  ds_read_b64_tr_b16 v[146:147], v201 offset:1024
  buffer_load_dwordx4 v209, s[20:23], s52 offen offset:1024 lds
  s_add_u32 m0, s51, 16384
  s_waitcnt lgkmcnt(6)
  v_mfma_f32_32x32x16_bf16 v[32:47], v[132:135], a[144:147], v[32:47]
  ds_read_b64_tr_b16 v[148:149], v202 offset:0
  v_mfma_f32_32x32x16_bf16 v[48:63], v[132:135], a[148:151], v[48:63]
  ds_read_b64_tr_b16 v[150:151], v202 offset:1024
  s_waitcnt lgkmcnt(6)
  v_mfma_f32_32x32x16_bf16 v[64:79], v[136:139], a[144:147], v[64:79]
  ds_read_b64_tr_b16 v[152:153], v203 offset:0
  v_mfma_f32_32x32x16_bf16 v[80:95], v[136:139], a[148:151], v[80:95]
  ds_read_b64_tr_b16 v[154:155], v203 offset:1024
  s_waitcnt lgkmcnt(6)
  v_mfma_f32_32x32x16_bf16 v[96:111], v[140:143], a[144:147], v[96:111]
  ds_read_b64_tr_b16 v[156:157], v204 offset:0
  s_add_u32 s52, s84, 1622016
  buffer_load_dwordx4 v206, s[16:19], s52 offen offset:0 lds
  v_mfma_f32_32x32x16_bf16 v[112:127], v[140:143], a[148:151], v[112:127]
  ds_read_b64_tr_b16 v[158:159], v204 offset:1024
  buffer_load_dwordx4 v207, s[16:19], s52 offen offset:1024 lds
  s_add_u32 m0, s51, 18432
  s_waitcnt lgkmcnt(6)
  v_mfma_f32_32x32x16_bf16 v[0:15], v[144:147], a[152:155], v[0:15]
  s_waitcnt vmcnt(10)
  ds_read_b64_tr_b16 v[128:129], v201 offset:4096
  buffer_load_dwordx4 v208, s[20:23], s52 offen offset:0 lds
  v_mfma_f32_32x32x16_bf16 v[16:31], v[144:147], a[156:159], v[16:31]
  ds_read_b64_tr_b16 v[130:131], v201 offset:5120
  buffer_load_dwordx4 v209, s[20:23], s52 offen offset:1024 lds
  s_add_u32 m0, s51, 0
  s_waitcnt lgkmcnt(6)
  v_mfma_f32_32x32x16_bf16 v[32:47], v[148:151], a[152:155], v[32:47]
  ds_read_b64_tr_b16 v[132:133], v202 offset:4096
  v_mfma_f32_32x32x16_bf16 v[48:63], v[148:151], a[156:159], v[48:63]
  ds_read_b64_tr_b16 v[134:135], v202 offset:5120
  s_waitcnt lgkmcnt(6)
  v_mfma_f32_32x32x16_bf16 v[64:79], v[152:155], a[152:155], v[64:79]
  ds_read_b64_tr_b16 v[136:137], v203 offset:4096
  v_mfma_f32_32x32x16_bf16 v[80:95], v[152:155], a[156:159], v[80:95]
  ds_read_b64_tr_b16 v[138:139], v203 offset:5120
  s_waitcnt lgkmcnt(6)
  v_mfma_f32_32x32x16_bf16 v[96:111], v[156:159], a[152:155], v[96:111]
  ds_read_b64_tr_b16 v[140:141], v204 offset:4096
  s_add_u32 s52, s85, 0
  buffer_load_dwordx4 v206, s[16:19], s52 offen offset:0 lds
  v_mfma_f32_32x32x16_bf16 v[112:127], v[156:159], a[156:159], v[112:127]
  ds_read_b64_tr_b16 v[142:143], v204 offset:5120
  buffer_load_dwordx4 v207, s[16:19], s52 offen offset:1024 lds
  s_add_u32 m0, s51, 2048
  s_waitcnt lgkmcnt(6)
  v_mfma_f32_32x32x16_bf16 v[0:15], v[128:131], a[160:163], v[0:15]
  s_waitcnt vmcnt(10)
  ds_read_b64_tr_b16 v[144:145], v201 offset:8192
  buffer_load_dwordx4 v208, s[20:23], s52 offen offset:0 lds
  v_mfma_f32_32x32x16_bf16 v[16:31], v[128:131], a[164:167], v[16:31]
  ds_read_b64_tr_b16 v[146:147], v201 offset:9216
  buffer_load_dwordx4 v209, s[20:23], s52 offen offset:1024 lds
  s_add_u32 m0, s51, 4096
  s_waitcnt lgkmcnt(6)
  v_mfma_f32_32x32x16_bf16 v[32:47], v[132:135], a[160:163], v[32:47]
  ds_read_b64_tr_b16 v[148:149], v202 offset:8192
  v_mfma_f32_32x32x16_bf16 v[48:63], v[132:135], a[164:167], v[48:63]
  ds_read_b64_tr_b16 v[150:151], v202 offset:9216
  s_waitcnt lgkmcnt(6)
  v_mfma_f32_32x32x16_bf16 v[64:79], v[136:139], a[160:163], v[64:79]
  ds_read_b64_tr_b16 v[152:153], v203 offset:8192
  v_mfma_f32_32x32x16_bf16 v[80:95], v[136:139], a[164:167], v[80:95]
  ds_read_b64_tr_b16 v[154:155], v203 offset:9216
  s_waitcnt lgkmcnt(6)
  v_mfma_f32_32x32x16_bf16 v[96:111], v[140:143], a[160:163], v[96:111]
  ds_read_b64_tr_b16 v[156:157], v204 offset:8192
  s_add_u32 s52, s85, 147456
  buffer_load_dwordx4 v206, s[16:19], s52 offen offset:0 lds
  v_mfma_f32_32x32x16_bf16 v[112:127], v[140:143], a[164:167], v[112:127]
  ds_read_b64_tr_b16 v[158:159], v204 offset:9216
  buffer_load_dwordx4 v207, s[16:19], s52 offen offset:1024 lds
  s_add_u32 m0, s51, 6144
  s_waitcnt lgkmcnt(6)
  v_mfma_f32_32x32x16_bf16 v[0:15], v[144:147], a[168:171], v[0:15]
  s_waitcnt vmcnt(10)
  ds_read_b64_tr_b16 v[128:129], v201 offset:12288
  buffer_load_dwordx4 v208, s[20:23], s52 offen offset:0 lds
  v_mfma_f32_32x32x16_bf16 v[16:31], v[144:147], a[172:175], v[16:31]
  ds_read_b64_tr_b16 v[130:131], v201 offset:13312
  buffer_load_dwordx4 v209, s[20:23], s52 offen offset:1024 lds
  s_add_u32 m0, s51, 8192
  s_waitcnt lgkmcnt(6)
  v_mfma_f32_32x32x16_bf16 v[32:47], v[148:151], a[168:171], v[32:47]
  ds_read_b64_tr_b16 v[132:133], v202 offset:12288
  v_mfma_f32_32x32x16_bf16 v[48:63], v[148:151], a[172:175], v[48:63]
  ds_read_b64_tr_b16 v[134:135], v202 offset:13312
  s_waitcnt lgkmcnt(6)
  v_mfma_f32_32x32x16_bf16 v[64:79], v[152:155], a[168:171], v[64:79]
  ds_read_b64_tr_b16 v[136:137], v203 offset:12288
  v_mfma_f32_32x32x16_bf16 v[80:95], v[152:155], a[172:175], v[80:95]
  ds_read_b64_tr_b16 v[138:139], v203 offset:13312
  s_waitcnt lgkmcnt(6)
  v_mfma_f32_32x32x16_bf16 v[96:111], v[156:159], a[168:171], v[96:111]
  ds_read_b64_tr_b16 v[140:141], v204 offset:12288
  s_add_u32 s52, s85, 294912
  buffer_load_dwordx4 v206, s[16:19], s52 offen offset:0 lds
  v_mfma_f32_32x32x16_bf16 v[112:127], v[156:159], a[172:175], v[112:127]
  ds_read_b64_tr_b16 v[142:143], v204 offset:13312
  buffer_load_dwordx4 v207, s[16:19], s52 offen offset:1024 lds
  s_add_u32 m0, s51, 10240
  s_waitcnt lgkmcnt(6)
  v_mfma_f32_32x32x16_bf16 v[0:15], v[128:131], a[176:179], v[0:15]
  s_waitcnt vmcnt(10)
  ds_read_b64_tr_b16 v[144:145], v201 offset:16384
  buffer_load_dwordx4 v208, s[20:23], s52 offen offset:0 lds
  v_mfma_f32_32x32x16_bf16 v[16:31], v[128:131], a[180:183], v[16:31]
  ds_read_b64_tr_b16 v[146:147], v201 offset:17408
  buffer_load_dwordx4 v209, s[20:23], s52 offen offset:1024 lds
  s_add_u32 m0, s51, 12288
  s_waitcnt lgkmcnt(6)
  v_mfma_f32_32x32x16_bf16 v[32:47], v[132:135], a[176:179], v[32:47]
  ds_read_b64_tr_b16 v[148:149], v202 offset:16384
  v_mfma_f32_32x32x16_bf16 v[48:63], v[132:135], a[180:183], v[48:63]
  ds_read_b64_tr_b16 v[150:151], v202 offset:17408
  s_waitcnt lgkmcnt(6)
  v_mfma_f32_32x32x16_bf16 v[64:79], v[136:139], a[176:179], v[64:79]
  ds_read_b64_tr_b16 v[152:153], v203 offset:16384
  v_mfma_f32_32x32x16_bf16 v[80:95], v[136:139], a[180:183], v[80:95]
  ds_read_b64_tr_b16 v[154:155], v203 offset:17408
  s_waitcnt lgkmcnt(6)
  v_mfma_f32_32x32x16_bf16 v[96:111], v[140:143], a[176:179], v[96:111]
  ds_read_b64_tr_b16 v[156:157], v204 offset:16384
  s_add_u32 s52, s85, 442368
  buffer_load_dwordx4 v206, s[16:19], s52 offen offset:0 lds
  v_mfma_f32_32x32x16_bf16 v[112:127], v[140:143], a[180:183], v[112:127]
  ds_read_b64_tr_b16 v[158:159], v204 offset:17408
  buffer_load_dwordx4 v207, s[16:19], s52 offen offset:1024 lds
  s_add_u32 m0, s51, 14336
  s_waitcnt lgkmcnt(6)
  v_mfma_f32_32x32x16_bf16 v[0:15], v[144:147], a[184:187], v[0:15]
  s_waitcnt vmcnt(10)
  ds_read_b64_tr_b16 v[128:129], v201 offset:0
  buffer_load_dwordx4 v208, s[20:23], s52 offen offset:0 lds
  v_mfma_f32_32x32x16_bf16 v[16:31], v[144:147], a[188:191], v[16:31]
  ds_read_b64_tr_b16 v[130:131], v201 offset:1024
  buffer_load_dwordx4 v209, s[20:23], s52 offen offset:1024 lds
  s_add_u32 m0, s51, 16384
  s_waitcnt lgkmcnt(6)
  v_mfma_f32_32x32x16_bf16 v[32:47], v[148:151], a[184:187], v[32:47]
  ds_read_b64_tr_b16 v[132:133], v202 offset:0
  v_mfma_f32_32x32x16_bf16 v[48:63], v[148:151], a[188:191], v[48:63]
  ds_read_b64_tr_b16 v[134:135], v202 offset:1024
  s_waitcnt lgkmcnt(6)
  v_mfma_f32_32x32x16_bf16 v[64:79], v[152:155], a[184:187], v[64:79]
  ds_read_b64_tr_b16 v[136:137], v203 offset:0
  v_mfma_f32_32x32x16_bf16 v[80:95], v[152:155], a[188:191], v[80:95]
  ds_read_b64_tr_b16 v[138:139], v203 offset:1024
  s_waitcnt lgkmcnt(6)
  v_mfma_f32_32x32x16_bf16 v[96:111], v[156:159], a[184:187], v[96:111]
  ds_read_b64_tr_b16 v[140:141], v204 offset:0
  s_add_u32 s52, s85, 589824
  buffer_load_dwordx4 v206, s[16:19], s52 offen offset:0 lds
  v_mfma_f32_32x32x16_bf16 v[112:127], v[156:159], a[188:191], v[112:127]
  ds_read_b64_tr_b16 v[142:143], v204 offset:1024
  buffer_load_dwordx4 v207, s[16:19], s52 offen offset:1024 lds
  s_add_u32 m0, s51, 18432
  s_waitcnt lgkmcnt(6)
  v_mfma_f32_32x32x16_bf16 v[0:15], v[128:131], a[192:195], v[0:15]
  s_waitcnt vmcnt(10)
  ds_read_b64_tr_b16 v[144:145], v201 offset:4096
  buffer_load_dwordx4 v208, s[20:23], s52 offen offset:0 lds
  v_mfma_f32_32x32x16_bf16 v[16:31], v[128:131], a[196:199], v[16:31]
  ds_read_b64_tr_b16 v[146:147], v201 offset:5120
  buffer_load_dwordx4 v209, s[20:23], s52 offen offset:1024 lds
  s_add_u32 m0, s51, 0
  s_waitcnt lgkmcnt(6)
  v_mfma_f32_32x32x16_bf16 v[32:47], v[132:135], a[192:195], v[32:47]
  ds_read_b64_tr_b16 v[148:149], v202 offset:4096
  v_mfma_f32_32x32x16_bf16 v[48:63], v[132:135], a[196:199], v[48:63]
  ds_read_b64_tr_b16 v[150:151], v202 offset:5120
  s_waitcnt lgkmcnt(6)
  v_mfma_f32_32x32x16_bf16 v[64:79], v[136:139], a[192:195], v[64:79]
  ds_read_b64_tr_b16 v[152:153], v203 offset:4096
  v_mfma_f32_32x32x16_bf16 v[80:95], v[136:139], a[196:199], v[80:95]
  ds_read_b64_tr_b16 v[154:155], v203 offset:5120
  s_waitcnt lgkmcnt(6)
  v_mfma_f32_32x32x16_bf16 v[96:111], v[140:143], a[192:195], v[96:111]
  ds_read_b64_tr_b16 v[156:157], v204 offset:4096
  s_add_u32 s52, s85, 737280
  buffer_load_dwordx4 v206, s[16:19], s52 offen offset:0 lds
  v_mfma_f32_32x32x16_bf16 v[112:127], v[140:143], a[196:199], v[112:127]
  ds_read_b64_tr_b16 v[158:159], v204 offset:5120
  buffer_load_dwordx4 v207, s[16:19], s52 offen offset:1024 lds
  s_add_u32 m0, s51, 2048
  s_waitcnt lgkmcnt(6)
  v_mfma_f32_32x32x16_bf16 v[0:15], v[144:147], a[200:203], v[0:15]
  s_waitcnt vmcnt(10)
  ds_read_b64_tr_b16 v[128:129], v201 offset:8192
  buffer_load_dwordx4 v208, s[20:23], s52 offen offset:0 lds
  v_mfma_f32_32x32x16_bf16 v[16:31], v[144:147], a[204:207], v[16:31]
  ds_read_b64_tr_b16 v[130:131], v201 offset:9216
  buffer_load_dwordx4 v209, s[20:23], s52 offen offset:1024 lds
  s_add_u32 m0, s51, 4096
  s_waitcnt lgkmcnt(6)
  v_mfma_f32_32x32x16_bf16 v[32:47], v[148:151], a[200:203], v[32:47]
  ds_read_b64_tr_b16 v[132:133], v202 offset:8192
  v_mfma_f32_32x32x16_bf16 v[48:63], v[148:151], a[204:207], v[48:63]
  ds_read_b64_tr_b16 v[134:135], v202 offset:9216
  s_waitcnt lgkmcnt(6)
  v_mfma_f32_32x32x16_bf16 v[64:79], v[152:155], a[200:203], v[64:79]
  ds_read_b64_tr_b16 v[136:137], v203 offset:8192
  v_mfma_f32_32x32x16_bf16 v[80:95], v[152:155], a[204:207], v[80:95]
  ds_read_b64_tr_b16 v[138:139], v203 offset:9216
  s_waitcnt lgkmcnt(6)
  v_mfma_f32_32x32x16_bf16 v[96:111], v[156:159], a[200:203], v[96:111]
  ds_read_b64_tr_b16 v[140:141], v204 offset:8192
  s_add_u32 s52, s85, 884736
  buffer_load_dwordx4 v206, s[16:19], s52 offen offset:0 lds
  v_mfma_f32_32x32x16_bf16 v[112:127], v[156:159], a[204:207], v[112:127]
  ds_read_b64_tr_b16 v[142:143], v204 offset:9216
  buffer_load_dwordx4 v207, s[16:19], s52 offen offset:1024 lds
  s_add_u32 m0, s51, 6144
  s_waitcnt lgkmcnt(6)
  v_mfma_f32_32x32x16_bf16 v[0:15], v[128:131], a[208:211], v[0:15]
  s_waitcnt vmcnt(10)
  ds_read_b64_tr_b16 v[144:145], v201 offset:12288
  buffer_load_dwordx4 v208, s[20:23], s52 offen offset:0 lds
  v_mfma_f32_32x32x16_bf16 v[16:31], v[128:131], a[212:215], v[16:31]
  ds_read_b64_tr_b16 v[146:147], v201 offset:13312
  buffer_load_dwordx4 v209, s[20:23], s52 offen offset:1024 lds
  s_add_u32 m0, s51, 8192
  s_waitcnt lgkmcnt(6)
  v_mfma_f32_32x32x16_bf16 v[32:47], v[132:135], a[208:211], v[32:47]
  ds_read_b64_tr_b16 v[148:149], v202 offset:12288
  v_mfma_f32_32x32x16_bf16 v[48:63], v[132:135], a[212:215], v[48:63]
  ds_read_b64_tr_b16 v[150:151], v202 offset:13312
  s_waitcnt lgkmcnt(6)
  v_mfma_f32_32x32x16_bf16 v[64:79], v[136:139], a[208:211], v[64:79]
  ds_read_b64_tr_b16 v[152:153], v203 offset:12288
  v_mfma_f32_32x32x16_bf16 v[80:95], v[136:139], a[212:215], v[80:95]
  ds_read_b64_tr_b16 v[154:155], v203 offset:13312
  s_waitcnt lgkmcnt(6)
  v_mfma_f32_32x32x16_bf16 v[96:111], v[140:143], a[208:211], v[96:111]
  ds_read_b64_tr_b16 v[156:157], v204 offset:12288
  s_add_u32 s52, s85, 1032192
  buffer_load_dwordx4 v206, s[16:19], s52 offen offset:0 lds
  v_mfma_f32_32x32x16_bf16 v[112:127], v[140:143], a[212:215], v[112:127]
  ds_read_b64_tr_b16 v[158:159], v204 offset:13312
  buffer_load_dwordx4 v207, s[16:19], s52 offen offset:1024 lds
  s_add_u32 m0, s51, 10240
  s_waitcnt lgkmcnt(6)
  v_mfma_f32_32x32x16_bf16 v[0:15], v[144:147], a[216:219], v[0:15]
  s_waitcnt vmcnt(10)
  ds_read_b64_tr_b16 v[128:129], v201 offset:16384
  buffer_load_dwordx4 v208, s[20:23], s52 offen offset:0 lds
  v_mfma_f32_32x32x16_bf16 v[16:31], v[144:147], a[220:223], v[16:31]
  ds_read_b64_tr_b16 v[130:131], v201 offset:17408
  buffer_load_dwordx4 v209, s[20:23], s52 offen offset:1024 lds
  s_add_u32 m0, s51, 12288
  s_waitcnt lgkmcnt(6)
  v_mfma_f32_32x32x16_bf16 v[32:47], v[148:151], a[216:219], v[32:47]
  ds_read_b64_tr_b16 v[132:133], v202 offset:16384
  v_mfma_f32_32x32x16_bf16 v[48:63], v[148:151], a[220:223], v[48:63]
  ds_read_b64_tr_b16 v[134:135], v202 offset:17408
  s_waitcnt lgkmcnt(6)
  v_mfma_f32_32x32x16_bf16 v[64:79], v[152:155], a[216:219], v[64:79]
  ds_read_b64_tr_b16 v[136:137], v203 offset:16384
  v_mfma_f32_32x32x16_bf16 v[80:95], v[152:155], a[220:223], v[80:95]
  ds_read_b64_tr_b16 v[138:139], v203 offset:17408
  s_waitcnt lgkmcnt(6)
  v_mfma_f32_32x32x16_bf16 v[96:111], v[156:159], a[216:219], v[96:111]
  ds_read_b64_tr_b16 v[140:141], v204 offset:16384
  s_add_u32 s52, s85, 1179648
  buffer_load_dwordx4 v206, s[16:19], s52 offen offset:0 lds
  v_mfma_f32_32x32x16_bf16 v[112:127], v[156:159], a[220:223], v[112:127]
  ds_read_b64_tr_b16 v[142:143], v204 offset:17408
  buffer_load_dwordx4 v207, s[16:19], s52 offen offset:1024 lds
  s_add_u32 m0, s51, 14336
  s_waitcnt lgkmcnt(6)
  v_mfma_f32_32x32x16_bf16 v[0:15], v[128:131], a[224:227], v[0:15]
  s_waitcnt vmcnt(10)
  ds_read_b64_tr_b16 v[144:145], v201 offset:0
  buffer_load_dwordx4 v208, s[20:23], s52 offen offset:0 lds
  v_mfma_f32_32x32x16_bf16 v[16:31], v[128:131], a[228:231], v[16:31]
  ds_read_b64_tr_b16 v[146:147], v201 offset:1024
  buffer_load_dwordx4 v209, s[20:23], s52 offen offset:1024 lds
  s_add_u32 m0, s51, 16384
  s_waitcnt lgkmcnt(6)
  v_mfma_f32_32x32x16_bf16 v[32:47], v[132:135], a[224:227], v[32:47]
  ds_read_b64_tr_b16 v[148:149], v202 offset:0
  v_mfma_f32_32x32x16_bf16 v[48:63], v[132:135], a[228:231], v[48:63]
  ds_read_b64_tr_b16 v[150:151], v202 offset:1024
  s_waitcnt lgkmcnt(6)
  v_mfma_f32_32x32x16_bf16 v[64:79], v[136:139], a[224:227], v[64:79]
  ds_read_b64_tr_b16 v[152:153], v203 offset:0
  v_mfma_f32_32x32x16_bf16 v[80:95], v[136:139], a[228:231], v[80:95]
  ds_read_b64_tr_b16 v[154:155], v203 offset:1024
  s_waitcnt lgkmcnt(6)
  v_mfma_f32_32x32x16_bf16 v[96:111], v[140:143], a[224:227], v[96:111]
  ds_read_b64_tr_b16 v[156:157], v204 offset:0
  s_add_u32 s52, s85, 1327104
  buffer_load_dwordx4 v206, s[16:19], s52 offen offset:0 lds
  v_mfma_f32_32x32x16_bf16 v[112:127], v[140:143], a[228:231], v[112:127]
  ds_read_b64_tr_b16 v[158:159], v204 offset:1024
  buffer_load_dwordx4 v207, s[16:19], s52 offen offset:1024 lds
  s_add_u32 m0, s51, 18432
  s_waitcnt lgkmcnt(6)
  v_mfma_f32_32x32x16_bf16 v[0:15], v[144:147], a[232:235], v[0:15]
  s_waitcnt vmcnt(10)
  ds_read_b64_tr_b16 v[128:129], v201 offset:4096
  buffer_load_dwordx4 v208, s[20:23], s52 offen offset:0 lds
  v_mfma_f32_32x32x16_bf16 v[16:31], v[144:147], a[236:239], v[16:31]
  ds_read_b64_tr_b16 v[130:131], v201 offset:5120
  buffer_load_dwordx4 v209, s[20:23], s52 offen offset:1024 lds
  s_add_u32 m0, s51, 0
  s_waitcnt lgkmcnt(6)
  v_mfma_f32_32x32x16_bf16 v[32:47], v[148:151], a[232:235], v[32:47]
  ds_read_b64_tr_b16 v[132:133], v202 offset:4096
  v_mfma_f32_32x32x16_bf16 v[48:63], v[148:151], a[236:239], v[48:63]
  ds_read_b64_tr_b16 v[134:135], v202 offset:5120
  s_waitcnt lgkmcnt(6)
  v_mfma_f32_32x32x16_bf16 v[64:79], v[152:155], a[232:235], v[64:79]
  ds_read_b64_tr_b16 v[136:137], v203 offset:4096
  v_mfma_f32_32x32x16_bf16 v[80:95], v[152:155], a[236:239], v[80:95]
  ds_read_b64_tr_b16 v[138:139], v203 offset:5120
  s_waitcnt lgkmcnt(6)
  v_mfma_f32_32x32x16_bf16 v[96:111], v[156:159], a[232:235], v[96:111]
  ds_read_b64_tr_b16 v[140:141], v204 offset:4096
  s_add_u32 s52, s85, 1474560
  buffer_load_dwordx4 v206, s[16:19], s52 offen offset:0 lds
  v_mfma_f32_32x32x16_bf16 v[112:127], v[156:159], a[236:239], v[112:127]
  ds_read_b64_tr_b16 v[142:143], v204 offset:5120
  buffer_load_dwordx4 v207, s[16:19], s52 offen offset:1024 lds
  s_add_u32 m0, s51, 2048
  s_waitcnt lgkmcnt(6)
  v_mfma_f32_32x32x16_bf16 v[0:15], v[128:131], a[240:243], v[0:15]
  s_waitcnt vmcnt(10)
  ds_read_b64_tr_b16 v[144:145], v201 offset:8192
  buffer_load_dwordx4 v208, s[20:23], s52 offen offset:0 lds
  v_mfma_f32_32x32x16_bf16 v[16:31], v[128:131], a[244:247], v[16:31]
  ds_read_b64_tr_b16 v[146:147], v201 offset:9216
  buffer_load_dwordx4 v209, s[20:23], s52 offen offset:1024 lds
  s_add_u32 m0, s51, 4096
  s_waitcnt lgkmcnt(6)
  v_mfma_f32_32x32x16_bf16 v[32:47], v[132:135], a[240:243], v[32:47]
  ds_read_b64_tr_b16 v[148:149], v202 offset:8192
  v_mfma_f32_32x32x16_bf16 v[48:63], v[132:135], a[244:247], v[48:63]
  ds_read_b64_tr_b16 v[150:151], v202 offset:9216
  s_waitcnt lgkmcnt(6)
  v_mfma_f32_32x32x16_bf16 v[64:79], v[136:139], a[240:243], v[64:79]
  ds_read_b64_tr_b16 v[152:153], v203 offset:8192
  v_mfma_f32_32x32x16_bf16 v[80:95], v[136:139], a[244:247], v[80:95]
  ds_read_b64_tr_b16 v[154:155], v203 offset:9216
  s_waitcnt lgkmcnt(6)
  v_mfma_f32_32x32x16_bf16 v[96:111], v[140:143], a[240:243], v[96:111]
  ds_read_b64_tr_b16 v[156:157], v204 offset:8192
  s_add_u32 s52, s85, 1622016
  buffer_load_dwordx4 v206, s[16:19], s52 offen offset:0 lds
  v_mfma_f32_32x32x16_bf16 v[112:127], v[140:143], a[244:247], v[112:127]
  ds_read_b64_tr_b16 v[158:159], v204 offset:9216
  buffer_load_dwordx4 v207, s[16:19], s52 offen offset:1024 lds
  s_add_u32 m0, s51, 6144
  s_waitcnt lgkmcnt(6)
  v_mfma_f32_32x32x16_bf16 v[0:15], v[144:147], a[248:251], v[0:15]
  s_waitcnt vmcnt(10)
  ds_read_b64_tr_b16 v[128:129], v201 offset:12288
  buffer_load_dwordx4 v208, s[20:23], s52 offen offset:0 lds
  v_mfma_f32_32x32x16_bf16 v[16:31], v[144:147], a[252:255], v[16:31]
  ds_read_b64_tr_b16 v[130:131], v201 offset:13312
  buffer_load_dwordx4 v209, s[20:23], s52 offen offset:1024 lds
  s_add_u32 m0, s51, 8192
  s_waitcnt lgkmcnt(6)
  v_mfma_f32_32x32x16_bf16 v[32:47], v[148:151], a[248:251], v[32:47]
  ds_read_b64_tr_b16 v[132:133], v202 offset:12288
  v_mfma_f32_32x32x16_bf16 v[48:63], v[148:151], a[252:255], v[48:63]
  ds_read_b64_tr_b16 v[134:135], v202 offset:13312
  s_waitcnt lgkmcnt(6)
  v_mfma_f32_32x32x16_bf16 v[64:79], v[152:155], a[248:251], v[64:79]
  ds_read_b64_tr_b16 v[136:137], v203 offset:12288
  v_mfma_f32_32x32x16_bf16 v[80:95], v[152:155], a[252:255], v[80:95]
  ds_read_b64_tr_b16 v[138:139], v203 offset:13312
  s_waitcnt lgkmcnt(6)
  v_mfma_f32_32x32x16_bf16 v[96:111], v[156:159], a[248:251], v[96:111]
  ds_read_b64_tr_b16 v[140:141], v204 offset:12288
  s_add_u32 s52, s88, 0
  buffer_load_dwordx4 v210, s[44:47], s52 offen offset:0 lds
  v_mfma_f32_32x32x16_bf16 v[112:127], v[156:159], a[252:255], v[112:127]
  ds_read_b64_tr_b16 v[142:143], v204 offset:13312
  buffer_load_dwordx4 v210, s[44:47], s52 offen offset:1024 lds
  s_add_u32 m0, s51, 10240
  s_waitcnt lgkmcnt(6)
  v_mfma_f32_32x32x16_bf16 v[0:15], v[128:131], v[224:227], v[0:15]
  s_waitcnt vmcnt(10)
  ds_read_b64_tr_b16 v[144:145], v201 offset:16384
  s_add_u32 s52, s88, 2048
  buffer_load_dwordx4 v210, s[44:47], s52 offen offset:0 lds
  v_mfma_f32_32x32x16_bf16 v[16:31], v[128:131], v[228:231], v[16:31]
  ds_read_b64_tr_b16 v[146:147], v201 offset:17408
  buffer_load_dwordx4 v210, s[44:47], s52 offen offset:1024 lds
  s_add_u32 m0, s51, 12288
  s_waitcnt lgkmcnt(6)
  v_mfma_f32_32x32x16_bf16 v[32:47], v[132:135], v[224:227], v[32:47]
  ds_read_b64_tr_b16 v[148:149], v202 offset:16384
  v_mfma_f32_32x32x16_bf16 v[48:63], v[132:135], v[228:231], v[48:63]
  ds_read_b64_tr_b16 v[150:151], v202 offset:17408
  s_waitcnt lgkmcnt(6)
  v_mfma_f32_32x32x16_bf16 v[64:79], v[136:139], v[224:227], v[64:79]
  ds_read_b64_tr_b16 v[152:153], v203 offset:16384
  v_mfma_f32_32x32x16_bf16 v[80:95], v[136:139], v[228:231], v[80:95]
  ds_read_b64_tr_b16 v[154:155], v203 offset:17408
  s_waitcnt lgkmcnt(6)
  v_mfma_f32_32x32x16_bf16 v[96:111], v[140:143], v[224:227], v[96:111]
  ds_read_b64_tr_b16 v[156:157], v204 offset:16384
  s_add_u32 s52, s88, 4096
  buffer_load_dwordx4 v210, s[44:47], s52 offen offset:0 lds
  v_mfma_f32_32x32x16_bf16 v[112:127], v[140:143], v[228:231], v[112:127]
  ds_read_b64_tr_b16 v[158:159], v204 offset:17408
  buffer_load_dwordx4 v210, s[44:47], s52 offen offset:1024 lds
  s_add_u32 m0, s51, 14336
  s_waitcnt lgkmcnt(6)
  v_mfma_f32_32x32x16_bf16 v[0:15], v[144:147], v[232:235], v[0:15]
  s_waitcnt vmcnt(10)
  ds_read_b64_tr_b16 v[128:129], v201 offset:0
  s_add_u32 s52, s88, 6144
  buffer_load_dwordx4 v210, s[44:47], s52 offen offset:0 lds
  v_mfma_f32_32x32x16_bf16 v[16:31], v[144:147], v[236:239], v[16:31]
  ds_read_b64_tr_b16 v[130:131], v201 offset:1024
  buffer_load_dwordx4 v210, s[44:47], s52 offen offset:1024 lds
  s_add_u32 m0, s51, 16384
  s_waitcnt lgkmcnt(6)
  v_mfma_f32_32x32x16_bf16 v[32:47], v[148:151], v[232:235], v[32:47]
  ds_read_b64_tr_b16 v[132:133], v202 offset:0
  v_mfma_f32_32x32x16_bf16 v[48:63], v[148:151], v[236:239], v[48:63]
  ds_read_b64_tr_b16 v[134:135], v202 offset:1024
  s_waitcnt lgkmcnt(6)
  v_mfma_f32_32x32x16_bf16 v[64:79], v[152:155], v[232:235], v[64:79]
  ds_read_b64_tr_b16 v[136:137], v203 offset:0
  v_mfma_f32_32x32x16_bf16 v[80:95], v[152:155], v[236:239], v[80:95]
  ds_read_b64_tr_b16 v[138:139], v203 offset:1024
  s_waitcnt lgkmcnt(6)
  v_mfma_f32_32x32x16_bf16 v[96:111], v[156:159], v[232:235], v[96:111]
  ds_read_b64_tr_b16 v[140:141], v204 offset:0
  s_add_u32 s52, s88, 8192
  buffer_load_dwordx4 v210, s[44:47], s52 offen offset:0 lds
  v_mfma_f32_32x32x16_bf16 v[112:127], v[156:159], v[236:239], v[112:127]
  ds_read_b64_tr_b16 v[142:143], v204 offset:1024
  buffer_load_dwordx4 v210, s[44:47], s52 offen offset:1024 lds
  s_add_u32 m0, s51, 18432
  s_waitcnt lgkmcnt(6)
  v_mfma_f32_32x32x16_bf16 v[0:15], v[128:131], v[240:243], v[0:15]
  s_waitcnt vmcnt(10)
  ds_read_b64_tr_b16 v[144:145], v201 offset:4096
  s_add_u32 s52, s88, 10240
  buffer_load_dwordx4 v210, s[44:47], s52 offen offset:0 lds
  v_mfma_f32_32x32x16_bf16 v[16:31], v[128:131], v[244:247], v[16:31]
  ds_read_b64_tr_b16 v[146:147], v201 offset:5120
  buffer_load_dwordx4 v210, s[44:47], s52 offen offset:1024 lds
  s_add_u32 m0, s51, 20480
  s_waitcnt lgkmcnt(6)
  v_mfma_f32_32x32x16_bf16 v[32:47], v[132:135], v[240:243], v[32:47]
  ds_read_b64_tr_b16 v[148:149], v202 offset:4096
  s_add_u32 s52, s3, 0
  buffer_load_dwordx4 v217, s[24:27], s52 offen offset:0 lds
  v_mfma_f32_32x32x16_bf16 v[48:63], v[132:135], v[244:247], v[48:63]
  ds_read_b64_tr_b16 v[150:151], v202 offset:5120
  buffer_load_dwordx4 v218, s[24:27], s52 offen offset:1024 lds
  s_add_u32 m0, s51, 0
  s_waitcnt lgkmcnt(6)
  v_mfma_f32_32x32x16_bf16 v[64:79], v[136:139], v[240:243], v[64:79]
  ds_read_b64_tr_b16 v[152:153], v203 offset:4096
  v_mfma_f32_32x32x16_bf16 v[80:95], v[136:139], v[244:247], v[80:95]
  ds_read_b64_tr_b16 v[154:155], v203 offset:5120
  s_waitcnt lgkmcnt(6)
  v_mfma_f32_32x32x16_bf16 v[96:111], v[140:143], v[240:243], v[96:111]
  ds_read_b64_tr_b16 v[156:157], v204 offset:4096
  s_add_u32 s52, s3, 18432
  buffer_load_dwordx4 v217, s[24:27], s52 offen offset:0 lds
  v_mfma_f32_32x32x16_bf16 v[112:127], v[140:143], v[244:247], v[112:127]
  ds_read_b64_tr_b16 v[158:159], v204 offset:5120
  buffer_load_dwordx4 v218, s[24:27], s52 offen offset:1024 lds
  s_add_u32 m0, s51, 2048
  s_waitcnt lgkmcnt(6)
  v_mfma_f32_32x32x16_bf16 v[0:15], v[144:147], v[248:251], v[0:15]
  s_waitcnt vmcnt(14)
  ds_read_b64_tr_b16 v[128:129], v205 offset:8192
  s_add_u32 s52, s3, 36864
  buffer_load_dwordx4 v217, s[24:27], s52 offen offset:0 lds
  v_mfma_f32_32x32x16_bf16 v[16:31], v[144:147], v[252:255], v[16:31]
  ds_read_b64_tr_b16 v[130:131], v205 offset:8448
  buffer_load_dwordx4 v218, s[24:27], s52 offen offset:1024 lds
  s_add_u32 m0, s51, 4096
  s_waitcnt lgkmcnt(6)
  v_mfma_f32_32x32x16_bf16 v[32:47], v[148:151], v[248:251], v[32:47]
  ds_read_b64_tr_b16 v[132:133], v205 offset:8704
  v_mfma_f32_32x32x16_bf16 v[48:63], v[148:151], v[252:255], v[48:63]
  ds_read_b64_tr_b16 v[134:135], v205 offset:8960
  s_waitcnt lgkmcnt(6)
  v_mfma_f32_32x32x16_bf16 v[64:79], v[152:155], v[248:251], v[64:79]
  s_waitcnt vmcnt(14)
  ds_read_b64_tr_b16 v[136:137], v205 offset:10240
  v_mfma_f32_32x32x16_bf16 v[80:95], v[152:155], v[252:255], v[80:95]
  ds_read_b64_tr_b16 v[138:139], v205 offset:10496
  s_waitcnt lgkmcnt(6)
  v_mfma_f32_32x32x16_bf16 v[96:111], v[156:159], v[248:251], v[96:111]
  ds_read_b64_tr_b16 v[140:141], v205 offset:10752
  s_add_u32 s52, s3, 55296
  buffer_load_dwordx4 v217, s[24:27], s52 offen offset:0 lds
  v_mfma_f32_32x32x16_bf16 v[112:127], v[156:159], v[252:255], v[112:127]
  ds_read_b64_tr_b16 v[142:143], v205 offset:11008
  buffer_load_dwordx4 v218, s[24:27], s52 offen offset:1024 lds
  s_add_u32 m0, s51, 6144
  s_waitcnt lgkmcnt(6)
  v_mfma_f32_32x32x16_bf16 v[160:175], v[128:131], a[192:195], v[160:175]
  s_waitcnt vmcnt(14)
  ds_read_b64_tr_b16 v[144:145], v205 offset:12288
  s_add_u32 s52, s3, 147456
  buffer_load_dwordx4 v217, s[24:27], s52 offen offset:0 lds
  v_mfma_f32_32x32x16_bf16 v[176:191], v[128:131], a[196:199], v[176:191]
  ds_read_b64_tr_b16 v[146:147], v205 offset:12544
  buffer_load_dwordx4 v218, s[24:27], s52 offen offset:1024 lds
  s_add_u32 m0, s51, 8192
  v_max_f32 v0, 0, v0
  v_max_f32 v1, 0, v1
  v_mul_f32 v0, v0, v8
  s_waitcnt lgkmcnt(6)
  v_mfma_f32_32x32x16_bf16 v[160:175], v[132:135], a[200:203], v[160:175]
  ds_read_b64_tr_b16 v[148:149], v205 offset:12800
  s_add_u32 s52, s3, 165888
  buffer_load_dwordx4 v217, s[24:27], s52 offen offset:0 lds
  v_mul_f32 v1, v1, v9
  v_mfma_f32_32x32x16_bf16 v[176:191], v[132:135], a[204:207], v[176:191]
  ds_read_b64_tr_b16 v[150:151], v205 offset:13056
  buffer_load_dwordx4 v218, s[24:27], s52 offen offset:1024 lds
  s_add_u32 m0, s51, 10240
  v_cvt_pk_bf16_f32 v0, v0, v1
  v_max_f32 v2, 0, v2
  v_max_f32 v3, 0, v3
  s_waitcnt lgkmcnt(6)
  v_mfma_f32_32x32x16_bf16 v[160:175], v[136:139], a[208:211], v[160:175]
  s_waitcnt vmcnt(16)
  ds_read_b64_tr_b16 v[152:153], v205 offset:14336
  v_mul_f32 v2, v2, v10
  v_mul_f32 v3, v3, v11
  v_cvt_pk_bf16_f32 v1, v2, v3
  v_mfma_f32_32x32x16_bf16 v[176:191], v[136:139], a[212:215], v[176:191]
  ds_read_b64_tr_b16 v[154:155], v205 offset:14592
  v_max_f32 v4, 0, v4
  v_max_f32 v5, 0, v5
  v_mul_f32 v4, v4, v12
  v_mul_f32 v5, v5, v13
  s_waitcnt lgkmcnt(6)
  v_mfma_f32_32x32x16_bf16 v[160:175], v[140:143], a[216:219], v[160:175]
  ds_read_b64_tr_b16 v[156:157], v205 offset:14848
  s_add_u32 s52, s3, 184320
  buffer_load_dwordx4 v217, s[24:27], s52 offen offset:0 lds
  v_cvt_pk_bf16_f32 v2, v4, v5
  v_mfma_f32_32x32x16_bf16 v[176:191], v[140:143], a[220:223], v[176:191]
  ds_read_b64_tr_b16 v[158:159], v205 offset:15104
  buffer_load_dwordx4 v218, s[24:27], s52 offen offset:1024 lds
  s_add_u32 m0, s51, 12288
  v_max_f32 v6, 0, v6
  v_max_f32 v7, 0, v7
  v_mul_f32 v6, v6, v14
  s_waitcnt lgkmcnt(6)
  v_mfma_f32_32x32x16_bf16 v[160:175], v[144:147], a[224:227], v[160:175]
  s_waitcnt vmcnt(16)
  ds_read_b64_tr_b16 v[128:129], v205 offset:16384
  v_mul_f32 v7, v7, v15
  v_cvt_pk_bf16_f32 v3, v6, v7
  ds_write_b128 v214, v[0:3] offset:32768
  v_mfma_f32_32x32x16_bf16 v[176:191], v[144:147], a[228:231], v[176:191]
  ds_read_b64_tr_b16 v[130:131], v205 offset:16640
  v_max_f32 v16, 0, v16
  v_max_f32 v17, 0, v17
  v_mul_f32 v16, v16, v24
  v_mul_f32 v17, v17, v25
  s_waitcnt lgkmcnt(7)
  v_mfma_f32_32x32x16_bf16 v[160:175], v[148:151], a[232:235], v[160:175]
  ds_read_b64_tr_b16 v[132:133], v205 offset:16896
  s_add_u32 s52, s3, 202752
  buffer_load_dwordx4 v217, s[24:27], s52 offen offset:0 lds
  v_cvt_pk_bf16_f32 v16, v16, v17
  v_mfma_f32_32x32x16_bf16 v[176:191], v[148:151], a[236:239], v[176:191]
  ds_read_b64_tr_b16 v[134:135], v205 offset:17152
  buffer_load_dwordx4 v218, s[24:27], s52 offen offset:1024 lds
  s_add_u32 m0, s51, 14336
  v_max_f32 v18, 0, v18
  v_max_f32 v19, 0, v19
  v_mul_f32 v18, v18, v26
  s_waitcnt lgkmcnt(7)
  v_mfma_f32_32x32x16_bf16 v[160:175], v[152:155], a[240:243], v[160:175]
  s_waitcnt vmcnt(16)
  ds_read_b64_tr_b16 v[136:137], v205 offset:18432
  v_mul_f32 v19, v19, v27
  v_cvt_pk_bf16_f32 v17, v18, v19
  v_max_f32 v20, 0, v20
  v_mfma_f32_32x32x16_bf16 v[176:191], v[152:155], a[244:247], v[176:191]
  ds_read_b64_tr_b16 v[138:139], v205 offset:18688
  v_max_f32 v21, 0, v21
  v_mul_f32 v20, v20, v28
  v_mul_f32 v21, v21, v29
  v_cvt_pk_bf16_f32 v18, v20, v21
  s_waitcnt lgkmcnt(7)
  v_mfma_f32_32x32x16_bf16 v[160:175], v[156:159], a[248:251], v[160:175]
  ds_read_b64_tr_b16 v[140:141], v205 offset:18944
  s_add_u32 s52, s3, 294912
  buffer_load_dwordx4 v217, s[24:27], s52 offen offset:0 lds
  v_max_f32 v22, 0, v22
  v_mfma_f32_32x32x16_bf16 v[176:191], v[156:159], a[252:255], v[176:191]
  ds_read_b64_tr_b16 v[142:143], v205 offset:19200
  buffer_load_dwordx4 v218, s[24:27], s52 offen offset:1024 lds
  s_add_u32 m0, s51, 16384
  v_max_f32 v23, 0, v23
  v_mul_f32 v22, v22, v30
  v_mul_f32 v23, v23, v31
  s_waitcnt lgkmcnt(6)
  v_mfma_f32_32x32x16_bf16 v[160:175], v[128:131], v[224:227], v[160:175]
  s_waitcnt vmcnt(16)
  ds_read_b128 a[0:3], v212 offset:0
  ds_read_b64_tr_b16 v[144:145], v215 offset:20480
  v_cvt_pk_bf16_f32 v19, v22, v23
  ds_write_b128 v214, v[16:19] offset:33792
  v_mfma_f32_32x32x16_bf16 v[176:191], v[128:131], v[228:231], v[176:191]
  ds_read_b64_tr_b16 v[146:147], v215 offset:21504
  v_max_f32 v32, 0, v32
  v_max_f32 v33, 0, v33
  v_mul_f32 v32, v32, v40
  v_mul_f32 v33, v33, v41
  s_waitcnt lgkmcnt(8)
  v_mfma_f32_32x32x16_bf16 v[160:175], v[132:135], v[232:235], v[160:175]
  ds_read_b128 a[4:7], v212 offset:1024
  ds_read_b64_tr_b16 v[148:149], v216 offset:20480
  s_add_u32 s52, s3, 313344
  buffer_load_dwordx4 v217, s[24:27], s52 offen offset:0 lds
  v_mfma_f32_32x32x16_bf16 v[176:191], v[132:135], v[236:239], v[176:191]
  ds_read_b64_tr_b16 v[150:151], v216 offset:21504
  buffer_load_dwordx4 v218, s[24:27], s52 offen offset:1024 lds
  s_add_u32 m0, s51, 18432
  v_cvt_pk_bf16_f32 v32, v32, v33
  v_max_f32 v34, 0, v34
  v_max_f32 v35, 0, v35
  s_waitcnt lgkmcnt(9)
  v_mfma_f32_32x32x16_bf16 v[160:175], v[136:139], v[240:243], v[160:175]
  s_waitcnt vmcnt(16)
  ds_read_b128 a[8:11], v212 offset:2048
  ds_read_b64_tr_b16 v[152:153], v215 offset:0
  v_mul_f32 v34, v34, v42
  v_mul_f32 v35, v35, v43
  v_mfma_f32_32x32x16_bf16 v[176:191], v[136:139], v[244:247], v[176:191]
  ds_read_b64_tr_b16 v[154:155], v215 offset:1024
  v_cvt_pk_bf16_f32 v33, v34, v35
  v_max_f32 v36, 0, v36
  v_max_f32 v37, 0, v37
  v_mul_f32 v36, v36, v44
  s_waitcnt lgkmcnt(10)
  v_mfma_f32_32x32x16_bf16 v[160:175], v[140:143], v[248:251], v[160:175]
  ds_read_b128 a[12:15], v212 offset:3072
  ds_read_b64_tr_b16 v[156:157], v216 offset:0
  s_add_u32 s52, s3, 331776
  buffer_load_dwordx4 v217, s[24:27], s52 offen offset:0 lds
  v_mfma_f32_32x32x16_bf16 v[176:191], v[140:143], v[252:255], v[176:191]
  ds_read_b64_tr_b16 v[158:159], v216 offset:1024
  buffer_load_dwordx4 v218, s[24:27], s52 offen offset:1024 lds
  s_add_u32 m0, s51, 20480
  v_mul_f32 v37, v37, v45
  v_cvt_pk_bf16_f32 v34, v36, v37
  v_max_f32 v38, 0, v38
  v_max_f32 v39, 0, v39
  v_mul_f32 v38, v38, v46
  v_mul_f32 v39, v39, v47
  v_cvt_pk_bf16_f32 v35, v38, v39
  ds_write_b128 v214, v[32:35] offset:34816
  v_max_f32 v48, 0, v48
  v_max_f32 v49, 0, v49
  v_mul_f32 v48, v48, v56
  v_mul_f32 v49, v49, v57
  v_cvt_pk_bf16_f32 v48, v48, v49
  v_max_f32 v50, 0, v50
  v_max_f32 v51, 0, v51
  v_mul_f32 v50, v50, v58
  v_mul_f32 v51, v51, v59
  v_cvt_pk_bf16_f32 v49, v50, v51
  v_max_f32 v52, 0, v52
  v_max_f32 v53, 0, v53
  v_mul_f32 v52, v52, v60
  v_mul_f32 v53, v53, v61
  v_cvt_pk_bf16_f32 v50, v52, v53
  v_max_f32 v54, 0, v54
  v_max_f32 v55, 0, v55
  v_mul_f32 v54, v54, v62
  v_mul_f32 v55, v55, v63
  v_cvt_pk_bf16_f32 v51, v54, v55
  ds_write_b128 v214, v[48:51] offset:35840
  s_waitcnt lgkmcnt(11)
  v_mfma_f32_32x32x16_bf16 v[0:15], v[144:147], a[0:3], 0
  s_waitcnt vmcnt(16)
  ds_read_b128 a[16:19], v212 offset:4096
  ds_read_b64_tr_b16 v[128:129], v215 offset:2048
  s_waitcnt lgkmcnt(12)
  v_mfma_f32_32x32x16_bf16 v[16:31], v[144:147], a[4:7], 0
  ds_read_b64_tr_b16 v[130:131], v215 offset:3072
  s_waitcnt lgkmcnt(11)
  v_mfma_f32_32x32x16_bf16 v[32:47], v[148:151], a[0:3], 0
  ds_read_b128 a[20:23], v212 offset:5120
  ds_read_b64_tr_b16 v[132:133], v216 offset:2048
  s_add_u32 s52, s3, 350208
  buffer_load_dwordx4 v217, s[24:27], s52 offen offset:0 lds
  v_mfma_f32_32x32x16_bf16 v[48:63], v[148:151], a[4:7], 0
  ds_read_b64_tr_b16 v[134:135], v216 offset:3072
  buffer_load_dwordx4 v218, s[24:27], s52 offen offset:1024 lds
  s_add_u32 m0, s51, 0
  v_max_f32 v64, 0, v64
  v_max_f32 v65, 0, v65
  v_mul_f32 v64, v64, v72
  s_waitcnt lgkmcnt(11)
  v_mfma_f32_32x32x16_bf16 v[0:15], v[152:155], a[8:11], v[0:15]
  s_waitcnt vmcnt(16)
  ds_read_b128 a[24:27], v212 offset:6144
  ds_read_b64_tr_b16 v[136:137], v215 offset:4096
  v_mul_f32 v65, v65, v73
  v_cvt_pk_bf16_f32 v64, v64, v65
  s_waitcnt lgkmcnt(12)
  v_mfma_f32_32x32x16_bf16 v[16:31], v[152:155], a[12:15], v[16:31]
  ds_read_b64_tr_b16 v[138:139], v215 offset:5120
  v_max_f32 v66, 0, v66
  v_max_f32 v67, 0, v67
  v_mul_f32 v66, v66, v74
  v_mul_f32 v67, v67, v75
  s_waitcnt lgkmcnt(11)
  v_mfma_f32_32x32x16_bf16 v[32:47], v[156:159], a[8:11], v[32:47]
  ds_read_b128 a[28:31], v212 offset:7168
  ds_read_b64_tr_b16 v[140:141], v216 offset:4096
  s_add_u32 s52, s3, 442368
  buffer_load_dwordx4 v217, s[24:27], s52 offen offset:0 lds
  v_mfma_f32_32x32x16_bf16 v[48:63], v[156:159], a[12:15], v[48:63]
  ds_read_b64_tr_b16 v[142:143], v216 offset:5120
  buffer_load_dwordx4 v218, s[24:27], s52 offen offset:1024 lds
  s_add_u32 m0, s51, 2048
  v_cvt_pk_bf16_f32 v65, v66, v67
  v_max_f32 v68, 0, v68
  v_max_f32 v69, 0, v69
  s_waitcnt lgkmcnt(9)
  v_mfma_f32_32x32x16_bf16 v[0:15], v[128:131], a[16:19], v[0:15]
  s_waitcnt vmcnt(16)
  ds_read_b128 a[32:35], v212 offset:8192
  ds_read_b64_tr_b16 v[144:145], v215 offset:6144
  v_mul_f32 v68, v68, v76
  v_mul_f32 v69, v69, v77
  s_waitcnt lgkmcnt(10)
  v_mfma_f32_32x32x16_bf16 v[16:31], v[128:131], a[20:23], v[16:31]
  ds_read_b64_tr_b16 v[146:147], v215 offset:7168
  v_cvt_pk_bf16_f32 v66, v68, v69
  v_max_f32 v70, 0, v70
  v_max_f32 v71, 0, v71
  v_mul_f32 v70, v70, v78
  s_waitcnt lgkmcnt(9)
  v_mfma_f32_32x32x16_bf16 v[32:47], v[132:135], a[16:19], v[32:47]
  ds_read_b128 a[36:39], v212 offset:9216
  ds_read_b64_tr_b16 v[148:149], v216 offset:6144
  s_add_u32 s52, s3, 460800
  buffer_load_dwordx4 v217, s[24:27], s52 offen offset:0 lds
  v_mfma_f32_32x32x16_bf16 v[48:63], v[132:135], a[20:23], v[48:63]
  ds_read_b64_tr_b16 v[150:151], v216 offset:7168
  buffer_load_dwordx4 v218, s[24:27], s52 offen offset:1024 lds
  s_add_u32 m0, s51, 4096
  v_mul_f32 v71, v71, v79
  v_cvt_pk_bf16_f32 v67, v70, v71
  ds_write_b128 v214, v[64:67] offset:36864
  s_waitcnt lgkmcnt(10)
  v_mfma_f32_32x32x16_bf16 v[0:15], v[136:139], a[24:27], v[0:15]
  s_waitcnt vmcnt(16)
  ds_read_b128 a[40:43], v212 offset:10240
  ds_read_b64_tr_b16 v[152:153], v215 offset:8192
  v_max_f32 v80, 0, v80
  v_max_f32 v81, 0, v81
  s_waitcnt lgkmcnt(11)
  v_mfma_f32_32x32x16_bf16 v[16:31], v[136:139], a[28:31], v[16:31]
  ds_read_b64_tr_b16 v[154:155], v215 offset:9216
  v_mul_f32 v80, v80, v88
  v_mul_f32 v81, v81, v89
  v_cvt_pk_bf16_f32 v80, v80, v81
  v_max_f32 v82, 0, v82
  s_waitcnt lgkmcnt(10)
  v_mfma_f32_32x32x16_bf16 v[32:47], v[140:143], a[24:27], v[32:47]
  ds_read_b128 a[44:47], v212 offset:11264
  ds_read_b64_tr_b16 v[156:157], v216 offset:8192
  s_add_u32 s52, s3, 479232
  buffer_load_dwordx4 v217, s[24:27], s52 offen offset:0 lds
  v_mfma_f32_32x32x16_bf16 v[48:63], v[140:143], a[28:31], v[48:63]
  ds_read_b64_tr_b16 v[158:159], v216 offset:9216
  buffer_load_dwordx4 v218, s[24:27], s52 offen offset:1024 lds
  s_add_u32 m0, s51, 6144
  v_max_f32 v83, 0, v83
  v_mul_f32 v82, v82, v90
  v_mul_f32 v83, v83, v91
  s_waitcnt lgkmcnt(10)
  v_mfma_f32_32x32x16_bf16 v[0:15], v[144:147], a[32:35], v[0:15]
  s_waitcnt vmcnt(16)
  ds_read_b128 a[48:51], v212 offset:12288
  ds_read_b64_tr_b16 v[128:129], v215 offset:10240
  v_cvt_pk_bf16_f32 v81, v82, v83
  v_max_f32 v84, 0, v84
  s_waitcnt lgkmcnt(11)
  v_mfma_f32_32x32x16_bf16 v[16:31], v[144:147], a[36:39], v[16:31]
  ds_read_b64_tr_b16 v[130:131], v215 offset:11264
  v_max_f32 v85, 0, v85
  v_mul_f32 v84, v84, v92
  v_mul_f32 v85, v85, v93
  v_cvt_pk_bf16_f32 v82, v84, v85
  s_waitcnt lgkmcnt(10)
  v_mfma_f32_32x32x16_bf16 v[32:47], v[148:151], a[32:35], v[32:47]
  ds_read_b128 a[52:55], v212 offset:13312
  ds_read_b64_tr_b16 v[132:133], v216 offset:10240
  s_add_u32 s52, s3, 497664
  buffer_load_dwordx4 v217, s[24:27], s52 offen offset:0 lds
  v_mfma_f32_32x32x16_bf16 v[48:63], v[148:151], a[36:39], v[48:63]
  ds_read_b64_tr_b16 v[134:135], v216 offset:11264
  buffer_load_dwordx4 v218, s[24:27], s52 offen offset:1024 lds
  s_add_u32 m0, s51, 8192
  v_max_f32 v86, 0, v86
  v_max_f32 v87, 0, v87
  v_mul_f32 v86, v86, v94
  s_waitcnt lgkmcnt(9)
  v_mfma_f32_32x32x16_bf16 v[0:15], v[152:155], a[40:43], v[0:15]
  s_waitcnt vmcnt(16)
  ds_read_b128 a[56:59], v212 offset:14336
  ds_read_b64_tr_b16 v[136:137], v215 offset:12288
  v_mul_f32 v87, v87, v95
  v_cvt_pk_bf16_f32 v83, v86, v87
  s_waitcnt lgkmcnt(10)
  v_mfma_f32_32x32x16_bf16 v[16:31], v[152:155], a[44:47], v[16:31]
  ds_read_b64_tr_b16 v[138:139], v215 offset:13312
  ds_write_b128 v214, v[80:83] offset:37888
  v_max_f32 v96, 0, v96
  v_max_f32 v97, 0, v97
  v_mul_f32 v96, v96, v104
  s_waitcnt lgkmcnt(10)
  v_mfma_f32_32x32x16_bf16 v[32:47], v[156:159], a[40:43], v[32:47]
  ds_read_b128 a[60:63], v212 offset:15360
  ds_read_b64_tr_b16 v[140:141], v216 offset:12288
  s_add_u32 s52, s14, 0
  buffer_load_dwordx4 v217, s[24:27], s52 offen offset:0 lds
  v_mfma_f32_32x32x16_bf16 v[48:63], v[156:159], a[44:47], v[48:63]
  ds_read_b64_tr_b16 v[142:143], v216 offset:13312
  buffer_load_dwordx4 v218, s[24:27], s52 offen offset:1024 lds
  s_add_u32 m0, s51, 10240
  v_mul_f32 v97, v97, v105
  v_cvt_pk_bf16_f32 v96, v96, v97
  v_max_f32 v98, 0, v98
  s_waitcnt lgkmcnt(10)
  v_mfma_f32_32x32x16_bf16 v[0:15], v[128:131], a[48:51], v[0:15]
  s_waitcnt vmcnt(16)
  ds_read_b128 a[64:67], v212 offset:16384
  ds_read_b64_tr_b16 v[144:145], v215 offset:14336
  v_max_f32 v99, 0, v99
  v_mul_f32 v98, v98, v106
  s_waitcnt lgkmcnt(11)
  v_mfma_f32_32x32x16_bf16 v[16:31], v[128:131], a[52:55], v[16:31]
  ds_read_b64_tr_b16 v[146:147], v215 offset:15360
  v_mul_f32 v99, v99, v107
  v_cvt_pk_bf16_f32 v97, v98, v99
  v_max_f32 v100, 0, v100
  v_max_f32 v101, 0, v101
  s_waitcnt lgkmcnt(10)
  v_mfma_f32_32x32x16_bf16 v[32:47], v[132:135], a[48:51], v[32:47]
  ds_read_b128 a[68:71], v212 offset:17408
  ds_read_b64_tr_b16 v[148:149], v216 offset:14336
  s_add_u32 s52, s14, 18432
  buffer_load_dwordx4 v217, s[24:27], s52 offen offset:0 lds
  v_mfma_f32_32x32x16_bf16 v[48:63], v[132:135], a[52:55], v[48:63]
  ds_read_b64_tr_b16 v[150:151], v216 offset:15360
  buffer_load_dwordx4 v218, s[24:27], s52 offen offset:1024 lds
  s_add_u32 m0, s51, 12288
  v_mul_f32 v100, v100, v108
  v_mul_f32 v101, v101, v109
  v_cvt_pk_bf16_f32 v98, v100, v101
  s_waitcnt lgkmcnt(10)
  v_mfma_f32_32x32x16_bf16 v[0:15], v[136:139], a[56:59], v[0:15]
  s_waitcnt vmcnt(16)
  ds_read_b128 a[72:75], v212 offset:18432
  ds_read_b64_tr_b16 v[152:153], v215 offset:16384
  v_max_f32 v102, 0, v102
  v_max_f32 v103, 0, v103
  s_waitcnt lgkmcnt(10)
  v_mfma_f32_32x32x16_bf16 v[16:31], v[136:139], a[60:63], v[16:31]
  ds_read_b64_tr_b16 v[154:155], v215 offset:17408
  v_mul_f32 v102, v102, v110
  v_mul_f32 v103, v103, v111
  v_cvt_pk_bf16_f32 v99, v102, v103
  ds_write_b128 v214, v[96:99] offset:38912
  s_waitcnt lgkmcnt(10)
  v_mfma_f32_32x32x16_bf16 v[32:47], v[140:143], a[56:59], v[32:47]
  ds_read_b128 a[76:79], v212 offset:19456
  ds_read_b64_tr_b16 v[156:157], v216 offset:16384
  s_add_u32 s52, s14, 36864
  buffer_load_dwordx4 v217, s[24:27], s52 offen offset:0 lds
  v_mfma_f32_32x32x16_bf16 v[48:63], v[140:143], a[60:63], v[48:63]
  ds_read_b64_tr_b16 v[158:159], v216 offset:17408
  buffer_load_dwordx4 v218, s[24:27], s52 offen offset:1024 lds
  s_add_u32 m0, s51, 14336
  v_max_f32 v112, 0, v112
  v_max_f32 v113, 0, v113
  v_mul_f32 v112, v112, v120
  s_waitcnt lgkmcnt(10)
  v_mfma_f32_32x32x16_bf16 v[0:15], v[144:147], a[64:67], v[0:15]
  s_waitcnt vmcnt(16)
  ds_read_b128 a[80:83], v212 offset:20480
  ds_read_b64_tr_b16 v[128:129], v215 offset:18432
  v_mul_f32 v113, v113, v121
  v_cvt_pk_bf16_f32 v112, v112, v113
  s_waitcnt lgkmcnt(11)
  v_mfma_f32_32x32x16_bf16 v[16:31], v[144:147], a[68:71], v[16:31]
  ds_read_b64_tr_b16 v[130:131], v215 offset:19456
  v_max_f32 v114, 0, v114
  v_max_f32 v115, 0, v115
  v_mul_f32 v114, v114, v122
  v_mul_f32 v115, v115, v123
  s_waitcnt lgkmcnt(10)
  v_mfma_f32_32x32x16_bf16 v[32:47], v[148:151], a[64:67], v[32:47]
  ds_read_b128 a[84:87], v212 offset:21504
  ds_read_b64_tr_b16 v[132:133], v216 offset:18432
  s_add_u32 s52, s14, 55296
  buffer_load_dwordx4 v217, s[24:27], s52 offen offset:0 lds
  v_mfma_f32_32x32x16_bf16 v[48:63], v[148:151], a[68:71], v[48:63]
  ds_read_b64_tr_b16 v[134:135], v216 offset:19456
  buffer_load_dwordx4 v218, s[24:27], s52 offen offset:1024 lds
  s_add_u32 m0, s51, 16384
  v_cvt_pk_bf16_f32 v113, v114, v115
  v_max_f32 v116, 0, v116
  v_max_f32 v117, 0, v117
  s_waitcnt lgkmcnt(10)
  v_mfma_f32_32x32x16_bf16 v[0:15], v[152:155], a[72:75], v[0:15]
  s_waitcnt vmcnt(16)
  ds_read_b128 a[88:91], v212 offset:22528
  ds_read_b64_tr_b16 v[136:137], v215 offset:20480
  v_mul_f32 v116, v116, v124
  v_mul_f32 v117, v117, v125
  s_waitcnt lgkmcnt(10)
  v_mfma_f32_32x32x16_bf16 v[16:31], v[152:155], a[76:79], v[16:31]
  ds_read_b64_tr_b16 v[138:139], v215 offset:21504
  v_cvt_pk_bf16_f32 v114, v116, v117
  v_max_f32 v118, 0, v118
  v_max_f32 v119, 0, v119
  v_mul_f32 v118, v118, v126
  s_waitcnt lgkmcnt(9)
  v_mfma_f32_32x32x16_bf16 v[32:47], v[156:159], a[72:75], v[32:47]
  ds_read_b128 a[92:95], v212 offset:23552
  ds_read_b64_tr_b16 v[140:141], v216 offset:20480
  s_add_u32 s52, s14, 147456
  buffer_load_dwordx4 v217, s[24:27], s52 offen offset:0 lds
  v_mfma_f32_32x32x16_bf16 v[48:63], v[156:159], a[76:79], v[48:63]
  ds_read_b64_tr_b16 v[142:143], v216 offset:21504
  buffer_load_dwordx4 v218, s[24:27], s52 offen offset:1024 lds
  s_add_u32 m0, s51, 18432
  v_mul_f32 v119, v119, v127
  v_cvt_pk_bf16_f32 v115, v118, v119
  ds_write_b128 v214, v[112:115] offset:39936
  s_waitcnt lgkmcnt(10)
  v_mfma_f32_32x32x16_bf16 v[0:15], v[128:131], a[80:83], v[0:15]
  s_waitcnt vmcnt(16)
  ds_read_b128 a[96:99], v212 offset:24576
  ds_read_b64_tr_b16 v[144:145], v215 offset:0
  v_max_f32 v160, 0, v160
  v_max_f32 v161, 0, v161
  s_waitcnt lgkmcnt(11)
  v_mfma_f32_32x32x16_bf16 v[16:31], v[128:131], a[84:87], v[16:31]
  ds_read_b64_tr_b16 v[146:147], v215 offset:1024
  v_mul_f32 v160, v160, v168
  v_mul_f32 v161, v161, v169
  v_cvt_pk_bf16_f32 v160, v160, v161
  v_max_f32 v162, 0, v162
  s_waitcnt lgkmcnt(10)
  v_mfma_f32_32x32x16_bf16 v[32:47], v[132:135], a[80:83], v[32:47]
  ds_read_b128 a[100:103], v212 offset:25600
  ds_read_b64_tr_b16 v[148:149], v216 offset:0
  s_add_u32 s52, s14, 165888
  buffer_load_dwordx4 v217, s[24:27], s52 offen offset:0 lds
  v_mfma_f32_32x32x16_bf16 v[48:63], v[132:135], a[84:87], v[48:63]
  ds_read_b64_tr_b16 v[150:151], v216 offset:1024
  buffer_load_dwordx4 v218, s[24:27], s52 offen offset:1024 lds
  s_add_u32 m0, s51, 20480
  v_max_f32 v163, 0, v163
  v_mul_f32 v162, v162, v170
  v_mul_f32 v163, v163, v171
  s_waitcnt lgkmcnt(10)
  v_mfma_f32_32x32x16_bf16 v[0:15], v[136:139], a[88:91], v[0:15]
  s_waitcnt vmcnt(16)
  ds_read_b128 a[104:107], v212 offset:26624
  ds_read_b64_tr_b16 v[152:153], v215 offset:2048
  v_cvt_pk_bf16_f32 v161, v162, v163
  v_max_f32 v164, 0, v164
  s_waitcnt lgkmcnt(11)
  v_mfma_f32_32x32x16_bf16 v[16:31], v[136:139], a[92:95], v[16:31]
  ds_read_b64_tr_b16 v[154:155], v215 offset:3072
  v_max_f32 v165, 0, v165
  v_mul_f32 v164, v164, v172
  v_mul_f32 v165, v165, v173
  v_cvt_pk_bf16_f32 v162, v164, v165
  s_waitcnt lgkmcnt(10)
  v_mfma_f32_32x32x16_bf16 v[32:47], v[140:143], a[88:91], v[32:47]
  ds_read_b128 a[108:111], v212 offset:27648
  ds_read_b64_tr_b16 v[156:157], v216 offset:2048
  s_add_u32 s52, s14, 184320
  buffer_load_dwordx4 v217, s[24:27], s52 offen offset:0 lds
  v_mfma_f32_32x32x16_bf16 v[48:63], v[140:143], a[92:95], v[48:63]
  ds_read_b64_tr_b16 v[158:159], v216 offset:3072
  buffer_load_dwordx4 v218, s[24:27], s52 offen offset:1024 lds
  s_add_u32 m0, s51, 0
  v_max_f32 v166, 0, v166
  v_max_f32 v167, 0, v167
  v_mul_f32 v166, v166, v174
  s_waitcnt lgkmcnt(9)
  v_mfma_f32_32x32x16_bf16 v[0:15], v[144:147], a[96:99], v[0:15]
  s_waitcnt vmcnt(16)
  ds_read_b128 a[112:115], v212 offset:28672
  ds_read_b64_tr_b16 v[128:129], v215 offset:4096
  v_mul_f32 v167, v167, v175
  v_cvt_pk_bf16_f32 v163, v166, v167
  s_waitcnt lgkmcnt(10)
  v_mfma_f32_32x32x16_bf16 v[16:31], v[144:147], a[100:103], v[16:31]
  ds_read_b64_tr_b16 v[130:131], v215 offset:5120
  ds_write_b128 v223, v[160:163] offset:0
  v_max_f32 v176, 0, v176
  v_max_f32 v177, 0, v177
  v_mul_f32 v176, v176, v184
  s_waitcnt lgkmcnt(10)
  v_mfma_f32_32x32x16_bf16 v[32:47], v[148:151], a[96:99], v[32:47]
  ds_read_b128 a[116:119], v212 offset:29696
  ds_read_b64_tr_b16 v[132:133], v216 offset:4096
  s_add_u32 s52, s14, 202752
  buffer_load_dwordx4 v217, s[24:27], s52 offen offset:0 lds
  v_mfma_f32_32x32x16_bf16 v[48:63], v[148:151], a[100:103], v[48:63]
  ds_read_b64_tr_b16 v[134:135], v216 offset:5120
  buffer_load_dwordx4 v218, s[24:27], s52 offen offset:1024 lds
  s_add_u32 m0, s51, 2048
  v_mul_f32 v177, v177, v185
  v_cvt_pk_bf16_f32 v176, v176, v177
  v_max_f32 v178, 0, v178
  v_max_f32 v179, 0, v179
  v_mul_f32 v178, v178, v186
  v_mul_f32 v179, v179, v187
  v_cvt_pk_bf16_f32 v177, v178, v179
  v_max_f32 v180, 0, v180
  v_max_f32 v181, 0, v181
  v_mul_f32 v180, v180, v188
  v_mul_f32 v181, v181, v189
  v_cvt_pk_bf16_f32 v178, v180, v181
  v_max_f32 v182, 0, v182
  v_max_f32 v183, 0, v183
  v_mul_f32 v182, v182, v190
  v_mul_f32 v183, v183, v191
  v_cvt_pk_bf16_f32 v179, v182, v183
  ds_write_b128 v223, v[176:179] offset:1024
  s_waitcnt lgkmcnt(11)
  v_mfma_f32_32x32x16_bf16 v[0:15], v[152:155], a[104:107], v[0:15]
  s_waitcnt vmcnt(16)
  ds_read_b128 a[120:123], v212 offset:30720
  ds_read_b64_tr_b16 v[136:137], v215 offset:6144
  s_waitcnt lgkmcnt(12)
  v_mfma_f32_32x32x16_bf16 v[16:31], v[152:155], a[108:111], v[16:31]
  ds_read_b64_tr_b16 v[138:139], v215 offset:7168
  s_waitcnt lgkmcnt(0)
  s_barrier
  v_mfma_f32_32x32x16_bf16 v[32:47], v[156:159], a[104:107], v[32:47]
  ds_read_b128 a[124:127], v212 offset:31744
  ds_read_b64_tr_b16 v[140:141], v216 offset:6144
  s_add_u32 s52, s14, 294912
  buffer_load_dwordx4 v217, s[24:27], s52 offen offset:0 lds
  v_mfma_f32_32x32x16_bf16 v[48:63], v[156:159], a[108:111], v[48:63]
  ds_read_b64_tr_b16 v[142:143], v216 offset:7168
  buffer_load_dwordx4 v218, s[24:27], s52 offen offset:1024 lds
  s_add_u32 m0, s51, 4096
  v_bfe_u32 v219, v200, 3, 2
  v_mul_u32_u24 v201, 73728, v219
  v_mfma_f32_32x32x16_bf16 v[0:15], v[128:131], a[112:115], v[0:15]
  s_waitcnt vmcnt(16)
  ds_read_b128 a[128:131], v212 offset:32768
  ds_read_b64_tr_b16 v[144:145], v215 offset:8192
  v_and_b32 v219, 7, v200
  v_mfma_f32_32x32x16_bf16 v[16:31], v[128:131], a[116:119], v[16:31]
  ds_read_b64_tr_b16 v[146:147], v215 offset:9216
  v_lshl_add_u32 v201, v219, 4, v201
  v_lshrrev_b32 v219, 5, v200
  v_lshl_add_u32 v201, v219, 7, v201
  v_mfma_f32_32x32x16_bf16 v[32:47], v[132:135], a[112:115], v[32:47]
  ds_read_b128 a[132:135], v212 offset:33792
  ds_read_b64_tr_b16 v[148:149], v216 offset:8192
  s_add_u32 s52, s14, 313344
  buffer_load_dwordx4 v217, s[24:27], s52 offen offset:0 lds
  v_mfma_f32_32x32x16_bf16 v[48:63], v[132:135], a[116:119], v[48:63]
  ds_read_b64_tr_b16 v[150:151], v216 offset:9216
  buffer_load_dwordx4 v218, s[24:27], s52 offen offset:1024 lds
  s_add_u32 m0, s51, 6144
  s_lshl_b32 s92, s48, 12
  v_add_u32 v202, s92, v212
  v_mfma_f32_32x32x16_bf16 v[0:15], v[136:139], a[120:123], v[0:15]
  s_waitcnt vmcnt(16)
  ds_read_b128 a[136:139], v212 offset:34816
  ds_read_b64_tr_b16 v[152:153], v215 offset:10240
  s_lshl_b32 s92, s48, 14
  s_waitcnt lgkmcnt(10)
  v_mfma_f32_32x32x16_bf16 v[16:31], v[136:139], a[124:127], v[16:31]
  ds_read_b64_tr_b16 v[154:155], v215 offset:11264
  v_add_u32 v203, s92, v212
  s_mul_i32 s92, s49, 589824
  s_add_u32 s93, s49, 8
  s_waitcnt lgkmcnt(9)
  v_mfma_f32_32x32x16_bf16 v[32:47], v[140:143], a[120:123], v[32:47]
  ds_read_b128 a[140:143], v212 offset:35840
  ds_read_b64_tr_b16 v[156:157], v216 offset:10240
  s_add_u32 s52, s14, 331776
  buffer_load_dwordx4 v217, s[24:27], s52 offen offset:0 lds
  v_mfma_f32_32x32x16_bf16 v[48:63], v[140:143], a[124:127], v[48:63]
  ds_read_b64_tr_b16 v[158:159], v216 offset:11264
  buffer_load_dwordx4 v218, s[24:27], s52 offen offset:1024 lds
  s_add_u32 m0, s51, 8192
  s_lshr_b32 s93, s93, 5
  s_mul_i32 s93, s93, 4718592
  s_waitcnt lgkmcnt(9)
  v_mfma_f32_32x32x16_bf16 v[0:15], v[144:147], a[128:131], v[0:15]
  s_waitcnt vmcnt(16)
  ds_read_b128 a[144:147], v212 offset:36864
  ds_read_b64_tr_b16 v[128:129], v215 offset:12288
  s_add_u32 s92, s92, s93
  s_waitcnt lgkmcnt(10)
  v_mfma_f32_32x32x16_bf16 v[16:31], v[144:147], a[132:135], v[16:31]
  ds_read_b64_tr_b16 v[130:131], v215 offset:13312
  s_add_u32 s92, s92, 18874368
  s_mul_i32 s95, s50, 73728
  s_add_u32 s95, s95, s92
  s_waitcnt lgkmcnt(9)
  v_mfma_f32_32x32x16_bf16 v[32:47], v[148:151], a[128:131], v[32:47]
  ds_read_b128 a[148:151], v212 offset:37888
  ds_read_b64_tr_b16 v[132:133], v216 offset:12288
  s_add_u32 s52, s14, 350208
  buffer_load_dwordx4 v217, s[24:27], s52 offen offset:0 lds
  v_mfma_f32_32x32x16_bf16 v[48:63], v[148:151], a[132:135], v[48:63]
  ds_read_b64_tr_b16 v[134:135], v216 offset:13312
  buffer_load_dwordx4 v218, s[24:27], s52 offen offset:1024 lds
  s_add_u32 m0, s51, 10240
  s_mul_i32 s93, s50, 9216
  s_add_u32 s92, s92, s93
  s_waitcnt lgkmcnt(9)
  v_mfma_f32_32x32x16_bf16 v[0:15], v[152:155], a[136:139], v[0:15]
  s_waitcnt vmcnt(16)
  ds_read_b128 a[152:155], v212 offset:38912
  ds_read_b64_tr_b16 v[136:137], v215 offset:14336
  s_lshl_b32 s93, s48, 10
  s_waitcnt lgkmcnt(10)
  v_mfma_f32_32x32x16_bf16 v[16:31], v[152:155], a[140:143], v[16:31]
  ds_read_b64_tr_b16 v[138:139], v215 offset:15360
  s_add_u32 s54, s92, s93
  s_add_u32 s55, s54, 294912
  s_and_b32 s93, s48, 1
  s_waitcnt lgkmcnt(9)
  v_mfma_f32_32x32x16_bf16 v[32:47], v[156:159], a[136:139], v[32:47]
  ds_read_b128 a[156:159], v212 offset:39936
  ds_read_b64_tr_b16 v[140:141], v216 offset:14336
  s_add_u32 s52, s14, 442368
  buffer_load_dwordx4 v217, s[24:27], s52 offen offset:0 lds
  v_mfma_f32_32x32x16_bf16 v[48:63], v[156:159], a[140:143], v[48:63]
  ds_read_b64_tr_b16 v[142:143], v216 offset:15360
  buffer_load_dwordx4 v218, s[24:27], s52 offen offset:1024 lds
  s_add_u32 m0, s51, 12288
  s_mul_i32 s93, s93, 294912
  s_add_u32 s92, s92, s93
  s_waitcnt lgkmcnt(9)
  v_mfma_f32_32x32x16_bf16 v[0:15], v[128:131], a[144:147], v[0:15]
  s_waitcnt vmcnt(16)
  ds_read_b128 a[160:163], v212 offset:40960
  ds_read_b64_tr_b16 v[144:145], v215 offset:16384
  s_lshr_b32 s93, s48, 1
  s_waitcnt lgkmcnt(10)
  v_mfma_f32_32x32x16_bf16 v[16:31], v[128:131], a[148:151], v[16:31]
  ds_read_b64_tr_b16 v[146:147], v215 offset:17408
  s_lshl_b32 s93, s93, 9
  s_add_u32 s92, s92, s93
  s_add_u32 s56, s92, 8192
  s_waitcnt lgkmcnt(9)
  v_mfma_f32_32x32x16_bf16 v[32:47], v[132:135], a[144:147], v[32:47]
  ds_read_b128 a[164:167], v212 offset:41984
  ds_read_b64_tr_b16 v[148:149], v216 offset:16384
  s_add_u32 s52, s14, 460800
  buffer_load_dwordx4 v217, s[24:27], s52 offen offset:0 lds
  v_mfma_f32_32x32x16_bf16 v[48:63], v[132:135], a[148:151], v[48:63]
  ds_read_b64_tr_b16 v[150:151], v216 offset:17408
  buffer_load_dwordx4 v218, s[24:27], s52 offen offset:1024 lds
  s_add_u32 m0, s51, 14336
  s_lshl_b32 s92, s48, 10
  v_add_u32 v204, s92, v212
  s_waitcnt lgkmcnt(9)
  v_mfma_f32_32x32x16_bf16 v[0:15], v[136:139], a[152:155], v[0:15]
  s_waitcnt vmcnt(16)
  ds_read_b128 a[168:171], v212 offset:43008
  ds_read_b64_tr_b16 v[152:153], v215 offset:18432
  v_mul_u32_u24 v206, 9216, v200
  s_waitcnt lgkmcnt(10)
  v_mfma_f32_32x32x16_bf16 v[16:31], v[136:139], a[156:159], v[16:31]
  ds_read_b64_tr_b16 v[154:155], v215 offset:19456
  s_add_u32 s92, s92, 1008
  v_add_u32 v206, s92, v206
  v_mov_b32 v219, 2130706432
  s_waitcnt lgkmcnt(9)
  v_mfma_f32_32x32x16_bf16 v[32:47], v[140:143], a[152:155], v[32:47]
  ds_read_b128 a[172:175], v212 offset:44032
  ds_read_b64_tr_b16 v[156:157], v216 offset:18432
  s_add_u32 s52, s14, 479232
  buffer_load_dwordx4 v217, s[24:27], s52 offen offset:0 lds
  v_mfma_f32_32x32x16_bf16 v[48:63], v[140:143], a[156:159], v[48:63]
  ds_read_b64_tr_b16 v[158:159], v216 offset:19456
  buffer_load_dwordx4 v218, s[24:27], s52 offen offset:1024 lds
  s_add_u32 m0, s51, 16384
  v_cmp_gt_u32 vcc, 8, v200
  s_nop 1
  v_cndmask_b32 v206, v219, v206, vcc
  s_waitcnt lgkmcnt(9)
  v_mfma_f32_32x32x16_bf16 v[0:15], v[144:147], a[160:163], v[0:15]
  s_waitcnt vmcnt(16)
  ds_read_b128 a[176:179], v212 offset:45056
  ds_read_b64_tr_b16 v[128:129], v215 offset:20480
  s_lshl_b32 s92, s48, 8
  s_waitcnt lgkmcnt(10)
  v_mfma_f32_32x32x16_bf16 v[16:31], v[144:147], a[164:167], v[16:31]
  ds_read_b64_tr_b16 v[130:131], v215 offset:21504
  s_add_u32 s92, s92, 8192
  v_add_u32 v205, s92, v212
  v_cmp_gt_u32 vcc, 16, v200
  s_waitcnt lgkmcnt(9)
  v_mfma_f32_32x32x16_bf16 v[32:47], v[148:151], a[160:163], v[32:47]
  ds_read_b128 a[180:183], v212 offset:46080
  ds_read_b64_tr_b16 v[132:133], v216 offset:20480
  s_add_u32 s52, s14, 497664
  buffer_load_dwordx4 v217, s[24:27], s52 offen offset:0 lds
  v_mfma_f32_32x32x16_bf16 v[48:63], v[148:151], a[164:167], v[48:63]
  ds_read_b64_tr_b16 v[134:135], v216 offset:21504
  buffer_load_dwordx4 v218, s[24:27], s52 offen offset:1024 lds
  s_add_u32 m0, s51, 18432
  v_cndmask_b32 v205, v219, v205, vcc
  s_movk_i32 s94, 4096
  s_waitcnt lgkmcnt(9)
  v_mfma_f32_32x32x16_bf16 v[0:15], v[152:155], a[168:171], v[0:15]
  s_waitcnt vmcnt(16)
  ds_read_b128 a[184:187], v212 offset:47104
  ds_read_b64_tr_b16 v[136:137], v215 offset:0
  s_mov_b32 s57, 0
  s_waitcnt lgkmcnt(10)
  v_mfma_f32_32x32x16_bf16 v[16:31], v[152:155], a[172:175], v[16:31]
  ds_read_b64_tr_b16 v[138:139], v215 offset:1024
  s_waitcnt lgkmcnt(9)
  v_mfma_f32_32x32x16_bf16 v[32:47], v[156:159], a[168:171], v[32:47]
  ds_read_b128 a[188:191], v212 offset:48128
  ds_read_b64_tr_b16 v[140:141], v216 offset:0
  s_add_u32 s52, s15, 0
  buffer_load_dwordx4 v217, s[24:27], s52 offen offset:0 lds
  v_mfma_f32_32x32x16_bf16 v[48:63], v[156:159], a[172:175], v[48:63]
  ds_read_b64_tr_b16 v[142:143], v216 offset:1024
  buffer_load_dwordx4 v218, s[24:27], s52 offen offset:1024 lds
  s_add_u32 m0, s51, 20480
  s_waitcnt lgkmcnt(9)
  v_mfma_f32_32x32x16_bf16 v[0:15], v[128:131], a[176:179], v[0:15]
  s_waitcnt vmcnt(16)
  ds_read_b128 a[192:195], v212 offset:49152
  ds_read_b64_tr_b16 v[144:145], v215 offset:2048
  s_waitcnt lgkmcnt(10)
  v_mfma_f32_32x32x16_bf16 v[16:31], v[128:131], a[180:183], v[16:31]
  ds_read_b64_tr_b16 v[146:147], v215 offset:3072
  s_waitcnt lgkmcnt(9)
  v_mfma_f32_32x32x16_bf16 v[32:47], v[132:135], a[176:179], v[32:47]
  ds_read_b128 a[196:199], v212 offset:50176
  ds_read_b64_tr_b16 v[148:149], v216 offset:2048
  s_add_u32 s52, s15, 18432
  buffer_load_dwordx4 v217, s[24:27], s52 offen offset:0 lds
  v_mfma_f32_32x32x16_bf16 v[48:63], v[132:135], a[180:183], v[48:63]
  ds_read_b64_tr_b16 v[150:151], v216 offset:3072
  buffer_load_dwordx4 v218, s[24:27], s52 offen offset:1024 lds
  s_add_u32 m0, s51, 0
  s_waitcnt lgkmcnt(9)
  v_mfma_f32_32x32x16_bf16 v[0:15], v[136:139], a[184:187], v[0:15]
  s_waitcnt vmcnt(16)
  ds_read_b128 a[200:203], v212 offset:51200
  ds_read_b64_tr_b16 v[152:153], v215 offset:4096
  s_waitcnt lgkmcnt(10)
  v_mfma_f32_32x32x16_bf16 v[16:31], v[136:139], a[188:191], v[16:31]
  ds_read_b64_tr_b16 v[154:155], v215 offset:5120
  s_waitcnt lgkmcnt(9)
  v_mfma_f32_32x32x16_bf16 v[32:47], v[140:143], a[184:187], v[32:47]
  ds_read_b128 a[204:207], v212 offset:52224
  ds_read_b64_tr_b16 v[156:157], v216 offset:4096
  s_add_u32 s52, s15, 36864
  buffer_load_dwordx4 v217, s[24:27], s52 offen offset:0 lds
  v_mfma_f32_32x32x16_bf16 v[48:63], v[140:143], a[188:191], v[48:63]
  ds_read_b64_tr_b16 v[158:159], v216 offset:5120
  buffer_load_dwordx4 v218, s[24:27], s52 offen offset:1024 lds
  s_add_u32 m0, s51, 2048
  s_waitcnt lgkmcnt(9)
  v_mfma_f32_32x32x16_bf16 v[0:15], v[144:147], a[192:195], v[0:15]
  s_waitcnt vmcnt(16)
  ds_read_b128 a[208:211], v212 offset:53248
  ds_read_b64_tr_b16 v[128:129], v215 offset:6144
  s_waitcnt lgkmcnt(10)
  v_mfma_f32_32x32x16_bf16 v[16:31], v[144:147], a[196:199], v[16:31]
  ds_read_b64_tr_b16 v[130:131], v215 offset:7168
  s_waitcnt lgkmcnt(9)
  v_mfma_f32_32x32x16_bf16 v[32:47], v[148:151], a[192:195], v[32:47]
  ds_read_b128 a[212:215], v212 offset:54272
  ds_read_b64_tr_b16 v[132:133], v216 offset:6144
  s_add_u32 s52, s15, 55296
  buffer_load_dwordx4 v217, s[24:27], s52 offen offset:0 lds
  v_mfma_f32_32x32x16_bf16 v[48:63], v[148:151], a[196:199], v[48:63]
  ds_read_b64_tr_b16 v[134:135], v216 offset:7168
  buffer_load_dwordx4 v218, s[24:27], s52 offen offset:1024 lds
  s_add_u32 m0, s51, 4096
  s_waitcnt lgkmcnt(9)
  v_mfma_f32_32x32x16_bf16 v[0:15], v[152:155], a[200:203], v[0:15]
  s_waitcnt vmcnt(16)
  ds_read_b128 a[216:219], v212 offset:55296
  ds_read_b64_tr_b16 v[136:137], v215 offset:8192
  s_waitcnt lgkmcnt(10)
  v_mfma_f32_32x32x16_bf16 v[16:31], v[152:155], a[204:207], v[16:31]
  ds_read_b64_tr_b16 v[138:139], v215 offset:9216
  s_waitcnt lgkmcnt(9)
  v_mfma_f32_32x32x16_bf16 v[32:47], v[156:159], a[200:203], v[32:47]
  ds_read_b128 a[220:223], v212 offset:56320
  ds_read_b64_tr_b16 v[140:141], v216 offset:8192
  s_add_u32 s52, s3, 128
  buffer_load_dwordx4 v217, s[24:27], s52 offen offset:0 lds
  v_mfma_f32_32x32x16_bf16 v[48:63], v[156:159], a[204:207], v[48:63]
  ds_read_b64_tr_b16 v[142:143], v216 offset:9216
  buffer_load_dwordx4 v218, s[24:27], s52 offen offset:1024 lds
  s_add_u32 m0, s51, 6144
  s_waitcnt lgkmcnt(9)
  v_mfma_f32_32x32x16_bf16 v[0:15], v[128:131], a[208:211], v[0:15]
  s_waitcnt vmcnt(16)
  ds_read_b128 a[224:227], v212 offset:57344
  ds_read_b64_tr_b16 v[144:145], v215 offset:10240
  s_waitcnt lgkmcnt(10)
  v_mfma_f32_32x32x16_bf16 v[16:31], v[128:131], a[212:215], v[16:31]
  ds_read_b64_tr_b16 v[146:147], v215 offset:11264
  s_waitcnt lgkmcnt(9)
  v_mfma_f32_32x32x16_bf16 v[32:47], v[132:135], a[208:211], v[32:47]
  ds_read_b128 a[228:231], v212 offset:58368
  ds_read_b64_tr_b16 v[148:149], v216 offset:10240
  s_add_u32 s52, s3, 18560
  buffer_load_dwordx4 v217, s[24:27], s52 offen offset:0 lds
  v_mfma_f32_32x32x16_bf16 v[48:63], v[132:135], a[212:215], v[48:63]
  ds_read_b64_tr_b16 v[150:151], v216 offset:11264
  buffer_load_dwordx4 v218, s[24:27], s52 offen offset:1024 lds
  s_add_u32 m0, s51, 8192
  s_waitcnt lgkmcnt(9)
  v_mfma_f32_32x32x16_bf16 v[0:15], v[136:139], a[216:219], v[0:15]
  s_waitcnt vmcnt(16)
  ds_read_b128 a[232:235], v212 offset:59392
  ds_read_b64_tr_b16 v[152:153], v215 offset:12288
  s_waitcnt lgkmcnt(10)
  v_mfma_f32_32x32x16_bf16 v[16:31], v[136:139], a[220:223], v[16:31]
  ds_read_b64_tr_b16 v[154:155], v215 offset:13312
  s_waitcnt lgkmcnt(9)
  v_mfma_f32_32x32x16_bf16 v[32:47], v[140:143], a[216:219], v[32:47]
  ds_read_b128 a[236:239], v212 offset:60416
  ds_read_b64_tr_b16 v[156:157], v216 offset:12288
  s_add_u32 s52, s3, 36992
  buffer_load_dwordx4 v217, s[24:27], s52 offen offset:0 lds
  v_mfma_f32_32x32x16_bf16 v[48:63], v[140:143], a[220:223], v[48:63]
  ds_read_b64_tr_b16 v[158:159], v216 offset:13312
  buffer_load_dwordx4 v218, s[24:27], s52 offen offset:1024 lds
  s_add_u32 m0, s51, 10240
  s_waitcnt lgkmcnt(9)
  v_mfma_f32_32x32x16_bf16 v[0:15], v[144:147], a[224:227], v[0:15]
  s_waitcnt vmcnt(16)
  ds_read_b128 a[240:243], v212 offset:61440
  ds_read_b64_tr_b16 v[128:129], v215 offset:14336
  s_waitcnt lgkmcnt(10)
  v_mfma_f32_32x32x16_bf16 v[16:31], v[144:147], a[228:231], v[16:31]
  ds_read_b64_tr_b16 v[130:131], v215 offset:15360
  s_waitcnt lgkmcnt(9)
  v_mfma_f32_32x32x16_bf16 v[32:47], v[148:151], a[224:227], v[32:47]
  ds_read_b128 a[244:247], v212 offset:62464
  ds_read_b64_tr_b16 v[132:133], v216 offset:14336
  s_add_u32 s52, s3, 55424
  buffer_load_dwordx4 v217, s[24:27], s52 offen offset:0 lds
  v_mfma_f32_32x32x16_bf16 v[48:63], v[148:151], a[228:231], v[48:63]
  ds_read_b64_tr_b16 v[134:135], v216 offset:15360
  buffer_load_dwordx4 v218, s[24:27], s52 offen offset:1024 lds
  s_add_u32 m0, s51, 12288
  s_waitcnt lgkmcnt(9)
  v_mfma_f32_32x32x16_bf16 v[0:15], v[152:155], a[232:235], v[0:15]
  s_waitcnt vmcnt(16)
  ds_read_b128 a[248:251], v212 offset:63488
  ds_read_b64_tr_b16 v[136:137], v215 offset:16384
  s_waitcnt lgkmcnt(10)
  v_mfma_f32_32x32x16_bf16 v[16:31], v[152:155], a[236:239], v[16:31]
  ds_read_b64_tr_b16 v[138:139], v215 offset:17408
  s_waitcnt lgkmcnt(9)
  v_mfma_f32_32x32x16_bf16 v[32:47], v[156:159], a[232:235], v[32:47]
  ds_read_b128 a[252:255], v212 offset:64512
  ds_read_b64_tr_b16 v[140:141], v216 offset:16384
  s_add_u32 s52, s3, 147584
  buffer_load_dwordx4 v217, s[24:27], s52 offen offset:0 lds
  v_mfma_f32_32x32x16_bf16 v[48:63], v[156:159], a[236:239], v[48:63]
  ds_read_b64_tr_b16 v[142:143], v216 offset:17408
  buffer_load_dwordx4 v218, s[24:27], s52 offen offset:1024 lds
  s_add_u32 m0, s51, 14336
  s_waitcnt lgkmcnt(9)
  v_mfma_f32_32x32x16_bf16 v[0:15], v[128:131], a[240:243], v[0:15]
  s_waitcnt vmcnt(16)
  ds_read_b128 v[224:227], v213 offset:0
  ds_read_b64_tr_b16 v[144:145], v215 offset:18432
  s_waitcnt lgkmcnt(10)
  v_mfma_f32_32x32x16_bf16 v[16:31], v[128:131], a[244:247], v[16:31]
  ds_read_b64_tr_b16 v[146:147], v215 offset:19456
  s_waitcnt lgkmcnt(9)
  v_mfma_f32_32x32x16_bf16 v[32:47], v[132:135], a[240:243], v[32:47]
  ds_read_b128 v[228:231], v213 offset:1024
  ds_read_b64_tr_b16 v[148:149], v216 offset:18432
  s_add_u32 s52, s3, 166016
  buffer_load_dwordx4 v217, s[24:27], s52 offen offset:0 lds
  v_mfma_f32_32x32x16_bf16 v[48:63], v[132:135], a[244:247], v[48:63]
  ds_read_b64_tr_b16 v[150:151], v216 offset:19456
  buffer_load_dwordx4 v218, s[24:27], s52 offen offset:1024 lds
  s_add_u32 m0, s51, 16384
  s_waitcnt lgkmcnt(9)
  v_mfma_f32_32x32x16_bf16 v[0:15], v[136:139], a[248:251], v[0:15]
  s_waitcnt vmcnt(16)
  ds_read_b128 v[232:235], v213 offset:2048
  ds_read_b64_tr_b16 v[152:153], v215 offset:20480
  s_waitcnt lgkmcnt(10)
  v_mfma_f32_32x32x16_bf16 v[16:31], v[136:139], a[252:255], v[16:31]
  ds_read_b64_tr_b16 v[154:155], v215 offset:21504
  s_waitcnt lgkmcnt(9)
  v_mfma_f32_32x32x16_bf16 v[32:47], v[140:143], a[248:251], v[32:47]
  ds_read_b128 v[236:239], v213 offset:3072
  ds_read_b64_tr_b16 v[156:157], v216 offset:20480
  s_add_u32 s52, s3, 184448
  buffer_load_dwordx4 v217, s[24:27], s52 offen offset:0 lds
  v_mfma_f32_32x32x16_bf16 v[48:63], v[140:143], a[252:255], v[48:63]
  ds_read_b64_tr_b16 v[158:159], v216 offset:21504
  buffer_load_dwordx4 v218, s[24:27], s52 offen offset:1024 lds
  s_add_u32 m0, s51, 18432
  s_waitcnt lgkmcnt(9)
  v_mfma_f32_32x32x16_bf16 v[0:15], v[144:147], v[224:227], v[0:15]
  s_waitcnt vmcnt(16)
  ds_read_b128 v[240:243], v213 offset:4096
  ds_read_b64_tr_b16 v[128:129], v215 offset:0
  s_waitcnt lgkmcnt(10)
  v_mfma_f32_32x32x16_bf16 v[16:31], v[144:147], v[228:231], v[16:31]
  ds_read_b64_tr_b16 v[130:131], v215 offset:1024
  s_waitcnt lgkmcnt(9)
  v_mfma_f32_32x32x16_bf16 v[32:47], v[148:151], v[224:227], v[32:47]
  ds_read_b128 v[244:247], v213 offset:5120
  ds_read_b64_tr_b16 v[132:133], v216 offset:0
  s_add_u32 s52, s3, 202880
  buffer_load_dwordx4 v217, s[24:27], s52 offen offset:0 lds
  v_mfma_f32_32x32x16_bf16 v[48:63], v[148:151], v[228:231], v[48:63]
  ds_read_b64_tr_b16 v[134:135], v216 offset:1024
  buffer_load_dwordx4 v218, s[24:27], s52 offen offset:1024 lds
  s_add_u32 m0, s51, 20480
  s_waitcnt lgkmcnt(9)
  v_mfma_f32_32x32x16_bf16 v[0:15], v[152:155], v[232:235], v[0:15]
  s_waitcnt vmcnt(16)
  ds_read_b128 v[248:251], v213 offset:6144
  ds_read_b64_tr_b16 v[136:137], v215 offset:2048
  s_waitcnt lgkmcnt(10)
  v_mfma_f32_32x32x16_bf16 v[16:31], v[152:155], v[236:239], v[16:31]
  ds_read_b64_tr_b16 v[138:139], v215 offset:3072
  s_waitcnt lgkmcnt(9)
  v_mfma_f32_32x32x16_bf16 v[32:47], v[156:159], v[232:235], v[32:47]
  ds_read_b128 v[252:255], v213 offset:7168
  ds_read_b64_tr_b16 v[140:141], v216 offset:2048
  s_add_u32 s52, s3, 295040
  buffer_load_dwordx4 v217, s[24:27], s52 offen offset:0 lds
  v_mfma_f32_32x32x16_bf16 v[48:63], v[156:159], v[236:239], v[48:63]
  ds_read_b64_tr_b16 v[142:143], v216 offset:3072
  buffer_load_dwordx4 v218, s[24:27], s52 offen offset:1024 lds
  s_add_u32 m0, s51, 0
  s_waitcnt lgkmcnt(9)
  v_mfma_f32_32x32x16_bf16 v[0:15], v[128:131], v[240:243], v[0:15]
  s_waitcnt vmcnt(16)
  ds_read_b64_tr_b16 v[144:145], v215 offset:4096
  s_waitcnt lgkmcnt(9)
  v_mfma_f32_32x32x16_bf16 v[16:31], v[128:131], v[244:247], v[16:31]
  ds_read_b64_tr_b16 v[146:147], v215 offset:5120
  s_waitcnt lgkmcnt(8)
  v_mfma_f32_32x32x16_bf16 v[32:47], v[132:135], v[240:243], v[32:47]
  ds_read_b64_tr_b16 v[148:149], v216 offset:4096
  s_add_u32 s52, s3, 313472
  buffer_load_dwordx4 v217, s[24:27], s52 offen offset:0 lds
  v_mfma_f32_32x32x16_bf16 v[48:63], v[132:135], v[244:247], v[48:63]
  ds_read_b64_tr_b16 v[150:151], v216 offset:5120
  buffer_load_dwordx4 v218, s[24:27], s52 offen offset:1024 lds
  s_add_u32 m0, s51, 2048
  s_waitcnt lgkmcnt(7)
  v_mfma_f32_32x32x16_bf16 v[0:15], v[136:139], v[248:251], v[0:15]
  s_waitcnt vmcnt(16)
  ds_read_b64_tr_b16 v[152:153], v215 offset:6144
  s_waitcnt lgkmcnt(7)
  v_mfma_f32_32x32x16_bf16 v[16:31], v[136:139], v[252:255], v[16:31]
  ds_read_b64_tr_b16 v[154:155], v215 offset:7168
  s_waitcnt lgkmcnt(6)
  v_mfma_f32_32x32x16_bf16 v[32:47], v[140:143], v[248:251], v[32:47]
  ds_read_b64_tr_b16 v[156:157], v216 offset:6144
  s_add_u32 s52, s3, 331904
  buffer_load_dwordx4 v217, s[24:27], s52 offen offset:0 lds
  v_mfma_f32_32x32x16_bf16 v[48:63], v[140:143], v[252:255], v[48:63]
  ds_read_b64_tr_b16 v[158:159], v216 offset:7168
  buffer_load_dwordx4 v218, s[24:27], s52 offen offset:1024 lds
  s_add_u32 m0, s51, 4096
  s_waitcnt lgkmcnt(6)
  v_mfma_f32_32x32x16_bf16 v[64:79], v[144:147], a[0:3], 0
  s_waitcnt vmcnt(16)
  ds_read_b64_tr_b16 v[128:129], v215 offset:8192
  v_mfma_f32_32x32x16_bf16 v[80:95], v[144:147], a[4:7], 0
  ds_read_b64_tr_b16 v[130:131], v215 offset:9216
  s_waitcnt lgkmcnt(6)
  v_mfma_f32_32x32x16_bf16 v[96:111], v[148:151], a[0:3], 0
  ds_read_b64_tr_b16 v[132:133], v216 offset:8192
  s_add_u32 s52, s3, 350336
  buffer_load_dwordx4 v217, s[24:27], s52 offen offset:0 lds
  v_mfma_f32_32x32x16_bf16 v[112:127], v[148:151], a[4:7], 0
  ds_read_b64_tr_b16 v[134:135], v216 offset:9216
  buffer_load_dwordx4 v218, s[24:27], s52 offen offset:1024 lds
  s_add_u32 m0, s51, 6144
  v_cvt_pk_bf16_f32 v160, v0, v1
  v_cvt_pk_bf16_f32 v161, v2, v3
  s_waitcnt lgkmcnt(6)
  v_mfma_f32_32x32x16_bf16 v[64:79], v[152:155], a[8:11], v[64:79]
  s_waitcnt vmcnt(16)
  ds_read_b64_tr_b16 v[136:137], v215 offset:10240
  v_and_b32 v160, 0xfffffffe, v160
  v_cvt_pk_bf16_f32 v162, v4, v5
  v_mfma_f32_32x32x16_bf16 v[80:95], v[152:155], a[12:15], v[80:95]
  ds_read_b64_tr_b16 v[138:139], v215 offset:11264
  v_cvt_pk_bf16_f32 v163, v6, v7
  v_cvt_pk_bf16_f32 v164, v8, v9
  v_cvt_pk_bf16_f32 v165, v10, v11
  s_waitcnt lgkmcnt(6)
  v_mfma_f32_32x32x16_bf16 v[96:111], v[156:159], a[8:11], v[96:111]
  ds_read_b64_tr_b16 v[140:141], v216 offset:10240
  s_add_u32 s52, s3, 442496
  buffer_load_dwordx4 v217, s[24:27], s52 offen offset:0 lds
  v_mfma_f32_32x32x16_bf16 v[112:127], v[156:159], a[12:15], v[112:127]
  ds_read_b64_tr_b16 v[142:143], v216 offset:11264
  buffer_load_dwordx4 v218, s[24:27], s52 offen offset:1024 lds
  s_add_u32 m0, s51, 8192
  v_and_b32 v164, 0xfffffffe, v164
  v_cvt_pk_bf16_f32 v166, v12, v13
  s_waitcnt lgkmcnt(6)
  v_mfma_f32_32x32x16_bf16 v[64:79], v[128:131], a[16:19], v[64:79]
  s_waitcnt vmcnt(16)
  ds_read_b64_tr_b16 v[144:145], v215 offset:12288
  v_cvt_pk_bf16_f32 v167, v14, v15
  buffer_store_dwordx4 v[160:163], v201, s[32:35], s54 offen offset:0 sc1
  v_mfma_f32_32x32x16_bf16 v[80:95], v[128:131], a[20:23], v[80:95]
  ds_read_b64_tr_b16 v[146:147], v215 offset:13312
  buffer_store_dwordx4 v[164:167], v201, s[32:35], s54 offen offset:256 sc1
  v_cvt_pk_bf16_f32 v168, v16, v17
  v_cvt_pk_bf16_f32 v169, v18, v19
  s_waitcnt lgkmcnt(6)
  v_mfma_f32_32x32x16_bf16 v[96:111], v[132:135], a[16:19], v[96:111]
  ds_read_b64_tr_b16 v[148:149], v216 offset:12288
  s_add_u32 s52, s3, 460928
  buffer_load_dwordx4 v217, s[24:27], s52 offen offset:0 lds
  v_mfma_f32_32x32x16_bf16 v[112:127], v[132:135], a[20:23], v[112:127]
  ds_read_b64_tr_b16 v[150:151], v216 offset:13312
  buffer_load_dwordx4 v218, s[24:27], s52 offen offset:1024 lds
  s_add_u32 m0, s51, 10240
  v_and_b32 v168, 0xfffffffe, v168
  v_cvt_pk_bf16_f32 v170, v20, v21
  s_waitcnt lgkmcnt(6)
  v_mfma_f32_32x32x16_bf16 v[64:79], v[136:139], a[24:27], v[64:79]
  s_waitcnt vmcnt(18)
  ds_read_b64_tr_b16 v[152:153], v215 offset:14336
  v_cvt_pk_bf16_f32 v171, v22, v23
  v_cvt_pk_bf16_f32 v172, v24, v25
  v_mfma_f32_32x32x16_bf16 v[80:95], v[136:139], a[28:31], v[80:95]
  ds_read_b64_tr_b16 v[154:155], v215 offset:15360
  v_cvt_pk_bf16_f32 v173, v26, v27
  v_and_b32 v172, 0xfffffffe, v172
  v_cvt_pk_bf16_f32 v174, v28, v29
  s_waitcnt lgkmcnt(6)
  v_mfma_f32_32x32x16_bf16 v[96:111], v[140:143], a[24:27], v[96:111]
  ds_read_b64_tr_b16 v[156:157], v216 offset:14336
  s_add_u32 s52, s3, 479360
  buffer_load_dwordx4 v217, s[24:27], s52 offen offset:0 lds
  v_mfma_f32_32x32x16_bf16 v[112:127], v[140:143], a[28:31], v[112:127]
  ds_read_b64_tr_b16 v[158:159], v216 offset:15360
  buffer_load_dwordx4 v218, s[24:27], s52 offen offset:1024 lds
  s_add_u32 m0, s51, 12288
  v_cvt_pk_bf16_f32 v175, v30, v31
  buffer_store_dwordx4 v[168:171], v201, s[32:35], s55 offen offset:0 sc1
  s_waitcnt lgkmcnt(6)
  v_mfma_f32_32x32x16_bf16 v[64:79], v[144:147], a[32:35], v[64:79]
  s_waitcnt vmcnt(19)
  ds_read_b64_tr_b16 v[128:129], v215 offset:16384
  buffer_store_dwordx4 v[172:175], v201, s[32:35], s55 offen offset:256 sc1
  v_cvt_pk_bf16_f32 v176, v32, v33
  v_mfma_f32_32x32x16_bf16 v[80:95], v[144:147], a[36:39], v[80:95]
  ds_read_b64_tr_b16 v[130:131], v215 offset:17408
  v_cvt_pk_bf16_f32 v177, v34, v35
  v_and_b32 v176, 0xfffffffe, v176
  v_cvt_pk_bf16_f32 v178, v36, v37
  s_waitcnt lgkmcnt(6)
  v_mfma_f32_32x32x16_bf16 v[96:111], v[148:151], a[32:35], v[96:111]
  ds_read_b64_tr_b16 v[132:133], v216 offset:16384
  s_add_u32 s52, s3, 497792
  buffer_load_dwordx4 v217, s[24:27], s52 offen offset:0 lds
  v_mfma_f32_32x32x16_bf16 v[112:127], v[148:151], a[36:39], v[112:127]
  ds_read_b64_tr_b16 v[134:135], v216 offset:17408
  buffer_load_dwordx4 v218, s[24:27], s52 offen offset:1024 lds
  s_add_u32 m0, s51, 14336
  v_cvt_pk_bf16_f32 v179, v38, v39
  v_cvt_pk_bf16_f32 v180, v40, v41
  s_waitcnt lgkmcnt(6)
  v_mfma_f32_32x32x16_bf16 v[64:79], v[152:155], a[40:43], v[64:79]
  s_waitcnt vmcnt(20)
  ds_read_b64_tr_b16 v[136:137], v215 offset:18432
  v_cvt_pk_bf16_f32 v181, v42, v43
  v_and_b32 v180, 0xfffffffe, v180
  v_mfma_f32_32x32x16_bf16 v[80:95], v[152:155], a[44:47], v[80:95]
  ds_read_b64_tr_b16 v[138:139], v215 offset:19456
  v_cvt_pk_bf16_f32 v182, v44, v45
  v_cvt_pk_bf16_f32 v183, v46, v47
  buffer_store_dwordx4 v[176:179], v201, s[32:35], s54 offen offset:512 sc1
  s_waitcnt lgkmcnt(6)
  v_mfma_f32_32x32x16_bf16 v[96:111], v[156:159], a[40:43], v[96:111]
  ds_read_b64_tr_b16 v[140:141], v216 offset:18432
  s_add_u32 s52, s14, 128
  buffer_load_dwordx4 v217, s[24:27], s52 offen offset:0 lds
  v_mfma_f32_32x32x16_bf16 v[112:127], v[156:159], a[44:47], v[112:127]
  ds_read_b64_tr_b16 v[142:143], v216 offset:19456
  buffer_load_dwordx4 v218, s[24:27], s52 offen offset:1024 lds
  s_add_u32 m0, s51, 16384
  buffer_store_dwordx4 v[180:183], v201, s[32:35], s54 offen offset:768 sc1
  v_cvt_pk_bf16_f32 v184, v48, v49
  s_waitcnt lgkmcnt(6)
  v_mfma_f32_32x32x16_bf16 v[64:79], v[128:131], a[48:51], v[64:79]
  s_waitcnt vmcnt(22)
  ds_read_b64_tr_b16 v[144:145], v215 offset:20480
  v_cvt_pk_bf16_f32 v185, v50, v51
  v_and_b32 v184, 0xfffffffe, v184
  v_mfma_f32_32x32x16_bf16 v[80:95], v[128:131], a[52:55], v[80:95]
  ds_read_b64_tr_b16 v[146:147], v215 offset:21504
  v_cvt_pk_bf16_f32 v186, v52, v53
  v_cvt_pk_bf16_f32 v187, v54, v55
  v_cvt_pk_bf16_f32 v188, v56, v57
  s_waitcnt lgkmcnt(6)
  v_mfma_f32_32x32x16_bf16 v[96:111], v[132:135], a[48:51], v[96:111]
  ds_read_b64_tr_b16 v[148:149], v216 offset:20480
  s_add_u32 s52, s14, 18560
  buffer_load_dwordx4 v217, s[24:27], s52 offen offset:0 lds
  v_mfma_f32_32x32x16_bf16 v[112:127], v[132:135], a[52:55], v[112:127]
  ds_read_b64_tr_b16 v[150:151], v216 offset:21504
  buffer_load_dwordx4 v218, s[24:27], s52 offen offset:1024 lds
  s_add_u32 m0, s51, 18432
  v_cvt_pk_bf16_f32 v189, v58, v59
  v_and_b32 v188, 0xfffffffe, v188
  s_waitcnt lgkmcnt(6)
  v_mfma_f32_32x32x16_bf16 v[64:79], v[136:139], a[56:59], v[64:79]
  s_waitcnt vmcnt(22)
  ds_read_b64_tr_b16 v[152:153], v215 offset:0
  v_cvt_pk_bf16_f32 v190, v60, v61
  v_cvt_pk_bf16_f32 v191, v62, v63
  v_mfma_f32_32x32x16_bf16 v[80:95], v[136:139], a[60:63], v[80:95]
  ds_read_b64_tr_b16 v[154:155], v215 offset:1024
  buffer_store_dwordx4 v[184:187], v201, s[32:35], s55 offen offset:512 sc1
  buffer_store_dwordx4 v[188:191], v201, s[32:35], s55 offen offset:768 sc1
  s_add_u32 s54, s54, 4096
  s_waitcnt lgkmcnt(6)
  v_mfma_f32_32x32x16_bf16 v[96:111], v[140:143], a[56:59], v[96:111]
  ds_read_b64_tr_b16 v[156:157], v216 offset:0
  s_add_u32 s52, s14, 36992
  buffer_load_dwordx4 v217, s[24:27], s52 offen offset:0 lds
  v_mfma_f32_32x32x16_bf16 v[112:127], v[140:143], a[60:63], v[112:127]
  ds_read_b64_tr_b16 v[158:159], v216 offset:1024
  buffer_load_dwordx4 v218, s[24:27], s52 offen offset:1024 lds
  s_add_u32 m0, s51, 20480
  s_add_u32 s55, s55, 4096
  s_waitcnt lgkmcnt(6)
  v_mfma_f32_32x32x16_bf16 v[64:79], v[144:147], a[64:67], v[64:79]
  s_waitcnt vmcnt(24)
  ds_read_b64_tr_b16 v[128:129], v215 offset:2048
  v_mfma_f32_32x32x16_bf16 v[80:95], v[144:147], a[68:71], v[80:95]
  ds_read_b64_tr_b16 v[130:131], v215 offset:3072
  s_waitcnt lgkmcnt(6)
  v_mfma_f32_32x32x16_bf16 v[96:111], v[148:151], a[64:67], v[96:111]
  ds_read_b64_tr_b16 v[132:133], v216 offset:2048
  s_add_u32 s52, s14, 55424
  buffer_load_dwordx4 v217, s[24:27], s52 offen offset:0 lds
  v_mfma_f32_32x32x16_bf16 v[112:127], v[148:151], a[68:71], v[112:127]
  ds_read_b64_tr_b16 v[134:135], v216 offset:3072
  buffer_load_dwordx4 v218, s[24:27], s52 offen offset:1024 lds
  s_add_u32 m0, s51, 0
  s_waitcnt lgkmcnt(6)
  v_mfma_f32_32x32x16_bf16 v[64:79], v[152:155], a[72:75], v[64:79]
  s_waitcnt vmcnt(24)
  ds_read_b64_tr_b16 v[136:137], v215 offset:4096
  v_mfma_f32_32x32x16_bf16 v[80:95], v[152:155], a[76:79], v[80:95]
  ds_read_b64_tr_b16 v[138:139], v215 offset:5120
  s_waitcnt lgkmcnt(6)
  v_mfma_f32_32x32x16_bf16 v[96:111], v[156:159], a[72:75], v[96:111]
  ds_read_b64_tr_b16 v[140:141], v216 offset:4096
  s_add_u32 s52, s14, 147584
  buffer_load_dwordx4 v217, s[24:27], s52 offen offset:0 lds
  v_mfma_f32_32x32x16_bf16 v[112:127], v[156:159], a[76:79], v[112:127]
  ds_read_b64_tr_b16 v[142:143], v216 offset:5120
  buffer_load_dwordx4 v218, s[24:27], s52 offen offset:1024 lds
  s_add_u32 m0, s51, 2048
  s_waitcnt lgkmcnt(6)
  v_mfma_f32_32x32x16_bf16 v[64:79], v[128:131], a[80:83], v[64:79]
  s_waitcnt vmcnt(24)
  ds_read_b128 a[0:3], v214 offset:0
  ds_read_b64_tr_b16 v[144:145], v215 offset:6144
  v_mfma_f32_32x32x16_bf16 v[80:95], v[128:131], a[84:87], v[80:95]
  ds_read_b64_tr_b16 v[146:147], v215 offset:7168
  s_waitcnt lgkmcnt(7)
  v_mfma_f32_32x32x16_bf16 v[96:111], v[132:135], a[80:83], v[96:111]
  ds_read_b128 a[4:7], v214 offset:1024
  ds_read_b64_tr_b16 v[148:149], v216 offset:6144
  s_add_u32 s52, s14, 166016
  buffer_load_dwordx4 v217, s[24:27], s52 offen offset:0 lds
  v_mfma_f32_32x32x16_bf16 v[112:127], v[132:135], a[84:87], v[112:127]
  ds_read_b64_tr_b16 v[150:151], v216 offset:7168
  buffer_load_dwordx4 v218, s[24:27], s52 offen offset:1024 lds
  s_add_u32 m0, s51, 4096
  s_waitcnt lgkmcnt(8)
  v_mfma_f32_32x32x16_bf16 v[64:79], v[136:139], a[88:91], v[64:79]
  s_waitcnt vmcnt(22)
  ds_read_b128 a[8:11], v214 offset:2048
  ds_read_b64_tr_b16 v[152:153], v215 offset:8192
  v_mfma_f32_32x32x16_bf16 v[80:95], v[136:139], a[92:95], v[80:95]
  ds_read_b64_tr_b16 v[154:155], v215 offset:9216
  s_waitcnt lgkmcnt(9)
  v_mfma_f32_32x32x16_bf16 v[96:111], v[140:143], a[88:91], v[96:111]
  ds_read_b128 a[12:15], v214 offset:3072
  ds_read_b64_tr_b16 v[156:157], v216 offset:8192
  s_add_u32 s52, s14, 184448
  buffer_load_dwordx4 v217, s[24:27], s52 offen offset:0 lds
  v_mfma_f32_32x32x16_bf16 v[112:127], v[140:143], a[92:95], v[112:127]
  ds_read_b64_tr_b16 v[158:159], v216 offset:9216
  buffer_load_dwordx4 v218, s[24:27], s52 offen offset:1024 lds
  s_add_u32 m0, s51, 6144
  s_waitcnt lgkmcnt(9)
  v_mfma_f32_32x32x16_bf16 v[64:79], v[144:147], a[96:99], v[64:79]
  s_waitcnt vmcnt(22)
  ds_read_b128 a[16:19], v214 offset:4096
  ds_read_b64_tr_b16 v[128:129], v215 offset:10240
  v_mfma_f32_32x32x16_bf16 v[80:95], v[144:147], a[100:103], v[80:95]
  ds_read_b64_tr_b16 v[130:131], v215 offset:11264
  s_waitcnt lgkmcnt(9)
  v_mfma_f32_32x32x16_bf16 v[96:111], v[148:151], a[96:99], v[96:111]
  ds_read_b128 a[20:23], v214 offset:5120
  ds_read_b64_tr_b16 v[132:133], v216 offset:10240
  s_add_u32 s52, s14, 202880
  buffer_load_dwordx4 v217, s[24:27], s52 offen offset:0 lds
  v_mfma_f32_32x32x16_bf16 v[112:127], v[148:151], a[100:103], v[112:127]
  ds_read_b64_tr_b16 v[134:135], v216 offset:11264
  buffer_load_dwordx4 v218, s[24:27], s52 offen offset:1024 lds
  s_add_u32 m0, s51, 8192
  s_waitcnt lgkmcnt(9)
  v_mfma_f32_32x32x16_bf16 v[64:79], v[152:155], a[104:107], v[64:79]
  s_waitcnt vmcnt(20)
  ds_read_b128 a[24:27], v214 offset:6144
  ds_read_b64_tr_b16 v[136:137], v215 offset:12288
  v_mfma_f32_32x32x16_bf16 v[80:95], v[152:155], a[108:111], v[80:95]
  ds_read_b64_tr_b16 v[138:139], v215 offset:13312
  s_waitcnt lgkmcnt(9)
  v_mfma_f32_32x32x16_bf16 v[96:111], v[156:159], a[104:107], v[96:111]
  ds_read_b128 a[28:31], v214 offset:7168
  ds_read_b64_tr_b16 v[140:141], v216 offset:12288
  s_add_u32 s52, s14, 295040
  buffer_load_dwordx4 v217, s[24:27], s52 offen offset:0 lds
  v_mfma_f32_32x32x16_bf16 v[112:127], v[156:159], a[108:111], v[112:127]
  ds_read_b64_tr_b16 v[142:143], v216 offset:13312
  buffer_load_dwordx4 v218, s[24:27], s52 offen offset:1024 lds
  s_add_u32 m0, s51, 10240
  s_waitcnt lgkmcnt(9)
  v_mfma_f32_32x32x16_bf16 v[64:79], v[128:131], a[112:115], v[64:79]
  s_waitcnt vmcnt(19)
  ds_read_b128 a[32:35], v214 offset:32768
  ds_read_b64_tr_b16 v[144:145], v215 offset:14336
  v_mfma_f32_32x32x16_bf16 v[80:95], v[128:131], a[116:119], v[80:95]
  ds_read_b64_tr_b16 v[146:147], v215 offset:15360
  s_waitcnt lgkmcnt(9)
  v_mfma_f32_32x32x16_bf16 v[96:111], v[132:135], a[112:115], v[96:111]
  ds_read_b128 a[36:39], v214 offset:33792
  ds_read_b64_tr_b16 v[148:149], v216 offset:14336
  s_add_u32 s52, s14, 313472
  buffer_load_dwordx4 v217, s[24:27], s52 offen offset:0 lds
  v_mfma_f32_32x32x16_bf16 v[112:127], v[132:135], a[116:119], v[112:127]
  ds_read_b64_tr_b16 v[150:151], v216 offset:15360
  buffer_load_dwordx4 v218, s[24:27], s52 offen offset:1024 lds
  s_add_u32 m0, s51, 12288
  s_waitcnt lgkmcnt(9)
  v_mfma_f32_32x32x16_bf16 v[64:79], v[136:139], a[120:123], v[64:79]
  s_waitcnt vmcnt(18)
  ds_read_b128 a[40:43], v214 offset:34816
  ds_read_b64_tr_b16 v[152:153], v215 offset:16384
  v_mfma_f32_32x32x16_bf16 v[80:95], v[136:139], a[124:127], v[80:95]
  ds_read_b64_tr_b16 v[154:155], v215 offset:17408
  s_waitcnt lgkmcnt(9)
  v_mfma_f32_32x32x16_bf16 v[96:111], v[140:143], a[120:123], v[96:111]
  ds_read_b128 a[44:47], v214 offset:35840
  ds_read_b64_tr_b16 v[156:157], v216 offset:16384
  s_add_u32 s52, s14, 331904
  buffer_load_dwordx4 v217, s[24:27], s52 offen offset:0 lds
  v_mfma_f32_32x32x16_bf16 v[112:127], v[140:143], a[124:127], v[112:127]
  ds_read_b64_tr_b16 v[158:159], v216 offset:17408
  buffer_load_dwordx4 v218, s[24:27], s52 offen offset:1024 lds
  s_add_u32 m0, s51, 14336
  s_waitcnt lgkmcnt(9)
  v_mfma_f32_32x32x16_bf16 v[64:79], v[144:147], a[128:131], v[64:79]
  s_waitcnt vmcnt(16)
  ds_read_b128 a[48:51], v214 offset:36864
  ds_read_b64_tr_b16 v[128:129], v215 offset:18432
  v_mfma_f32_32x32x16_bf16 v[80:95], v[144:147], a[132:135], v[80:95]
  ds_read_b64_tr_b16 v[130:131], v215 offset:19456
  s_waitcnt lgkmcnt(9)
  v_mfma_f32_32x32x16_bf16 v[96:111], v[148:151], a[128:131], v[96:111]
  ds_read_b128 a[52:55], v214 offset:37888
  ds_read_b64_tr_b16 v[132:133], v216 offset:18432
  s_add_u32 s52, s14, 350336
  buffer_load_dwordx4 v217, s[24:27], s52 offen offset:0 lds
  v_mfma_f32_32x32x16_bf16 v[112:127], v[148:151], a[132:135], v[112:127]
  ds_read_b64_tr_b16 v[134:135], v216 offset:19456
  buffer_load_dwordx4 v218, s[24:27], s52 offen offset:1024 lds
  s_add_u32 m0, s51, 16384
  s_waitcnt lgkmcnt(9)
  v_mfma_f32_32x32x16_bf16 v[64:79], v[152:155], a[136:139], v[64:79]
  s_waitcnt vmcnt(16)
  ds_read_b128 a[56:59], v214 offset:38912
  ds_read_b64_tr_b16 v[136:137], v215 offset:20480
  v_mfma_f32_32x32x16_bf16 v[80:95], v[152:155], a[140:143], v[80:95]
  ds_read_b64_tr_b16 v[138:139], v215 offset:21504
  s_waitcnt lgkmcnt(9)
  v_mfma_f32_32x32x16_bf16 v[96:111], v[156:159], a[136:139], v[96:111]
  ds_read_b128 a[60:63], v214 offset:39936
  ds_read_b64_tr_b16 v[140:141], v216 offset:20480
  s_add_u32 s52, s14, 442496
  buffer_load_dwordx4 v217, s[24:27], s52 offen offset:0 lds
  v_mfma_f32_32x32x16_bf16 v[112:127], v[156:159], a[140:143], v[112:127]
  ds_read_b64_tr_b16 v[142:143], v216 offset:21504
  buffer_load_dwordx4 v218, s[24:27], s52 offen offset:1024 lds
  s_add_u32 m0, s51, 18432
  s_waitcnt lgkmcnt(9)
  v_mfma_f32_32x32x16_bf16 v[64:79], v[128:131], a[144:147], v[64:79]
  s_waitcnt vmcnt(16)
  ds_read_b128 a[64:67], v223 offset:0
  ds_read_b64_tr_b16 v[144:145], v215 offset:0
  v_mfma_f32_32x32x16_bf16 v[80:95], v[128:131], a[148:151], v[80:95]
  ds_read_b64_tr_b16 v[146:147], v215 offset:1024
  s_waitcnt lgkmcnt(9)
  v_mfma_f32_32x32x16_bf16 v[96:111], v[132:135], a[144:147], v[96:111]
  ds_read_b128 a[68:71], v223 offset:1024
  ds_read_b64_tr_b16 v[148:149], v216 offset:0
  s_add_u32 s52, s14, 460928
  buffer_load_dwordx4 v217, s[24:27], s52 offen offset:0 lds
  v_mfma_f32_32x32x16_bf16 v[112:127], v[132:135], a[148:151], v[112:127]
  ds_read_b64_tr_b16 v[150:151], v216 offset:1024
  buffer_load_dwordx4 v218, s[24:27], s52 offen offset:1024 lds
  s_add_u32 m0, s51, 20480
  s_waitcnt lgkmcnt(9)
  v_mfma_f32_32x32x16_bf16 v[64:79], v[136:139], a[152:155], v[64:79]
  s_waitcnt vmcnt(16)
  ds_read_b64_tr_b16 v[152:153], v215 offset:2048
  v_mfma_f32_32x32x16_bf16 v[80:95], v[136:139], a[156:159], v[80:95]
  ds_read_b64_tr_b16 v[154:155], v215 offset:3072
  s_waitcnt lgkmcnt(8)
  v_mfma_f32_32x32x16_bf16 v[96:111], v[140:143], a[152:155], v[96:111]
  ds_read_b64_tr_b16 v[156:157], v216 offset:2048
  s_add_u32 s52, s14, 479360
  buffer_load_dwordx4 v217, s[24:27], s52 offen offset:0 lds
  v_mfma_f32_32x32x16_bf16 v[112:127], v[140:143], a[156:159], v[112:127]
  ds_read_b64_tr_b16 v[158:159], v216 offset:3072
  buffer_load_dwordx4 v218, s[24:27], s52 offen offset:1024 lds
  s_add_u32 m0, s51, 0
  s_waitcnt lgkmcnt(7)
  v_mfma_f32_32x32x16_bf16 v[64:79], v[144:147], a[160:163], v[64:79]
  s_waitcnt vmcnt(16)
  ds_read_b64_tr_b16 v[128:129], v215 offset:4096
  v_mfma_f32_32x32x16_bf16 v[80:95], v[144:147], a[164:167], v[80:95]
  ds_read_b64_tr_b16 v[130:131], v215 offset:5120
  s_waitcnt lgkmcnt(6)
  v_mfma_f32_32x32x16_bf16 v[96:111], v[148:151], a[160:163], v[96:111]
  ds_read_b64_tr_b16 v[132:133], v216 offset:4096
  s_add_u32 s52, s14, 497792
  buffer_load_dwordx4 v217, s[24:27], s52 offen offset:0 lds
  v_mfma_f32_32x32x16_bf16 v[112:127], v[148:151], a[164:167], v[112:127]
  ds_read_b64_tr_b16 v[134:135], v216 offset:5120
  buffer_load_dwordx4 v218, s[24:27], s52 offen offset:1024 lds
  s_add_u32 m0, s51, 2048
  s_waitcnt lgkmcnt(6)
  v_mfma_f32_32x32x16_bf16 v[64:79], v[152:155], a[168:171], v[64:79]
  s_waitcnt vmcnt(16)
  ds_read_b64_tr_b16 v[136:137], v215 offset:6144
  v_mfma_f32_32x32x16_bf16 v[80:95], v[152:155], a[172:175], v[80:95]
  ds_read_b64_tr_b16 v[138:139], v215 offset:7168
  s_waitcnt lgkmcnt(6)
  v_mfma_f32_32x32x16_bf16 v[96:111], v[156:159], a[168:171], v[96:111]
  ds_read_b64_tr_b16 v[140:141], v216 offset:6144
  s_add_u32 s52, s15, 128
  buffer_load_dwordx4 v217, s[24:27], s52 offen offset:0 lds
  v_mfma_f32_32x32x16_bf16 v[112:127], v[156:159], a[172:175], v[112:127]
  ds_read_b64_tr_b16 v[142:143], v216 offset:7168
  buffer_load_dwordx4 v218, s[24:27], s52 offen offset:1024 lds
  s_add_u32 m0, s51, 4096
  s_waitcnt lgkmcnt(6)
  v_mfma_f32_32x32x16_bf16 v[64:79], v[128:131], a[176:179], v[64:79]
  s_waitcnt vmcnt(16)
  ds_read_b64_tr_b16 v[144:145], v215 offset:8192
  v_mfma_f32_32x32x16_bf16 v[80:95], v[128:131], a[180:183], v[80:95]
  ds_read_b64_tr_b16 v[146:147], v215 offset:9216
  s_waitcnt lgkmcnt(6)
  v_mfma_f32_32x32x16_bf16 v[96:111], v[132:135], a[176:179], v[96:111]
  ds_read_b64_tr_b16 v[148:149], v216 offset:8192
  s_add_u32 s52, s15, 18560
  buffer_load_dwordx4 v217, s[24:27], s52 offen offset:0 lds
  v_mfma_f32_32x32x16_bf16 v[112:127], v[132:135], a[180:183], v[112:127]
  ds_read_b64_tr_b16 v[150:151], v216 offset:9216
  buffer_load_dwordx4 v218, s[24:27], s52 offen offset:1024 lds
  s_add_u32 m0, s51, 6144
  s_waitcnt lgkmcnt(6)
  v_mfma_f32_32x32x16_bf16 v[64:79], v[136:139], a[184:187], v[64:79]
  s_waitcnt vmcnt(16)
  ds_read_b64_tr_b16 v[152:153], v215 offset:10240
  v_mfma_f32_32x32x16_bf16 v[80:95], v[136:139], a[188:191], v[80:95]
  ds_read_b64_tr_b16 v[154:155], v215 offset:11264
  s_waitcnt lgkmcnt(6)
  v_mfma_f32_32x32x16_bf16 v[96:111], v[140:143], a[184:187], v[96:111]
  ds_read_b64_tr_b16 v[156:157], v216 offset:10240
  s_add_u32 s52, s15, 36992
  buffer_load_dwordx4 v217, s[24:27], s52 offen offset:0 lds
  v_mfma_f32_32x32x16_bf16 v[112:127], v[140:143], a[188:191], v[112:127]
  ds_read_b64_tr_b16 v[158:159], v216 offset:11264
  buffer_load_dwordx4 v218, s[24:27], s52 offen offset:1024 lds
  s_add_u32 m0, s51, 8192
  s_waitcnt lgkmcnt(6)
  v_mfma_f32_32x32x16_bf16 v[64:79], v[144:147], a[192:195], v[64:79]
  s_waitcnt vmcnt(16)
  ds_read_b64_tr_b16 v[128:129], v215 offset:12288
  v_mfma_f32_32x32x16_bf16 v[80:95], v[144:147], a[196:199], v[80:95]
  ds_read_b64_tr_b16 v[130:131], v215 offset:13312
  s_waitcnt lgkmcnt(6)
  v_mfma_f32_32x32x16_bf16 v[96:111], v[148:151], a[192:195], v[96:111]
  ds_read_b64_tr_b16 v[132:133], v216 offset:12288
  s_add_u32 s52, s15, 55424
  buffer_load_dwordx4 v217, s[24:27], s52 offen offset:0 lds
  v_mfma_f32_32x32x16_bf16 v[112:127], v[148:151], a[196:199], v[112:127]
  ds_read_b64_tr_b16 v[134:135], v216 offset:13312
  buffer_load_dwordx4 v218, s[24:27], s52 offen offset:1024 lds
  s_add_u32 m0, s51, 10240
  s_waitcnt lgkmcnt(6)
  v_mfma_f32_32x32x16_bf16 v[64:79], v[152:155], a[200:203], v[64:79]
  s_waitcnt vmcnt(16)
  ds_read_b64_tr_b16 v[136:137], v215 offset:14336
  v_mfma_f32_32x32x16_bf16 v[80:95], v[152:155], a[204:207], v[80:95]
  ds_read_b64_tr_b16 v[138:139], v215 offset:15360
  s_waitcnt lgkmcnt(6)
  v_mfma_f32_32x32x16_bf16 v[96:111], v[156:159], a[200:203], v[96:111]
  ds_read_b64_tr_b16 v[140:141], v216 offset:14336
  s_add_u32 s52, s100, 0
  buffer_load_dwordx4 v217, s[24:27], s52 offen offset:0 lds
  v_mfma_f32_32x32x16_bf16 v[112:127], v[156:159], a[204:207], v[112:127]
  ds_read_b64_tr_b16 v[142:143], v216 offset:15360
  buffer_load_dwordx4 v218, s[24:27], s52 offen offset:1024 lds
  s_add_u32 m0, s51, 12288
  s_waitcnt lgkmcnt(6)
  v_mfma_f32_32x32x16_bf16 v[64:79], v[128:131], a[208:211], v[64:79]
  s_waitcnt vmcnt(16)
  ds_read_b64_tr_b16 v[144:145], v215 offset:16384
  v_mfma_f32_32x32x16_bf16 v[80:95], v[128:131], a[212:215], v[80:95]
  ds_read_b64_tr_b16 v[146:147], v215 offset:17408
  s_waitcnt lgkmcnt(6)
  v_mfma_f32_32x32x16_bf16 v[96:111], v[132:135], a[208:211], v[96:111]
  ds_read_b64_tr_b16 v[148:149], v216 offset:16384
  s_add_u32 s52, s100, 18432
  buffer_load_dwordx4 v217, s[24:27], s52 offen offset:0 lds
  v_mfma_f32_32x32x16_bf16 v[112:127], v[132:135], a[212:215], v[112:127]
  ds_read_b64_tr_b16 v[150:151], v216 offset:17408
  buffer_load_dwordx4 v218, s[24:27], s52 offen offset:1024 lds
  s_add_u32 m0, s51, 14336
  s_waitcnt lgkmcnt(6)
  v_mfma_f32_32x32x16_bf16 v[64:79], v[136:139], a[216:219], v[64:79]
  s_waitcnt vmcnt(16)
  ds_read_b64_tr_b16 v[152:153], v215 offset:18432
  v_mfma_f32_32x32x16_bf16 v[80:95], v[136:139], a[220:223], v[80:95]
  ds_read_b64_tr_b16 v[154:155], v215 offset:19456
  s_waitcnt lgkmcnt(6)
  v_mfma_f32_32x32x16_bf16 v[96:111], v[140:143], a[216:219], v[96:111]
  ds_read_b64_tr_b16 v[156:157], v216 offset:18432
  s_add_u32 s52, s100, 36864
  buffer_load_dwordx4 v217, s[24:27], s52 offen offset:0 lds
  v_mfma_f32_32x32x16_bf16 v[112:127], v[140:143], a[220:223], v[112:127]
  ds_read_b64_tr_b16 v[158:159], v216 offset:19456
  buffer_load_dwordx4 v218, s[24:27], s52 offen offset:1024 lds
  s_add_u32 m0, s51, 16384
  s_waitcnt lgkmcnt(6)
  v_mfma_f32_32x32x16_bf16 v[64:79], v[144:147], a[224:227], v[64:79]
  s_waitcnt vmcnt(16)
  ds_read_b64_tr_b16 v[128:129], v215 offset:20480
  v_mfma_f32_32x32x16_bf16 v[80:95], v[144:147], a[228:231], v[80:95]
  ds_read_b64_tr_b16 v[130:131], v215 offset:21504
  s_waitcnt lgkmcnt(6)
  v_mfma_f32_32x32x16_bf16 v[96:111], v[148:151], a[224:227], v[96:111]
  ds_read_b64_tr_b16 v[132:133], v216 offset:20480
  s_add_u32 s52, s100, 55296
  buffer_load_dwordx4 v217, s[24:27], s52 offen offset:0 lds
  v_mfma_f32_32x32x16_bf16 v[112:127], v[148:151], a[228:231], v[112:127]
  ds_read_b64_tr_b16 v[134:135], v216 offset:21504
  buffer_load_dwordx4 v218, s[24:27], s52 offen offset:1024 lds
  s_add_u32 m0, s51, 18432
  s_waitcnt lgkmcnt(6)
  v_mfma_f32_32x32x16_bf16 v[64:79], v[152:155], a[232:235], v[64:79]
  s_waitcnt vmcnt(16)
  ds_read_b64_tr_b16 v[136:137], v215 offset:0
  v_mfma_f32_32x32x16_bf16 v[80:95], v[152:155], a[236:239], v[80:95]
  ds_read_b64_tr_b16 v[138:139], v215 offset:1024
  s_waitcnt lgkmcnt(6)
  v_mfma_f32_32x32x16_bf16 v[96:111], v[156:159], a[232:235], v[96:111]
  ds_read_b64_tr_b16 v[140:141], v216 offset:0
  s_add_u32 s52, s101, 0
  buffer_load_dwordx4 v217, s[24:27], s52 offen offset:0 lds
  v_mfma_f32_32x32x16_bf16 v[112:127], v[156:159], a[236:239], v[112:127]
  ds_read_b64_tr_b16 v[142:143], v216 offset:1024
  buffer_load_dwordx4 v218, s[24:27], s52 offen offset:1024 lds
  s_add_u32 m0, s51, 20480
  s_waitcnt lgkmcnt(6)
  v_mfma_f32_32x32x16_bf16 v[64:79], v[128:131], a[240:243], v[64:79]
  s_waitcnt vmcnt(16)
  ds_read_b64_tr_b16 v[144:145], v215 offset:2048
  v_mfma_f32_32x32x16_bf16 v[80:95], v[128:131], a[244:247], v[80:95]
  ds_read_b64_tr_b16 v[146:147], v215 offset:3072
  s_waitcnt lgkmcnt(6)
  v_mfma_f32_32x32x16_bf16 v[96:111], v[132:135], a[240:243], v[96:111]
  ds_read_b64_tr_b16 v[148:149], v216 offset:2048
  s_add_u32 s52, s101, 18432
  buffer_load_dwordx4 v217, s[24:27], s52 offen offset:0 lds
  v_mfma_f32_32x32x16_bf16 v[112:127], v[132:135], a[244:247], v[112:127]
  ds_read_b64_tr_b16 v[150:151], v216 offset:3072
  buffer_load_dwordx4 v218, s[24:27], s52 offen offset:1024 lds
  s_add_u32 m0, s51, 0
  s_waitcnt lgkmcnt(6)
  v_mfma_f32_32x32x16_bf16 v[64:79], v[136:139], a[248:251], v[64:79]
  s_waitcnt vmcnt(16)
  ds_read_b64_tr_b16 v[152:153], v215 offset:4096
  v_mfma_f32_32x32x16_bf16 v[80:95], v[136:139], a[252:255], v[80:95]
  ds_read_b64_tr_b16 v[154:155], v215 offset:5120
  s_waitcnt lgkmcnt(6)
  v_mfma_f32_32x32x16_bf16 v[96:111], v[140:143], a[248:251], v[96:111]
  ds_read_b64_tr_b16 v[156:157], v216 offset:4096
  s_add_u32 s52, s101, 36864
  buffer_load_dwordx4 v217, s[24:27], s52 offen offset:0 lds
  v_mfma_f32_32x32x16_bf16 v[112:127], v[140:143], a[252:255], v[112:127]
  ds_read_b64_tr_b16 v[158:159], v216 offset:5120
  buffer_load_dwordx4 v218, s[24:27], s52 offen offset:1024 lds
  s_add_u32 m0, s51, 2048
  s_waitcnt lgkmcnt(6)
  v_mfma_f32_32x32x16_bf16 v[64:79], v[144:147], v[224:227], v[64:79]
  s_waitcnt vmcnt(16)
  ds_read_b64_tr_b16 v[128:129], v215 offset:6144
  v_mfma_f32_32x32x16_bf16 v[80:95], v[144:147], v[228:231], v[80:95]
  ds_read_b64_tr_b16 v[130:131], v215 offset:7168
  s_waitcnt lgkmcnt(6)
  v_mfma_f32_32x32x16_bf16 v[96:111], v[148:151], v[224:227], v[96:111]
  ds_read_b64_tr_b16 v[132:133], v216 offset:6144
  s_add_u32 s52, s101, 55296
  buffer_load_dwordx4 v217, s[24:27], s52 offen offset:0 lds
  v_mfma_f32_32x32x16_bf16 v[112:127], v[148:151], v[228:231], v[112:127]
  ds_read_b64_tr_b16 v[134:135], v216 offset:7168
  buffer_load_dwordx4 v218, s[24:27], s52 offen offset:1024 lds
  s_add_u32 m0, s51, 4096
  s_waitcnt lgkmcnt(6)
  v_mfma_f32_32x32x16_bf16 v[64:79], v[152:155], v[232:235], v[64:79]
  s_waitcnt vmcnt(16)
  ds_read_b64_tr_b16 v[136:137], v215 offset:8192
  v_mfma_f32_32x32x16_bf16 v[80:95], v[152:155], v[236:239], v[80:95]
  ds_read_b64_tr_b16 v[138:139], v215 offset:9216
  s_waitcnt lgkmcnt(6)
  v_mfma_f32_32x32x16_bf16 v[96:111], v[156:159], v[232:235], v[96:111]
  ds_read_b64_tr_b16 v[140:141], v216 offset:8192
  s_add_u32 s52, s78, 0
  buffer_load_dwordx4 v217, s[24:27], s52 offen offset:0 lds
  v_mfma_f32_32x32x16_bf16 v[112:127], v[156:159], v[236:239], v[112:127]
  ds_read_b64_tr_b16 v[142:143], v216 offset:9216
  buffer_load_dwordx4 v218, s[24:27], s52 offen offset:1024 lds
  s_waitcnt lgkmcnt(6)
  v_mfma_f32_32x32x16_bf16 v[64:79], v[128:131], v[240:243], v[64:79]
  s_waitcnt vmcnt(16)
  ds_read_b64_tr_b16 v[144:145], v215 offset:10240
  v_mfma_f32_32x32x16_bf16 v[80:95], v[128:131], v[244:247], v[80:95]
  ds_read_b64_tr_b16 v[146:147], v215 offset:11264
  s_waitcnt lgkmcnt(6)
  v_mfma_f32_32x32x16_bf16 v[96:111], v[132:135], v[240:243], v[96:111]
  s_waitcnt vmcnt(14)
  ds_read_b64_tr_b16 v[148:149], v215 offset:12288
  v_mfma_f32_32x32x16_bf16 v[112:127], v[132:135], v[244:247], v[112:127]
  ds_read_b64_tr_b16 v[150:151], v215 offset:13312
  s_waitcnt lgkmcnt(6)
  v_mfma_f32_32x32x16_bf16 v[64:79], v[136:139], v[248:251], v[64:79]
  s_waitcnt vmcnt(12)
  ds_read_b64_tr_b16 v[152:153], v215 offset:14336
  v_mfma_f32_32x32x16_bf16 v[80:95], v[136:139], v[252:255], v[80:95]
  ds_read_b64_tr_b16 v[154:155], v215 offset:15360
  s_waitcnt lgkmcnt(6)
  v_mfma_f32_32x32x16_bf16 v[96:111], v[140:143], v[248:251], v[96:111]
  s_waitcnt vmcnt(10)
  ds_read_b64_tr_b16 v[156:157], v215 offset:16384
  v_mfma_f32_32x32x16_bf16 v[112:127], v[140:143], v[252:255], v[112:127]
  ds_read_b64_tr_b16 v[158:159], v215 offset:17408
  s_add_u32 s92, s95, 0
  buffer_load_dwordx4 v[224:227], v204, s[32:35], s92 offen sc1
  s_waitcnt lgkmcnt(6)
  v_mfma_f32_32x32x16_bf16 v[0:15], v[144:147], a[0:3], 0
  s_waitcnt vmcnt(9)
  ds_read_b64_tr_b16 v[128:129], v215 offset:18432
  s_add_u32 s92, s95, 9216
  buffer_load_dwordx4 v[228:231], v204, s[32:35], s92 offen sc1
  v_mfma_f32_32x32x16_bf16 v[16:31], v[144:147], a[4:7], 0
  ds_read_b64_tr_b16 v[130:131], v215 offset:19456
  s_add_u32 s92, s95, 18432
  buffer_load_dwordx4 v[232:235], v204, s[32:35], s92 offen sc1
  s_waitcnt lgkmcnt(6)
  v_mfma_f32_32x32x16_bf16 v[0:15], v[148:151], a[8:11], v[0:15]
  s_waitcnt vmcnt(9)
  ds_read_b64_tr_b16 v[132:133], v215 offset:20480
  s_add_u32 s92, s95, 27648
  buffer_load_dwordx4 v[236:239], v204, s[32:35], s92 offen sc1
  v_mfma_f32_32x32x16_bf16 v[16:31], v[148:151], a[12:15], v[16:31]
  ds_read_b64_tr_b16 v[134:135], v215 offset:21504
  s_add_u32 s92, s95, 36864
  buffer_load_dwordx4 v[240:243], v204, s[32:35], s92 offen sc1
  s_waitcnt lgkmcnt(6)
  v_mfma_f32_32x32x16_bf16 v[0:15], v[152:155], a[16:19], v[0:15]
  s_waitcnt vmcnt(9)
  ds_read_b64_tr_b16 v[136:137], v215 offset:0
  s_add_u32 s92, s95, 46080
  buffer_load_dwordx4 v[244:247], v204, s[32:35], s92 offen sc1
  v_mfma_f32_32x32x16_bf16 v[16:31], v[152:155], a[20:23], v[16:31]
  ds_read_b64_tr_b16 v[138:139], v215 offset:1024
  s_add_u32 s92, s95, 55296
  buffer_load_dwordx4 v[248:251], v204, s[32:35], s92 offen sc1
  s_waitcnt lgkmcnt(6)
  v_mfma_f32_32x32x16_bf16 v[0:15], v[156:159], a[24:27], v[0:15]
  s_waitcnt vmcnt(9)
  ds_read_b64_tr_b16 v[140:141], v215 offset:2048
  s_add_u32 s92, s95, 64512
  buffer_load_dwordx4 v[252:255], v204, s[32:35], s92 offen sc1
  v_mfma_f32_32x32x16_bf16 v[16:31], v[156:159], a[28:31], v[16:31]
  ds_read_b64_tr_b16 v[142:143], v215 offset:3072
  s_waitcnt lgkmcnt(6)
  v_mfma_f32_32x32x16_bf16 v[0:15], v[128:131], a[32:35], v[0:15]
  s_waitcnt vmcnt(8)
  ds_read_b64_tr_b16 v[144:145], v215 offset:4096
  v_cvt_pk_bf16_f32 v160, v64, v65
  v_cvt_pk_bf16_f32 v161, v66, v67
  v_and_b32 v160, 0xfffffffe, v160
  v_mfma_f32_32x32x16_bf16 v[16:31], v[128:131], a[36:39], v[16:31]
  ds_read_b64_tr_b16 v[146:147], v215 offset:5120
  v_cvt_pk_bf16_f32 v162, v68, v69
  v_cvt_pk_bf16_f32 v163, v70, v71
  v_cvt_pk_bf16_f32 v164, v72, v73
  v_cvt_pk_bf16_f32 v165, v74, v75
  s_waitcnt lgkmcnt(6)
  v_mfma_f32_32x32x16_bf16 v[0:15], v[132:135], a[40:43], v[0:15]
  ds_read_b64_tr_b16 v[148:149], v216 offset:10240
  v_and_b32 v164, 0xfffffffe, v164
  v_cvt_pk_bf16_f32 v166, v76, v77
  v_cvt_pk_bf16_f32 v167, v78, v79
  buffer_store_dwordx4 v[160:163], v201, s[32:35], s54 offen offset:0 sc1
  v_mfma_f32_32x32x16_bf16 v[16:31], v[132:135], a[44:47], v[16:31]
  ds_read_b64_tr_b16 v[150:151], v216 offset:11264
  buffer_store_dwordx4 v[164:167], v201, s[32:35], s54 offen offset:256 sc1
  v_cvt_pk_bf16_f32 v168, v80, v81
  v_cvt_pk_bf16_f32 v169, v82, v83
  v_and_b32 v168, 0xfffffffe, v168
  s_waitcnt lgkmcnt(6)
  v_mfma_f32_32x32x16_bf16 v[0:15], v[136:139], a[48:51], v[0:15]
  ds_read_b64_tr_b16 v[152:153], v216 offset:12288
  v_cvt_pk_bf16_f32 v170, v84, v85
  v_cvt_pk_bf16_f32 v171, v86, v87
  v_cvt_pk_bf16_f32 v172, v88, v89
  v_cvt_pk_bf16_f32 v173, v90, v91
  v_mfma_f32_32x32x16_bf16 v[16:31], v[136:139], a[52:55], v[16:31]
  ds_read_b64_tr_b16 v[154:155], v216 offset:13312
  v_and_b32 v172, 0xfffffffe, v172
  v_cvt_pk_bf16_f32 v174, v92, v93
  v_cvt_pk_bf16_f32 v175, v94, v95
  buffer_store_dwordx4 v[168:171], v201, s[32:35], s55 offen offset:0 sc1
  s_waitcnt lgkmcnt(6)
  v_mfma_f32_32x32x16_bf16 v[0:15], v[140:143], a[56:59], v[0:15]
  ds_read_b64_tr_b16 v[156:157], v216 offset:14336
  buffer_store_dwordx4 v[172:175], v201, s[32:35], s55 offen offset:256 sc1
  v_cvt_pk_bf16_f32 v176, v96, v97
  v_cvt_pk_bf16_f32 v177, v98, v99
  v_and_b32 v176, 0xfffffffe, v176
  v_mfma_f32_32x32x16_bf16 v[16:31], v[140:143], a[60:63], v[16:31]
  ds_read_b64_tr_b16 v[158:159], v216 offset:15360
  v_cvt_pk_bf16_f32 v178, v100, v101
  v_cvt_pk_bf16_f32 v179, v102, v103
  v_cvt_pk_bf16_f32 v180, v104, v105
  v_cvt_pk_bf16_f32 v181, v106, v107
  s_waitcnt lgkmcnt(6)
  v_mfma_f32_32x32x16_bf16 v[0:15], v[144:147], a[64:67], v[0:15]
  ds_read_b64_tr_b16 v[128:129], v216 offset:16384
  v_and_b32 v180, 0xfffffffe, v180
  v_cvt_pk_bf16_f32 v182, v108, v109
  v_cvt_pk_bf16_f32 v183, v110, v111
  buffer_store_dwordx4 v[176:179], v201, s[32:35], s54 offen offset:512 sc1
  v_mfma_f32_32x32x16_bf16 v[16:31], v[144:147], a[68:71], v[16:31]
  ds_read_b64_tr_b16 v[130:131], v216 offset:17408
  buffer_store_dwordx4 v[180:183], v201, s[32:35], s54 offen offset:768 sc1
  v_cvt_pk_bf16_f32 v184, v112, v113
  v_cvt_pk_bf16_f32 v185, v114, v115
  v_and_b32 v184, 0xfffffffe, v184
  s_waitcnt lgkmcnt(6)
  v_mfma_f32_32x32x16_bf16 v[32:47], v[148:151], a[0:3], 0
  ds_read_b64_tr_b16 v[132:133], v216 offset:18432
  v_cvt_pk_bf16_f32 v186, v116, v117
  v_cvt_pk_bf16_f32 v187, v118, v119
  v_cvt_pk_bf16_f32 v188, v120, v121
  v_cvt_pk_bf16_f32 v189, v122, v123
  s_barrier
  v_mfma_f32_32x32x16_bf16 v[48:63], v[148:151], a[4:7], 0
  ds_read_b64_tr_b16 v[134:135], v216 offset:19456
  v_and_b32 v188, 0xfffffffe, v188
  v_cvt_pk_bf16_f32 v190, v124, v125
  v_cvt_pk_bf16_f32 v191, v126, v127
  buffer_store_dwordx4 v[184:187], v201, s[32:35], s55 offen offset:512 sc1
  s_waitcnt lgkmcnt(6)
  v_mfma_f32_32x32x16_bf16 v[32:47], v[152:155], a[8:11], v[32:47]
  ds_read_b64_tr_b16 v[136:137], v216 offset:20480
  buffer_store_dwordx4 v[188:191], v201, s[32:35], s55 offen offset:768 sc1
  s_add_u32 s54, s54, 4096
  s_add_u32 s55, s55, 4096
  ds_write_b128 v203, v[0:3] offset:0
  ds_write_b128 v203, v[4:7] offset:1024
  ds_write_b128 v203, v[8:11] offset:2048
  v_mfma_f32_32x32x16_bf16 v[48:63], v[152:155], a[12:15], v[48:63]
  ds_read_b64_tr_b16 v[138:139], v216 offset:21504
  ds_write_b128 v203, v[12:15] offset:3072
  ds_write_b128 v203, v[16:19] offset:4096
  ds_write_b128 v203, v[20:23] offset:5120
  ds_write_b128 v203, v[24:27] offset:6144
  ds_write_b128 v203, v[28:31] offset:7168
  s_waitcnt lgkmcnt(14)
  v_mfma_f32_32x32x16_bf16 v[32:47], v[156:159], a[16:19], v[32:47]
  ds_read_b64_tr_b16 v[140:141], v216 offset:0
  v_mfma_f32_32x32x16_bf16 v[48:63], v[156:159], a[20:23], v[48:63]
  ds_read_b64_tr_b16 v[142:143], v216 offset:1024
  s_waitcnt lgkmcnt(14)
  v_mfma_f32_32x32x16_bf16 v[32:47], v[128:131], a[24:27], v[32:47]
  ds_read_b64_tr_b16 v[144:145], v216 offset:2048
  v_mfma_f32_32x32x16_bf16 v[48:63], v[128:131], a[28:31], v[48:63]
  ds_read_b64_tr_b16 v[146:147], v216 offset:3072
  s_waitcnt lgkmcnt(14)
  v_mfma_f32_32x32x16_bf16 v[32:47], v[132:135], a[32:35], v[32:47]
  ds_read_b64_tr_b16 v[148:149], v216 offset:4096
  v_mfma_f32_32x32x16_bf16 v[48:63], v[132:135], a[36:39], v[48:63]
  ds_read_b64_tr_b16 v[150:151], v216 offset:5120
  s_waitcnt lgkmcnt(11)
  v_mfma_f32_32x32x16_bf16 v[32:47], v[136:139], a[40:43], v[32:47]
  v_mfma_f32_32x32x16_bf16 v[48:63], v[136:139], a[44:47], v[48:63]
  s_waitcnt lgkmcnt(4)
  v_mfma_f32_32x32x16_bf16 v[32:47], v[140:143], a[48:51], v[32:47]
  v_mfma_f32_32x32x16_bf16 v[48:63], v[140:143], a[52:55], v[48:63]
  s_waitcnt lgkmcnt(2)
  v_mfma_f32_32x32x16_bf16 v[32:47], v[144:147], a[56:59], v[32:47]
  v_mfma_f32_32x32x16_bf16 v[48:63], v[144:147], a[60:63], v[48:63]
  s_waitcnt lgkmcnt(0)
  v_mfma_f32_32x32x16_bf16 v[32:47], v[148:151], a[64:67], v[32:47]
  v_mfma_f32_32x32x16_bf16 v[48:63], v[148:151], a[68:71], v[48:63]
  s_nop 10
  ds_write_b128 v203, v[32:35] offset:8192
  ds_write_b128 v203, v[36:39] offset:9216
  ds_write_b128 v203, v[40:43] offset:10240
  ds_write_b128 v203, v[44:47] offset:11264
  ds_write_b128 v203, v[48:51] offset:12288
  ds_write_b128 v203, v[52:55] offset:13312
  ds_write_b128 v203, v[56:59] offset:14336
  ds_write_b128 v203, v[60:63] offset:15360
  v_and_b32 v220, 7, v200
  v_bfe_u32 v221, v200, 3, 1
  v_lshrrev_b32 v213, 4, v200
  v_mov_b32 v219, 2130706432
  v_cmp_gt_u32 vcc, 16, v200
  s_add_u32 s36, s12, 56623104
  s_addc_u32 s37, s13, 0
  s_mov_b32 s38, 2359296
  s_mov_b32 s39, 0x00020000
  s_mov_b32 s40, s10
  s_mov_b32 s41, s11
  s_mov_b32 s42, 2359296
  s_mov_b32 s43, 0x00020000
  s_lshl_b32 s92, s49, 3
  s_add_u32 s92, s92, s50
  s_mul_i32 s92, s92, 9216
  v_mul_u32_u24 v210, 1152, v220
  v_add_u32 v210, s92, v210
  v_mul_u32_u24 v209, 16, v221
  v_add_u32 v210, v210, v209
  v_lshl_add_u32 v209, v213, 5, v210
  s_lshl_b32 s92, s48, 8
  v_add_u32 v209, s92, v209
  s_lshl_b32 s92, s48, 5
  s_add_u32 s92, s92, 1024
  v_add_u32 v210, s92, v210
  v_cndmask_b32 v210, v219, v210, vcc
  s_waitcnt lgkmcnt(0)
  s_barrier
  ds_read_b128 v[0:3], v202 offset:0
  ds_read_b128 v[4:7], v202 offset:1024
  ds_read_b128 v[8:11], v202 offset:2048
  ds_read_b128 v[12:15], v202 offset:3072
  ds_read_b128 v[16:19], v202 offset:16384
  ds_read_b128 v[20:23], v202 offset:17408
  ds_read_b128 v[24:27], v202 offset:18432
  ds_read_b128 v[28:31], v202 offset:19456
  ds_read_b128 v[32:35], v202 offset:32768
  ds_read_b128 v[36:39], v202 offset:33792
  ds_read_b128 v[40:43], v202 offset:34816
  ds_read_b128 v[44:47], v202 offset:35840
  ds_read_b128 v[48:51], v202 offset:49152
  ds_read_b128 v[52:55], v202 offset:50176
  ds_read_b128 v[56:59], v202 offset:51200
  ds_read_b128 v[60:63], v202 offset:52224
  s_lshl_b32 s92, s49, 3
  s_add_u32 s92, s92, s50
  s_mul_i32 s55, s92, 9216
  s_add_u32 s54, s55, 4096
  s_mov_b32 s58, 0x00003f80
  s_mov_b32 s59, 0x3f800000
  s_waitcnt lgkmcnt(11)
  v_add_f32 v0, v0, v16
  v_add_f32 v1, v1, v17
  v_add_f32 v2, v2, v18
  v_add_f32 v3, v3, v19
  s_waitcnt lgkmcnt(10)
  v_add_f32 v4, v4, v20
  v_add_f32 v5, v5, v21
  v_add_f32 v6, v6, v22
  v_add_f32 v7, v7, v23
  s_waitcnt lgkmcnt(9)
  v_add_f32 v8, v8, v24
  v_add_f32 v9, v9, v25
  v_add_f32 v10, v10, v26
  v_add_f32 v11, v11, v27
  s_waitcnt lgkmcnt(8)
  v_add_f32 v12, v12, v28
  v_add_f32 v13, v13, v29
  v_add_f32 v14, v14, v30
  v_add_f32 v15, v15, v31
  s_waitcnt lgkmcnt(3)
  v_add_f32 v32, v32, v48
  v_add_f32 v33, v33, v49
  v_add_f32 v34, v34, v50
  v_add_f32 v35, v35, v51
  s_waitcnt lgkmcnt(2)
  v_add_f32 v36, v36, v52
  v_add_f32 v37, v37, v53
  v_add_f32 v38, v38, v54
  v_add_f32 v39, v39, v55
  s_waitcnt lgkmcnt(1)
  v_add_f32 v40, v40, v56
  v_add_f32 v41, v41, v57
  v_add_f32 v42, v42, v58
  v_add_f32 v43, v43, v59
  s_waitcnt lgkmcnt(0)
  v_add_f32 v44, v44, v60
  v_add_f32 v45, v45, v61
  v_add_f32 v46, v46, v62
  v_add_f32 v47, v47, v63
  v_add_f32 v0, v0, v32
  v_add_f32 v1, v1, v33
  v_add_f32 v2, v2, v34
  v_add_f32 v3, v3, v35
  v_add_f32 v4, v4, v36
  v_add_f32 v5, v5, v37
  v_add_f32 v6, v6, v38
  v_add_f32 v7, v7, v39
  v_add_f32 v8, v8, v40
  v_add_f32 v9, v9, v41
  v_add_f32 v10, v10, v42
  v_add_f32 v11, v11, v43
  v_add_f32 v12, v12, v44
  v_add_f32 v13, v13, v45
  v_add_f32 v14, v14, v46
  v_add_f32 v15, v15, v47
  v_cvt_pk_bf16_f32 v192, v0, v1
  v_cvt_pk_bf16_f32 v193, v2, v3
  v_and_b32 v192, 0xfffffffe, v192
  v_cvt_pk_bf16_f32 v194, v4, v5
  v_cvt_pk_bf16_f32 v195, v6, v7
  v_cvt_pk_bf16_f32 v196, v8, v9
  v_cvt_pk_bf16_f32 v197, v10, v11
  v_and_b32 v196, 0xfffffffe, v196
  v_cvt_pk_bf16_f32 v198, v12, v13
  v_cvt_pk_bf16_f32 v199, v14, v15
  buffer_store_dwordx4 v[192:195], v201, s[32:35], s56 offen offset:0 sc1
  buffer_store_dwordx4 v[196:199], v201, s[32:35], s56 offen offset:256 sc1
  buffer_load_dwordx4 v[160:163], v204, s[36:39], s55 offen
  buffer_load_dwordx4 v[164:167], v204, s[36:39], s54 offen
  buffer_load_dwordx4 v[168:171], v205, s[36:39], s55 offen
  s_waitcnt vmcnt(18)
  v_or3_b32 v219, v224, v228, v232
  s_waitcnt vmcnt(16)
  v_or3_b32 v219, v219, v236, v240
  s_waitcnt vmcnt(14)
  v_or3_b32 v219, v219, v244, v248
  s_waitcnt vmcnt(13)
  v_or_b32 v219, v219, v252
  v_and_b32 v219, 1, v219
  v_cmp_eq_u32 vcc, 1, v219
  s_cmp_ge_u32 s57, 16384
  s_nop 2
  s_cbranch_scc1 K4_AOK
  s_cbranch_vccz K4_AOK
K4_AP:
  s_add_u32 s92, s95, 0
  buffer_load_dword v219, v206, s[32:35], s92 offen sc1
  s_add_u32 s57, s57, 1
  s_waitcnt vmcnt(0)
  v_and_b32 v219, 1, v219
  v_cmp_eq_u32 vcc, 1, v219
  s_cmp_ge_u32 s57, 16384
  s_cbranch_scc1 K4_AP_GO
  s_nop 2
  s_cbranch_vccnz K4_AP
K4_AP_GO:
  s_add_u32 s92, s95, 0
  buffer_load_dwordx4 v[224:227], v204, s[32:35], s92 offen sc1
  s_add_u32 s92, s95, 9216
  buffer_load_dwordx4 v[228:231], v204, s[32:35], s92 offen sc1
  s_add_u32 s92, s95, 18432
  buffer_load_dwordx4 v[232:235], v204, s[32:35], s92 offen sc1
  s_add_u32 s92, s95, 27648
  buffer_load_dwordx4 v[236:239], v204, s[32:35], s92 offen sc1
  s_add_u32 s92, s95, 36864
  buffer_load_dwordx4 v[240:243], v204, s[32:35], s92 offen sc1
  s_add_u32 s92, s95, 46080
  buffer_load_dwordx4 v[244:247], v204, s[32:35], s92 offen sc1
  s_add_u32 s92, s95, 55296
  buffer_load_dwordx4 v[248:251], v204, s[32:35], s92 offen sc1
  s_add_u32 s92, s95, 64512
  buffer_load_dwordx4 v[252:255], v204, s[32:35], s92 offen sc1
  s_waitcnt vmcnt(0)
  v_or3_b32 v219, v224, v228, v232
  v_or3_b32 v219, v219, v236, v240
  v_or3_b32 v219, v219, v244, v248
  v_or_b32 v219, v219, v252
  v_and_b32 v219, 1, v219
  v_cmp_eq_u32 vcc, 1, v219
  s_cmp_ge_u32 s57, 16384
  s_nop 2
  s_cbranch_scc1 K4_AOK
  s_cbranch_vccnz K4_AP
K4_AOK:
  v_lshlrev_b32 v128, 16, v224
  v_and_b32 v129, 0xffff0000, v224
  v_lshlrev_b32 v130, 16, v225
  v_and_b32 v131, 0xffff0000, v225
  v_lshlrev_b32 v132, 16, v226
  v_and_b32 v133, 0xffff0000, v226
  v_lshlrev_b32 v134, 16, v227
  v_and_b32 v135, 0xffff0000, v227
  v_dot2c_f32_bf16 v128, s58, v228
  v_dot2c_f32_bf16 v129, s59, v228
  v_dot2c_f32_bf16 v130, s58, v229
  v_dot2c_f32_bf16 v131, s59, v229
  v_dot2c_f32_bf16 v132, s58, v230
  v_dot2c_f32_bf16 v133, s59, v230
  v_dot2c_f32_bf16 v134, s58, v231
  v_dot2c_f32_bf16 v135, s59, v231
  v_dot2c_f32_bf16 v128, s58, v232
  v_dot2c_f32_bf16 v129, s59, v232
  v_dot2c_f32_bf16 v130, s58, v233
  v_dot2c_f32_bf16 v131, s59, v233
  v_dot2c_f32_bf16 v132, s58, v234
  v_dot2c_f32_bf16 v133, s59, v234
  v_dot2c_f32_bf16 v134, s58, v235
  v_dot2c_f32_bf16 v135, s59, v235
  v_dot2c_f32_bf16 v128, s58, v236
  v_dot2c_f32_bf16 v129, s59, v236
  v_dot2c_f32_bf16 v130, s58, v237
  v_dot2c_f32_bf16 v131, s59, v237
  v_dot2c_f32_bf16 v132, s58, v238
  v_dot2c_f32_bf16 v133, s59, v238
  v_dot2c_f32_bf16 v134, s58, v239
  v_dot2c_f32_bf16 v135, s59, v239
  v_dot2c_f32_bf16 v128, s58, v240
  v_dot2c_f32_bf16 v129, s59, v240
  v_dot2c_f32_bf16 v130, s58, v241
  v_dot2c_f32_bf16 v131, s59, v241
  v_dot2c_f32_bf16 v132, s58, v242
  v_dot2c_f32_bf16 v133, s59, v242
  v_dot2c_f32_bf16 v134, s58, v243
  v_dot2c_f32_bf16 v135, s59, v243
  v_dot2c_f32_bf16 v128, s58, v244
  v_dot2c_f32_bf16 v129, s59, v244
  v_dot2c_f32_bf16 v130, s58, v245
  v_dot2c_f32_bf16 v131, s59, v245
  v_dot2c_f32_bf16 v132, s58, v246
  v_dot2c_f32_bf16 v133, s59, v246
  v_dot2c_f32_bf16 v134, s58, v247
  v_dot2c_f32_bf16 v135, s59, v247
  v_dot2c_f32_bf16 v128, s58, v248
  v_dot2c_f32_bf16 v129, s59, v248
  v_dot2c_f32_bf16 v130, s58, v249
  v_dot2c_f32_bf16 v131, s59, v249
  v_dot2c_f32_bf16 v132, s58, v250
  v_dot2c_f32_bf16 v133, s59, v250
  v_dot2c_f32_bf16 v134, s58, v251
  v_dot2c_f32_bf16 v135, s59, v251
  v_dot2c_f32_bf16 v128, s58, v252
  v_dot2c_f32_bf16 v129, s59, v252
  v_dot2c_f32_bf16 v130, s58, v253
  v_dot2c_f32_bf16 v131, s59, v253
  v_dot2c_f32_bf16 v132, s58, v254
  v_dot2c_f32_bf16 v133, s59, v254
  v_dot2c_f32_bf16 v134, s58, v255
  v_dot2c_f32_bf16 v135, s59, v255
K4_BP:
  s_add_u32 s92, s95, 4096
  buffer_load_dword v219, v206, s[32:35], s92 offen sc1
  s_add_u32 s57, s57, 1
  s_waitcnt vmcnt(0)
  v_and_b32 v219, 1, v219
  v_cmp_eq_u32 vcc, 1, v219
  s_cmp_ge_u32 s57, 16384
  s_cbranch_scc1 K4_BP_GO
  s_nop 2
  s_cbranch_vccnz K4_BP
K4_BP_GO:
  s_add_u32 s92, s95, 4096
  buffer_load_dwordx4 v[64:67], v204, s[32:35], s92 offen sc1
  s_add_u32 s92, s95, 13312
  buffer_load_dwordx4 v[68:71], v204, s[32:35], s92 offen sc1
  s_add_u32 s92, s95, 22528
  buffer_load_dwordx4 v[72:75], v204, s[32:35], s92 offen sc1
  s_add_u32 s92, s95, 31744
  buffer_load_dwordx4 v[76:79], v204, s[32:35], s92 offen sc1
  s_add_u32 s92, s95, 40960
  buffer_load_dwordx4 v[80:83], v204, s[32:35], s92 offen sc1
  s_add_u32 s92, s95, 50176
  buffer_load_dwordx4 v[84:87], v204, s[32:35], s92 offen sc1
  s_add_u32 s92, s95, 59392
  buffer_load_dwordx4 v[88:91], v204, s[32:35], s92 offen sc1
  s_add_u32 s92, s95, 68608
  buffer_load_dwordx4 v[92:95], v204, s[32:35], s92 offen sc1
  s_add_u32 s92, s95, 0
  buffer_load_dwordx4 v[96:99], v205, s[32:35], s92 offen sc1
  s_add_u32 s92, s95, 9216
  buffer_load_dwordx4 v[100:103], v205, s[32:35], s92 offen sc1
  s_add_u32 s92, s95, 18432
  buffer_load_dwordx4 v[104:107], v205, s[32:35], s92 offen sc1
  s_add_u32 s92, s95, 27648
  buffer_load_dwordx4 v[108:111], v205, s[32:35], s92 offen sc1
  s_add_u32 s92, s95, 36864
  buffer_load_dwordx4 v[112:115], v205, s[32:35], s92 offen sc1
  s_add_u32 s92, s95, 46080
  buffer_load_dwordx4 v[116:119], v205, s[32:35], s92 offen sc1
  s_add_u32 s92, s95, 55296
  buffer_load_dwordx4 v[120:123], v205, s[32:35], s92 offen sc1
  s_add_u32 s92, s95, 64512
  buffer_load_dwordx4 v[124:127], v205, s[32:35], s92 offen sc1
  s_waitcnt vmcnt(13)
  v_or3_b32 v219, v64, v68, v72
  s_waitcnt vmcnt(11)
  v_or3_b32 v219, v219, v76, v80
  s_waitcnt vmcnt(9)
  v_or3_b32 v219, v219, v84, v88
  s_waitcnt vmcnt(8)
  v_or_b32 v219, v219, v92
  v_and_b32 v219, 1, v219
  v_cmp_eq_u32 vcc, 1, v219
  s_cmp_ge_u32 s57, 16384
  s_nop 2
  s_cbranch_scc1 K4_BOK
  s_cbranch_vccnz K4_BP
K4_BOK:
  v_lshlrev_b32 v136, 16, v64
  v_and_b32 v137, 0xffff0000, v64
  v_lshlrev_b32 v138, 16, v65
  v_and_b32 v139, 0xffff0000, v65
  v_lshlrev_b32 v140, 16, v66
  v_and_b32 v141, 0xffff0000, v66
  v_lshlrev_b32 v142, 16, v67
  v_and_b32 v143, 0xffff0000, v67
  v_dot2c_f32_bf16 v136, s58, v68
  v_dot2c_f32_bf16 v137, s59, v68
  v_dot2c_f32_bf16 v138, s58, v69
  v_dot2c_f32_bf16 v139, s59, v69
  v_dot2c_f32_bf16 v140, s58, v70
  v_dot2c_f32_bf16 v141, s59, v70
  v_dot2c_f32_bf16 v142, s58, v71
  v_dot2c_f32_bf16 v143, s59, v71
  v_dot2c_f32_bf16 v136, s58, v72
  v_dot2c_f32_bf16 v137, s59, v72
  v_dot2c_f32_bf16 v138, s58, v73
  v_dot2c_f32_bf16 v139, s59, v73
  v_dot2c_f32_bf16 v140, s58, v74
  v_dot2c_f32_bf16 v141, s59, v74
  v_dot2c_f32_bf16 v142, s58, v75
  v_dot2c_f32_bf16 v143, s59, v75
  v_dot2c_f32_bf16 v136, s58, v76
  v_dot2c_f32_bf16 v137, s59, v76
  v_dot2c_f32_bf16 v138, s58, v77
  v_dot2c_f32_bf16 v139, s59, v77
  v_dot2c_f32_bf16 v140, s58, v78
  v_dot2c_f32_bf16 v141, s59, v78
  v_dot2c_f32_bf16 v142, s58, v79
  v_dot2c_f32_bf16 v143, s59, v79
  v_dot2c_f32_bf16 v136, s58, v80
  v_dot2c_f32_bf16 v137, s59, v80
  v_dot2c_f32_bf16 v138, s58, v81
  v_dot2c_f32_bf16 v139, s59, v81
  v_dot2c_f32_bf16 v140, s58, v82
  v_dot2c_f32_bf16 v141, s59, v82
  v_dot2c_f32_bf16 v142, s58, v83
  v_dot2c_f32_bf16 v143, s59, v83
  v_dot2c_f32_bf16 v136, s58, v84
  v_dot2c_f32_bf16 v137, s59, v84
  v_dot2c_f32_bf16 v138, s58, v85
  v_dot2c_f32_bf16 v139, s59, v85
  v_dot2c_f32_bf16 v140, s58, v86
  v_dot2c_f32_bf16 v141, s59, v86
  v_dot2c_f32_bf16 v142, s58, v87
  v_dot2c_f32_bf16 v143, s59, v87
  v_dot2c_f32_bf16 v136, s58, v88
  v_dot2c_f32_bf16 v137, s59, v88
  v_dot2c_f32_bf16 v138, s58, v89
  v_dot2c_f32_bf16 v139, s59, v89
  v_dot2c_f32_bf16 v140, s58, v90
  v_dot2c_f32_bf16 v141, s59, v90
  v_dot2c_f32_bf16 v142, s58, v91
  v_dot2c_f32_bf16 v143, s59, v91
  v_dot2c_f32_bf16 v136, s58, v92
  v_dot2c_f32_bf16 v137, s59, v92
  v_dot2c_f32_bf16 v138, s58, v93
  v_dot2c_f32_bf16 v139, s59, v93
  v_dot2c_f32_bf16 v140, s58, v94
  v_dot2c_f32_bf16 v141, s59, v94
  v_dot2c_f32_bf16 v142, s58, v95
  v_dot2c_f32_bf16 v143, s59, v95
  s_waitcnt vmcnt(5)
  v_or3_b32 v219, v96, v100, v104
  s_waitcnt vmcnt(3)
  v_or3_b32 v219, v219, v108, v112
  s_waitcnt vmcnt(1)
  v_or3_b32 v219, v219, v116, v120
  s_waitcnt vmcnt(0)
  v_or_b32 v219, v219, v124
  v_and_b32 v219, 1, v219
  v_cmp_eq_u32 vcc, 1, v219
  s_cmp_ge_u32 s57, 16384
  s_nop 2
  s_cbranch_scc1 K4_OOK
  s_cbranch_vccz K4_OOK
K4_OR:
  s_add_u32 s92, s95, 0
  buffer_load_dwordx4 v[96:99], v205, s[32:35], s92 offen sc1
  s_add_u32 s92, s95, 9216
  buffer_load_dwordx4 v[100:103], v205, s[32:35], s92 offen sc1
  s_add_u32 s92, s95, 18432
  buffer_load_dwordx4 v[104:107], v205, s[32:35], s92 offen sc1
  s_add_u32 s92, s95, 27648
  buffer_load_dwordx4 v[108:111], v205, s[32:35], s92 offen sc1
  s_add_u32 s92, s95, 36864
  buffer_load_dwordx4 v[112:115], v205, s[32:35], s92 offen sc1
  s_add_u32 s92, s95, 46080
  buffer_load_dwordx4 v[116:119], v205, s[32:35], s92 offen sc1
  s_add_u32 s92, s95, 55296
  buffer_load_dwordx4 v[120:123], v205, s[32:35], s92 offen sc1
  s_add_u32 s92, s95, 64512
  buffer_load_dwordx4 v[124:127], v205, s[32:35], s92 offen sc1
  s_add_u32 s57, s57, 1
  s_waitcnt vmcnt(0)
  v_or3_b32 v219, v96, v100, v104
  v_or3_b32 v219, v219, v108, v112
  v_or3_b32 v219, v219, v116, v120
  v_or_b32 v219, v219, v124
  v_and_b32 v219, 1, v219
  v_cmp_eq_u32 vcc, 1, v219
  s_cmp_ge_u32 s57, 16384
  s_nop 2
  s_cbranch_scc1 K4_OOK
  s_cbranch_vccnz K4_OR
K4_OOK:
  v_lshlrev_b32 v144, 16, v96
  v_and_b32 v145, 0xffff0000, v96
  v_lshlrev_b32 v146, 16, v97
  v_and_b32 v147, 0xffff0000, v97
  v_lshlrev_b32 v148, 16, v98
  v_and_b32 v149, 0xffff0000, v98
  v_lshlrev_b32 v150, 16, v99
  v_and_b32 v151, 0xffff0000, v99
  v_dot2c_f32_bf16 v144, s58, v100
  v_dot2c_f32_bf16 v145, s59, v100
  v_dot2c_f32_bf16 v146, s58, v101
  v_dot2c_f32_bf16 v147, s59, v101
  v_dot2c_f32_bf16 v148, s58, v102
  v_dot2c_f32_bf16 v149, s59, v102
  v_dot2c_f32_bf16 v150, s58, v103
  v_dot2c_f32_bf16 v151, s59, v103
  v_dot2c_f32_bf16 v144, s58, v104
  v_dot2c_f32_bf16 v145, s59, v104
  v_dot2c_f32_bf16 v146, s58, v105
  v_dot2c_f32_bf16 v147, s59, v105
  v_dot2c_f32_bf16 v148, s58, v106
  v_dot2c_f32_bf16 v149, s59, v106
  v_dot2c_f32_bf16 v150, s58, v107
  v_dot2c_f32_bf16 v151, s59, v107
  v_dot2c_f32_bf16 v144, s58, v108
  v_dot2c_f32_bf16 v145, s59, v108
  v_dot2c_f32_bf16 v146, s58, v109
  v_dot2c_f32_bf16 v147, s59, v109
  v_dot2c_f32_bf16 v148, s58, v110
  v_dot2c_f32_bf16 v149, s59, v110
  v_dot2c_f32_bf16 v150, s58, v111
  v_dot2c_f32_bf16 v151, s59, v111
  v_dot2c_f32_bf16 v144, s58, v112
  v_dot2c_f32_bf16 v145, s59, v112
  v_dot2c_f32_bf16 v146, s58, v113
  v_dot2c_f32_bf16 v147, s59, v113
  v_dot2c_f32_bf16 v148, s58, v114
  v_dot2c_f32_bf16 v149, s59, v114
  v_dot2c_f32_bf16 v150, s58, v115
  v_dot2c_f32_bf16 v151, s59, v115
  v_dot2c_f32_bf16 v144, s58, v116
  v_dot2c_f32_bf16 v145, s59, v116
  v_dot2c_f32_bf16 v146, s58, v117
  v_dot2c_f32_bf16 v147, s59, v117
  v_dot2c_f32_bf16 v148, s58, v118
  v_dot2c_f32_bf16 v149, s59, v118
  v_dot2c_f32_bf16 v150, s58, v119
  v_dot2c_f32_bf16 v151, s59, v119
  v_dot2c_f32_bf16 v144, s58, v120
  v_dot2c_f32_bf16 v145, s59, v120
  v_dot2c_f32_bf16 v146, s58, v121
  v_dot2c_f32_bf16 v147, s59, v121
  v_dot2c_f32_bf16 v148, s58, v122
  v_dot2c_f32_bf16 v149, s59, v122
  v_dot2c_f32_bf16 v150, s58, v123
  v_dot2c_f32_bf16 v151, s59, v123
  v_dot2c_f32_bf16 v144, s58, v124
  v_dot2c_f32_bf16 v145, s59, v124
  v_dot2c_f32_bf16 v146, s58, v125
  v_dot2c_f32_bf16 v147, s59, v125
  v_dot2c_f32_bf16 v148, s58, v126
  v_dot2c_f32_bf16 v149, s59, v126
  v_dot2c_f32_bf16 v150, s58, v127
  v_dot2c_f32_bf16 v151, s59, v127
  v_dot2c_f32_bf16 v128, s58, v160
  v_dot2c_f32_bf16 v129, s59, v160
  v_dot2c_f32_bf16 v130, s58, v161
  v_dot2c_f32_bf16 v131, s59, v161
  v_dot2c_f32_bf16 v132, s58, v162
  v_dot2c_f32_bf16 v133, s59, v162
  v_dot2c_f32_bf16 v134, s58, v163
  v_dot2c_f32_bf16 v135, s59, v163
  v_dot2c_f32_bf16 v136, s58, v164
  v_dot2c_f32_bf16 v137, s59, v164
  v_dot2c_f32_bf16 v138, s58, v165
  v_dot2c_f32_bf16 v139, s59, v165
  v_dot2c_f32_bf16 v140, s58, v166
  v_dot2c_f32_bf16 v141, s59, v166
  v_dot2c_f32_bf16 v142, s58, v167
  v_dot2c_f32_bf16 v143, s59, v167
  v_dot2c_f32_bf16 v144, s58, v168
  v_dot2c_f32_bf16 v145, s59, v168
  v_dot2c_f32_bf16 v146, s58, v169
  v_dot2c_f32_bf16 v147, s59, v169
  v_dot2c_f32_bf16 v148, s58, v170
  v_dot2c_f32_bf16 v149, s59, v170
  v_dot2c_f32_bf16 v150, s58, v171
  v_dot2c_f32_bf16 v151, s59, v171
  v_cmp_eq_u32 vcc, 1, v221
  v_cvt_pk_bf16_f32 v0, v128, v129
  v_cvt_pk_bf16_f32 v1, v130, v131
  v_cvt_pk_bf16_f32 v2, v132, v133
  v_cvt_pk_bf16_f32 v3, v134, v135
  v_cndmask_b32 v4, v2, v0, vcc
  v_cndmask_b32 v5, v3, v1, vcc
  s_nop 0
  v_mov_b32_dpp v6, v4 row_ror:8 row_mask:0xf bank_mask:0xf
  v_mov_b32_dpp v7, v5 row_ror:8 row_mask:0xf bank_mask:0xf
  v_cndmask_b32 v8, v0, v6, vcc
  v_cndmask_b32 v9, v1, v7, vcc
  v_cndmask_b32 v10, v6, v2, vcc
  v_cndmask_b32 v11, v7, v3, vcc
  buffer_store_dwordx4 v[8:11], v209, s[40:43], 0 offen offset:0 sc1
  v_cvt_pk_bf16_f32 v12, v136, v137
  v_cvt_pk_bf16_f32 v13, v138, v139
  v_cvt_pk_bf16_f32 v14, v140, v141
  v_cvt_pk_bf16_f32 v15, v142, v143
  v_cndmask_b32 v16, v14, v12, vcc
  v_cndmask_b32 v17, v15, v13, vcc
  s_nop 0
  v_mov_b32_dpp v18, v16 row_ror:8 row_mask:0xf bank_mask:0xf
  v_mov_b32_dpp v19, v17 row_ror:8 row_mask:0xf bank_mask:0xf
  v_cndmask_b32 v20, v12, v18, vcc
  v_cndmask_b32 v21, v13, v19, vcc
  v_cndmask_b32 v22, v18, v14, vcc
  v_cndmask_b32 v23, v19, v15, vcc
  buffer_store_dwordx4 v[20:23], v209, s[40:43], 0 offen offset:128 sc1
  v_cvt_pk_bf16_f32 v24, v144, v145
  v_cvt_pk_bf16_f32 v25, v146, v147
  v_cvt_pk_bf16_f32 v26, v148, v149
  v_cvt_pk_bf16_f32 v27, v150, v151
  v_cndmask_b32 v28, v26, v24, vcc
  v_cndmask_b32 v29, v27, v25, vcc
  s_nop 0
  v_mov_b32_dpp v30, v28 row_ror:8 row_mask:0xf bank_mask:0xf
  v_mov_b32_dpp v31, v29 row_ror:8 row_mask:0xf bank_mask:0xf
  v_cndmask_b32 v32, v24, v30, vcc
  v_cndmask_b32 v33, v25, v31, vcc
  v_cndmask_b32 v34, v30, v26, vcc
  v_cndmask_b32 v35, v31, v27, vcc
  buffer_store_dwordx4 v[32:35], v210, s[40:43], 0 offen offset:0 sc1
K4_END:
  s_endpgm
.section .rodata,"a"
.p2align 6
.amdhsa_kernel ffn_kernel
  .amdhsa_next_free_vgpr 512
  .amdhsa_next_free_sgpr 102
  .amdhsa_accum_offset 256
  .amdhsa_group_segment_fixed_size 0
  .amdhsa_kernarg_size 104
  .amdhsa_user_sgpr_count 2
  .amdhsa_user_sgpr_kernarg_segment_ptr 1
  .amdhsa_system_sgpr_workgroup_id_x 1
.end_amdhsa_kernel
```
